```python
import torch

def _softmax(x, axis=-1):
    return torch.softmax(x, dim=axis)
def _gelu(x):
    return torch.nn.functional.gelu(x, approximate="tanh")
def _silu(x):
    return torch.nn.functional.silu(x)
def _sigmoid(x):
    return torch.sigmoid(x)
def _layernorm(x, axis=-1, eps=1e-5):
    m = x.mean(dim=axis, keepdim=True)
    v = x.var(dim=axis, keepdim=True, unbiased=False)
    return (x - m) / torch.sqrt(v + eps)
def _scatter_add(tgt, idx, src, axis=0):
    return tgt.clone().index_add_(axis, idx, src)
def _segment_sum(src, seg, n):
    out = torch.zeros((n,) + src.shape[1:], dtype=src.dtype)
    return out.index_add_(0, seg, src)
def _pad(x, pw):
    flat = tuple(v for pair in reversed(pw) for v in pair)
    return torch.nn.functional.pad(x, flat)

kernel_name = 'gated_mix__linear_kernel_hedgehog__geglu_ffn__prompt'

def setup_inputs():

    _w = (lambda a: (lambda t: t.to(torch.bfloat16) if t.is_floating_point() else t)(torch.as_tensor(a)))
    def _A_setup():
        B, S, D, H = 1, 2048, 576, 32
        Dh = D // H
        return {
            "x": _w((lambda *s: torch.randn(*s, dtype=torch.bfloat16) * 0.05)(B, S, D)),
            "wqkv": _w((lambda *s: torch.randn(*s, dtype=torch.bfloat16) * 0.8)(D, 3 * D)),
            "w_phi": _w((lambda *s: torch.randn(*s, dtype=torch.bfloat16) * 0.8)(H, Dh, Dh) * (Dh ** -0.5)),
            "wo": _w((lambda *s: torch.randn(*s, dtype=torch.bfloat16) * 0.05)(D, D)),
        }
    _A_in = _A_setup()

    def _B_setup():
        B, S, D, F = 1, 2048, 576, 4608
        return {
            "x": _w((lambda *s: torch.randn(*s, dtype=torch.bfloat16) * 0.05)(B, S, D)),
            "w_gate": _w((lambda *s: torch.randn(*s, dtype=torch.bfloat16) * 0.05)(D, F)),
            "w_up": _w((lambda *s: torch.randn(*s, dtype=torch.bfloat16) * 0.05)(D, F)),
            "w_down": _w((lambda *s: torch.randn(*s, dtype=torch.bfloat16) * 0.05)(F, D)),
        }
    _B_in = _B_setup()

    return {
        "A_x": _A_in["x"],
        "A_wqkv": _A_in["wqkv"],
        "A_w_phi": _A_in["w_phi"],
        "A_wo": _A_in["wo"],
        "B_x": _B_in["x"],
        "B_w_gate": _B_in["w_gate"],
        "B_w_up": _B_in["w_up"],
        "B_w_down": _B_in["w_down"],
        "gate_w": _w((lambda *s: torch.randn(*s, dtype=torch.bfloat16) * 0.05)(576) * 16.0),
    }

def reference(A_x, A_wqkv, A_w_phi, A_wo, B_x, B_w_gate, B_w_up, B_w_down, gate_w):
    def _A_ref(x, wqkv, w_phi, wo):
        B, S, D = x.shape
        H = 32; Dh = D // H
        qkv = (lambda x, *d: x.permute(*d))((x @ wqkv).reshape(B, S, 3, H, Dh), 2, 0, 3, 1, 4)
        q, k, v = qkv[0], qkv[1], qkv[2]
        pq = torch.einsum("bhsd,hdf->bhsf", q, w_phi)
        pk = torch.einsum("bhsd,hdf->bhsf", k, w_phi)
        phi_q = torch.concatenate([_softmax(pq, axis=-1), _softmax(-pq, axis=-1)], axis=-1)
        phi_k = torch.concatenate([_softmax(pk, axis=-1), _softmax(-pk, axis=-1)], axis=-1)
        kv = torch.einsum("bhsf,bhsd->bhfd", phi_k, v)
        z  = torch.einsum("bhsf->bhf", phi_k)
        num = torch.einsum("bhqf,bhfd->bhqd", phi_q, kv)
        den = torch.einsum("bhqf,bhf->bhq", phi_q, z)[..., None] + 1e-6
        o = num / den
        return (lambda x, *d: x.permute(*d))(o, 0, 2, 1, 3).reshape(B, S, D) @ wo

    def _B_ref(x, w_gate, w_up, w_down):
        return (_gelu(x @ w_gate) * (x @ w_up)) @ w_down

    x = A_x
    g = _sigmoid((x * gate_w).sum(-1, keepdims=True))
    a = _A_ref(x, A_wqkv, A_w_phi, A_wo)
    b = _B_ref(x, B_w_gate, B_w_up, B_w_down)
    return g * a + (1 - g) * b
```

```asm
; @launch grid=(256,1,1) block=(256,1,1) lds=163840
.amdgcn_target "amdgcn-amd-amdhsa--gfx950"
.text
.globl gated_mix__linear_kernel_hedgehog__geglu_ffn__prompt_kernel
.p2align 8
.type gated_mix__linear_kernel_hedgehog__geglu_ffn__prompt_kernel,@function
gated_mix__linear_kernel_hedgehog__geglu_ffn__prompt_kernel:
  s_cmp_ge_u32 s2, 256
  s_cbranch_scc1 L_exit
  s_getpc_b64 s[4:5]
L_pc0:
  s_lshr_b32 s6, s2, 3
  s_mul_i32 s6, s6, 2688
  v_lshlrev_b32 v1, 7, v0
  v_add_u32 v1, s6, v1
  v_min_u32 v1, L_all_end-L_pc0-4, v1
  v_and_b32 v1, -4, v1
  v_cmp_gt_u32 vcc, 21, v0
  s_nop 1
  v_cndmask_b32 v1, 0, v1, vcc
  global_load_dword v250, v1, s[4:5]
  s_lshr_b32 s69, s2, 3
  s_cmp_ge_u32 s69, 24
  s_cbranch_scc1 L_attn
  s_load_dwordx2 s[48:49], s[0:1], 0
  s_load_dwordx2 s[50:51], s[0:1], 40
  s_load_dwordx2 s[52:53], s[0:1], 48
  s_load_dwordx2 s[54:55], s[0:1], 88
  s_load_dwordx2 s[70:71], s[0:1], 80
  s_and_b32 s24, s2, 7
  s_lshr_b32 s25, s2, 3
  s_mul_i32 s26, s25, 171
  s_lshr_b32 s26, s26, 9
  s_mul_i32 s42, s26, 3
  s_sub_u32 s27, s25, s42
  s_mul_i32 s42, s24, 3
  s_add_u32 s27, s27, s42
  v_lshrrev_b32 v231, 6, v0
  v_and_b32 v228, 63, v0
  v_readfirstlane_b32 s28, v231
  v_lshrrev_b32 v229, 4, v228
  v_and_b32 v230, 15, v228
  v_lshrrev_b32 v231, 3, v228
  v_add_u32 v231, 0, v231
  v_mul_u32_u24 v14, 1152, v231
  v_and_b32 v231, 7, v228
  v_add_u32 v232, 0, v229
  v_xor_b32 v231, v231, v232
  v_lshl_add_u32 v14, v231, 4, v14
  v_lshrrev_b32 v231, 3, v228
  v_add_u32 v231, 8, v231
  v_mul_u32_u24 v15, 1152, v231
  v_and_b32 v231, 7, v228
  v_add_u32 v232, 4, v229
  v_xor_b32 v231, v231, v232
  v_lshl_add_u32 v15, v231, 4, v15
  v_bfe_u32 v231, v228, 4, 1
  v_bfe_u32 v232, v228, 1, 2
  v_xor_b32 v231, v231, v232
  v_lshrrev_b32 v232, 3, v228
  v_mul_u32_u24 v16, 9216, v232
  v_lshl_add_u32 v16, v231, 5, v16
  v_and_b32 v231, 1, v228
  v_lshl_add_u32 v16, v231, 4, v16
  v_bfe_u32 v231, v228, 4, 1
  v_or_b32 v231, 2, v231
  v_bfe_u32 v232, v228, 1, 2
  v_xor_b32 v231, v231, v232
  v_lshrrev_b32 v232, 3, v228
  v_mul_u32_u24 v17, 9216, v232
  v_lshl_add_u32 v17, v231, 5, v17
  v_and_b32 v231, 1, v228
  v_lshl_add_u32 v17, v231, 4, v17
  s_mul_i32 s41, s28, 9216
  s_mul_i32 s44, s28, 6144
  s_add_u32 s44, s44, 73728
  s_mul_i32 s42, s26, 3
  s_sub_u32 s42, s25, s42
  s_mul_i32 s42, s42, 3
  s_add_u32 s42, s42, s26
  s_cmp_ge_u32 s42, 9
  s_cselect_b32 s47, 9, 0
  s_sub_u32 s47, s42, s47
  s_mul_i32 s47, s26, 3
  s_sub_u32 s47, s25, s47
  s_mul_i32 s47, s47, 3
  s_add_u32 s42, s47, 0
  s_cmp_ge_u32 s42, 9
  s_cselect_b32 s73, 9, 0
  s_sub_u32 s73, s42, s73
  s_lshl_b32 s73, s73, 7
  s_add_u32 s42, s47, 1
  s_cmp_ge_u32 s42, 9
  s_cselect_b32 s74, 9, 0
  s_sub_u32 s74, s42, s74
  s_lshl_b32 s74, s74, 7
  s_mul_i32 s46, s27, 384
  s_waitcnt lgkmcnt(0)
  s_mov_b32 s8, s48
  s_and_b32 s9, s49, 0xffff
  s_mov_b32 s10, 2359296
  s_mov_b32 s11, 0x00020000
  s_mov_b32 s12, s50
  s_and_b32 s13, s51, 0xffff
  s_mov_b32 s14, 5308416
  s_mov_b32 s15, 0x00020000
  s_mov_b32 s16, s52
  s_and_b32 s17, s53, 0xffff
  s_mov_b32 s18, 5308416
  s_mov_b32 s19, 0x00020000
  s_lshl_b32 s42, s26, 2
  s_add_u32 s42, s42, s28
  s_mul_i32 s32, s42, 73728
  s_add_u32 s33, s32, 18432
  s_add_u32 s34, s32, 36864
  s_add_u32 s35, s32, 55296
  s_lshl_b32 s87, s28, 11
  s_mul_i32 s88, s28, 147456
  s_add_u32 s88, s88, s46
  s_add_u32 s89, s88, 73728
  s_add_u32 m0, s87, 98304
  s_mul_i32 s42, s73, 4608
  s_add_u32 s42, s42, s88
  buffer_load_dwordx4 v16, s[12:15], s42 offen lds
  s_add_u32 m0, s87, 99328
  s_mul_i32 s42, s73, 4608
  s_add_u32 s42, s42, s89
  buffer_load_dwordx4 v17, s[12:15], s42 offen lds
  s_add_u32 m0, s87, 106496
  s_mul_i32 s42, s73, 4608
  s_add_u32 s42, s42, s88
  buffer_load_dwordx4 v16, s[16:19], s42 offen lds
  s_add_u32 m0, s87, 107520
  s_mul_i32 s42, s73, 4608
  s_add_u32 s42, s42, s89
  buffer_load_dwordx4 v17, s[16:19], s42 offen lds
  s_add_u32 m0, s44, 0
  s_add_u32 s42, s32, s73
  buffer_load_dwordx4 v14, s[8:11], s42 offen lds
  s_add_u32 m0, s44, 1024
  s_nop 0
  buffer_load_dwordx4 v15, s[8:11], s42 offen lds
  s_add_u32 m0, s44, 2048
  s_add_u32 s42, s33, s73
  buffer_load_dwordx4 v14, s[8:11], s42 offen lds
  s_add_u32 m0, s44, 3072
  s_nop 0
  buffer_load_dwordx4 v15, s[8:11], s42 offen lds
  s_add_u32 m0, s44, 4096
  s_add_u32 s42, s34, s73
  buffer_load_dwordx4 v14, s[8:11], s42 offen lds
  s_add_u32 m0, s44, 5120
  s_nop 0
  buffer_load_dwordx4 v15, s[8:11], s42 offen lds
  s_add_u32 m0, s41, 0
  s_add_u32 s42, s35, s73
  buffer_load_dwordx4 v14, s[8:11], s42 offen lds
  s_add_u32 m0, s41, 1024
  s_nop 0
  buffer_load_dwordx4 v15, s[8:11], s42 offen lds
  s_and_b32 s91, s28, 1
  s_mul_i32 s91, s91, 36
  s_mul_i32 s69, s26, 72
  s_add_u32 s91, s91, s69
  s_mul_i32 s91, s91, 9216
  s_mul_i32 s69, s27, 384
  s_add_u32 s91, s91, s69
  s_add_u32 s91, s91, 0
  s_lshr_b32 s69, s28, 1
  s_cmp_eq_u32 s69, 0
  s_cselect_b32 s96, s12, s16
  s_cselect_b32 s97, s13, s17
  s_cselect_b32 s98, s14, s18
  s_cselect_b32 s99, s15, s19
  v_and_b32 v253, 63, v0
  v_mul_u32_u24 v252, 9216, v253
  v_mov_b32 v235, 0x7f000000
  v_cmp_gt_u32 vcc, 36, v253
  s_nop 1
  v_cndmask_b32 v252, v235, v252, vcc
  buffer_load_dword v250, v252, s[96:99], s91 offen
  s_add_u32 m0, s87, 114688
  s_mul_i32 s42, s74, 4608
  s_add_u32 s42, s42, s88
  buffer_load_dwordx4 v16, s[12:15], s42 offen lds
  s_add_u32 m0, s87, 115712
  s_mul_i32 s42, s74, 4608
  s_add_u32 s42, s42, s89
  buffer_load_dwordx4 v17, s[12:15], s42 offen lds
  s_add_u32 m0, s87, 122880
  s_mul_i32 s42, s74, 4608
  s_add_u32 s42, s42, s88
  buffer_load_dwordx4 v16, s[16:19], s42 offen lds
  s_add_u32 m0, s87, 123904
  s_mul_i32 s42, s74, 4608
  s_add_u32 s42, s42, s89
  buffer_load_dwordx4 v17, s[16:19], s42 offen lds
  s_add_u32 m0, s41, 2048
  s_add_u32 s42, s32, s74
  buffer_load_dwordx4 v14, s[8:11], s42 offen lds
  s_add_u32 m0, s41, 3072
  s_nop 0
  buffer_load_dwordx4 v15, s[8:11], s42 offen lds
  s_add_u32 m0, s41, 4096
  s_add_u32 s42, s33, s74
  buffer_load_dwordx4 v14, s[8:11], s42 offen lds
  s_add_u32 m0, s41, 5120
  s_nop 0
  buffer_load_dwordx4 v15, s[8:11], s42 offen lds
  s_add_u32 m0, s41, 6144
  s_add_u32 s42, s34, s74
  buffer_load_dwordx4 v14, s[8:11], s42 offen lds
  s_add_u32 m0, s41, 7168
  s_nop 0
  buffer_load_dwordx4 v15, s[8:11], s42 offen lds
  s_add_u32 m0, s41, 36864
  s_add_u32 s42, s35, s74
  buffer_load_dwordx4 v14, s[8:11], s42 offen lds
  s_add_u32 m0, s41, 37888
  s_nop 0
  buffer_load_dwordx4 v15, s[8:11], s42 offen lds
  v_lshrrev_b32 v231, 1, v230
  v_add_u32 v232, 0, v229
  v_xor_b32 v231, v231, v232
  v_lshlrev_b32 v231, 4, v231
  v_lshl_add_u32 v224, v230, 7, v231
  v_lshrrev_b32 v231, 1, v230
  v_add_u32 v232, 4, v229
  v_xor_b32 v231, v231, v232
  v_lshlrev_b32 v231, 4, v231
  v_lshl_add_u32 v225, v230, 7, v231
  v_add_u32 v226, s44, v224
  v_add_u32 v224, s41, v224
  v_add_u32 v227, s44, v225
  v_add_u32 v225, s41, v225
  v_bfe_u32 v231, v228, 2, 2
  v_lshl_add_u32 v232, v229, 3, v231
  v_lshlrev_b32 v232, 7, v232
  v_and_b32 v233, 3, v228
  v_lshl_add_u32 v232, v233, 3, v232
  v_add_u32 v232, 98304, v232
  v_lshrrev_b32 v231, 1, v231
  v_and_b32 v233, 1, v229
  v_lshl_add_u32 v231, v233, 1, v231
  v_xor_b32 v233, 0, v231
  v_lshl_add_u32 v18, v233, 5, v232
  v_xor_b32 v233, 1, v231
  v_lshl_add_u32 v19, v233, 5, v232
  v_xor_b32 v233, 2, v231
  v_lshl_add_u32 v20, v233, 5, v232
  v_xor_b32 v233, 3, v231
  v_lshl_add_u32 v21, v233, 5, v232
  v_lshrrev_b32 v231, 2, v228
  v_mul_u32_u24 v10, 9216, v231
  v_lshrrev_b32 v231, 1, v228
  v_lshrrev_b32 v232, 5, v228
  v_xor_b32 v231, v231, v232
  v_and_b32 v231, 1, v231
  v_lshl_add_u32 v10, v231, 5, v10
  v_and_b32 v231, 1, v228
  v_lshl_add_u32 v10, v231, 4, v10
  v_lshlrev_b32 v11, 4, v228
  v_bfe_u32 v231, v228, 2, 2
  v_lshl_add_u32 v231, v229, 3, v231
  v_lshlrev_b32 v231, 6, v231
  v_and_b32 v232, 3, v228
  v_lshl_add_u32 v231, v232, 3, v231
  v_and_b32 v232, 1, v229
  v_lshl_add_u32 v22, v232, 5, v231
  v_xor_b32 v232, 1, v232
  v_lshl_add_u32 v23, v232, 5, v231
  v_add_u32 v2, 0, v22
  v_add_u32 v3, 0, v23
  v_add_u32 v4, 36864, v22
  v_add_u32 v5, 36864, v23
  v_add_u32 v6, 73728, v22
  v_add_u32 v7, 73728, v23
  v_add_u32 v8, 110592, v22
  v_add_u32 v9, 110592, v23
  v_mov_b32 v12, 0xc0135761
  s_mov_b32 s20, s54
  s_and_b32 s21, s55, 0xffff
  s_mov_b32 s22, 21233664
  s_mov_b32 s23, 0x00020000
  s_lshr_b32 s72, s27, 2
  s_mul_i32 s42, s26, 6
  s_add_u32 s72, s72, s42
  s_lshl_b32 s42, s26, 2
  s_add_u32 s42, s42, s28
  s_mul_i32 s36, s42, 663552
  s_mul_i32 s42, s27, 6144
  s_add_u32 s36, s36, s42
  s_add_u32 s37, s36, 165888
  s_add_u32 s38, s36, 331776
  s_add_u32 s39, s36, 497664
  s_add_u32 s42, s47, 2
  s_cmp_ge_u32 s42, 9
  s_cselect_b32 s75, 9, 0
  s_sub_u32 s75, s42, s75
  s_lshl_b32 s75, s75, 7
  s_add_u32 s42, s47, 3
  s_cmp_ge_u32 s42, 9
  s_cselect_b32 s76, 9, 0
  s_sub_u32 s76, s42, s76
  s_lshl_b32 s76, s76, 7
  s_add_u32 s42, s47, 4
  s_cmp_ge_u32 s42, 9
  s_cselect_b32 s77, 9, 0
  s_sub_u32 s77, s42, s77
  s_lshl_b32 s77, s77, 7
  s_add_u32 s42, s47, 5
  s_cmp_ge_u32 s42, 9
  s_cselect_b32 s78, 9, 0
  s_sub_u32 s78, s42, s78
  s_lshl_b32 s78, s78, 7
  s_add_u32 s42, s47, 6
  s_cmp_ge_u32 s42, 9
  s_cselect_b32 s79, 9, 0
  s_sub_u32 s79, s42, s79
  s_lshl_b32 s79, s79, 7
  s_add_u32 s42, s47, 7
  s_cmp_ge_u32 s42, 9
  s_cselect_b32 s80, 9, 0
  s_sub_u32 s80, s42, s80
  s_lshl_b32 s80, s80, 7
  s_add_u32 s42, s47, 8
  s_cmp_ge_u32 s42, 9
  s_cselect_b32 s81, 9, 0
  s_sub_u32 s81, s42, s81
  s_lshl_b32 s81, s81, 7
  s_mul_i32 s40, s28, 9
  s_lshl_b32 s42, s47, 2
  s_add_u32 s40, s40, s42
  s_add_u32 s42, s40, 0
  s_cmp_ge_u32 s42, 36
  s_cselect_b32 s3, 36, 0
  s_sub_u32 s3, s42, s3
  s_cmp_ge_u32 s3, 36
  s_cselect_b32 s42, 36, 0
  s_sub_u32 s3, s3, s42
  s_mul_i32 s3, s3, 147456
  s_add_u32 s42, s40, 1
  s_cmp_ge_u32 s42, 36
  s_cselect_b32 s4, 36, 0
  s_sub_u32 s4, s42, s4
  s_cmp_ge_u32 s4, 36
  s_cselect_b32 s42, 36, 0
  s_sub_u32 s4, s4, s42
  s_mul_i32 s4, s4, 147456
  s_add_u32 s42, s40, 2
  s_cmp_ge_u32 s42, 36
  s_cselect_b32 s5, 36, 0
  s_sub_u32 s5, s42, s5
  s_cmp_ge_u32 s5, 36
  s_cselect_b32 s42, 36, 0
  s_sub_u32 s5, s5, s42
  s_mul_i32 s5, s5, 147456
  s_add_u32 s42, s40, 3
  s_cmp_ge_u32 s42, 36
  s_cselect_b32 s6, 36, 0
  s_sub_u32 s6, s42, s6
  s_cmp_ge_u32 s6, 36
  s_cselect_b32 s42, 36, 0
  s_sub_u32 s6, s6, s42
  s_mul_i32 s6, s6, 147456
  s_add_u32 s42, s40, 4
  s_cmp_ge_u32 s42, 36
  s_cselect_b32 s7, 36, 0
  s_sub_u32 s7, s42, s7
  s_cmp_ge_u32 s7, 36
  s_cselect_b32 s42, 36, 0
  s_sub_u32 s7, s7, s42
  s_mul_i32 s7, s7, 147456
  s_add_u32 s42, s40, 5
  s_cmp_ge_u32 s42, 36
  s_cselect_b32 s29, 36, 0
  s_sub_u32 s29, s42, s29
  s_cmp_ge_u32 s29, 36
  s_cselect_b32 s42, 36, 0
  s_sub_u32 s29, s29, s42
  s_mul_i32 s29, s29, 147456
  s_add_u32 s42, s40, 6
  s_cmp_ge_u32 s42, 36
  s_cselect_b32 s30, 36, 0
  s_sub_u32 s30, s42, s30
  s_cmp_ge_u32 s30, 36
  s_cselect_b32 s42, 36, 0
  s_sub_u32 s30, s30, s42
  s_mul_i32 s30, s30, 147456
  s_add_u32 s42, s40, 7
  s_cmp_ge_u32 s42, 36
  s_cselect_b32 s31, 36, 0
  s_sub_u32 s31, s42, s31
  s_cmp_ge_u32 s31, 36
  s_cselect_b32 s42, 36, 0
  s_sub_u32 s31, s31, s42
  s_mul_i32 s31, s31, 147456
  s_add_u32 s42, s40, 8
  s_cmp_ge_u32 s42, 36
  s_cselect_b32 s45, 36, 0
  s_sub_u32 s45, s42, s45
  s_cmp_ge_u32 s45, 36
  s_cselect_b32 s42, 36, 0
  s_sub_u32 s45, s45, s42
  s_mul_i32 s45, s45, 147456
  s_load_dwordx2 s[56:57], s[0:1], 56
  s_mov_b32 s66, s72
  s_mul_i32 s69, s24, 6
  s_lshr_b32 s98, s25, 2
  s_add_u32 s69, s69, s98
  s_lshr_b32 s83, s69, 3
  s_and_b32 s84, s69, 7
  s_and_b32 s85, s25, 3
  s_mul_i32 s68, s84, 6
  s_add_u32 s68, s68, s83
  s_mul_i32 s60, s83, 884736
  s_mul_i32 s64, s85, 288
  s_add_u32 s60, s60, s64
  s_lshl_b32 s86, s28, 10
  s_mov_b32 s61, 0
  s_lshl_b32 s69, s84, 2
  s_add_u32 s69, s69, s28
  s_mul_i32 s65, s69, 663552
  s_getpc_b64 s[96:97]
L_dn_pc:
  s_add_u32 s96, s96, L_dn_table-L_dn_pc
  s_addc_u32 s97, s97, 0
  s_mul_i32 s69, s83, 384
  s_lshl_b32 s99, s28, 6
  v_add_u32 v231, s99, v228
  v_mul_u32_u24 v232, 58255, v231
  v_lshrrev_b32 v232, 20, v232
  v_mul_u32_u24 v233, 18, v232
  v_sub_u32 v233, v231, v233
  v_lshlrev_b32 v233, 4, v233
  v_mul_u32_u24 v236, 1152, v232
  v_add_u32 v236, v236, v233
  v_min_u32 v232, 95, v232
  v_lshlrev_b32 v232, 2, v232
  v_add_u32 v232, s69, v232
  global_load_dword v243, v232, s[96:97]
  v_add_u32 v231, s99, v228
  v_add_u32 v231, 256, v231
  v_mul_u32_u24 v232, 58255, v231
  v_lshrrev_b32 v232, 20, v232
  v_mul_u32_u24 v233, 18, v232
  v_sub_u32 v233, v231, v233
  v_lshlrev_b32 v233, 4, v233
  v_mul_u32_u24 v237, 1152, v232
  v_add_u32 v237, v237, v233
  v_min_u32 v232, 95, v232
  v_lshlrev_b32 v232, 2, v232
  v_add_u32 v232, s69, v232
  global_load_dword v244, v232, s[96:97]
  v_add_u32 v231, s99, v228
  v_add_u32 v231, 512, v231
  v_mul_u32_u24 v232, 58255, v231
  v_lshrrev_b32 v232, 20, v232
  v_mul_u32_u24 v233, 18, v232
  v_sub_u32 v233, v231, v233
  v_lshlrev_b32 v233, 4, v233
  v_mul_u32_u24 v238, 1152, v232
  v_add_u32 v238, v238, v233
  v_min_u32 v232, 95, v232
  v_lshlrev_b32 v232, 2, v232
  v_add_u32 v232, s69, v232
  global_load_dword v245, v232, s[96:97]
  v_add_u32 v231, s99, v228
  v_add_u32 v231, 768, v231
  v_mul_u32_u24 v232, 58255, v231
  v_lshrrev_b32 v232, 20, v232
  v_mul_u32_u24 v233, 18, v232
  v_sub_u32 v233, v231, v233
  v_lshlrev_b32 v233, 4, v233
  v_mul_u32_u24 v239, 1152, v232
  v_add_u32 v239, v239, v233
  v_min_u32 v232, 95, v232
  v_lshlrev_b32 v232, 2, v232
  v_add_u32 v232, s69, v232
  global_load_dword v246, v232, s[96:97]
  v_add_u32 v231, s99, v228
  v_add_u32 v231, 1024, v231
  v_mul_u32_u24 v232, 58255, v231
  v_lshrrev_b32 v232, 20, v232
  v_mul_u32_u24 v233, 18, v232
  v_sub_u32 v233, v231, v233
  v_lshlrev_b32 v233, 4, v233
  v_mul_u32_u24 v240, 1152, v232
  v_add_u32 v240, v240, v233
  v_min_u32 v232, 95, v232
  v_lshlrev_b32 v232, 2, v232
  v_add_u32 v232, s69, v232
  global_load_dword v247, v232, s[96:97]
  v_add_u32 v231, s99, v228
  v_add_u32 v231, 1280, v231
  v_mul_u32_u24 v232, 58255, v231
  v_lshrrev_b32 v232, 20, v232
  v_mul_u32_u24 v233, 18, v232
  v_sub_u32 v233, v231, v233
  v_lshlrev_b32 v233, 4, v233
  v_mul_u32_u24 v241, 1152, v232
  v_add_u32 v241, v241, v233
  v_min_u32 v232, 95, v232
  v_lshlrev_b32 v232, 2, v232
  v_add_u32 v232, s69, v232
  global_load_dword v248, v232, s[96:97]
  v_add_u32 v231, s99, v228
  v_add_u32 v231, 1536, v231
  v_mul_u32_u24 v232, 58255, v231
  v_lshrrev_b32 v232, 20, v232
  v_mul_u32_u24 v233, 18, v232
  v_sub_u32 v233, v231, v233
  v_lshlrev_b32 v233, 4, v233
  v_mul_u32_u24 v242, 1152, v232
  v_add_u32 v242, v242, v233
  v_min_u32 v232, 95, v232
  v_lshlrev_b32 v232, 2, v232
  v_add_u32 v232, s69, v232
  global_load_dword v249, v232, s[96:97]
  s_waitcnt lgkmcnt(0)
  s_and_b32 s57, s57, 0xffff
  s_mov_b32 s58, 5308416
  s_mov_b32 s59, 0x00020000
  s_waitcnt vmcnt(20)
  ds_read_b128 a[0:3], v226 offset:0
  ds_read_b128 a[16:19], v227 offset:0
  ds_read_b128 a[4:7], v226 offset:2048
  ds_read_b128 a[20:23], v227 offset:2048
  ds_read_b128 a[8:11], v226 offset:4096
  ds_read_b128 a[24:27], v227 offset:4096
  ds_read_b128 a[12:15], v224 offset:0
  ds_read_b128 a[28:31], v225 offset:0
  s_barrier
  ds_read_b64_tr_b16 v[32:33], v18 offset:0
  ds_read_b64_tr_b16 v[34:35], v18 offset:512
  ds_read_b64_tr_b16 v[36:37], v19 offset:0
  ds_read_b64_tr_b16 v[38:39], v19 offset:512
  ds_read_b64_tr_b16 v[40:41], v18 offset:8192
  ds_read_b64_tr_b16 v[42:43], v18 offset:8704
  ds_read_b64_tr_b16 v[44:45], v19 offset:8192
  ds_read_b64_tr_b16 v[46:47], v19 offset:8704
  s_add_u32 s46, s46, 128
  s_waitcnt vmcnt(13) lgkmcnt(0)
  v_mfma_f32_16x16x32_bf16 v[64:67], v[32:35], a[0:3], 0
  ds_read_b64_tr_b16 v[48:49], v20 offset:0
  ds_read_b64_tr_b16 v[50:51], v20 offset:512
  ds_read_b64_tr_b16 v[52:53], v21 offset:0
  ds_read_b64_tr_b16 v[54:55], v21 offset:512
  v_mfma_f32_16x16x32_bf16 v[68:71], v[32:35], a[4:7], 0
  ds_read_b64_tr_b16 v[56:57], v20 offset:8192
  ds_read_b64_tr_b16 v[58:59], v20 offset:8704
  ds_read_b64_tr_b16 v[60:61], v21 offset:8192
  ds_read_b64_tr_b16 v[62:63], v21 offset:8704
  v_mfma_f32_16x16x32_bf16 v[72:75], v[32:35], a[8:11], 0
  ds_read_b128 a[32:35], v224 offset:2048
  ds_read_b128 a[48:51], v225 offset:2048
  s_add_u32 m0, s87, 131072
  s_mul_i32 s42, s75, 4608
  v_mfma_f32_16x16x32_bf16 v[76:79], v[32:35], a[12:15], 0
  s_add_u32 s42, s42, s88
  buffer_load_dwordx4 v16, s[12:15], s42 offen lds
  s_add_u32 m0, s87, 132096
  s_mul_i32 s42, s75, 4608
  v_mfma_f32_16x16x32_bf16 v[80:83], v[36:39], a[0:3], 0
  s_add_u32 s42, s42, s89
  buffer_load_dwordx4 v17, s[12:15], s42 offen lds
  s_add_u32 m0, s87, 139264
  s_mul_i32 s42, s75, 4608
  v_mfma_f32_16x16x32_bf16 v[84:87], v[36:39], a[4:7], 0
  s_add_u32 s42, s42, s88
  buffer_load_dwordx4 v16, s[16:19], s42 offen lds
  s_add_u32 m0, s87, 140288
  s_mul_i32 s42, s75, 4608
  v_mfma_f32_16x16x32_bf16 v[88:91], v[36:39], a[8:11], 0
  s_add_u32 s42, s42, s89
  buffer_load_dwordx4 v17, s[16:19], s42 offen lds
  s_add_u32 m0, s44, 0
  s_add_u32 s42, s35, s75
  v_mfma_f32_16x16x32_bf16 v[92:95], v[36:39], a[12:15], 0
  buffer_load_dwordx4 v14, s[8:11], s42 offen lds
  s_add_u32 m0, s44, 1024
  s_nop 0
  buffer_load_dwordx4 v15, s[8:11], s42 offen lds
  v_mfma_f32_16x16x32_bf16 v[96:99], v[40:43], a[0:3], 0
  s_add_u32 m0, s44, 2048
  s_add_u32 s42, s32, s76
  buffer_load_dwordx4 v14, s[8:11], s42 offen lds
  s_add_u32 m0, s44, 3072
  v_mfma_f32_16x16x32_bf16 v[100:103], v[40:43], a[4:7], 0
  s_nop 0
  buffer_load_dwordx4 v15, s[8:11], s42 offen lds
  s_add_u32 m0, s44, 4096
  s_add_u32 s42, s33, s76
  v_mfma_f32_16x16x32_bf16 v[104:107], v[40:43], a[8:11], 0
  buffer_load_dwordx4 v14, s[8:11], s42 offen lds
  s_add_u32 m0, s44, 5120
  s_nop 0
  buffer_load_dwordx4 v15, s[8:11], s42 offen lds
  v_mfma_f32_16x16x32_bf16 v[108:111], v[40:43], a[12:15], 0
  s_add_u32 m0, s41, 0
  s_add_u32 s42, s34, s76
  buffer_load_dwordx4 v14, s[8:11], s42 offen lds
  s_add_u32 m0, s41, 1024
  v_mfma_f32_16x16x32_bf16 v[112:115], v[44:47], a[0:3], 0
  s_nop 0
  buffer_load_dwordx4 v15, s[8:11], s42 offen lds
  v_mfma_f32_16x16x32_bf16 v[116:119], v[44:47], a[4:7], 0
  v_mfma_f32_16x16x32_bf16 v[120:123], v[44:47], a[8:11], 0
  v_mfma_f32_16x16x32_bf16 v[124:127], v[44:47], a[12:15], 0
  s_waitcnt vmcnt(23) lgkmcnt(0)
  v_mfma_f32_16x16x32_bf16 v[128:131], v[48:51], a[0:3], 0
  ds_read_b64_tr_b16 v[32:33], v18 offset:4096
  ds_read_b64_tr_b16 v[34:35], v18 offset:4608
  v_mfma_f32_16x16x32_bf16 v[132:135], v[48:51], a[4:7], 0
  ds_read_b64_tr_b16 v[36:37], v19 offset:4096
  ds_read_b64_tr_b16 v[38:39], v19 offset:4608
  v_mfma_f32_16x16x32_bf16 v[136:139], v[48:51], a[8:11], 0
  ds_read_b64_tr_b16 v[40:41], v18 offset:12288
  ds_read_b64_tr_b16 v[42:43], v18 offset:12800
  v_mfma_f32_16x16x32_bf16 v[140:143], v[48:51], a[12:15], 0
  ds_read_b64_tr_b16 v[44:45], v19 offset:12288
  ds_read_b64_tr_b16 v[46:47], v19 offset:12800
  v_mfma_f32_16x16x32_bf16 v[144:147], v[52:55], a[0:3], 0
  ds_read_b128 a[36:39], v224 offset:4096
  ds_read_b128 a[52:55], v225 offset:4096
  v_mfma_f32_16x16x32_bf16 v[148:151], v[52:55], a[4:7], 0
  s_add_u32 m0, s41, 38912
  s_add_u32 s42, s32, s75
  v_mfma_f32_16x16x32_bf16 v[152:155], v[52:55], a[8:11], 0
  buffer_load_dwordx4 v14, s[8:11], s42 offen lds
  s_add_u32 m0, s41, 39936
  v_mfma_f32_16x16x32_bf16 v[156:159], v[52:55], a[12:15], 0
  s_nop 0
  buffer_load_dwordx4 v15, s[8:11], s42 offen lds
  v_mfma_f32_16x16x32_bf16 v[160:163], v[56:59], a[0:3], 0
  s_add_u32 m0, s41, 40960
  s_add_u32 s42, s33, s75
  v_mfma_f32_16x16x32_bf16 v[164:167], v[56:59], a[4:7], 0
  buffer_load_dwordx4 v14, s[8:11], s42 offen lds
  s_add_u32 m0, s41, 41984
  v_mfma_f32_16x16x32_bf16 v[168:171], v[56:59], a[8:11], 0
  s_nop 0
  buffer_load_dwordx4 v15, s[8:11], s42 offen lds
  v_mfma_f32_16x16x32_bf16 v[172:175], v[56:59], a[12:15], 0
  s_add_u32 m0, s41, 2048
  s_add_u32 s42, s35, s76
  v_mfma_f32_16x16x32_bf16 v[176:179], v[60:63], a[0:3], 0
  buffer_load_dwordx4 v14, s[8:11], s42 offen lds
  s_add_u32 m0, s41, 3072
  v_mfma_f32_16x16x32_bf16 v[180:183], v[60:63], a[4:7], 0
  s_nop 0
  buffer_load_dwordx4 v15, s[8:11], s42 offen lds
  v_mfma_f32_16x16x32_bf16 v[184:187], v[60:63], a[8:11], 0
  v_mfma_f32_16x16x32_bf16 v[188:191], v[60:63], a[12:15], 0
  s_waitcnt vmcnt(27) lgkmcnt(0)
  v_mfma_f32_16x16x32_bf16 v[64:67], v[32:35], a[16:19], v[64:67]
  ds_read_b64_tr_b16 v[48:49], v20 offset:4096
  ds_read_b64_tr_b16 v[50:51], v20 offset:4608
  ds_read_b64_tr_b16 v[52:53], v21 offset:4096
  v_mfma_f32_16x16x32_bf16 v[68:71], v[32:35], a[20:23], v[68:71]
  ds_read_b64_tr_b16 v[54:55], v21 offset:4608
  ds_read_b64_tr_b16 v[56:57], v20 offset:12288
  ds_read_b64_tr_b16 v[58:59], v20 offset:12800
  v_mfma_f32_16x16x32_bf16 v[72:75], v[32:35], a[24:27], v[72:75]
  ds_read_b64_tr_b16 v[60:61], v21 offset:12288
  ds_read_b64_tr_b16 v[62:63], v21 offset:12800
  ds_read_b128 a[40:43], v224 offset:6144
  v_mfma_f32_16x16x32_bf16 v[76:79], v[32:35], a[28:31], v[76:79]
  ds_read_b128 a[56:59], v225 offset:6144
  s_add_u32 m0, s41, 43008
  s_add_u32 s42, s34, s75
  v_mfma_f32_16x16x32_bf16 v[80:83], v[36:39], a[16:19], v[80:83]
  buffer_load_dwordx4 v14, s[8:11], s42 offen lds
  s_add_u32 m0, s41, 44032
  s_nop 0
  v_mfma_f32_16x16x32_bf16 v[84:87], v[36:39], a[20:23], v[84:87]
  buffer_load_dwordx4 v15, s[8:11], s42 offen lds
  s_add_u32 m0, s87, 147456
  s_mul_i32 s42, s76, 4608
  v_mfma_f32_16x16x32_bf16 v[88:91], v[36:39], a[24:27], v[88:91]
  s_add_u32 s42, s42, s88
  buffer_load_dwordx4 v16, s[12:15], s42 offen lds
  s_add_u32 m0, s87, 148480
  v_mfma_f32_16x16x32_bf16 v[92:95], v[36:39], a[28:31], v[92:95]
  s_mul_i32 s42, s76, 4608
  s_add_u32 s42, s42, s89
  buffer_load_dwordx4 v17, s[12:15], s42 offen lds
  v_mfma_f32_16x16x32_bf16 v[96:99], v[40:43], a[16:19], v[96:99]
  s_add_u32 m0, s87, 155648
  s_mul_i32 s42, s76, 4608
  s_add_u32 s42, s42, s88
  v_mfma_f32_16x16x32_bf16 v[100:103], v[40:43], a[20:23], v[100:103]
  buffer_load_dwordx4 v16, s[16:19], s42 offen lds
  s_add_u32 m0, s87, 156672
  s_mul_i32 s42, s76, 4608
  v_mfma_f32_16x16x32_bf16 v[104:107], v[40:43], a[24:27], v[104:107]
  s_add_u32 s42, s42, s89
  buffer_load_dwordx4 v17, s[16:19], s42 offen lds
  s_add_u32 m0, s41, 4096
  v_mfma_f32_16x16x32_bf16 v[108:111], v[40:43], a[28:31], v[108:111]
  s_add_u32 s42, s32, s77
  buffer_load_dwordx4 v14, s[8:11], s42 offen lds
  s_add_u32 m0, s41, 5120
  v_mfma_f32_16x16x32_bf16 v[112:115], v[44:47], a[16:19], v[112:115]
  s_nop 0
  buffer_load_dwordx4 v15, s[8:11], s42 offen lds
  v_mfma_f32_16x16x32_bf16 v[116:119], v[44:47], a[20:23], v[116:119]
  v_mfma_f32_16x16x32_bf16 v[120:123], v[44:47], a[24:27], v[120:123]
  v_mfma_f32_16x16x32_bf16 v[124:127], v[44:47], a[28:31], v[124:127]
  s_waitcnt vmcnt(33) lgkmcnt(0)
  s_barrier
  v_mfma_f32_16x16x32_bf16 v[128:131], v[48:51], a[16:19], v[128:131]
  ds_read_b64_tr_b16 v[32:33], v18 offset:16384
  ds_read_b64_tr_b16 v[34:35], v18 offset:16896
  v_mfma_f32_16x16x32_bf16 v[132:135], v[48:51], a[20:23], v[132:135]
  ds_read_b64_tr_b16 v[36:37], v19 offset:16384
  ds_read_b64_tr_b16 v[38:39], v19 offset:16896
  v_mfma_f32_16x16x32_bf16 v[136:139], v[48:51], a[24:27], v[136:139]
  ds_read_b64_tr_b16 v[40:41], v18 offset:24576
  ds_read_b64_tr_b16 v[42:43], v18 offset:25088
  v_mfma_f32_16x16x32_bf16 v[140:143], v[48:51], a[28:31], v[140:143]
  ds_read_b64_tr_b16 v[44:45], v19 offset:24576
  ds_read_b64_tr_b16 v[46:47], v19 offset:25088
  v_mfma_f32_16x16x32_bf16 v[144:147], v[52:55], a[16:19], v[144:147]
  ds_read_b128 a[44:47], v224 offset:36864
  ds_read_b128 a[60:63], v225 offset:36864
  v_mfma_f32_16x16x32_bf16 v[148:151], v[52:55], a[20:23], v[148:151]
  s_add_u32 m0, s41, 6144
  s_add_u32 s42, s33, s77
  v_mfma_f32_16x16x32_bf16 v[152:155], v[52:55], a[24:27], v[152:155]
  buffer_load_dwordx4 v14, s[8:11], s42 offen lds
  s_add_u32 m0, s41, 7168
  v_mfma_f32_16x16x32_bf16 v[156:159], v[52:55], a[28:31], v[156:159]
  s_nop 0
  buffer_load_dwordx4 v15, s[8:11], s42 offen lds
  v_mfma_f32_16x16x32_bf16 v[160:163], v[56:59], a[16:19], v[160:163]
  s_add_u32 m0, s87, 98304
  s_mul_i32 s42, s77, 4608
  v_mfma_f32_16x16x32_bf16 v[164:167], v[56:59], a[20:23], v[164:167]
  s_add_u32 s42, s42, s88
  buffer_load_dwordx4 v16, s[12:15], s42 offen lds
  v_mfma_f32_16x16x32_bf16 v[168:171], v[56:59], a[24:27], v[168:171]
  s_add_u32 m0, s87, 99328
  s_mul_i32 s42, s77, 4608
  v_mfma_f32_16x16x32_bf16 v[172:175], v[56:59], a[28:31], v[172:175]
  s_add_u32 s42, s42, s89
  buffer_load_dwordx4 v17, s[12:15], s42 offen lds
  v_mfma_f32_16x16x32_bf16 v[176:179], v[60:63], a[16:19], v[176:179]
  s_add_u32 m0, s87, 106496
  s_mul_i32 s42, s77, 4608
  v_mfma_f32_16x16x32_bf16 v[180:183], v[60:63], a[20:23], v[180:183]
  s_add_u32 s42, s42, s88
  buffer_load_dwordx4 v16, s[16:19], s42 offen lds
  v_mfma_f32_16x16x32_bf16 v[184:187], v[60:63], a[24:27], v[184:187]
  s_add_u32 m0, s87, 107520
  s_mul_i32 s42, s77, 4608
  v_mfma_f32_16x16x32_bf16 v[188:191], v[60:63], a[28:31], v[188:191]
  s_add_u32 s42, s42, s89
  buffer_load_dwordx4 v17, s[16:19], s42 offen lds
  s_waitcnt vmcnt(18) lgkmcnt(0)
  v_mfma_f32_16x16x32_bf16 v[64:67], v[32:35], a[32:35], v[64:67]
  ds_read_b64_tr_b16 v[48:49], v20 offset:16384
  v_mfma_f32_16x16x32_bf16 v[68:71], v[32:35], a[36:39], v[68:71]
  ds_read_b64_tr_b16 v[50:51], v20 offset:16896
  v_mfma_f32_16x16x32_bf16 v[72:75], v[32:35], a[40:43], v[72:75]
  ds_read_b64_tr_b16 v[52:53], v21 offset:16384
  v_mfma_f32_16x16x32_bf16 v[76:79], v[32:35], a[44:47], v[76:79]
  ds_read_b64_tr_b16 v[54:55], v21 offset:16896
  v_mfma_f32_16x16x32_bf16 v[80:83], v[36:39], a[32:35], v[80:83]
  ds_read_b64_tr_b16 v[56:57], v20 offset:24576
  v_mfma_f32_16x16x32_bf16 v[84:87], v[36:39], a[36:39], v[84:87]
  ds_read_b64_tr_b16 v[58:59], v20 offset:25088
  v_mfma_f32_16x16x32_bf16 v[88:91], v[36:39], a[40:43], v[88:91]
  ds_read_b64_tr_b16 v[60:61], v21 offset:24576
  v_mfma_f32_16x16x32_bf16 v[92:95], v[36:39], a[44:47], v[92:95]
  ds_read_b64_tr_b16 v[62:63], v21 offset:25088
  v_mfma_f32_16x16x32_bf16 v[96:99], v[40:43], a[32:35], v[96:99]
  ds_read_b128 a[64:67], v224 offset:38912
  v_mfma_f32_16x16x32_bf16 v[100:103], v[40:43], a[36:39], v[100:103]
  ds_read_b128 a[80:83], v225 offset:38912
  v_mfma_f32_16x16x32_bf16 v[104:107], v[40:43], a[40:43], v[104:107]
  s_add_u32 m0, s41, 36864
  v_mfma_f32_16x16x32_bf16 v[108:111], v[40:43], a[44:47], v[108:111]
  s_add_u32 s42, s34, s77
  v_mfma_f32_16x16x32_bf16 v[112:115], v[44:47], a[32:35], v[112:115]
  buffer_load_dwordx4 v14, s[8:11], s42 offen lds
  v_mfma_f32_16x16x32_bf16 v[116:119], v[44:47], a[36:39], v[116:119]
  s_add_u32 m0, s41, 37888
  v_mfma_f32_16x16x32_bf16 v[120:123], v[44:47], a[40:43], v[120:123]
  s_nop 0
  v_mfma_f32_16x16x32_bf16 v[124:127], v[44:47], a[44:47], v[124:127]
  buffer_load_dwordx4 v15, s[8:11], s42 offen lds
  s_waitcnt vmcnt(18) lgkmcnt(0)
  v_mfma_f32_16x16x32_bf16 v[128:131], v[48:51], a[32:35], v[128:131]
  ds_read_b64_tr_b16 v[32:33], v18 offset:20480
  v_mfma_f32_16x16x32_bf16 v[132:135], v[48:51], a[36:39], v[132:135]
  ds_read_b64_tr_b16 v[34:35], v18 offset:20992
  v_mfma_f32_16x16x32_bf16 v[136:139], v[48:51], a[40:43], v[136:139]
  ds_read_b64_tr_b16 v[36:37], v19 offset:20480
  v_mfma_f32_16x16x32_bf16 v[140:143], v[48:51], a[44:47], v[140:143]
  ds_read_b64_tr_b16 v[38:39], v19 offset:20992
  v_mfma_f32_16x16x32_bf16 v[144:147], v[52:55], a[32:35], v[144:147]
  ds_read_b64_tr_b16 v[40:41], v18 offset:28672
  v_mfma_f32_16x16x32_bf16 v[148:151], v[52:55], a[36:39], v[148:151]
  ds_read_b64_tr_b16 v[42:43], v18 offset:29184
  v_mfma_f32_16x16x32_bf16 v[152:155], v[52:55], a[40:43], v[152:155]
  ds_read_b64_tr_b16 v[44:45], v19 offset:28672
  v_mfma_f32_16x16x32_bf16 v[156:159], v[52:55], a[44:47], v[156:159]
  ds_read_b64_tr_b16 v[46:47], v19 offset:29184
  v_mfma_f32_16x16x32_bf16 v[160:163], v[56:59], a[32:35], v[160:163]
  ds_read_b128 a[68:71], v224 offset:40960
  v_mfma_f32_16x16x32_bf16 v[164:167], v[56:59], a[36:39], v[164:167]
  ds_read_b128 a[84:87], v225 offset:40960
  v_mfma_f32_16x16x32_bf16 v[168:171], v[56:59], a[40:43], v[168:171]
  s_add_u32 m0, s41, 38912
  v_mfma_f32_16x16x32_bf16 v[172:175], v[56:59], a[44:47], v[172:175]
  s_add_u32 s42, s35, s77
  v_mfma_f32_16x16x32_bf16 v[176:179], v[60:63], a[32:35], v[176:179]
  buffer_load_dwordx4 v14, s[8:11], s42 offen lds
  v_mfma_f32_16x16x32_bf16 v[180:183], v[60:63], a[36:39], v[180:183]
  s_add_u32 m0, s41, 39936
  v_mfma_f32_16x16x32_bf16 v[184:187], v[60:63], a[40:43], v[184:187]
  s_nop 0
  v_mfma_f32_16x16x32_bf16 v[188:191], v[60:63], a[44:47], v[188:191]
  buffer_load_dwordx4 v15, s[8:11], s42 offen lds
  s_waitcnt vmcnt(16) lgkmcnt(0)
  v_mfma_f32_16x16x32_bf16 v[64:67], v[32:35], a[48:51], v[64:67]
  ds_read_b64_tr_b16 v[48:49], v20 offset:20480
  v_mfma_f32_16x16x32_bf16 v[68:71], v[32:35], a[52:55], v[68:71]
  ds_read_b64_tr_b16 v[50:51], v20 offset:20992
  v_mfma_f32_16x16x32_bf16 v[72:75], v[32:35], a[56:59], v[72:75]
  ds_read_b64_tr_b16 v[52:53], v21 offset:20480
  v_mfma_f32_16x16x32_bf16 v[76:79], v[32:35], a[60:63], v[76:79]
  ds_read_b64_tr_b16 v[54:55], v21 offset:20992
  v_mfma_f32_16x16x32_bf16 v[80:83], v[36:39], a[48:51], v[80:83]
  ds_read_b64_tr_b16 v[56:57], v20 offset:28672
  v_mfma_f32_16x16x32_bf16 v[84:87], v[36:39], a[52:55], v[84:87]
  ds_read_b64_tr_b16 v[58:59], v20 offset:29184
  v_mfma_f32_16x16x32_bf16 v[88:91], v[36:39], a[56:59], v[88:91]
  ds_read_b64_tr_b16 v[60:61], v21 offset:28672
  v_mfma_f32_16x16x32_bf16 v[92:95], v[36:39], a[60:63], v[92:95]
  ds_read_b64_tr_b16 v[62:63], v21 offset:29184
  v_mfma_f32_16x16x32_bf16 v[96:99], v[40:43], a[48:51], v[96:99]
  ds_read_b128 a[72:75], v224 offset:43008
  v_mfma_f32_16x16x32_bf16 v[100:103], v[40:43], a[52:55], v[100:103]
  ds_read_b128 a[88:91], v225 offset:43008
  v_mfma_f32_16x16x32_bf16 v[104:107], v[40:43], a[56:59], v[104:107]
  s_add_u32 m0, s41, 40960
  v_mfma_f32_16x16x32_bf16 v[108:111], v[40:43], a[60:63], v[108:111]
  s_add_u32 s42, s32, s78
  v_mfma_f32_16x16x32_bf16 v[112:115], v[44:47], a[48:51], v[112:115]
  buffer_load_dwordx4 v14, s[8:11], s42 offen lds
  v_mfma_f32_16x16x32_bf16 v[116:119], v[44:47], a[52:55], v[116:119]
  s_add_u32 m0, s41, 41984
  v_mfma_f32_16x16x32_bf16 v[120:123], v[44:47], a[56:59], v[120:123]
  s_nop 0
  v_mfma_f32_16x16x32_bf16 v[124:127], v[44:47], a[60:63], v[124:127]
  buffer_load_dwordx4 v15, s[8:11], s42 offen lds
  s_waitcnt vmcnt(32) lgkmcnt(0)
  s_barrier
  v_mfma_f32_16x16x32_bf16 v[128:131], v[48:51], a[48:51], v[128:131]
  ds_read_b64_tr_b16 v[32:33], v18 offset:32768
  ds_read_b64_tr_b16 v[34:35], v18 offset:33280
  v_mfma_f32_16x16x32_bf16 v[132:135], v[48:51], a[52:55], v[132:135]
  ds_read_b64_tr_b16 v[36:37], v19 offset:32768
  ds_read_b64_tr_b16 v[38:39], v19 offset:33280
  v_mfma_f32_16x16x32_bf16 v[136:139], v[48:51], a[56:59], v[136:139]
  ds_read_b64_tr_b16 v[40:41], v18 offset:40960
  ds_read_b64_tr_b16 v[42:43], v18 offset:41472
  v_mfma_f32_16x16x32_bf16 v[140:143], v[48:51], a[60:63], v[140:143]
  ds_read_b64_tr_b16 v[44:45], v19 offset:40960
  ds_read_b64_tr_b16 v[46:47], v19 offset:41472
  v_mfma_f32_16x16x32_bf16 v[144:147], v[52:55], a[48:51], v[144:147]
  ds_read_b128 a[76:79], v226 offset:0
  ds_read_b128 a[92:95], v227 offset:0
  v_mfma_f32_16x16x32_bf16 v[148:151], v[52:55], a[52:55], v[148:151]
  s_add_u32 m0, s41, 43008
  s_add_u32 s42, s33, s78
  v_mfma_f32_16x16x32_bf16 v[152:155], v[52:55], a[56:59], v[152:155]
  buffer_load_dwordx4 v14, s[8:11], s42 offen lds
  s_add_u32 m0, s41, 44032
  v_mfma_f32_16x16x32_bf16 v[156:159], v[52:55], a[60:63], v[156:159]
  s_nop 0
  buffer_load_dwordx4 v15, s[8:11], s42 offen lds
  v_mfma_f32_16x16x32_bf16 v[160:163], v[56:59], a[48:51], v[160:163]
  s_add_u32 m0, s87, 114688
  s_mul_i32 s42, s78, 4608
  v_mfma_f32_16x16x32_bf16 v[164:167], v[56:59], a[52:55], v[164:167]
  s_add_u32 s42, s42, s88
  buffer_load_dwordx4 v16, s[12:15], s42 offen lds
  v_mfma_f32_16x16x32_bf16 v[168:171], v[56:59], a[56:59], v[168:171]
  s_add_u32 m0, s87, 115712
  s_mul_i32 s42, s78, 4608
  v_mfma_f32_16x16x32_bf16 v[172:175], v[56:59], a[60:63], v[172:175]
  s_add_u32 s42, s42, s89
  buffer_load_dwordx4 v17, s[12:15], s42 offen lds
  v_mfma_f32_16x16x32_bf16 v[176:179], v[60:63], a[48:51], v[176:179]
  s_add_u32 m0, s87, 122880
  s_mul_i32 s42, s78, 4608
  v_mfma_f32_16x16x32_bf16 v[180:183], v[60:63], a[52:55], v[180:183]
  s_add_u32 s42, s42, s88
  buffer_load_dwordx4 v16, s[16:19], s42 offen lds
  v_mfma_f32_16x16x32_bf16 v[184:187], v[60:63], a[56:59], v[184:187]
  s_add_u32 m0, s87, 123904
  s_mul_i32 s42, s78, 4608
  v_mfma_f32_16x16x32_bf16 v[188:191], v[60:63], a[60:63], v[188:191]
  s_add_u32 s42, s42, s89
  buffer_load_dwordx4 v17, s[16:19], s42 offen lds
  s_waitcnt vmcnt(36) lgkmcnt(0)
  v_mfma_f32_16x16x32_bf16 v[64:67], v[32:35], a[64:67], v[64:67]
  ds_read_b64_tr_b16 v[48:49], v20 offset:32768
  v_mfma_f32_16x16x32_bf16 v[68:71], v[32:35], a[68:71], v[68:71]
  ds_read_b64_tr_b16 v[50:51], v20 offset:33280
  v_mfma_f32_16x16x32_bf16 v[72:75], v[32:35], a[72:75], v[72:75]
  ds_read_b64_tr_b16 v[52:53], v21 offset:32768
  v_mfma_f32_16x16x32_bf16 v[76:79], v[32:35], a[76:79], v[76:79]
  ds_read_b64_tr_b16 v[54:55], v21 offset:33280
  v_mfma_f32_16x16x32_bf16 v[80:83], v[36:39], a[64:67], v[80:83]
  ds_read_b64_tr_b16 v[56:57], v20 offset:40960
  v_mfma_f32_16x16x32_bf16 v[84:87], v[36:39], a[68:71], v[84:87]
  ds_read_b64_tr_b16 v[58:59], v20 offset:41472
  v_mfma_f32_16x16x32_bf16 v[88:91], v[36:39], a[72:75], v[88:91]
  ds_read_b64_tr_b16 v[60:61], v21 offset:40960
  v_mfma_f32_16x16x32_bf16 v[92:95], v[36:39], a[76:79], v[92:95]
  ds_read_b64_tr_b16 v[62:63], v21 offset:41472
  v_mfma_f32_16x16x32_bf16 v[96:99], v[40:43], a[64:67], v[96:99]
  ds_read_b128 a[96:99], v226 offset:2048
  v_mfma_f32_16x16x32_bf16 v[100:103], v[40:43], a[68:71], v[100:103]
  ds_read_b128 a[112:115], v227 offset:2048
  v_mfma_f32_16x16x32_bf16 v[104:107], v[40:43], a[72:75], v[104:107]
  s_add_u32 m0, s44, 0
  v_mfma_f32_16x16x32_bf16 v[108:111], v[40:43], a[76:79], v[108:111]
  s_add_u32 s42, s34, s78
  v_mfma_f32_16x16x32_bf16 v[112:115], v[44:47], a[64:67], v[112:115]
  buffer_load_dwordx4 v14, s[8:11], s42 offen lds
  v_mfma_f32_16x16x32_bf16 v[116:119], v[44:47], a[68:71], v[116:119]
  s_add_u32 m0, s44, 1024
  v_mfma_f32_16x16x32_bf16 v[120:123], v[44:47], a[72:75], v[120:123]
  s_nop 0
  v_mfma_f32_16x16x32_bf16 v[124:127], v[44:47], a[76:79], v[124:127]
  buffer_load_dwordx4 v15, s[8:11], s42 offen lds
  s_waitcnt vmcnt(36) lgkmcnt(0)
  v_mfma_f32_16x16x32_bf16 v[128:131], v[48:51], a[64:67], v[128:131]
  ds_read_b64_tr_b16 v[32:33], v18 offset:36864
  v_mfma_f32_16x16x32_bf16 v[132:135], v[48:51], a[68:71], v[132:135]
  ds_read_b64_tr_b16 v[34:35], v18 offset:37376
  v_mfma_f32_16x16x32_bf16 v[136:139], v[48:51], a[72:75], v[136:139]
  ds_read_b64_tr_b16 v[36:37], v19 offset:36864
  v_mfma_f32_16x16x32_bf16 v[140:143], v[48:51], a[76:79], v[140:143]
  ds_read_b64_tr_b16 v[38:39], v19 offset:37376
  v_mfma_f32_16x16x32_bf16 v[144:147], v[52:55], a[64:67], v[144:147]
  ds_read_b64_tr_b16 v[40:41], v18 offset:45056
  v_mfma_f32_16x16x32_bf16 v[148:151], v[52:55], a[68:71], v[148:151]
  ds_read_b64_tr_b16 v[42:43], v18 offset:45568
  v_mfma_f32_16x16x32_bf16 v[152:155], v[52:55], a[72:75], v[152:155]
  ds_read_b64_tr_b16 v[44:45], v19 offset:45056
  v_mfma_f32_16x16x32_bf16 v[156:159], v[52:55], a[76:79], v[156:159]
  ds_read_b64_tr_b16 v[46:47], v19 offset:45568
  v_mfma_f32_16x16x32_bf16 v[160:163], v[56:59], a[64:67], v[160:163]
  ds_read_b128 a[100:103], v226 offset:4096
  v_mfma_f32_16x16x32_bf16 v[164:167], v[56:59], a[68:71], v[164:167]
  ds_read_b128 a[116:119], v227 offset:4096
  v_mfma_f32_16x16x32_bf16 v[168:171], v[56:59], a[72:75], v[168:171]
  s_add_u32 m0, s44, 2048
  v_mfma_f32_16x16x32_bf16 v[172:175], v[56:59], a[76:79], v[172:175]
  s_add_u32 s42, s35, s78
  v_mfma_f32_16x16x32_bf16 v[176:179], v[60:63], a[64:67], v[176:179]
  buffer_load_dwordx4 v14, s[8:11], s42 offen lds
  v_mfma_f32_16x16x32_bf16 v[180:183], v[60:63], a[68:71], v[180:183]
  s_add_u32 m0, s44, 3072
  v_mfma_f32_16x16x32_bf16 v[184:187], v[60:63], a[72:75], v[184:187]
  s_nop 0
  v_mfma_f32_16x16x32_bf16 v[188:191], v[60:63], a[76:79], v[188:191]
  buffer_load_dwordx4 v15, s[8:11], s42 offen lds
  s_waitcnt vmcnt(36) lgkmcnt(0)
  v_mfma_f32_16x16x32_bf16 v[64:67], v[32:35], a[80:83], v[64:67]
  ds_read_b64_tr_b16 v[48:49], v20 offset:36864
  ds_read_b64_tr_b16 v[50:51], v20 offset:37376
  v_mfma_f32_16x16x32_bf16 v[68:71], v[32:35], a[84:87], v[68:71]
  ds_read_b64_tr_b16 v[52:53], v21 offset:36864
  ds_read_b64_tr_b16 v[54:55], v21 offset:37376
  v_mfma_f32_16x16x32_bf16 v[72:75], v[32:35], a[88:91], v[72:75]
  ds_read_b64_tr_b16 v[56:57], v20 offset:45056
  ds_read_b64_tr_b16 v[58:59], v20 offset:45568
  v_mfma_f32_16x16x32_bf16 v[76:79], v[32:35], a[92:95], v[76:79]
  ds_read_b64_tr_b16 v[60:61], v21 offset:45056
  ds_read_b64_tr_b16 v[62:63], v21 offset:45568
  v_mfma_f32_16x16x32_bf16 v[80:83], v[36:39], a[80:83], v[80:83]
  ds_read_b128 a[104:107], v224 offset:0
  ds_read_b128 a[120:123], v225 offset:0
  v_mfma_f32_16x16x32_bf16 v[84:87], v[36:39], a[84:87], v[84:87]
  s_add_u32 m0, s44, 4096
  s_add_u32 s42, s32, s79
  v_mfma_f32_16x16x32_bf16 v[88:91], v[36:39], a[88:91], v[88:91]
  buffer_load_dwordx4 v14, s[8:11], s42 offen lds
  s_add_u32 m0, s44, 5120
  v_mfma_f32_16x16x32_bf16 v[92:95], v[36:39], a[92:95], v[92:95]
  s_nop 0
  buffer_load_dwordx4 v15, s[8:11], s42 offen lds
  v_mfma_f32_16x16x32_bf16 v[96:99], v[40:43], a[80:83], v[96:99]
  v_mul_u32_u24 v231, 1152, v243
  v_mul_u32_u24 v233, 3641, v236
  v_mfma_f32_16x16x32_bf16 v[100:103], v[40:43], a[84:87], v[100:103]
  v_lshrrev_b32 v233, 22, v233
  v_mul_u32_u24 v233, 1152, v233
  v_mfma_f32_16x16x32_bf16 v[104:107], v[40:43], a[88:91], v[104:107]
  v_sub_u32 v232, v236, v233
  v_add_u32 v243, v231, v232
  v_mfma_f32_16x16x32_bf16 v[108:111], v[40:43], a[92:95], v[108:111]
  v_mfma_f32_16x16x32_bf16 v[112:115], v[44:47], a[80:83], v[112:115]
  v_mfma_f32_16x16x32_bf16 v[116:119], v[44:47], a[84:87], v[116:119]
  v_mfma_f32_16x16x32_bf16 v[120:123], v[44:47], a[88:91], v[120:123]
  v_mfma_f32_16x16x32_bf16 v[124:127], v[44:47], a[92:95], v[124:127]
  s_waitcnt vmcnt(26) lgkmcnt(0)
  s_barrier
  v_mfma_f32_16x16x32_bf16 v[128:131], v[48:51], a[80:83], v[128:131]
  ds_read_b64_tr_b16 v[32:33], v18 offset:49152
  ds_read_b64_tr_b16 v[34:35], v18 offset:49664
  ds_read_b64_tr_b16 v[36:37], v19 offset:49152
  v_mfma_f32_16x16x32_bf16 v[132:135], v[48:51], a[84:87], v[132:135]
  ds_read_b64_tr_b16 v[38:39], v19 offset:49664
  ds_read_b64_tr_b16 v[40:41], v18 offset:57344
  ds_read_b64_tr_b16 v[42:43], v18 offset:57856
  v_mfma_f32_16x16x32_bf16 v[136:139], v[48:51], a[88:91], v[136:139]
  ds_read_b64_tr_b16 v[44:45], v19 offset:57344
  ds_read_b64_tr_b16 v[46:47], v19 offset:57856
  ds_read_b128 a[108:111], v224 offset:2048
  v_mfma_f32_16x16x32_bf16 v[140:143], v[48:51], a[92:95], v[140:143]
  ds_read_b128 a[124:127], v225 offset:2048
  s_add_u32 m0, s41, 0
  s_add_u32 s42, s33, s79
  v_mfma_f32_16x16x32_bf16 v[144:147], v[52:55], a[80:83], v[144:147]
  buffer_load_dwordx4 v14, s[8:11], s42 offen lds
  s_add_u32 m0, s41, 1024
  s_nop 0
  v_mfma_f32_16x16x32_bf16 v[148:151], v[52:55], a[84:87], v[148:151]
  buffer_load_dwordx4 v15, s[8:11], s42 offen lds
  s_add_u32 m0, s87, 131072
  s_mul_i32 s42, s79, 4608
  v_mfma_f32_16x16x32_bf16 v[152:155], v[52:55], a[88:91], v[152:155]
  s_add_u32 s42, s42, s88
  buffer_load_dwordx4 v16, s[12:15], s42 offen lds
  s_add_u32 m0, s87, 132096
  v_mfma_f32_16x16x32_bf16 v[156:159], v[52:55], a[92:95], v[156:159]
  s_mul_i32 s42, s79, 4608
  s_add_u32 s42, s42, s89
  buffer_load_dwordx4 v17, s[12:15], s42 offen lds
  v_mfma_f32_16x16x32_bf16 v[160:163], v[56:59], a[80:83], v[160:163]
  s_add_u32 m0, s87, 139264
  s_mul_i32 s42, s79, 4608
  s_add_u32 s42, s42, s88
  v_mfma_f32_16x16x32_bf16 v[164:167], v[56:59], a[84:87], v[164:167]
  buffer_load_dwordx4 v16, s[16:19], s42 offen lds
  s_add_u32 m0, s87, 140288
  s_mul_i32 s42, s79, 4608
  v_mfma_f32_16x16x32_bf16 v[168:171], v[56:59], a[88:91], v[168:171]
  s_add_u32 s42, s42, s89
  buffer_load_dwordx4 v17, s[16:19], s42 offen lds
  v_mul_u32_u24 v231, 1152, v244
  v_mfma_f32_16x16x32_bf16 v[172:175], v[56:59], a[92:95], v[172:175]
  v_mul_u32_u24 v233, 3641, v237
  v_lshrrev_b32 v233, 22, v233
  v_mul_u32_u24 v233, 1152, v233
  v_mfma_f32_16x16x32_bf16 v[176:179], v[60:63], a[80:83], v[176:179]
  v_sub_u32 v232, v237, v233
  v_add_u32 v244, v231, v232
  v_mfma_f32_16x16x32_bf16 v[180:183], v[60:63], a[84:87], v[180:183]
  v_mfma_f32_16x16x32_bf16 v[184:187], v[60:63], a[88:91], v[184:187]
  v_mfma_f32_16x16x32_bf16 v[188:191], v[60:63], a[92:95], v[188:191]
  s_waitcnt vmcnt(30) lgkmcnt(0)
  v_mfma_f32_16x16x32_bf16 v[64:67], v[32:35], a[96:99], v[64:67]
  ds_read_b64_tr_b16 v[48:49], v20 offset:49152
  ds_read_b64_tr_b16 v[50:51], v20 offset:49664
  v_mfma_f32_16x16x32_bf16 v[68:71], v[32:35], a[100:103], v[68:71]
  ds_read_b64_tr_b16 v[52:53], v21 offset:49152
  ds_read_b64_tr_b16 v[54:55], v21 offset:49664
  v_mfma_f32_16x16x32_bf16 v[72:75], v[32:35], a[104:107], v[72:75]
  ds_read_b64_tr_b16 v[56:57], v20 offset:57344
  ds_read_b64_tr_b16 v[58:59], v20 offset:57856
  v_mfma_f32_16x16x32_bf16 v[76:79], v[32:35], a[108:111], v[76:79]
  ds_read_b64_tr_b16 v[60:61], v21 offset:57344
  ds_read_b64_tr_b16 v[62:63], v21 offset:57856
  v_mfma_f32_16x16x32_bf16 v[80:83], v[36:39], a[96:99], v[80:83]
  ds_read_b128 a[128:131], v224 offset:4096
  ds_read_b128 a[144:147], v225 offset:4096
  v_mfma_f32_16x16x32_bf16 v[84:87], v[36:39], a[100:103], v[84:87]
  s_add_u32 m0, s41, 2048
  s_add_u32 s42, s34, s79
  v_mfma_f32_16x16x32_bf16 v[88:91], v[36:39], a[104:107], v[88:91]
  buffer_load_dwordx4 v14, s[8:11], s42 offen lds
  s_add_u32 m0, s41, 3072
  v_mfma_f32_16x16x32_bf16 v[92:95], v[36:39], a[108:111], v[92:95]
  s_nop 0
  buffer_load_dwordx4 v15, s[8:11], s42 offen lds
  v_mfma_f32_16x16x32_bf16 v[96:99], v[40:43], a[96:99], v[96:99]
  v_mul_u32_u24 v231, 1152, v245
  v_mul_u32_u24 v233, 3641, v238
  v_mfma_f32_16x16x32_bf16 v[100:103], v[40:43], a[100:103], v[100:103]
  v_lshrrev_b32 v233, 22, v233
  v_mul_u32_u24 v233, 1152, v233
  v_mfma_f32_16x16x32_bf16 v[104:107], v[40:43], a[104:107], v[104:107]
  v_sub_u32 v232, v238, v233
  v_add_u32 v245, v231, v232
  v_mfma_f32_16x16x32_bf16 v[108:111], v[40:43], a[108:111], v[108:111]
  v_mfma_f32_16x16x32_bf16 v[112:115], v[44:47], a[96:99], v[112:115]
  v_mfma_f32_16x16x32_bf16 v[116:119], v[44:47], a[100:103], v[116:119]
  v_mfma_f32_16x16x32_bf16 v[120:123], v[44:47], a[104:107], v[120:123]
  v_mfma_f32_16x16x32_bf16 v[124:127], v[44:47], a[108:111], v[124:127]
  s_waitcnt vmcnt(30) lgkmcnt(0)
  v_mfma_f32_16x16x32_bf16 v[128:131], v[48:51], a[96:99], v[128:131]
  ds_read_b64_tr_b16 v[32:33], v18 offset:53248
  ds_read_b64_tr_b16 v[34:35], v18 offset:53760
  v_mfma_f32_16x16x32_bf16 v[132:135], v[48:51], a[100:103], v[132:135]
  ds_read_b64_tr_b16 v[36:37], v19 offset:53248
  ds_read_b64_tr_b16 v[38:39], v19 offset:53760
  v_mfma_f32_16x16x32_bf16 v[136:139], v[48:51], a[104:107], v[136:139]
  ds_read_b64_tr_b16 v[40:41], v18 offset:61440
  ds_read_b64_tr_b16 v[42:43], v18 offset:61952
  v_mfma_f32_16x16x32_bf16 v[140:143], v[48:51], a[108:111], v[140:143]
  ds_read_b64_tr_b16 v[44:45], v19 offset:61440
  ds_read_b64_tr_b16 v[46:47], v19 offset:61952
  v_mfma_f32_16x16x32_bf16 v[144:147], v[52:55], a[96:99], v[144:147]
  ds_read_b128 a[132:135], v224 offset:6144
  ds_read_b128 a[148:151], v225 offset:6144
  v_mfma_f32_16x16x32_bf16 v[148:151], v[52:55], a[100:103], v[148:151]
  s_add_u32 m0, s41, 4096
  s_add_u32 s42, s35, s79
  v_mfma_f32_16x16x32_bf16 v[152:155], v[52:55], a[104:107], v[152:155]
  buffer_load_dwordx4 v14, s[8:11], s42 offen lds
  s_add_u32 m0, s41, 5120
  v_mfma_f32_16x16x32_bf16 v[156:159], v[52:55], a[108:111], v[156:159]
  s_nop 0
  buffer_load_dwordx4 v15, s[8:11], s42 offen lds
  v_mfma_f32_16x16x32_bf16 v[160:163], v[56:59], a[96:99], v[160:163]
  v_mul_u32_u24 v231, 1152, v246
  v_mul_u32_u24 v233, 3641, v239
  v_mfma_f32_16x16x32_bf16 v[164:167], v[56:59], a[100:103], v[164:167]
  v_lshrrev_b32 v233, 22, v233
  v_mul_u32_u24 v233, 1152, v233
  v_mfma_f32_16x16x32_bf16 v[168:171], v[56:59], a[104:107], v[168:171]
  v_sub_u32 v232, v239, v233
  v_add_u32 v246, v231, v232
  v_mfma_f32_16x16x32_bf16 v[172:175], v[56:59], a[108:111], v[172:175]
  v_mfma_f32_16x16x32_bf16 v[176:179], v[60:63], a[96:99], v[176:179]
  v_mfma_f32_16x16x32_bf16 v[180:183], v[60:63], a[100:103], v[180:183]
  v_mfma_f32_16x16x32_bf16 v[184:187], v[60:63], a[104:107], v[184:187]
  v_mfma_f32_16x16x32_bf16 v[188:191], v[60:63], a[108:111], v[188:191]
  s_waitcnt vmcnt(26) lgkmcnt(0)
  v_mfma_f32_16x16x32_bf16 v[64:67], v[32:35], a[112:115], v[64:67]
  ds_read_b64_tr_b16 v[48:49], v20 offset:53248
  ds_read_b64_tr_b16 v[50:51], v20 offset:53760
  v_mfma_f32_16x16x32_bf16 v[68:71], v[32:35], a[116:119], v[68:71]
  ds_read_b64_tr_b16 v[52:53], v21 offset:53248
  ds_read_b64_tr_b16 v[54:55], v21 offset:53760
  v_mfma_f32_16x16x32_bf16 v[72:75], v[32:35], a[120:123], v[72:75]
  ds_read_b64_tr_b16 v[56:57], v20 offset:61440
  ds_read_b64_tr_b16 v[58:59], v20 offset:61952
  v_mfma_f32_16x16x32_bf16 v[76:79], v[32:35], a[124:127], v[76:79]
  ds_read_b64_tr_b16 v[60:61], v21 offset:61440
  ds_read_b64_tr_b16 v[62:63], v21 offset:61952
  v_mfma_f32_16x16x32_bf16 v[80:83], v[36:39], a[112:115], v[80:83]
  ds_read_b128 a[136:139], v224 offset:36864
  ds_read_b128 a[152:155], v225 offset:36864
  v_mfma_f32_16x16x32_bf16 v[84:87], v[36:39], a[116:119], v[84:87]
  s_add_u32 m0, s41, 6144
  s_add_u32 s42, s32, s80
  v_mfma_f32_16x16x32_bf16 v[88:91], v[36:39], a[120:123], v[88:91]
  buffer_load_dwordx4 v14, s[8:11], s42 offen lds
  s_add_u32 m0, s41, 7168
  v_mfma_f32_16x16x32_bf16 v[92:95], v[36:39], a[124:127], v[92:95]
  s_nop 0
  buffer_load_dwordx4 v15, s[8:11], s42 offen lds
  v_mfma_f32_16x16x32_bf16 v[96:99], v[40:43], a[112:115], v[96:99]
  v_mul_u32_u24 v231, 1152, v247
  v_mul_u32_u24 v233, 3641, v240
  v_mfma_f32_16x16x32_bf16 v[100:103], v[40:43], a[116:119], v[100:103]
  v_lshrrev_b32 v233, 22, v233
  v_mul_u32_u24 v233, 1152, v233
  v_mfma_f32_16x16x32_bf16 v[104:107], v[40:43], a[120:123], v[104:107]
  v_sub_u32 v232, v240, v233
  v_add_u32 v247, v231, v232
  v_mfma_f32_16x16x32_bf16 v[108:111], v[40:43], a[124:127], v[108:111]
  v_mfma_f32_16x16x32_bf16 v[112:115], v[44:47], a[112:115], v[112:115]
  v_mfma_f32_16x16x32_bf16 v[116:119], v[44:47], a[116:119], v[116:119]
  v_mfma_f32_16x16x32_bf16 v[120:123], v[44:47], a[120:123], v[120:123]
  v_mfma_f32_16x16x32_bf16 v[124:127], v[44:47], a[124:127], v[124:127]
  s_waitcnt vmcnt(26) lgkmcnt(0)
  s_barrier
  v_mfma_f32_16x16x32_bf16 v[128:131], v[48:51], a[112:115], v[128:131]
  ds_read_b64_tr_b16 v[32:33], v18 offset:0
  ds_read_b64_tr_b16 v[34:35], v18 offset:512
  ds_read_b64_tr_b16 v[36:37], v19 offset:0
  v_mfma_f32_16x16x32_bf16 v[132:135], v[48:51], a[116:119], v[132:135]
  ds_read_b64_tr_b16 v[38:39], v19 offset:512
  ds_read_b64_tr_b16 v[40:41], v18 offset:8192
  ds_read_b64_tr_b16 v[42:43], v18 offset:8704
  v_mfma_f32_16x16x32_bf16 v[136:139], v[48:51], a[120:123], v[136:139]
  ds_read_b64_tr_b16 v[44:45], v19 offset:8192
  ds_read_b64_tr_b16 v[46:47], v19 offset:8704
  ds_read_b128 a[140:143], v224 offset:38912
  v_mfma_f32_16x16x32_bf16 v[140:143], v[48:51], a[124:127], v[140:143]
  ds_read_b128 a[156:159], v225 offset:38912
  s_add_u32 m0, s41, 36864
  s_add_u32 s42, s33, s80
  v_mfma_f32_16x16x32_bf16 v[144:147], v[52:55], a[112:115], v[144:147]
  buffer_load_dwordx4 v14, s[8:11], s42 offen lds
  s_add_u32 m0, s41, 37888
  s_nop 0
  v_mfma_f32_16x16x32_bf16 v[148:151], v[52:55], a[116:119], v[148:151]
  buffer_load_dwordx4 v15, s[8:11], s42 offen lds
  s_add_u32 m0, s87, 147456
  s_mul_i32 s42, s80, 4608
  v_mfma_f32_16x16x32_bf16 v[152:155], v[52:55], a[120:123], v[152:155]
  s_add_u32 s42, s42, s88
  buffer_load_dwordx4 v16, s[12:15], s42 offen lds
  s_add_u32 m0, s87, 148480
  v_mfma_f32_16x16x32_bf16 v[156:159], v[52:55], a[124:127], v[156:159]
  s_mul_i32 s42, s80, 4608
  s_add_u32 s42, s42, s89
  buffer_load_dwordx4 v17, s[12:15], s42 offen lds
  v_mfma_f32_16x16x32_bf16 v[160:163], v[56:59], a[112:115], v[160:163]
  s_add_u32 m0, s87, 155648
  s_mul_i32 s42, s80, 4608
  s_add_u32 s42, s42, s88
  v_mfma_f32_16x16x32_bf16 v[164:167], v[56:59], a[116:119], v[164:167]
  buffer_load_dwordx4 v16, s[16:19], s42 offen lds
  s_add_u32 m0, s87, 156672
  s_mul_i32 s42, s80, 4608
  v_mfma_f32_16x16x32_bf16 v[168:171], v[56:59], a[120:123], v[168:171]
  s_add_u32 s42, s42, s89
  buffer_load_dwordx4 v17, s[16:19], s42 offen lds
  v_mul_u32_u24 v231, 1152, v248
  v_mfma_f32_16x16x32_bf16 v[172:175], v[56:59], a[124:127], v[172:175]
  v_mul_u32_u24 v233, 3641, v241
  v_lshrrev_b32 v233, 22, v233
  v_mul_u32_u24 v233, 1152, v233
  v_mfma_f32_16x16x32_bf16 v[176:179], v[60:63], a[112:115], v[176:179]
  v_sub_u32 v232, v241, v233
  v_add_u32 v248, v231, v232
  v_mfma_f32_16x16x32_bf16 v[180:183], v[60:63], a[116:119], v[180:183]
  v_mfma_f32_16x16x32_bf16 v[184:187], v[60:63], a[120:123], v[184:187]
  v_mfma_f32_16x16x32_bf16 v[188:191], v[60:63], a[124:127], v[188:191]
  s_waitcnt vmcnt(30) lgkmcnt(0)
  v_mfma_f32_16x16x32_bf16 v[64:67], v[32:35], a[128:131], v[64:67]
  ds_read_b64_tr_b16 v[48:49], v20 offset:0
  ds_read_b64_tr_b16 v[50:51], v20 offset:512
  v_mfma_f32_16x16x32_bf16 v[68:71], v[32:35], a[132:135], v[68:71]
  ds_read_b64_tr_b16 v[52:53], v21 offset:0
  ds_read_b64_tr_b16 v[54:55], v21 offset:512
  v_mfma_f32_16x16x32_bf16 v[72:75], v[32:35], a[136:139], v[72:75]
  ds_read_b64_tr_b16 v[56:57], v20 offset:8192
  ds_read_b64_tr_b16 v[58:59], v20 offset:8704
  v_mfma_f32_16x16x32_bf16 v[76:79], v[32:35], a[140:143], v[76:79]
  ds_read_b64_tr_b16 v[60:61], v21 offset:8192
  ds_read_b64_tr_b16 v[62:63], v21 offset:8704
  v_mfma_f32_16x16x32_bf16 v[80:83], v[36:39], a[128:131], v[80:83]
  ds_read_b128 a[160:163], v224 offset:40960
  ds_read_b128 a[176:179], v225 offset:40960
  v_mfma_f32_16x16x32_bf16 v[84:87], v[36:39], a[132:135], v[84:87]
  s_add_u32 m0, s41, 38912
  s_add_u32 s42, s34, s80
  v_mfma_f32_16x16x32_bf16 v[88:91], v[36:39], a[136:139], v[88:91]
  buffer_load_dwordx4 v14, s[8:11], s42 offen lds
  s_add_u32 m0, s41, 39936
  v_mfma_f32_16x16x32_bf16 v[92:95], v[36:39], a[140:143], v[92:95]
  s_nop 0
  buffer_load_dwordx4 v15, s[8:11], s42 offen lds
  v_mfma_f32_16x16x32_bf16 v[96:99], v[40:43], a[128:131], v[96:99]
  v_mul_u32_u24 v231, 1152, v249
  v_mul_u32_u24 v233, 3641, v242
  v_mfma_f32_16x16x32_bf16 v[100:103], v[40:43], a[132:135], v[100:103]
  v_lshrrev_b32 v233, 22, v233
  v_mul_u32_u24 v233, 1152, v233
  v_mfma_f32_16x16x32_bf16 v[104:107], v[40:43], a[136:139], v[104:107]
  v_sub_u32 v232, v242, v233
  v_add_u32 v249, v231, v232
  v_mfma_f32_16x16x32_bf16 v[108:111], v[40:43], a[140:143], v[108:111]
  v_mfma_f32_16x16x32_bf16 v[112:115], v[44:47], a[128:131], v[112:115]
  v_mfma_f32_16x16x32_bf16 v[116:119], v[44:47], a[132:135], v[116:119]
  v_mfma_f32_16x16x32_bf16 v[120:123], v[44:47], a[136:139], v[120:123]
  v_mfma_f32_16x16x32_bf16 v[124:127], v[44:47], a[140:143], v[124:127]
  s_waitcnt vmcnt(30) lgkmcnt(0)
  v_mfma_f32_16x16x32_bf16 v[128:131], v[48:51], a[128:131], v[128:131]
  ds_read_b64_tr_b16 v[32:33], v18 offset:4096
  v_mfma_f32_16x16x32_bf16 v[132:135], v[48:51], a[132:135], v[132:135]
  ds_read_b64_tr_b16 v[34:35], v18 offset:4608
  v_mfma_f32_16x16x32_bf16 v[136:139], v[48:51], a[136:139], v[136:139]
  ds_read_b64_tr_b16 v[36:37], v19 offset:4096
  v_mfma_f32_16x16x32_bf16 v[140:143], v[48:51], a[140:143], v[140:143]
  ds_read_b64_tr_b16 v[38:39], v19 offset:4608
  v_mfma_f32_16x16x32_bf16 v[144:147], v[52:55], a[128:131], v[144:147]
  ds_read_b64_tr_b16 v[40:41], v18 offset:12288
  v_mfma_f32_16x16x32_bf16 v[148:151], v[52:55], a[132:135], v[148:151]
  ds_read_b64_tr_b16 v[42:43], v18 offset:12800
  v_mfma_f32_16x16x32_bf16 v[152:155], v[52:55], a[136:139], v[152:155]
  ds_read_b64_tr_b16 v[44:45], v19 offset:12288
  v_mfma_f32_16x16x32_bf16 v[156:159], v[52:55], a[140:143], v[156:159]
  ds_read_b64_tr_b16 v[46:47], v19 offset:12800
  v_mfma_f32_16x16x32_bf16 v[160:163], v[56:59], a[128:131], v[160:163]
  ds_read_b128 a[164:167], v224 offset:43008
  v_mfma_f32_16x16x32_bf16 v[164:167], v[56:59], a[132:135], v[164:167]
  ds_read_b128 a[180:183], v225 offset:43008
  v_mfma_f32_16x16x32_bf16 v[168:171], v[56:59], a[136:139], v[168:171]
  s_add_u32 m0, s41, 40960
  v_mfma_f32_16x16x32_bf16 v[172:175], v[56:59], a[140:143], v[172:175]
  s_add_u32 s42, s35, s80
  v_mfma_f32_16x16x32_bf16 v[176:179], v[60:63], a[128:131], v[176:179]
  buffer_load_dwordx4 v14, s[8:11], s42 offen lds
  v_mfma_f32_16x16x32_bf16 v[180:183], v[60:63], a[132:135], v[180:183]
  s_add_u32 m0, s41, 41984
  v_mfma_f32_16x16x32_bf16 v[184:187], v[60:63], a[136:139], v[184:187]
  s_nop 0
  v_mfma_f32_16x16x32_bf16 v[188:191], v[60:63], a[140:143], v[188:191]
  buffer_load_dwordx4 v15, s[8:11], s42 offen lds
  s_waitcnt vmcnt(26) lgkmcnt(0)
  v_mfma_f32_16x16x32_bf16 v[64:67], v[32:35], a[144:147], v[64:67]
  ds_read_b64_tr_b16 v[48:49], v20 offset:4096
  v_mfma_f32_16x16x32_bf16 v[68:71], v[32:35], a[148:151], v[68:71]
  ds_read_b64_tr_b16 v[50:51], v20 offset:4608
  v_mfma_f32_16x16x32_bf16 v[72:75], v[32:35], a[152:155], v[72:75]
  ds_read_b64_tr_b16 v[52:53], v21 offset:4096
  v_mfma_f32_16x16x32_bf16 v[76:79], v[32:35], a[156:159], v[76:79]
  ds_read_b64_tr_b16 v[54:55], v21 offset:4608
  v_mfma_f32_16x16x32_bf16 v[80:83], v[36:39], a[144:147], v[80:83]
  ds_read_b64_tr_b16 v[56:57], v20 offset:12288
  v_mfma_f32_16x16x32_bf16 v[84:87], v[36:39], a[148:151], v[84:87]
  ds_read_b64_tr_b16 v[58:59], v20 offset:12800
  v_mfma_f32_16x16x32_bf16 v[88:91], v[36:39], a[152:155], v[88:91]
  ds_read_b64_tr_b16 v[60:61], v21 offset:12288
  v_mfma_f32_16x16x32_bf16 v[92:95], v[36:39], a[156:159], v[92:95]
  ds_read_b64_tr_b16 v[62:63], v21 offset:12800
  v_mfma_f32_16x16x32_bf16 v[96:99], v[40:43], a[144:147], v[96:99]
  ds_read_b128 a[168:171], v226 offset:0
  v_mfma_f32_16x16x32_bf16 v[100:103], v[40:43], a[148:151], v[100:103]
  ds_read_b128 a[184:187], v227 offset:0
  v_mfma_f32_16x16x32_bf16 v[104:107], v[40:43], a[152:155], v[104:107]
  s_add_u32 m0, s41, 43008
  v_mfma_f32_16x16x32_bf16 v[108:111], v[40:43], a[156:159], v[108:111]
  s_add_u32 s42, s32, s81
  v_mfma_f32_16x16x32_bf16 v[112:115], v[44:47], a[144:147], v[112:115]
  buffer_load_dwordx4 v14, s[8:11], s42 offen lds
  v_mfma_f32_16x16x32_bf16 v[116:119], v[44:47], a[148:151], v[116:119]
  s_add_u32 m0, s41, 44032
  v_mfma_f32_16x16x32_bf16 v[120:123], v[44:47], a[152:155], v[120:123]
  s_nop 0
  v_mfma_f32_16x16x32_bf16 v[124:127], v[44:47], a[156:159], v[124:127]
  buffer_load_dwordx4 v15, s[8:11], s42 offen lds
  s_waitcnt vmcnt(26) lgkmcnt(0)
  s_barrier
  v_mfma_f32_16x16x32_bf16 v[128:131], v[48:51], a[144:147], v[128:131]
  ds_read_b64_tr_b16 v[32:33], v18 offset:16384
  ds_read_b64_tr_b16 v[34:35], v18 offset:16896
  v_mfma_f32_16x16x32_bf16 v[132:135], v[48:51], a[148:151], v[132:135]
  ds_read_b64_tr_b16 v[36:37], v19 offset:16384
  ds_read_b64_tr_b16 v[38:39], v19 offset:16896
  v_mfma_f32_16x16x32_bf16 v[136:139], v[48:51], a[152:155], v[136:139]
  ds_read_b64_tr_b16 v[40:41], v18 offset:24576
  ds_read_b64_tr_b16 v[42:43], v18 offset:25088
  v_mfma_f32_16x16x32_bf16 v[140:143], v[48:51], a[156:159], v[140:143]
  ds_read_b64_tr_b16 v[44:45], v19 offset:24576
  ds_read_b64_tr_b16 v[46:47], v19 offset:25088
  v_mfma_f32_16x16x32_bf16 v[144:147], v[52:55], a[144:147], v[144:147]
  ds_read_b128 a[172:175], v226 offset:2048
  ds_read_b128 a[188:191], v227 offset:2048
  v_mfma_f32_16x16x32_bf16 v[148:151], v[52:55], a[148:151], v[148:151]
  s_add_u32 m0, s44, 0
  s_add_u32 s42, s33, s81
  v_mfma_f32_16x16x32_bf16 v[152:155], v[52:55], a[152:155], v[152:155]
  buffer_load_dwordx4 v14, s[8:11], s42 offen lds
  s_add_u32 m0, s44, 1024
  v_mfma_f32_16x16x32_bf16 v[156:159], v[52:55], a[156:159], v[156:159]
  s_nop 0
  buffer_load_dwordx4 v15, s[8:11], s42 offen lds
  v_mfma_f32_16x16x32_bf16 v[160:163], v[56:59], a[144:147], v[160:163]
  s_add_u32 m0, s87, 98304
  s_mul_i32 s42, s81, 4608
  v_mfma_f32_16x16x32_bf16 v[164:167], v[56:59], a[148:151], v[164:167]
  s_add_u32 s42, s42, s88
  buffer_load_dwordx4 v16, s[12:15], s42 offen lds
  v_mfma_f32_16x16x32_bf16 v[168:171], v[56:59], a[152:155], v[168:171]
  s_add_u32 m0, s87, 99328
  s_mul_i32 s42, s81, 4608
  v_mfma_f32_16x16x32_bf16 v[172:175], v[56:59], a[156:159], v[172:175]
  s_add_u32 s42, s42, s89
  buffer_load_dwordx4 v17, s[12:15], s42 offen lds
  v_mfma_f32_16x16x32_bf16 v[176:179], v[60:63], a[144:147], v[176:179]
  s_add_u32 m0, s87, 106496
  s_mul_i32 s42, s81, 4608
  v_mfma_f32_16x16x32_bf16 v[180:183], v[60:63], a[148:151], v[180:183]
  s_add_u32 s42, s42, s88
  buffer_load_dwordx4 v16, s[16:19], s42 offen lds
  v_mfma_f32_16x16x32_bf16 v[184:187], v[60:63], a[152:155], v[184:187]
  s_add_u32 m0, s87, 107520
  s_mul_i32 s42, s81, 4608
  v_mfma_f32_16x16x32_bf16 v[188:191], v[60:63], a[156:159], v[188:191]
  s_add_u32 s42, s42, s89
  buffer_load_dwordx4 v17, s[16:19], s42 offen lds
  s_waitcnt vmcnt(30) lgkmcnt(0)
  v_mfma_f32_16x16x32_bf16 v[64:67], v[32:35], a[160:163], v[64:67]
  ds_read_b64_tr_b16 v[48:49], v20 offset:16384
  v_mfma_f32_16x16x32_bf16 v[68:71], v[32:35], a[164:167], v[68:71]
  ds_read_b64_tr_b16 v[50:51], v20 offset:16896
  v_mfma_f32_16x16x32_bf16 v[72:75], v[32:35], a[168:171], v[72:75]
  ds_read_b64_tr_b16 v[52:53], v21 offset:16384
  v_mfma_f32_16x16x32_bf16 v[76:79], v[32:35], a[172:175], v[76:79]
  ds_read_b64_tr_b16 v[54:55], v21 offset:16896
  v_mfma_f32_16x16x32_bf16 v[80:83], v[36:39], a[160:163], v[80:83]
  ds_read_b64_tr_b16 v[56:57], v20 offset:24576
  v_mfma_f32_16x16x32_bf16 v[84:87], v[36:39], a[164:167], v[84:87]
  ds_read_b64_tr_b16 v[58:59], v20 offset:25088
  v_mfma_f32_16x16x32_bf16 v[88:91], v[36:39], a[168:171], v[88:91]
  ds_read_b64_tr_b16 v[60:61], v21 offset:24576
  v_mfma_f32_16x16x32_bf16 v[92:95], v[36:39], a[172:175], v[92:95]
  ds_read_b64_tr_b16 v[62:63], v21 offset:25088
  v_mfma_f32_16x16x32_bf16 v[96:99], v[40:43], a[160:163], v[96:99]
  ds_read_b128 a[192:195], v226 offset:4096
  v_mfma_f32_16x16x32_bf16 v[100:103], v[40:43], a[164:167], v[100:103]
  ds_read_b128 a[208:211], v227 offset:4096
  v_mfma_f32_16x16x32_bf16 v[104:107], v[40:43], a[168:171], v[104:107]
  s_add_u32 m0, s44, 2048
  v_mfma_f32_16x16x32_bf16 v[108:111], v[40:43], a[172:175], v[108:111]
  s_add_u32 s42, s34, s81
  v_mfma_f32_16x16x32_bf16 v[112:115], v[44:47], a[160:163], v[112:115]
  buffer_load_dwordx4 v14, s[8:11], s42 offen lds
  v_mfma_f32_16x16x32_bf16 v[116:119], v[44:47], a[164:167], v[116:119]
  s_add_u32 m0, s44, 3072
  v_mfma_f32_16x16x32_bf16 v[120:123], v[44:47], a[168:171], v[120:123]
  s_nop 0
  v_mfma_f32_16x16x32_bf16 v[124:127], v[44:47], a[172:175], v[124:127]
  buffer_load_dwordx4 v15, s[8:11], s42 offen lds
  s_waitcnt vmcnt(30) lgkmcnt(0)
  v_mfma_f32_16x16x32_bf16 v[128:131], v[48:51], a[160:163], v[128:131]
  ds_read_b64_tr_b16 v[32:33], v18 offset:20480
  ds_read_b64_tr_b16 v[34:35], v18 offset:20992
  v_mfma_f32_16x16x32_bf16 v[132:135], v[48:51], a[164:167], v[132:135]
  ds_read_b64_tr_b16 v[36:37], v19 offset:20480
  ds_read_b64_tr_b16 v[38:39], v19 offset:20992
  v_mfma_f32_16x16x32_bf16 v[136:139], v[48:51], a[168:171], v[136:139]
  ds_read_b64_tr_b16 v[40:41], v18 offset:28672
  ds_read_b64_tr_b16 v[42:43], v18 offset:29184
  v_mfma_f32_16x16x32_bf16 v[140:143], v[48:51], a[172:175], v[140:143]
  ds_read_b64_tr_b16 v[44:45], v19 offset:28672
  ds_read_b64_tr_b16 v[46:47], v19 offset:29184
  v_mfma_f32_16x16x32_bf16 v[144:147], v[52:55], a[160:163], v[144:147]
  ds_read_b128 a[196:199], v224 offset:0
  ds_read_b128 a[212:215], v225 offset:0
  v_mfma_f32_16x16x32_bf16 v[148:151], v[52:55], a[164:167], v[148:151]
  s_add_u32 m0, s44, 4096
  s_add_u32 s42, s35, s81
  v_mfma_f32_16x16x32_bf16 v[152:155], v[52:55], a[168:171], v[152:155]
  buffer_load_dwordx4 v14, s[8:11], s42 offen lds
  s_add_u32 m0, s44, 5120
  v_mfma_f32_16x16x32_bf16 v[156:159], v[52:55], a[172:175], v[156:159]
  s_nop 0
  buffer_load_dwordx4 v15, s[8:11], s42 offen lds
  v_mfma_f32_16x16x32_bf16 v[160:163], v[56:59], a[160:163], v[160:163]
  s_add_u32 m0, s41, 8192
  s_add_u32 s42, s45, s46
  v_mfma_f32_16x16x32_bf16 v[164:167], v[56:59], a[164:167], v[164:167]
  buffer_load_dwordx4 v10, s[12:15], s42 offen lds
  s_add_u32 m0, s41, 45056
  v_mfma_f32_16x16x32_bf16 v[168:171], v[56:59], a[168:171], v[168:171]
  s_nop 0
  buffer_load_dwordx4 v10, s[16:19], s42 offen lds
  v_mfma_f32_16x16x32_bf16 v[172:175], v[56:59], a[172:175], v[172:175]
  v_mfma_f32_16x16x32_bf16 v[176:179], v[60:63], a[160:163], v[176:179]
  v_mfma_f32_16x16x32_bf16 v[180:183], v[60:63], a[164:167], v[180:183]
  v_mfma_f32_16x16x32_bf16 v[184:187], v[60:63], a[168:171], v[184:187]
  v_mfma_f32_16x16x32_bf16 v[188:191], v[60:63], a[172:175], v[188:191]
  s_waitcnt vmcnt(28) lgkmcnt(0)
  v_mfma_f32_16x16x32_bf16 v[64:67], v[32:35], a[176:179], v[64:67]
  ds_read_b64_tr_b16 v[48:49], v20 offset:20480
  ds_read_b64_tr_b16 v[50:51], v20 offset:20992
  v_mfma_f32_16x16x32_bf16 v[68:71], v[32:35], a[180:183], v[68:71]
  ds_read_b64_tr_b16 v[52:53], v21 offset:20480
  ds_read_b64_tr_b16 v[54:55], v21 offset:20992
  v_mfma_f32_16x16x32_bf16 v[72:75], v[32:35], a[184:187], v[72:75]
  ds_read_b64_tr_b16 v[56:57], v20 offset:28672
  ds_read_b64_tr_b16 v[58:59], v20 offset:29184
  v_mfma_f32_16x16x32_bf16 v[76:79], v[32:35], a[188:191], v[76:79]
  ds_read_b64_tr_b16 v[60:61], v21 offset:28672
  ds_read_b64_tr_b16 v[62:63], v21 offset:29184
  v_mfma_f32_16x16x32_bf16 v[80:83], v[36:39], a[176:179], v[80:83]
  ds_read_b128 a[200:203], v224 offset:2048
  ds_read_b128 a[216:219], v225 offset:2048
  v_mfma_f32_16x16x32_bf16 v[84:87], v[36:39], a[180:183], v[84:87]
  s_and_b32 s91, s28, 1
  s_mul_i32 s91, s91, 36
  v_mfma_f32_16x16x32_bf16 v[88:91], v[36:39], a[184:187], v[88:91]
  s_mul_i32 s69, s26, 72
  s_add_u32 s91, s91, s69
  v_mfma_f32_16x16x32_bf16 v[92:95], v[36:39], a[188:191], v[92:95]
  s_mul_i32 s91, s91, 9216
  s_mul_i32 s69, s27, 384
  v_mfma_f32_16x16x32_bf16 v[96:99], v[40:43], a[176:179], v[96:99]
  s_add_u32 s91, s91, s69
  s_add_u32 s91, s91, 128
  v_mfma_f32_16x16x32_bf16 v[100:103], v[40:43], a[180:183], v[100:103]
  s_lshr_b32 s69, s28, 1
  s_cmp_eq_u32 s69, 0
  v_mfma_f32_16x16x32_bf16 v[104:107], v[40:43], a[184:187], v[104:107]
  s_cselect_b32 s96, s12, s16
  s_cselect_b32 s97, s13, s17
  v_mfma_f32_16x16x32_bf16 v[108:111], v[40:43], a[188:191], v[108:111]
  s_cselect_b32 s98, s14, s18
  s_cselect_b32 s99, s15, s19
  v_mfma_f32_16x16x32_bf16 v[112:115], v[44:47], a[176:179], v[112:115]
  v_and_b32 v253, 63, v0
  v_mul_u32_u24 v252, 9216, v253
  v_mfma_f32_16x16x32_bf16 v[116:119], v[44:47], a[180:183], v[116:119]
  v_mov_b32 v235, 0x7f000000
  v_cmp_gt_u32 vcc, 36, v253
  v_mfma_f32_16x16x32_bf16 v[120:123], v[44:47], a[184:187], v[120:123]
  s_nop 1
  v_cndmask_b32 v252, v235, v252, vcc
  v_mfma_f32_16x16x32_bf16 v[124:127], v[44:47], a[188:191], v[124:127]
  buffer_load_dword v250, v252, s[96:99], s91 offen
  s_waitcnt vmcnt(27) lgkmcnt(0)
  s_barrier
  v_mfma_f32_16x16x32_bf16 v[128:131], v[48:51], a[176:179], v[128:131]
  ds_read_b64_tr_b16 v[32:33], v18 offset:32768
  v_mfma_f32_16x16x32_bf16 v[132:135], v[48:51], a[180:183], v[132:135]
  ds_read_b64_tr_b16 v[34:35], v18 offset:33280
  v_mfma_f32_16x16x32_bf16 v[136:139], v[48:51], a[184:187], v[136:139]
  ds_read_b64_tr_b16 v[36:37], v19 offset:32768
  v_mfma_f32_16x16x32_bf16 v[140:143], v[48:51], a[188:191], v[140:143]
  ds_read_b64_tr_b16 v[38:39], v19 offset:33280
  v_mfma_f32_16x16x32_bf16 v[144:147], v[52:55], a[176:179], v[144:147]
  ds_read_b64_tr_b16 v[40:41], v18 offset:40960
  v_mfma_f32_16x16x32_bf16 v[148:151], v[52:55], a[180:183], v[148:151]
  ds_read_b64_tr_b16 v[42:43], v18 offset:41472
  v_mfma_f32_16x16x32_bf16 v[152:155], v[52:55], a[184:187], v[152:155]
  ds_read_b64_tr_b16 v[44:45], v19 offset:40960
  v_mfma_f32_16x16x32_bf16 v[156:159], v[52:55], a[188:191], v[156:159]
  ds_read_b64_tr_b16 v[46:47], v19 offset:41472
  v_mfma_f32_16x16x32_bf16 v[160:163], v[56:59], a[176:179], v[160:163]
  ds_read_b128 a[204:207], v224 offset:4096
  v_mfma_f32_16x16x32_bf16 v[164:167], v[56:59], a[180:183], v[164:167]
  ds_read_b128 a[220:223], v225 offset:4096
  v_mfma_f32_16x16x32_bf16 v[168:171], v[56:59], a[184:187], v[168:171]
  v_mov_b32 v234, 0
  v_mfma_f32_16x16x32_bf16 v[172:175], v[56:59], a[188:191], v[172:175]
  global_load_dword v251, v234, s[70:71] sc1
  v_mfma_f32_16x16x32_bf16 v[176:179], v[60:63], a[176:179], v[176:179]
  s_and_b32 s75, s28, 1
  v_mfma_f32_16x16x32_bf16 v[180:183], v[60:63], a[180:183], v[180:183]
  s_mul_i32 s75, s75, 36
  v_mfma_f32_16x16x32_bf16 v[184:187], v[60:63], a[184:187], v[184:187]
  s_mul_i32 s76, s26, 72
  v_mfma_f32_16x16x32_bf16 v[188:191], v[60:63], a[188:191], v[188:191]
  s_waitcnt vmcnt(25) lgkmcnt(0)
  v_mfma_f32_16x16x32_bf16 v[64:67], v[32:35], a[192:195], v[64:67]
  ds_read_b64_tr_b16 v[48:49], v20 offset:32768
  v_mfma_f32_16x16x32_bf16 v[68:71], v[32:35], a[196:199], v[68:71]
  ds_read_b64_tr_b16 v[50:51], v20 offset:33280
  v_mfma_f32_16x16x32_bf16 v[72:75], v[32:35], a[200:203], v[72:75]
  ds_read_b64_tr_b16 v[52:53], v21 offset:32768
  v_mfma_f32_16x16x32_bf16 v[76:79], v[32:35], a[204:207], v[76:79]
  ds_read_b64_tr_b16 v[54:55], v21 offset:33280
  v_mfma_f32_16x16x32_bf16 v[80:83], v[36:39], a[192:195], v[80:83]
  ds_read_b64_tr_b16 v[56:57], v20 offset:40960
  v_mfma_f32_16x16x32_bf16 v[84:87], v[36:39], a[196:199], v[84:87]
  ds_read_b64_tr_b16 v[58:59], v20 offset:41472
  v_mfma_f32_16x16x32_bf16 v[88:91], v[36:39], a[200:203], v[88:91]
  ds_read_b64_tr_b16 v[60:61], v21 offset:40960
  v_mfma_f32_16x16x32_bf16 v[92:95], v[36:39], a[204:207], v[92:95]
  ds_read_b64_tr_b16 v[62:63], v21 offset:41472
  v_mfma_f32_16x16x32_bf16 v[96:99], v[40:43], a[192:195], v[96:99]
  ds_read_b128 a[224:227], v224 offset:6144
  v_mfma_f32_16x16x32_bf16 v[100:103], v[40:43], a[196:199], v[100:103]
  ds_read_b128 a[240:243], v225 offset:6144
  v_mfma_f32_16x16x32_bf16 v[104:107], v[40:43], a[200:203], v[104:107]
  s_add_u32 s75, s75, s76
  v_mfma_f32_16x16x32_bf16 v[108:111], v[40:43], a[204:207], v[108:111]
  s_mul_i32 s75, s75, 9216
  v_mfma_f32_16x16x32_bf16 v[112:115], v[44:47], a[192:195], v[112:115]
  s_mul_i32 s76, s27, 384
  v_mfma_f32_16x16x32_bf16 v[116:119], v[44:47], a[196:199], v[116:119]
  s_add_u32 s75, s75, s76
  v_mfma_f32_16x16x32_bf16 v[120:123], v[44:47], a[200:203], v[120:123]
  s_add_u32 s75, s75, 256
  v_mfma_f32_16x16x32_bf16 v[124:127], v[44:47], a[204:207], v[124:127]
  s_waitcnt vmcnt(23) lgkmcnt(0)
  v_mfma_f32_16x16x32_bf16 v[128:131], v[48:51], a[192:195], v[128:131]
  ds_read_b64_tr_b16 v[32:33], v18 offset:36864
  ds_read_b64_tr_b16 v[34:35], v18 offset:37376
  v_mfma_f32_16x16x32_bf16 v[132:135], v[48:51], a[196:199], v[132:135]
  ds_read_b64_tr_b16 v[36:37], v19 offset:36864
  ds_read_b64_tr_b16 v[38:39], v19 offset:37376
  v_mfma_f32_16x16x32_bf16 v[136:139], v[48:51], a[200:203], v[136:139]
  ds_read_b64_tr_b16 v[40:41], v18 offset:45056
  ds_read_b64_tr_b16 v[42:43], v18 offset:45568
  v_mfma_f32_16x16x32_bf16 v[140:143], v[48:51], a[204:207], v[140:143]
  ds_read_b64_tr_b16 v[44:45], v19 offset:45056
  ds_read_b64_tr_b16 v[46:47], v19 offset:45568
  v_mfma_f32_16x16x32_bf16 v[144:147], v[52:55], a[192:195], v[144:147]
  ds_read_b128 a[228:231], v224 offset:36864
  ds_read_b128 a[244:247], v225 offset:36864
  v_mfma_f32_16x16x32_bf16 v[148:151], v[52:55], a[196:199], v[148:151]
  s_lshr_b32 s76, s28, 1
  s_cmp_eq_u32 s76, 0
  v_mfma_f32_16x16x32_bf16 v[152:155], v[52:55], a[200:203], v[152:155]
  s_cselect_b32 s76, s12, s16
  s_cselect_b32 s77, s13, s17
  v_mfma_f32_16x16x32_bf16 v[156:159], v[52:55], a[204:207], v[156:159]
  s_cselect_b32 s78, s14, s18
  s_cselect_b32 s79, s15, s19
  v_mfma_f32_16x16x32_bf16 v[160:163], v[56:59], a[192:195], v[160:163]
  v_and_b32 v253, 63, v0
  v_mul_u32_u24 v252, 9216, v253
  v_mfma_f32_16x16x32_bf16 v[164:167], v[56:59], a[196:199], v[164:167]
  v_mfma_f32_16x16x32_bf16 v[168:171], v[56:59], a[200:203], v[168:171]
  v_mfma_f32_16x16x32_bf16 v[172:175], v[56:59], a[204:207], v[172:175]
  v_mfma_f32_16x16x32_bf16 v[176:179], v[60:63], a[192:195], v[176:179]
  v_mfma_f32_16x16x32_bf16 v[180:183], v[60:63], a[196:199], v[180:183]
  v_mfma_f32_16x16x32_bf16 v[184:187], v[60:63], a[200:203], v[184:187]
  v_mfma_f32_16x16x32_bf16 v[188:191], v[60:63], a[204:207], v[188:191]
  s_waitcnt vmcnt(17) lgkmcnt(0)
  v_mfma_f32_16x16x32_bf16 v[64:67], v[32:35], a[208:211], v[64:67]
  ds_read_b64_tr_b16 v[48:49], v20 offset:36864
  ds_read_b64_tr_b16 v[50:51], v20 offset:37376
  v_mfma_f32_16x16x32_bf16 v[68:71], v[32:35], a[212:215], v[68:71]
  ds_read_b64_tr_b16 v[52:53], v21 offset:36864
  ds_read_b64_tr_b16 v[54:55], v21 offset:37376
  v_mfma_f32_16x16x32_bf16 v[72:75], v[32:35], a[216:219], v[72:75]
  ds_read_b64_tr_b16 v[56:57], v20 offset:45056
  ds_read_b64_tr_b16 v[58:59], v20 offset:45568
  v_mfma_f32_16x16x32_bf16 v[76:79], v[32:35], a[220:223], v[76:79]
  ds_read_b64_tr_b16 v[60:61], v21 offset:45056
  ds_read_b64_tr_b16 v[62:63], v21 offset:45568
  v_mfma_f32_16x16x32_bf16 v[80:83], v[36:39], a[208:211], v[80:83]
  ds_read_b128 a[232:235], v224 offset:38912
  ds_read_b128 a[248:251], v225 offset:38912
  v_mfma_f32_16x16x32_bf16 v[84:87], v[36:39], a[212:215], v[84:87]
  s_add_u32 m0, s41, 0
  s_add_u32 s42, s3, s46
  v_mfma_f32_16x16x32_bf16 v[88:91], v[36:39], a[216:219], v[88:91]
  buffer_load_dwordx4 v10, s[12:15], s42 offen lds
  s_add_u32 m0, s41, 36864
  v_mfma_f32_16x16x32_bf16 v[92:95], v[36:39], a[220:223], v[92:95]
  s_nop 0
  buffer_load_dwordx4 v10, s[16:19], s42 offen lds
  v_mfma_f32_16x16x32_bf16 v[96:99], v[40:43], a[208:211], v[96:99]
  s_add_u32 m0, s41, 1024
  s_add_u32 s42, s4, s46
  v_mfma_f32_16x16x32_bf16 v[100:103], v[40:43], a[212:215], v[100:103]
  buffer_load_dwordx4 v10, s[12:15], s42 offen lds
  s_add_u32 m0, s41, 37888
  v_mfma_f32_16x16x32_bf16 v[104:107], v[40:43], a[216:219], v[104:107]
  s_nop 0
  buffer_load_dwordx4 v10, s[16:19], s42 offen lds
  v_mfma_f32_16x16x32_bf16 v[108:111], v[40:43], a[220:223], v[108:111]
  v_mov_b32 v235, 0x7f000000
  v_cmp_gt_u32 vcc, 36, v253
  v_mfma_f32_16x16x32_bf16 v[112:115], v[44:47], a[208:211], v[112:115]
  s_nop 1
  v_cndmask_b32 v252, v235, v252, vcc
  v_mfma_f32_16x16x32_bf16 v[116:119], v[44:47], a[212:215], v[116:119]
  s_mul_i32 s88, s24, 6
  s_lshr_b32 s69, s25, 2
  v_mfma_f32_16x16x32_bf16 v[120:123], v[44:47], a[216:219], v[120:123]
  v_mfma_f32_16x16x32_bf16 v[124:127], v[44:47], a[220:223], v[124:127]
  s_waitcnt vmcnt(19) lgkmcnt(0)
  s_barrier
  v_mfma_f32_16x16x32_bf16 v[128:131], v[48:51], a[208:211], v[128:131]
  ds_read_b64_tr_b16 v[32:33], v18 offset:49152
  ds_read_b64_tr_b16 v[34:35], v18 offset:49664
  v_mfma_f32_16x16x32_bf16 v[132:135], v[48:51], a[212:215], v[132:135]
  ds_read_b64_tr_b16 v[36:37], v19 offset:49152
  ds_read_b64_tr_b16 v[38:39], v19 offset:49664
  v_mfma_f32_16x16x32_bf16 v[136:139], v[48:51], a[216:219], v[136:139]
  ds_read_b64_tr_b16 v[40:41], v18 offset:57344
  ds_read_b64_tr_b16 v[42:43], v18 offset:57856
  v_mfma_f32_16x16x32_bf16 v[140:143], v[48:51], a[220:223], v[140:143]
  ds_read_b64_tr_b16 v[44:45], v19 offset:57344
  ds_read_b64_tr_b16 v[46:47], v19 offset:57856
  v_mfma_f32_16x16x32_bf16 v[144:147], v[52:55], a[208:211], v[144:147]
  ds_read_b128 a[236:239], v224 offset:40960
  ds_read_b128 a[252:255], v225 offset:40960
  v_mfma_f32_16x16x32_bf16 v[148:151], v[52:55], a[212:215], v[148:151]
  s_add_u32 m0, s41, 2048
  s_add_u32 s42, s5, s46
  v_mfma_f32_16x16x32_bf16 v[152:155], v[52:55], a[216:219], v[152:155]
  buffer_load_dwordx4 v10, s[12:15], s42 offen lds
  s_add_u32 m0, s41, 38912
  v_mfma_f32_16x16x32_bf16 v[156:159], v[52:55], a[220:223], v[156:159]
  s_nop 0
  buffer_load_dwordx4 v10, s[16:19], s42 offen lds
  v_mfma_f32_16x16x32_bf16 v[160:163], v[56:59], a[208:211], v[160:163]
  s_add_u32 m0, s41, 3072
  s_add_u32 s42, s6, s46
  v_mfma_f32_16x16x32_bf16 v[164:167], v[56:59], a[212:215], v[164:167]
  buffer_load_dwordx4 v10, s[12:15], s42 offen lds
  s_add_u32 m0, s41, 39936
  v_mfma_f32_16x16x32_bf16 v[168:171], v[56:59], a[216:219], v[168:171]
  s_nop 0
  buffer_load_dwordx4 v10, s[16:19], s42 offen lds
  v_mfma_f32_16x16x32_bf16 v[172:175], v[56:59], a[220:223], v[172:175]
  s_add_u32 s88, s88, s69
  s_lshr_b32 s88, s88, 3
  v_mfma_f32_16x16x32_bf16 v[176:179], v[60:63], a[208:211], v[176:179]
  s_mul_i32 s88, s88, 768
  s_lshl_b32 s69, s69, 7
  v_mfma_f32_16x16x32_bf16 v[180:183], v[60:63], a[212:215], v[180:183]
  v_mfma_f32_16x16x32_bf16 v[184:187], v[60:63], a[216:219], v[184:187]
  v_mfma_f32_16x16x32_bf16 v[188:191], v[60:63], a[220:223], v[188:191]
  s_waitcnt vmcnt(21) lgkmcnt(0)
  v_mfma_f32_16x16x32_bf16 v[64:67], v[32:35], a[224:227], v[64:67]
  ds_read_b64_tr_b16 v[48:49], v20 offset:49152
  ds_read_b64_tr_b16 v[50:51], v20 offset:49664
  v_mfma_f32_16x16x32_bf16 v[68:71], v[32:35], a[228:231], v[68:71]
  ds_read_b64_tr_b16 v[52:53], v21 offset:49152
  ds_read_b64_tr_b16 v[54:55], v21 offset:49664
  v_mfma_f32_16x16x32_bf16 v[72:75], v[32:35], a[232:235], v[72:75]
  ds_read_b64_tr_b16 v[56:57], v20 offset:57344
  ds_read_b64_tr_b16 v[58:59], v20 offset:57856
  v_mfma_f32_16x16x32_bf16 v[76:79], v[32:35], a[236:239], v[76:79]
  ds_read_b64_tr_b16 v[60:61], v21 offset:57344
  ds_read_b64_tr_b16 v[62:63], v21 offset:57856
  v_mfma_f32_16x16x32_bf16 v[80:83], v[36:39], a[224:227], v[80:83]
  ds_read_b128 v[192:195], v224 offset:43008
  ds_read_b128 v[208:211], v225 offset:43008
  v_mfma_f32_16x16x32_bf16 v[84:87], v[36:39], a[228:231], v[84:87]
  s_add_u32 m0, s41, 4096
  s_add_u32 s42, s7, s46
  v_mfma_f32_16x16x32_bf16 v[88:91], v[36:39], a[232:235], v[88:91]
  buffer_load_dwordx4 v10, s[12:15], s42 offen lds
  s_add_u32 m0, s41, 40960
  v_mfma_f32_16x16x32_bf16 v[92:95], v[36:39], a[236:239], v[92:95]
  s_nop 0
  buffer_load_dwordx4 v10, s[16:19], s42 offen lds
  v_mfma_f32_16x16x32_bf16 v[96:99], v[40:43], a[224:227], v[96:99]
  s_add_u32 m0, s41, 5120
  s_add_u32 s42, s29, s46
  v_mfma_f32_16x16x32_bf16 v[100:103], v[40:43], a[228:231], v[100:103]
  buffer_load_dwordx4 v10, s[12:15], s42 offen lds
  s_add_u32 m0, s41, 41984
  v_mfma_f32_16x16x32_bf16 v[104:107], v[40:43], a[232:235], v[104:107]
  s_nop 0
  buffer_load_dwordx4 v10, s[16:19], s42 offen lds
  v_mfma_f32_16x16x32_bf16 v[108:111], v[40:43], a[236:239], v[108:111]
  s_add_u32 s88, s88, s69
  s_lshl_b32 s69, s28, 5
  v_mfma_f32_16x16x32_bf16 v[112:115], v[44:47], a[224:227], v[112:115]
  s_add_u32 s88, s88, s69
  s_mul_i32 s88, s88, 1152
  v_mfma_f32_16x16x32_bf16 v[116:119], v[44:47], a[228:231], v[116:119]
  v_mfma_f32_16x16x32_bf16 v[120:123], v[44:47], a[232:235], v[120:123]
  v_mfma_f32_16x16x32_bf16 v[124:127], v[44:47], a[236:239], v[124:127]
  s_waitcnt vmcnt(23) lgkmcnt(0)
  v_mfma_f32_16x16x32_bf16 v[128:131], v[48:51], a[224:227], v[128:131]
  ds_read_b64_tr_b16 v[32:33], v18 offset:53248
  ds_read_b64_tr_b16 v[34:35], v18 offset:53760
  v_mfma_f32_16x16x32_bf16 v[132:135], v[48:51], a[228:231], v[132:135]
  ds_read_b64_tr_b16 v[36:37], v19 offset:53248
  ds_read_b64_tr_b16 v[38:39], v19 offset:53760
  v_mfma_f32_16x16x32_bf16 v[136:139], v[48:51], a[232:235], v[136:139]
  ds_read_b64_tr_b16 v[40:41], v18 offset:61440
  ds_read_b64_tr_b16 v[42:43], v18 offset:61952
  v_mfma_f32_16x16x32_bf16 v[140:143], v[48:51], a[236:239], v[140:143]
  ds_read_b64_tr_b16 v[44:45], v19 offset:61440
  ds_read_b64_tr_b16 v[46:47], v19 offset:61952
  v_mfma_f32_16x16x32_bf16 v[144:147], v[52:55], a[224:227], v[144:147]
  ds_read_b128 v[196:199], v226 offset:0
  ds_read_b128 v[212:215], v227 offset:0
  v_mfma_f32_16x16x32_bf16 v[148:151], v[52:55], a[228:231], v[148:151]
  s_add_u32 m0, s41, 6144
  s_add_u32 s42, s30, s46
  v_mfma_f32_16x16x32_bf16 v[152:155], v[52:55], a[232:235], v[152:155]
  buffer_load_dwordx4 v10, s[12:15], s42 offen lds
  s_add_u32 m0, s41, 43008
  v_mfma_f32_16x16x32_bf16 v[156:159], v[52:55], a[236:239], v[156:159]
  s_nop 0
  buffer_load_dwordx4 v10, s[16:19], s42 offen lds
  v_mfma_f32_16x16x32_bf16 v[160:163], v[56:59], a[224:227], v[160:163]
  s_add_u32 m0, s41, 7168
  s_add_u32 s42, s31, s46
  v_mfma_f32_16x16x32_bf16 v[164:167], v[56:59], a[228:231], v[164:167]
  buffer_load_dwordx4 v10, s[12:15], s42 offen lds
  s_add_u32 m0, s41, 44032
  v_mfma_f32_16x16x32_bf16 v[168:171], v[56:59], a[232:235], v[168:171]
  s_nop 0
  buffer_load_dwordx4 v10, s[16:19], s42 offen lds
  v_mfma_f32_16x16x32_bf16 v[172:175], v[56:59], a[236:239], v[172:175]
  s_and_b32 s69, s25, 3
  s_mul_i32 s69, s69, 288
  v_mfma_f32_16x16x32_bf16 v[176:179], v[60:63], a[224:227], v[176:179]
  s_add_u32 s88, s88, s69
  v_lshrrev_b32 v235, 2, v253
  v_mfma_f32_16x16x32_bf16 v[180:183], v[60:63], a[228:231], v[180:183]
  v_mfma_f32_16x16x32_bf16 v[184:187], v[60:63], a[232:235], v[184:187]
  v_mfma_f32_16x16x32_bf16 v[188:191], v[60:63], a[236:239], v[188:191]
  s_waitcnt vmcnt(21) lgkmcnt(0)
  v_mfma_f32_16x16x32_bf16 v[64:67], v[32:35], a[240:243], v[64:67]
  ds_read_b64_tr_b16 v[48:49], v20 offset:53248
  v_mfma_f32_16x16x32_bf16 v[68:71], v[32:35], a[244:247], v[68:71]
  ds_read_b64_tr_b16 v[50:51], v20 offset:53760
  v_mfma_f32_16x16x32_bf16 v[72:75], v[32:35], a[248:251], v[72:75]
  ds_read_b64_tr_b16 v[52:53], v21 offset:53248
  v_mfma_f32_16x16x32_bf16 v[76:79], v[32:35], a[252:255], v[76:79]
  ds_read_b64_tr_b16 v[54:55], v21 offset:53760
  v_mfma_f32_16x16x32_bf16 v[80:83], v[36:39], a[240:243], v[80:83]
  ds_read_b64_tr_b16 v[56:57], v20 offset:61440
  v_mfma_f32_16x16x32_bf16 v[84:87], v[36:39], a[244:247], v[84:87]
  ds_read_b64_tr_b16 v[58:59], v20 offset:61952
  v_mfma_f32_16x16x32_bf16 v[88:91], v[36:39], a[248:251], v[88:91]
  ds_read_b64_tr_b16 v[60:61], v21 offset:61440
  v_mfma_f32_16x16x32_bf16 v[92:95], v[36:39], a[252:255], v[92:95]
  ds_read_b64_tr_b16 v[62:63], v21 offset:61952
  v_mfma_f32_16x16x32_bf16 v[96:99], v[40:43], a[240:243], v[96:99]
  ds_read_b128 v[200:203], v226 offset:2048
  v_mfma_f32_16x16x32_bf16 v[100:103], v[40:43], a[244:247], v[100:103]
  ds_read_b128 v[216:219], v227 offset:2048
  v_mfma_f32_16x16x32_bf16 v[104:107], v[40:43], a[248:251], v[104:107]
  v_mul_u32_u24 v235, 1152, v235
  v_mfma_f32_16x16x32_bf16 v[108:111], v[40:43], a[252:255], v[108:111]
  v_and_b32 v253, 3, v253
  v_mfma_f32_16x16x32_bf16 v[112:115], v[44:47], a[240:243], v[112:115]
  v_mul_u32_u24 v253, 96, v253
  v_mfma_f32_16x16x32_bf16 v[116:119], v[44:47], a[244:247], v[116:119]
  v_add_u32 v253, v253, v235
  v_mfma_f32_16x16x32_bf16 v[120:123], v[44:47], a[248:251], v[120:123]
  v_mfma_f32_16x16x32_bf16 v[124:127], v[44:47], a[252:255], v[124:127]
  s_waitcnt vmcnt(19) lgkmcnt(0)
  s_barrier
  v_mfma_f32_16x16x32_bf16 v[128:131], v[48:51], a[240:243], v[128:131]
  ds_read_b64_tr_b16 v[32:33], v18 offset:0
  v_mfma_f32_16x16x32_bf16 v[132:135], v[48:51], a[244:247], v[132:135]
  ds_read_b64_tr_b16 v[34:35], v18 offset:512
  v_mfma_f32_16x16x32_bf16 v[136:139], v[48:51], a[248:251], v[136:139]
  ds_read_b64_tr_b16 v[36:37], v19 offset:0
  v_mfma_f32_16x16x32_bf16 v[140:143], v[48:51], a[252:255], v[140:143]
  ds_read_b64_tr_b16 v[38:39], v19 offset:512
  v_mfma_f32_16x16x32_bf16 v[144:147], v[52:55], a[240:243], v[144:147]
  ds_read_b64_tr_b16 v[40:41], v18 offset:8192
  v_mfma_f32_16x16x32_bf16 v[148:151], v[52:55], a[244:247], v[148:151]
  ds_read_b64_tr_b16 v[42:43], v18 offset:8704
  v_mfma_f32_16x16x32_bf16 v[152:155], v[52:55], a[248:251], v[152:155]
  ds_read_b64_tr_b16 v[44:45], v19 offset:8192
  v_mfma_f32_16x16x32_bf16 v[156:159], v[52:55], a[252:255], v[156:159]
  ds_read_b64_tr_b16 v[46:47], v19 offset:8704
  v_mfma_f32_16x16x32_bf16 v[160:163], v[56:59], a[240:243], v[160:163]
  ds_read_b128 v[204:207], v226 offset:4096
  v_mfma_f32_16x16x32_bf16 v[164:167], v[56:59], a[244:247], v[164:167]
  ds_read_b128 v[220:223], v227 offset:4096
  v_mfma_f32_16x16x32_bf16 v[168:171], v[56:59], a[248:251], v[168:171]
  v_mfma_f32_16x16x32_bf16 v[172:175], v[56:59], a[252:255], v[172:175]
  v_mfma_f32_16x16x32_bf16 v[176:179], v[60:63], a[240:243], v[176:179]
  v_mfma_f32_16x16x32_bf16 v[180:183], v[60:63], a[244:247], v[180:183]
  v_mfma_f32_16x16x32_bf16 v[184:187], v[60:63], a[248:251], v[184:187]
  v_mfma_f32_16x16x32_bf16 v[188:191], v[60:63], a[252:255], v[188:191]
  s_waitcnt lgkmcnt(0)
  v_mfma_f32_16x16x32_bf16 v[64:67], v[32:35], v[192:195], v[64:67]
  ds_read_b64_tr_b16 v[48:49], v20 offset:0
  ds_read_b64_tr_b16 v[50:51], v20 offset:512
  v_mfma_f32_16x16x32_bf16 v[68:71], v[32:35], v[196:199], v[68:71]
  ds_read_b64_tr_b16 v[52:53], v21 offset:0
  ds_read_b64_tr_b16 v[54:55], v21 offset:512
  v_mfma_f32_16x16x32_bf16 v[72:75], v[32:35], v[200:203], v[72:75]
  ds_read_b64_tr_b16 v[56:57], v20 offset:8192
  ds_read_b64_tr_b16 v[58:59], v20 offset:8704
  v_mfma_f32_16x16x32_bf16 v[76:79], v[32:35], v[204:207], v[76:79]
  ds_read_b64_tr_b16 v[60:61], v21 offset:8192
  ds_read_b64_tr_b16 v[62:63], v21 offset:8704
  v_mfma_f32_16x16x32_bf16 v[80:83], v[36:39], v[192:195], v[80:83]
  s_mul_i32 s42, s28, 9
  s_add_u32 s42, s42, 36
  v_mfma_f32_16x16x32_bf16 v[84:87], v[36:39], v[196:199], v[84:87]
  s_lshl_b32 s40, s47, 2
  s_sub_u32 s42, s42, s40
  v_mfma_f32_16x16x32_bf16 v[88:91], v[36:39], v[200:203], v[88:91]
  s_cmp_ge_u32 s42, 36
  s_cselect_b32 s3, 36, 0
  v_mfma_f32_16x16x32_bf16 v[92:95], v[36:39], v[204:207], v[92:95]
  s_sub_u32 s3, s42, s3
  s_lshl_b32 s3, s3, 10
  v_mfma_f32_16x16x32_bf16 v[96:99], v[40:43], v[192:195], v[96:99]
  s_mul_i32 s42, s28, 9
  s_add_u32 s42, s42, 37
  v_mfma_f32_16x16x32_bf16 v[100:103], v[40:43], v[196:199], v[100:103]
  s_lshl_b32 s40, s47, 2
  s_sub_u32 s42, s42, s40
  v_mfma_f32_16x16x32_bf16 v[104:107], v[40:43], v[200:203], v[104:107]
  s_cmp_ge_u32 s42, 36
  s_cselect_b32 s4, 36, 0
  v_mfma_f32_16x16x32_bf16 v[108:111], v[40:43], v[204:207], v[108:111]
  s_sub_u32 s4, s42, s4
  s_lshl_b32 s4, s4, 10
  v_mfma_f32_16x16x32_bf16 v[112:115], v[44:47], v[192:195], v[112:115]
  s_mul_i32 s42, s28, 9
  s_add_u32 s42, s42, 38
  v_mfma_f32_16x16x32_bf16 v[116:119], v[44:47], v[196:199], v[116:119]
  s_lshl_b32 s40, s47, 2
  v_mfma_f32_16x16x32_bf16 v[120:123], v[44:47], v[200:203], v[120:123]
  v_mfma_f32_16x16x32_bf16 v[124:127], v[44:47], v[204:207], v[124:127]
  s_waitcnt lgkmcnt(0)
  v_mfma_f32_16x16x32_bf16 v[128:131], v[48:51], v[192:195], v[128:131]
  ds_read_b64_tr_b16 v[32:33], v18 offset:4096
  ds_read_b64_tr_b16 v[34:35], v18 offset:4608
  v_mfma_f32_16x16x32_bf16 v[132:135], v[48:51], v[196:199], v[132:135]
  ds_read_b64_tr_b16 v[36:37], v19 offset:4096
  ds_read_b64_tr_b16 v[38:39], v19 offset:4608
  v_mfma_f32_16x16x32_bf16 v[136:139], v[48:51], v[200:203], v[136:139]
  ds_read_b64_tr_b16 v[40:41], v18 offset:12288
  ds_read_b64_tr_b16 v[42:43], v18 offset:12800
  v_mfma_f32_16x16x32_bf16 v[140:143], v[48:51], v[204:207], v[140:143]
  ds_read_b64_tr_b16 v[44:45], v19 offset:12288
  ds_read_b64_tr_b16 v[46:47], v19 offset:12800
  v_mfma_f32_16x16x32_bf16 v[144:147], v[52:55], v[192:195], v[144:147]
  s_sub_u32 s42, s42, s40
  s_cmp_ge_u32 s42, 36
  v_mfma_f32_16x16x32_bf16 v[148:151], v[52:55], v[196:199], v[148:151]
  s_cselect_b32 s5, 36, 0
  s_sub_u32 s5, s42, s5
  v_mfma_f32_16x16x32_bf16 v[152:155], v[52:55], v[200:203], v[152:155]
  s_lshl_b32 s5, s5, 10
  s_mul_i32 s42, s28, 9
  v_mfma_f32_16x16x32_bf16 v[156:159], v[52:55], v[204:207], v[156:159]
  s_add_u32 s42, s42, 39
  s_lshl_b32 s40, s47, 2
  v_mfma_f32_16x16x32_bf16 v[160:163], v[56:59], v[192:195], v[160:163]
  s_sub_u32 s42, s42, s40
  s_cmp_ge_u32 s42, 36
  v_mfma_f32_16x16x32_bf16 v[164:167], v[56:59], v[196:199], v[164:167]
  s_cselect_b32 s6, 36, 0
  s_sub_u32 s6, s42, s6
  v_mfma_f32_16x16x32_bf16 v[168:171], v[56:59], v[200:203], v[168:171]
  s_lshl_b32 s6, s6, 10
  s_mul_i32 s42, s28, 9
  v_mfma_f32_16x16x32_bf16 v[172:175], v[56:59], v[204:207], v[172:175]
  s_add_u32 s42, s42, 40
  s_lshl_b32 s40, s47, 2
  v_mfma_f32_16x16x32_bf16 v[176:179], v[60:63], v[192:195], v[176:179]
  s_sub_u32 s42, s42, s40
  s_cmp_ge_u32 s42, 36
  v_mfma_f32_16x16x32_bf16 v[180:183], v[60:63], v[196:199], v[180:183]
  s_cselect_b32 s7, 36, 0
  v_mfma_f32_16x16x32_bf16 v[184:187], v[60:63], v[200:203], v[184:187]
  v_mfma_f32_16x16x32_bf16 v[188:191], v[60:63], v[204:207], v[188:191]
  s_waitcnt lgkmcnt(0)
  v_mfma_f32_16x16x32_bf16 v[64:67], v[32:35], v[208:211], v[64:67]
  ds_read_b64_tr_b16 v[48:49], v20 offset:4096
  ds_read_b64_tr_b16 v[50:51], v20 offset:4608
  v_mfma_f32_16x16x32_bf16 v[68:71], v[32:35], v[212:215], v[68:71]
  ds_read_b64_tr_b16 v[52:53], v21 offset:4096
  ds_read_b64_tr_b16 v[54:55], v21 offset:4608
  v_mfma_f32_16x16x32_bf16 v[72:75], v[32:35], v[216:219], v[72:75]
  ds_read_b64_tr_b16 v[56:57], v20 offset:12288
  ds_read_b64_tr_b16 v[58:59], v20 offset:12800
  v_mfma_f32_16x16x32_bf16 v[76:79], v[32:35], v[220:223], v[76:79]
  ds_read_b64_tr_b16 v[60:61], v21 offset:12288
  ds_read_b64_tr_b16 v[62:63], v21 offset:12800
  v_mfma_f32_16x16x32_bf16 v[80:83], v[36:39], v[208:211], v[80:83]
  s_sub_u32 s7, s42, s7
  s_lshl_b32 s7, s7, 10
  v_mfma_f32_16x16x32_bf16 v[84:87], v[36:39], v[212:215], v[84:87]
  s_mul_i32 s42, s28, 9
  s_add_u32 s42, s42, 41
  v_mfma_f32_16x16x32_bf16 v[88:91], v[36:39], v[216:219], v[88:91]
  s_lshl_b32 s40, s47, 2
  s_sub_u32 s42, s42, s40
  v_mfma_f32_16x16x32_bf16 v[92:95], v[36:39], v[220:223], v[92:95]
  s_cmp_ge_u32 s42, 36
  s_cselect_b32 s29, 36, 0
  v_mfma_f32_16x16x32_bf16 v[96:99], v[40:43], v[208:211], v[96:99]
  s_sub_u32 s29, s42, s29
  s_lshl_b32 s29, s29, 10
  v_mfma_f32_16x16x32_bf16 v[100:103], v[40:43], v[212:215], v[100:103]
  s_mul_i32 s42, s28, 9
  s_add_u32 s42, s42, 42
  v_mfma_f32_16x16x32_bf16 v[104:107], v[40:43], v[216:219], v[104:107]
  s_lshl_b32 s40, s47, 2
  s_sub_u32 s42, s42, s40
  v_mfma_f32_16x16x32_bf16 v[108:111], v[40:43], v[220:223], v[108:111]
  s_cmp_ge_u32 s42, 36
  s_cselect_b32 s30, 36, 0
  v_mfma_f32_16x16x32_bf16 v[112:115], v[44:47], v[208:211], v[112:115]
  s_sub_u32 s30, s42, s30
  s_lshl_b32 s30, s30, 10
  v_mfma_f32_16x16x32_bf16 v[116:119], v[44:47], v[212:215], v[116:119]
  s_mul_i32 s42, s28, 9
  v_mfma_f32_16x16x32_bf16 v[120:123], v[44:47], v[216:219], v[120:123]
  v_mfma_f32_16x16x32_bf16 v[124:127], v[44:47], v[220:223], v[124:127]
  s_waitcnt vmcnt(0) lgkmcnt(0)
  s_barrier
  v_mfma_f32_16x16x32_bf16 v[128:131], v[48:51], v[208:211], v[128:131]
  ds_read_b64_tr_b16 v[32:33], v2 offset:0
  ds_read_b64_tr_b16 v[34:35], v2 offset:256
  v_mfma_f32_16x16x32_bf16 v[132:135], v[48:51], v[212:215], v[132:135]
  ds_read_b64_tr_b16 v[36:37], v3 offset:0
  ds_read_b64_tr_b16 v[38:39], v3 offset:256
  v_mfma_f32_16x16x32_bf16 v[136:139], v[48:51], v[216:219], v[136:139]
  ds_read_b64_tr_b16 v[40:41], v4 offset:0
  ds_read_b64_tr_b16 v[42:43], v4 offset:256
  v_mfma_f32_16x16x32_bf16 v[140:143], v[48:51], v[220:223], v[140:143]
  ds_read_b64_tr_b16 v[44:45], v5 offset:0
  ds_read_b64_tr_b16 v[46:47], v5 offset:256
  v_mfma_f32_16x16x32_bf16 v[144:147], v[52:55], v[208:211], v[144:147]
  s_add_u32 s42, s42, 43
  s_lshl_b32 s40, s47, 2
  v_mfma_f32_16x16x32_bf16 v[148:151], v[52:55], v[212:215], v[148:151]
  s_sub_u32 s42, s42, s40
  s_cmp_ge_u32 s42, 36
  v_mfma_f32_16x16x32_bf16 v[152:155], v[52:55], v[216:219], v[152:155]
  s_cselect_b32 s31, 36, 0
  s_sub_u32 s31, s42, s31
  v_mfma_f32_16x16x32_bf16 v[156:159], v[52:55], v[220:223], v[156:159]
  s_lshl_b32 s31, s31, 10
  s_mul_i32 s42, s28, 9
  v_mfma_f32_16x16x32_bf16 v[160:163], v[56:59], v[208:211], v[160:163]
  s_add_u32 s42, s42, 44
  s_lshl_b32 s40, s47, 2
  v_mfma_f32_16x16x32_bf16 v[164:167], v[56:59], v[212:215], v[164:167]
  s_sub_u32 s42, s42, s40
  s_cmp_ge_u32 s42, 36
  v_mfma_f32_16x16x32_bf16 v[168:171], v[56:59], v[216:219], v[168:171]
  s_cselect_b32 s45, 36, 0
  s_sub_u32 s45, s42, s45
  v_mfma_f32_16x16x32_bf16 v[172:175], v[56:59], v[220:223], v[172:175]
  s_lshl_b32 s45, s45, 10
  s_mul_i32 s40, s28, 1327104
  v_mfma_f32_16x16x32_bf16 v[176:179], v[60:63], v[208:211], v[176:179]
  s_add_u32 s40, s40, s46
  s_add_u32 s40, s40, 64
  v_mfma_f32_16x16x32_bf16 v[180:183], v[60:63], v[212:215], v[180:183]
  v_mfma_f32_16x16x32_bf16 v[184:187], v[60:63], v[216:219], v[184:187]
  v_mfma_f32_16x16x32_bf16 v[188:191], v[60:63], v[220:223], v[188:191]
  s_mov_b32 s82, 2
  s_mov_b32 s43, 1
  s_nop 7
  s_mov_b32 s96, 0xbdd2d3e8
  s_mov_b32 s97, 0xbdd2d3e8
  v_pk_mul_f32 v[16:17], v[64:65], v[64:65]
  v_pk_mul_f32 v[18:19], v[66:67], v[66:67]
  v_pk_mul_f32 v[20:21], v[80:81], v[80:81]
  v_pk_mul_f32 v[22:23], v[82:83], v[82:83]
  v_pk_fma_f32 v[16:17], v[16:17], s[96:97], v[12:13] op_sel_hi:[1,1,0]
  v_pk_fma_f32 v[18:19], v[18:19], s[96:97], v[12:13] op_sel_hi:[1,1,0]
  v_pk_fma_f32 v[20:21], v[20:21], s[96:97], v[12:13] op_sel_hi:[1,1,0]
  v_pk_fma_f32 v[22:23], v[22:23], s[96:97], v[12:13] op_sel_hi:[1,1,0]
  v_pk_mul_f32 v[16:17], v[16:17], v[64:65]
  v_pk_mul_f32 v[18:19], v[18:19], v[66:67]
  v_pk_mul_f32 v[20:21], v[20:21], v[80:81]
  v_pk_mul_f32 v[22:23], v[22:23], v[82:83]
  v_exp_f32 v16, v16
  v_exp_f32 v17, v17
  v_exp_f32 v18, v18
  v_exp_f32 v19, v19
  v_exp_f32 v20, v20
  v_exp_f32 v21, v21
  v_exp_f32 v22, v22
  v_exp_f32 v23, v23
  v_pk_mul_f32 v[96:97], v[64:65], v[96:97]
  v_pk_mul_f32 v[98:99], v[66:67], v[98:99]
  v_pk_mul_f32 v[112:113], v[80:81], v[112:113]
  v_pk_mul_f32 v[114:115], v[82:83], v[114:115]
  v_pk_add_f32 v[16:17], v[16:17], 1.0 op_sel_hi:[1,0]
  v_pk_add_f32 v[18:19], v[18:19], 1.0 op_sel_hi:[1,0]
  v_pk_add_f32 v[20:21], v[20:21], 1.0 op_sel_hi:[1,0]
  v_pk_add_f32 v[22:23], v[22:23], 1.0 op_sel_hi:[1,0]
  v_rcp_f32 v16, v16
  v_rcp_f32 v17, v17
  v_rcp_f32 v18, v18
  v_rcp_f32 v19, v19
  v_rcp_f32 v20, v20
  v_rcp_f32 v21, v21
  v_rcp_f32 v22, v22
  v_rcp_f32 v23, v23
  v_pk_mul_f32 v[96:97], v[96:97], v[16:17]
  v_pk_mul_f32 v[98:99], v[98:99], v[18:19]
  v_pk_mul_f32 v[112:113], v[112:113], v[20:21]
  v_pk_mul_f32 v[114:115], v[114:115], v[22:23]
  v_cvt_pk_bf16_f32 v24, v96, v97
  v_cvt_pk_bf16_f32 v25, v98, v99
  v_cvt_pk_bf16_f32 v26, v112, v113
  v_cvt_pk_bf16_f32 v27, v114, v115
  buffer_store_dwordx4 v[24:27], v11, s[20:23], s36 offen sc1
  v_pk_mul_f32 v[16:17], v[68:69], v[68:69]
  v_pk_mul_f32 v[18:19], v[70:71], v[70:71]
  v_pk_mul_f32 v[20:21], v[84:85], v[84:85]
  v_pk_mul_f32 v[22:23], v[86:87], v[86:87]
  v_pk_fma_f32 v[16:17], v[16:17], s[96:97], v[12:13] op_sel_hi:[1,1,0]
  v_pk_fma_f32 v[18:19], v[18:19], s[96:97], v[12:13] op_sel_hi:[1,1,0]
  v_pk_fma_f32 v[20:21], v[20:21], s[96:97], v[12:13] op_sel_hi:[1,1,0]
  v_pk_fma_f32 v[22:23], v[22:23], s[96:97], v[12:13] op_sel_hi:[1,1,0]
  v_pk_mul_f32 v[16:17], v[16:17], v[68:69]
  v_pk_mul_f32 v[18:19], v[18:19], v[70:71]
  v_pk_mul_f32 v[20:21], v[20:21], v[84:85]
  v_pk_mul_f32 v[22:23], v[22:23], v[86:87]
  v_exp_f32 v16, v16
  v_exp_f32 v17, v17
  v_exp_f32 v18, v18
  v_exp_f32 v19, v19
  v_exp_f32 v20, v20
  v_exp_f32 v21, v21
  v_exp_f32 v22, v22
  v_exp_f32 v23, v23
  v_pk_mul_f32 v[100:101], v[68:69], v[100:101]
  v_pk_mul_f32 v[102:103], v[70:71], v[102:103]
  v_pk_mul_f32 v[116:117], v[84:85], v[116:117]
  v_pk_mul_f32 v[118:119], v[86:87], v[118:119]
  v_pk_add_f32 v[16:17], v[16:17], 1.0 op_sel_hi:[1,0]
  v_pk_add_f32 v[18:19], v[18:19], 1.0 op_sel_hi:[1,0]
  v_pk_add_f32 v[20:21], v[20:21], 1.0 op_sel_hi:[1,0]
  v_pk_add_f32 v[22:23], v[22:23], 1.0 op_sel_hi:[1,0]
  v_rcp_f32 v16, v16
  v_rcp_f32 v17, v17
  v_rcp_f32 v18, v18
  v_rcp_f32 v19, v19
  v_rcp_f32 v20, v20
  v_rcp_f32 v21, v21
  v_rcp_f32 v22, v22
  v_rcp_f32 v23, v23
  v_pk_mul_f32 v[100:101], v[100:101], v[16:17]
  v_pk_mul_f32 v[102:103], v[102:103], v[18:19]
  v_pk_mul_f32 v[116:117], v[116:117], v[20:21]
  v_pk_mul_f32 v[118:119], v[118:119], v[22:23]
  v_cvt_pk_bf16_f32 v28, v100, v101
  v_cvt_pk_bf16_f32 v29, v102, v103
  v_cvt_pk_bf16_f32 v30, v116, v117
  v_cvt_pk_bf16_f32 v31, v118, v119
  buffer_store_dwordx4 v[28:31], v11, s[20:23], s37 offen sc1
  v_pk_mul_f32 v[16:17], v[72:73], v[72:73]
  v_pk_mul_f32 v[18:19], v[74:75], v[74:75]
  v_pk_mul_f32 v[20:21], v[88:89], v[88:89]
  v_pk_mul_f32 v[22:23], v[90:91], v[90:91]
  v_pk_fma_f32 v[16:17], v[16:17], s[96:97], v[12:13] op_sel_hi:[1,1,0]
  v_pk_fma_f32 v[18:19], v[18:19], s[96:97], v[12:13] op_sel_hi:[1,1,0]
  v_pk_fma_f32 v[20:21], v[20:21], s[96:97], v[12:13] op_sel_hi:[1,1,0]
  v_pk_fma_f32 v[22:23], v[22:23], s[96:97], v[12:13] op_sel_hi:[1,1,0]
  v_pk_mul_f32 v[16:17], v[16:17], v[72:73]
  v_pk_mul_f32 v[18:19], v[18:19], v[74:75]
  v_pk_mul_f32 v[20:21], v[20:21], v[88:89]
  v_pk_mul_f32 v[22:23], v[22:23], v[90:91]
  v_exp_f32 v16, v16
  v_exp_f32 v17, v17
  v_exp_f32 v18, v18
  v_exp_f32 v19, v19
  v_exp_f32 v20, v20
  v_exp_f32 v21, v21
  v_exp_f32 v22, v22
  v_exp_f32 v23, v23
  v_pk_mul_f32 v[104:105], v[72:73], v[104:105]
  v_pk_mul_f32 v[106:107], v[74:75], v[106:107]
  v_pk_mul_f32 v[120:121], v[88:89], v[120:121]
  v_pk_mul_f32 v[122:123], v[90:91], v[122:123]
  v_pk_add_f32 v[16:17], v[16:17], 1.0 op_sel_hi:[1,0]
  v_pk_add_f32 v[18:19], v[18:19], 1.0 op_sel_hi:[1,0]
  v_pk_add_f32 v[20:21], v[20:21], 1.0 op_sel_hi:[1,0]
  v_pk_add_f32 v[22:23], v[22:23], 1.0 op_sel_hi:[1,0]
  v_rcp_f32 v16, v16
  v_rcp_f32 v17, v17
  v_rcp_f32 v18, v18
  v_rcp_f32 v19, v19
  v_rcp_f32 v20, v20
  v_rcp_f32 v21, v21
  v_rcp_f32 v22, v22
  v_rcp_f32 v23, v23
  v_pk_mul_f32 v[104:105], v[104:105], v[16:17]
  v_pk_mul_f32 v[106:107], v[106:107], v[18:19]
  v_pk_mul_f32 v[120:121], v[120:121], v[20:21]
  v_pk_mul_f32 v[122:123], v[122:123], v[22:23]
  v_cvt_pk_bf16_f32 v24, v104, v105
  v_cvt_pk_bf16_f32 v25, v106, v107
  v_cvt_pk_bf16_f32 v26, v120, v121
  v_cvt_pk_bf16_f32 v27, v122, v123
  buffer_store_dwordx4 v[24:27], v11, s[20:23], s38 offen sc1
  v_pk_mul_f32 v[16:17], v[76:77], v[76:77]
  v_pk_mul_f32 v[18:19], v[78:79], v[78:79]
  v_pk_mul_f32 v[20:21], v[92:93], v[92:93]
  v_pk_mul_f32 v[22:23], v[94:95], v[94:95]
  v_pk_fma_f32 v[16:17], v[16:17], s[96:97], v[12:13] op_sel_hi:[1,1,0]
  v_pk_fma_f32 v[18:19], v[18:19], s[96:97], v[12:13] op_sel_hi:[1,1,0]
  v_pk_fma_f32 v[20:21], v[20:21], s[96:97], v[12:13] op_sel_hi:[1,1,0]
  v_pk_fma_f32 v[22:23], v[22:23], s[96:97], v[12:13] op_sel_hi:[1,1,0]
  v_pk_mul_f32 v[16:17], v[16:17], v[76:77]
  v_pk_mul_f32 v[18:19], v[18:19], v[78:79]
  v_pk_mul_f32 v[20:21], v[20:21], v[92:93]
  v_pk_mul_f32 v[22:23], v[22:23], v[94:95]
  v_exp_f32 v16, v16
  v_exp_f32 v17, v17
  v_exp_f32 v18, v18
  v_exp_f32 v19, v19
  v_exp_f32 v20, v20
  v_exp_f32 v21, v21
  v_exp_f32 v22, v22
  v_exp_f32 v23, v23
  v_pk_mul_f32 v[108:109], v[76:77], v[108:109]
  v_pk_mul_f32 v[110:111], v[78:79], v[110:111]
  v_pk_mul_f32 v[124:125], v[92:93], v[124:125]
  v_pk_mul_f32 v[126:127], v[94:95], v[126:127]
  v_pk_add_f32 v[16:17], v[16:17], 1.0 op_sel_hi:[1,0]
  v_pk_add_f32 v[18:19], v[18:19], 1.0 op_sel_hi:[1,0]
  v_pk_add_f32 v[20:21], v[20:21], 1.0 op_sel_hi:[1,0]
  v_pk_add_f32 v[22:23], v[22:23], 1.0 op_sel_hi:[1,0]
  v_rcp_f32 v16, v16
  v_rcp_f32 v17, v17
  v_rcp_f32 v18, v18
  v_rcp_f32 v19, v19
  v_rcp_f32 v20, v20
  v_rcp_f32 v21, v21
  v_rcp_f32 v22, v22
  v_rcp_f32 v23, v23
  v_pk_mul_f32 v[108:109], v[108:109], v[16:17]
  v_pk_mul_f32 v[110:111], v[110:111], v[18:19]
  v_pk_mul_f32 v[124:125], v[124:125], v[20:21]
  v_pk_mul_f32 v[126:127], v[126:127], v[22:23]
  v_cvt_pk_bf16_f32 v28, v108, v109
  v_cvt_pk_bf16_f32 v29, v110, v111
  v_cvt_pk_bf16_f32 v30, v124, v125
  v_cvt_pk_bf16_f32 v31, v126, v127
  buffer_store_dwordx4 v[28:31], v11, s[20:23], s39 offen sc1
  s_add_u32 s36, s36, 1024
  s_add_u32 s37, s37, 1024
  s_add_u32 s38, s38, 1024
  s_add_u32 s39, s39, 1024
.p2align 6
L_ffn_even:
  s_waitcnt lgkmcnt(0)
  v_mfma_f32_16x16x32_bf16 v[64:67], v[32:35], a[0:3], 0
  ds_read_b64_tr_b16 v[48:49], v2 offset:2048
  v_mfma_f32_16x16x32_bf16 v[68:71], v[32:35], a[4:7], 0
  ds_read_b64_tr_b16 v[50:51], v2 offset:2304
  v_mfma_f32_16x16x32_bf16 v[72:75], v[32:35], a[8:11], 0
  ds_read_b64_tr_b16 v[52:53], v3 offset:2048
  v_mfma_f32_16x16x32_bf16 v[76:79], v[32:35], a[12:15], 0
  ds_read_b64_tr_b16 v[54:55], v3 offset:2304
  v_mfma_f32_16x16x32_bf16 v[80:83], v[36:39], a[0:3], 0
  ds_read_b64_tr_b16 v[56:57], v4 offset:2048
  v_mul_f32 v16, v128, v128
  v_mfma_f32_16x16x32_bf16 v[84:87], v[36:39], a[4:7], 0
  ds_read_b64_tr_b16 v[58:59], v4 offset:2304
  v_mul_f32 v17, v129, v129
  v_mfma_f32_16x16x32_bf16 v[88:91], v[36:39], a[8:11], 0
  ds_read_b64_tr_b16 v[60:61], v5 offset:2048
  v_mul_f32 v18, v130, v130
  v_mfma_f32_16x16x32_bf16 v[92:95], v[36:39], a[12:15], 0
  ds_read_b64_tr_b16 v[62:63], v5 offset:2304
  v_mul_f32 v19, v131, v131
  v_mfma_f32_16x16x32_bf16 v[96:99], v[40:43], a[0:3], 0
  s_add_u32 m0, s3, 73728
  s_add_u32 s42, s40, 0
  v_fmamk_f32 v16, v16, 0xbdd2d3e8, v12
  v_fmamk_f32 v17, v17, 0xbdd2d3e8, v12
  v_mfma_f32_16x16x32_bf16 v[100:103], v[40:43], a[4:7], 0
  buffer_load_dwordx4 v10, s[12:15], s42 offen lds
  s_add_u32 m0, s3, 110592
  v_fmamk_f32 v18, v18, 0xbdd2d3e8, v12
  v_mfma_f32_16x16x32_bf16 v[104:107], v[40:43], a[8:11], 0
  buffer_load_dwordx4 v10, s[16:19], s42 offen lds
  v_fmamk_f32 v19, v19, 0xbdd2d3e8, v12
  v_mfma_f32_16x16x32_bf16 v[108:111], v[40:43], a[12:15], 0
  v_mul_f32 v16, v16, v128
  v_mul_f32 v17, v17, v129
  v_mfma_f32_16x16x32_bf16 v[112:115], v[44:47], a[0:3], 0
  v_mul_f32 v18, v18, v130
  v_mul_f32 v19, v19, v131
  v_mfma_f32_16x16x32_bf16 v[116:119], v[44:47], a[4:7], 0
  v_exp_f32 v16, v16
  v_mfma_f32_16x16x32_bf16 v[120:123], v[44:47], a[8:11], 0
  v_exp_f32 v17, v17
  v_mfma_f32_16x16x32_bf16 v[124:127], v[44:47], a[12:15], 0
  v_exp_f32 v18, v18
  s_waitcnt lgkmcnt(0)
  v_mfma_f32_16x16x32_bf16 v[64:67], v[48:51], a[16:19], v[64:67]
  ds_read_b64_tr_b16 v[32:33], v2 offset:4096
  v_mfma_f32_16x16x32_bf16 v[68:71], v[48:51], a[20:23], v[68:71]
  ds_read_b64_tr_b16 v[34:35], v2 offset:4352
  v_mfma_f32_16x16x32_bf16 v[72:75], v[48:51], a[24:27], v[72:75]
  ds_read_b64_tr_b16 v[36:37], v3 offset:4096
  v_mfma_f32_16x16x32_bf16 v[76:79], v[48:51], a[28:31], v[76:79]
  ds_read_b64_tr_b16 v[38:39], v3 offset:4352
  v_mfma_f32_16x16x32_bf16 v[80:83], v[52:55], a[16:19], v[80:83]
  ds_read_b64_tr_b16 v[40:41], v4 offset:4096
  v_mfma_f32_16x16x32_bf16 v[84:87], v[52:55], a[20:23], v[84:87]
  ds_read_b64_tr_b16 v[42:43], v4 offset:4352
  v_mfma_f32_16x16x32_bf16 v[88:91], v[52:55], a[24:27], v[88:91]
  ds_read_b64_tr_b16 v[44:45], v5 offset:4096
  v_mfma_f32_16x16x32_bf16 v[92:95], v[52:55], a[28:31], v[92:95]
  ds_read_b64_tr_b16 v[46:47], v5 offset:4352
  v_mfma_f32_16x16x32_bf16 v[96:99], v[56:59], a[16:19], v[96:99]
  s_add_u32 m0, s4, 73728
  s_add_u32 s42, s40, 147456
  v_exp_f32 v19, v19
  v_mfma_f32_16x16x32_bf16 v[100:103], v[56:59], a[20:23], v[100:103]
  buffer_load_dwordx4 v10, s[12:15], s42 offen lds
  s_add_u32 m0, s4, 110592
  v_mul_f32 v160, v128, v160
  v_mfma_f32_16x16x32_bf16 v[104:107], v[56:59], a[24:27], v[104:107]
  buffer_load_dwordx4 v10, s[16:19], s42 offen lds
  v_mul_f32 v161, v129, v161
  v_mfma_f32_16x16x32_bf16 v[108:111], v[56:59], a[28:31], v[108:111]
  v_mul_f32 v162, v130, v162
  v_mul_f32 v163, v131, v163
  v_mfma_f32_16x16x32_bf16 v[112:115], v[60:63], a[16:19], v[112:115]
  v_add_f32 v16, 1.0, v16
  v_add_f32 v17, 1.0, v17
  v_mfma_f32_16x16x32_bf16 v[116:119], v[60:63], a[20:23], v[116:119]
  v_add_f32 v18, 1.0, v18
  v_add_f32 v19, 1.0, v19
  v_mfma_f32_16x16x32_bf16 v[120:123], v[60:63], a[24:27], v[120:123]
  v_rcp_f32 v16, v16
  v_mfma_f32_16x16x32_bf16 v[124:127], v[60:63], a[28:31], v[124:127]
  v_rcp_f32 v17, v17
  s_waitcnt lgkmcnt(0)
  v_mfma_f32_16x16x32_bf16 v[64:67], v[32:35], a[32:35], v[64:67]
  ds_read_b64_tr_b16 v[48:49], v2 offset:6144
  v_mfma_f32_16x16x32_bf16 v[68:71], v[32:35], a[36:39], v[68:71]
  ds_read_b64_tr_b16 v[50:51], v2 offset:6400
  v_mfma_f32_16x16x32_bf16 v[72:75], v[32:35], a[40:43], v[72:75]
  ds_read_b64_tr_b16 v[52:53], v3 offset:6144
  v_mfma_f32_16x16x32_bf16 v[76:79], v[32:35], a[44:47], v[76:79]
  ds_read_b64_tr_b16 v[54:55], v3 offset:6400
  v_mfma_f32_16x16x32_bf16 v[80:83], v[36:39], a[32:35], v[80:83]
  ds_read_b64_tr_b16 v[56:57], v4 offset:6144
  v_mfma_f32_16x16x32_bf16 v[84:87], v[36:39], a[36:39], v[84:87]
  ds_read_b64_tr_b16 v[58:59], v4 offset:6400
  v_mfma_f32_16x16x32_bf16 v[88:91], v[36:39], a[40:43], v[88:91]
  ds_read_b64_tr_b16 v[60:61], v5 offset:6144
  v_mfma_f32_16x16x32_bf16 v[92:95], v[36:39], a[44:47], v[92:95]
  ds_read_b64_tr_b16 v[62:63], v5 offset:6400
  v_mfma_f32_16x16x32_bf16 v[96:99], v[40:43], a[32:35], v[96:99]
  v_rcp_f32 v18, v18
  v_mfma_f32_16x16x32_bf16 v[100:103], v[40:43], a[36:39], v[100:103]
  v_rcp_f32 v19, v19
  v_mfma_f32_16x16x32_bf16 v[104:107], v[40:43], a[40:43], v[104:107]
  v_mul_f32 v160, v160, v16
  v_mul_f32 v161, v161, v17
  v_mfma_f32_16x16x32_bf16 v[108:111], v[40:43], a[44:47], v[108:111]
  v_mul_f32 v162, v162, v18
  v_mul_f32 v163, v163, v19
  v_mfma_f32_16x16x32_bf16 v[112:115], v[44:47], a[32:35], v[112:115]
  v_cvt_pk_bf16_f32 v24, v160, v161
  v_cvt_pk_bf16_f32 v25, v162, v163
  v_mfma_f32_16x16x32_bf16 v[116:119], v[44:47], a[36:39], v[116:119]
  v_mul_f32 v20, v144, v144
  v_mul_f32 v21, v145, v145
  v_mfma_f32_16x16x32_bf16 v[120:123], v[44:47], a[40:43], v[120:123]
  v_mul_f32 v22, v146, v146
  v_mul_f32 v23, v147, v147
  v_mfma_f32_16x16x32_bf16 v[124:127], v[44:47], a[44:47], v[124:127]
  v_fmamk_f32 v20, v20, 0xbdd2d3e8, v12
  v_fmamk_f32 v21, v21, 0xbdd2d3e8, v12
  s_waitcnt lgkmcnt(0)
  v_mfma_f32_16x16x32_bf16 v[64:67], v[48:51], a[48:51], v[64:67]
  ds_read_b64_tr_b16 v[32:33], v2 offset:8192
  v_fmamk_f32 v22, v22, 0xbdd2d3e8, v12
  v_mfma_f32_16x16x32_bf16 v[68:71], v[48:51], a[52:55], v[68:71]
  ds_read_b64_tr_b16 v[34:35], v2 offset:8448
  v_fmamk_f32 v23, v23, 0xbdd2d3e8, v12
  v_mfma_f32_16x16x32_bf16 v[72:75], v[48:51], a[56:59], v[72:75]
  ds_read_b64_tr_b16 v[36:37], v3 offset:8192
  v_mul_f32 v20, v20, v144
  v_mfma_f32_16x16x32_bf16 v[76:79], v[48:51], a[60:63], v[76:79]
  ds_read_b64_tr_b16 v[38:39], v3 offset:8448
  v_mul_f32 v21, v21, v145
  v_mfma_f32_16x16x32_bf16 v[80:83], v[52:55], a[48:51], v[80:83]
  ds_read_b64_tr_b16 v[40:41], v4 offset:8192
  v_mul_f32 v22, v22, v146
  v_mfma_f32_16x16x32_bf16 v[84:87], v[52:55], a[52:55], v[84:87]
  ds_read_b64_tr_b16 v[42:43], v4 offset:8448
  v_mul_f32 v23, v23, v147
  v_mfma_f32_16x16x32_bf16 v[88:91], v[52:55], a[56:59], v[88:91]
  ds_read_b64_tr_b16 v[44:45], v5 offset:8192
  v_mfma_f32_16x16x32_bf16 v[92:95], v[52:55], a[60:63], v[92:95]
  ds_read_b64_tr_b16 v[46:47], v5 offset:8448
  v_mfma_f32_16x16x32_bf16 v[96:99], v[56:59], a[48:51], v[96:99]
  s_add_u32 m0, s5, 73728
  s_add_u32 s42, s40, 294912
  v_exp_f32 v20, v20
  v_mfma_f32_16x16x32_bf16 v[100:103], v[56:59], a[52:55], v[100:103]
  buffer_load_dwordx4 v10, s[12:15], s42 offen lds
  s_add_u32 m0, s5, 110592
  v_mfma_f32_16x16x32_bf16 v[104:107], v[56:59], a[56:59], v[104:107]
  buffer_load_dwordx4 v10, s[16:19], s42 offen lds
  v_mfma_f32_16x16x32_bf16 v[108:111], v[56:59], a[60:63], v[108:111]
  v_exp_f32 v21, v21
  v_mfma_f32_16x16x32_bf16 v[112:115], v[60:63], a[48:51], v[112:115]
  v_exp_f32 v22, v22
  v_mfma_f32_16x16x32_bf16 v[116:119], v[60:63], a[52:55], v[116:119]
  v_exp_f32 v23, v23
  v_mfma_f32_16x16x32_bf16 v[120:123], v[60:63], a[56:59], v[120:123]
  v_mul_f32 v176, v144, v176
  v_mul_f32 v177, v145, v177
  v_mfma_f32_16x16x32_bf16 v[124:127], v[60:63], a[60:63], v[124:127]
  v_mul_f32 v178, v146, v178
  v_mul_f32 v179, v147, v179
  s_waitcnt lgkmcnt(0)
  v_mfma_f32_16x16x32_bf16 v[64:67], v[32:35], a[64:67], v[64:67]
  ds_read_b64_tr_b16 v[48:49], v2 offset:10240
  v_add_f32 v20, 1.0, v20
  v_mfma_f32_16x16x32_bf16 v[68:71], v[32:35], a[68:71], v[68:71]
  ds_read_b64_tr_b16 v[50:51], v2 offset:10496
  v_add_f32 v21, 1.0, v21
  v_mfma_f32_16x16x32_bf16 v[72:75], v[32:35], a[72:75], v[72:75]
  ds_read_b64_tr_b16 v[52:53], v3 offset:10240
  v_add_f32 v22, 1.0, v22
  v_mfma_f32_16x16x32_bf16 v[76:79], v[32:35], a[76:79], v[76:79]
  ds_read_b64_tr_b16 v[54:55], v3 offset:10496
  v_add_f32 v23, 1.0, v23
  v_mfma_f32_16x16x32_bf16 v[80:83], v[36:39], a[64:67], v[80:83]
  ds_read_b64_tr_b16 v[56:57], v4 offset:10240
  v_mfma_f32_16x16x32_bf16 v[84:87], v[36:39], a[68:71], v[84:87]
  ds_read_b64_tr_b16 v[58:59], v4 offset:10496
  v_mfma_f32_16x16x32_bf16 v[88:91], v[36:39], a[72:75], v[88:91]
  ds_read_b64_tr_b16 v[60:61], v5 offset:10240
  v_mfma_f32_16x16x32_bf16 v[92:95], v[36:39], a[76:79], v[92:95]
  ds_read_b64_tr_b16 v[62:63], v5 offset:10496
  v_mfma_f32_16x16x32_bf16 v[96:99], v[40:43], a[64:67], v[96:99]
  s_add_u32 m0, s6, 73728
  s_add_u32 s42, s40, 442368
  v_rcp_f32 v20, v20
  v_mfma_f32_16x16x32_bf16 v[100:103], v[40:43], a[68:71], v[100:103]
  buffer_load_dwordx4 v10, s[12:15], s42 offen lds
  s_add_u32 m0, s6, 110592
  v_mfma_f32_16x16x32_bf16 v[104:107], v[40:43], a[72:75], v[104:107]
  buffer_load_dwordx4 v10, s[16:19], s42 offen lds
  v_mfma_f32_16x16x32_bf16 v[108:111], v[40:43], a[76:79], v[108:111]
  v_rcp_f32 v21, v21
  v_mfma_f32_16x16x32_bf16 v[112:115], v[44:47], a[64:67], v[112:115]
  v_rcp_f32 v22, v22
  v_mfma_f32_16x16x32_bf16 v[116:119], v[44:47], a[68:71], v[116:119]
  v_rcp_f32 v23, v23
  v_mfma_f32_16x16x32_bf16 v[120:123], v[44:47], a[72:75], v[120:123]
  v_mul_f32 v176, v176, v20
  v_mul_f32 v177, v177, v21
  v_mfma_f32_16x16x32_bf16 v[124:127], v[44:47], a[76:79], v[124:127]
  v_mul_f32 v178, v178, v22
  v_mul_f32 v179, v179, v23
  s_waitcnt lgkmcnt(0)
  v_mfma_f32_16x16x32_bf16 v[64:67], v[48:51], a[80:83], v[64:67]
  ds_read_b64_tr_b16 v[32:33], v2 offset:12288
  v_cvt_pk_bf16_f32 v26, v176, v177
  v_mfma_f32_16x16x32_bf16 v[68:71], v[48:51], a[84:87], v[68:71]
  ds_read_b64_tr_b16 v[34:35], v2 offset:12544
  v_cvt_pk_bf16_f32 v27, v178, v179
  v_mfma_f32_16x16x32_bf16 v[72:75], v[48:51], a[88:91], v[72:75]
  ds_read_b64_tr_b16 v[36:37], v3 offset:12288
  buffer_store_dwordx4 v[24:27], v11, s[20:23], s36 offen sc1
  v_mfma_f32_16x16x32_bf16 v[76:79], v[48:51], a[92:95], v[76:79]
  ds_read_b64_tr_b16 v[38:39], v3 offset:12544
  v_mul_f32 v16, v132, v132
  v_mfma_f32_16x16x32_bf16 v[80:83], v[52:55], a[80:83], v[80:83]
  ds_read_b64_tr_b16 v[40:41], v4 offset:12288
  v_mul_f32 v17, v133, v133
  v_mfma_f32_16x16x32_bf16 v[84:87], v[52:55], a[84:87], v[84:87]
  ds_read_b64_tr_b16 v[42:43], v4 offset:12544
  v_mul_f32 v18, v134, v134
  v_mfma_f32_16x16x32_bf16 v[88:91], v[52:55], a[88:91], v[88:91]
  ds_read_b64_tr_b16 v[44:45], v5 offset:12288
  v_mul_f32 v19, v135, v135
  v_mfma_f32_16x16x32_bf16 v[92:95], v[52:55], a[92:95], v[92:95]
  ds_read_b64_tr_b16 v[46:47], v5 offset:12544
  v_fmamk_f32 v16, v16, 0xbdd2d3e8, v12
  v_mfma_f32_16x16x32_bf16 v[96:99], v[56:59], a[80:83], v[96:99]
  v_fmamk_f32 v17, v17, 0xbdd2d3e8, v12
  v_fmamk_f32 v18, v18, 0xbdd2d3e8, v12
  v_mfma_f32_16x16x32_bf16 v[100:103], v[56:59], a[84:87], v[100:103]
  v_fmamk_f32 v19, v19, 0xbdd2d3e8, v12
  v_mul_f32 v16, v16, v132
  v_mfma_f32_16x16x32_bf16 v[104:107], v[56:59], a[88:91], v[104:107]
  v_mul_f32 v17, v17, v133
  v_mul_f32 v18, v18, v134
  v_mfma_f32_16x16x32_bf16 v[108:111], v[56:59], a[92:95], v[108:111]
  v_mul_f32 v19, v19, v135
  v_mfma_f32_16x16x32_bf16 v[112:115], v[60:63], a[80:83], v[112:115]
  v_exp_f32 v16, v16
  v_mfma_f32_16x16x32_bf16 v[116:119], v[60:63], a[84:87], v[116:119]
  v_exp_f32 v17, v17
  v_mfma_f32_16x16x32_bf16 v[120:123], v[60:63], a[88:91], v[120:123]
  v_exp_f32 v18, v18
  v_mfma_f32_16x16x32_bf16 v[124:127], v[60:63], a[92:95], v[124:127]
  v_exp_f32 v19, v19
  s_waitcnt lgkmcnt(0)
  v_mfma_f32_16x16x32_bf16 v[64:67], v[32:35], a[96:99], v[64:67]
  ds_read_b64_tr_b16 v[48:49], v2 offset:14336
  v_mul_f32 v164, v132, v164
  v_mfma_f32_16x16x32_bf16 v[68:71], v[32:35], a[100:103], v[68:71]
  ds_read_b64_tr_b16 v[50:51], v2 offset:14592
  v_mul_f32 v165, v133, v165
  v_mfma_f32_16x16x32_bf16 v[72:75], v[32:35], a[104:107], v[72:75]
  ds_read_b64_tr_b16 v[52:53], v3 offset:14336
  v_mul_f32 v166, v134, v166
  v_mfma_f32_16x16x32_bf16 v[76:79], v[32:35], a[108:111], v[76:79]
  ds_read_b64_tr_b16 v[54:55], v3 offset:14592
  v_mul_f32 v167, v135, v167
  v_mfma_f32_16x16x32_bf16 v[80:83], v[36:39], a[96:99], v[80:83]
  ds_read_b64_tr_b16 v[56:57], v4 offset:14336
  v_add_f32 v16, 1.0, v16
  v_mfma_f32_16x16x32_bf16 v[84:87], v[36:39], a[100:103], v[84:87]
  ds_read_b64_tr_b16 v[58:59], v4 offset:14592
  v_add_f32 v17, 1.0, v17
  v_mfma_f32_16x16x32_bf16 v[88:91], v[36:39], a[104:107], v[88:91]
  ds_read_b64_tr_b16 v[60:61], v5 offset:14336
  v_add_f32 v18, 1.0, v18
  v_mfma_f32_16x16x32_bf16 v[92:95], v[36:39], a[108:111], v[92:95]
  ds_read_b64_tr_b16 v[62:63], v5 offset:14592
  v_add_f32 v19, 1.0, v19
  v_mfma_f32_16x16x32_bf16 v[96:99], v[40:43], a[96:99], v[96:99]
  s_add_u32 m0, s7, 73728
  s_add_u32 s42, s40, 589824
  v_rcp_f32 v16, v16
  v_mfma_f32_16x16x32_bf16 v[100:103], v[40:43], a[100:103], v[100:103]
  buffer_load_dwordx4 v10, s[12:15], s42 offen lds
  s_add_u32 m0, s7, 110592
  v_mfma_f32_16x16x32_bf16 v[104:107], v[40:43], a[104:107], v[104:107]
  buffer_load_dwordx4 v10, s[16:19], s42 offen lds
  v_mfma_f32_16x16x32_bf16 v[108:111], v[40:43], a[108:111], v[108:111]
  v_rcp_f32 v17, v17
  v_mfma_f32_16x16x32_bf16 v[112:115], v[44:47], a[96:99], v[112:115]
  v_rcp_f32 v18, v18
  v_mfma_f32_16x16x32_bf16 v[116:119], v[44:47], a[100:103], v[116:119]
  v_rcp_f32 v19, v19
  v_mfma_f32_16x16x32_bf16 v[120:123], v[44:47], a[104:107], v[120:123]
  v_mul_f32 v164, v164, v16
  v_mul_f32 v165, v165, v17
  v_mfma_f32_16x16x32_bf16 v[124:127], v[44:47], a[108:111], v[124:127]
  v_mul_f32 v166, v166, v18
  v_mul_f32 v167, v167, v19
  s_waitcnt lgkmcnt(0)
  v_mfma_f32_16x16x32_bf16 v[64:67], v[48:51], a[112:115], v[64:67]
  ds_read_b64_tr_b16 v[32:33], v2 offset:16384
  v_cvt_pk_bf16_f32 v28, v164, v165
  v_mfma_f32_16x16x32_bf16 v[68:71], v[48:51], a[116:119], v[68:71]
  ds_read_b64_tr_b16 v[34:35], v2 offset:16640
  v_cvt_pk_bf16_f32 v29, v166, v167
  v_mfma_f32_16x16x32_bf16 v[72:75], v[48:51], a[120:123], v[72:75]
  ds_read_b64_tr_b16 v[36:37], v3 offset:16384
  v_mul_f32 v20, v148, v148
  v_mfma_f32_16x16x32_bf16 v[76:79], v[48:51], a[124:127], v[76:79]
  ds_read_b64_tr_b16 v[38:39], v3 offset:16640
  v_mul_f32 v21, v149, v149
  v_mfma_f32_16x16x32_bf16 v[80:83], v[52:55], a[112:115], v[80:83]
  ds_read_b64_tr_b16 v[40:41], v4 offset:16384
  v_mul_f32 v22, v150, v150
  v_mfma_f32_16x16x32_bf16 v[84:87], v[52:55], a[116:119], v[84:87]
  ds_read_b64_tr_b16 v[42:43], v4 offset:16640
  v_mul_f32 v23, v151, v151
  v_mfma_f32_16x16x32_bf16 v[88:91], v[52:55], a[120:123], v[88:91]
  ds_read_b64_tr_b16 v[44:45], v5 offset:16384
  v_fmamk_f32 v20, v20, 0xbdd2d3e8, v12
  v_mfma_f32_16x16x32_bf16 v[92:95], v[52:55], a[124:127], v[92:95]
  ds_read_b64_tr_b16 v[46:47], v5 offset:16640
  v_fmamk_f32 v21, v21, 0xbdd2d3e8, v12
  v_mfma_f32_16x16x32_bf16 v[96:99], v[56:59], a[112:115], v[96:99]
  s_add_u32 m0, s29, 73728
  s_add_u32 s42, s40, 737280
  v_fmamk_f32 v22, v22, 0xbdd2d3e8, v12
  v_fmamk_f32 v23, v23, 0xbdd2d3e8, v12
  v_mfma_f32_16x16x32_bf16 v[100:103], v[56:59], a[116:119], v[100:103]
  buffer_load_dwordx4 v10, s[12:15], s42 offen lds
  s_add_u32 m0, s29, 110592
  v_mul_f32 v20, v20, v148
  v_mfma_f32_16x16x32_bf16 v[104:107], v[56:59], a[120:123], v[104:107]
  buffer_load_dwordx4 v10, s[16:19], s42 offen lds
  v_mul_f32 v21, v21, v149
  v_mfma_f32_16x16x32_bf16 v[108:111], v[56:59], a[124:127], v[108:111]
  v_mul_f32 v22, v22, v150
  v_mul_f32 v23, v23, v151
  v_mfma_f32_16x16x32_bf16 v[112:115], v[60:63], a[112:115], v[112:115]
  v_exp_f32 v20, v20
  v_mfma_f32_16x16x32_bf16 v[116:119], v[60:63], a[116:119], v[116:119]
  v_exp_f32 v21, v21
  v_mfma_f32_16x16x32_bf16 v[120:123], v[60:63], a[120:123], v[120:123]
  v_exp_f32 v22, v22
  v_mfma_f32_16x16x32_bf16 v[124:127], v[60:63], a[124:127], v[124:127]
  v_exp_f32 v23, v23
  s_waitcnt lgkmcnt(0)
  v_mfma_f32_16x16x32_bf16 v[64:67], v[32:35], a[128:131], v[64:67]
  ds_read_b64_tr_b16 v[48:49], v2 offset:18432
  v_mul_f32 v180, v148, v180
  v_mfma_f32_16x16x32_bf16 v[68:71], v[32:35], a[132:135], v[68:71]
  ds_read_b64_tr_b16 v[50:51], v2 offset:18688
  v_mul_f32 v181, v149, v181
  v_mfma_f32_16x16x32_bf16 v[72:75], v[32:35], a[136:139], v[72:75]
  ds_read_b64_tr_b16 v[52:53], v3 offset:18432
  v_mul_f32 v182, v150, v182
  v_mfma_f32_16x16x32_bf16 v[76:79], v[32:35], a[140:143], v[76:79]
  ds_read_b64_tr_b16 v[54:55], v3 offset:18688
  v_mul_f32 v183, v151, v183
  v_mfma_f32_16x16x32_bf16 v[80:83], v[36:39], a[128:131], v[80:83]
  ds_read_b64_tr_b16 v[56:57], v4 offset:18432
  v_add_f32 v20, 1.0, v20
  v_mfma_f32_16x16x32_bf16 v[84:87], v[36:39], a[132:135], v[84:87]
  ds_read_b64_tr_b16 v[58:59], v4 offset:18688
  v_add_f32 v21, 1.0, v21
  v_mfma_f32_16x16x32_bf16 v[88:91], v[36:39], a[136:139], v[88:91]
  ds_read_b64_tr_b16 v[60:61], v5 offset:18432
  v_add_f32 v22, 1.0, v22
  v_mfma_f32_16x16x32_bf16 v[92:95], v[36:39], a[140:143], v[92:95]
  ds_read_b64_tr_b16 v[62:63], v5 offset:18688
  v_add_f32 v23, 1.0, v23
  v_mfma_f32_16x16x32_bf16 v[96:99], v[40:43], a[128:131], v[96:99]
  v_rcp_f32 v20, v20
  v_mfma_f32_16x16x32_bf16 v[100:103], v[40:43], a[132:135], v[100:103]
  v_rcp_f32 v21, v21
  v_mfma_f32_16x16x32_bf16 v[104:107], v[40:43], a[136:139], v[104:107]
  v_rcp_f32 v22, v22
  v_mfma_f32_16x16x32_bf16 v[108:111], v[40:43], a[140:143], v[108:111]
  v_rcp_f32 v23, v23
  v_mfma_f32_16x16x32_bf16 v[112:115], v[44:47], a[128:131], v[112:115]
  v_mul_f32 v180, v180, v20
  v_mul_f32 v181, v181, v21
  v_mfma_f32_16x16x32_bf16 v[116:119], v[44:47], a[132:135], v[116:119]
  v_mul_f32 v182, v182, v22
  v_mul_f32 v183, v183, v23
  v_mfma_f32_16x16x32_bf16 v[120:123], v[44:47], a[136:139], v[120:123]
  v_cvt_pk_bf16_f32 v30, v180, v181
  v_cvt_pk_bf16_f32 v31, v182, v183
  v_mfma_f32_16x16x32_bf16 v[124:127], v[44:47], a[140:143], v[124:127]
  buffer_store_dwordx4 v[28:31], v11, s[20:23], s37 offen sc1
  v_mul_f32 v16, v136, v136
  s_waitcnt lgkmcnt(0)
  v_mfma_f32_16x16x32_bf16 v[64:67], v[48:51], a[144:147], v[64:67]
  ds_read_b64_tr_b16 v[32:33], v2 offset:20480
  v_mul_f32 v17, v137, v137
  v_mfma_f32_16x16x32_bf16 v[68:71], v[48:51], a[148:151], v[68:71]
  ds_read_b64_tr_b16 v[34:35], v2 offset:20736
  v_mul_f32 v18, v138, v138
  v_mfma_f32_16x16x32_bf16 v[72:75], v[48:51], a[152:155], v[72:75]
  ds_read_b64_tr_b16 v[36:37], v3 offset:20480
  v_mul_f32 v19, v139, v139
  v_mfma_f32_16x16x32_bf16 v[76:79], v[48:51], a[156:159], v[76:79]
  ds_read_b64_tr_b16 v[38:39], v3 offset:20736
  v_fmamk_f32 v16, v16, 0xbdd2d3e8, v12
  v_mfma_f32_16x16x32_bf16 v[80:83], v[52:55], a[144:147], v[80:83]
  ds_read_b64_tr_b16 v[40:41], v4 offset:20480
  v_fmamk_f32 v17, v17, 0xbdd2d3e8, v12
  v_mfma_f32_16x16x32_bf16 v[84:87], v[52:55], a[148:151], v[84:87]
  ds_read_b64_tr_b16 v[42:43], v4 offset:20736
  v_fmamk_f32 v18, v18, 0xbdd2d3e8, v12
  v_mfma_f32_16x16x32_bf16 v[88:91], v[52:55], a[152:155], v[88:91]
  ds_read_b64_tr_b16 v[44:45], v5 offset:20480
  v_fmamk_f32 v19, v19, 0xbdd2d3e8, v12
  v_mfma_f32_16x16x32_bf16 v[92:95], v[52:55], a[156:159], v[92:95]
  ds_read_b64_tr_b16 v[46:47], v5 offset:20736
  v_mul_f32 v16, v16, v136
  v_mfma_f32_16x16x32_bf16 v[96:99], v[56:59], a[144:147], v[96:99]
  s_add_u32 m0, s30, 73728
  s_add_u32 s42, s40, 884736
  v_mul_f32 v17, v17, v137
  v_mul_f32 v18, v18, v138
  v_mfma_f32_16x16x32_bf16 v[100:103], v[56:59], a[148:151], v[100:103]
  buffer_load_dwordx4 v10, s[12:15], s42 offen lds
  s_add_u32 m0, s30, 110592
  v_mul_f32 v19, v19, v139
  v_mfma_f32_16x16x32_bf16 v[104:107], v[56:59], a[152:155], v[104:107]
  buffer_load_dwordx4 v10, s[16:19], s42 offen lds
  v_mfma_f32_16x16x32_bf16 v[108:111], v[56:59], a[156:159], v[108:111]
  v_exp_f32 v16, v16
  v_mfma_f32_16x16x32_bf16 v[112:115], v[60:63], a[144:147], v[112:115]
  v_exp_f32 v17, v17
  v_mfma_f32_16x16x32_bf16 v[116:119], v[60:63], a[148:151], v[116:119]
  v_exp_f32 v18, v18
  v_mfma_f32_16x16x32_bf16 v[120:123], v[60:63], a[152:155], v[120:123]
  v_exp_f32 v19, v19
  v_mfma_f32_16x16x32_bf16 v[124:127], v[60:63], a[156:159], v[124:127]
  v_mul_f32 v168, v136, v168
  v_mul_f32 v169, v137, v169
  s_waitcnt lgkmcnt(0)
  v_mfma_f32_16x16x32_bf16 v[64:67], v[32:35], a[160:163], v[64:67]
  ds_read_b64_tr_b16 v[48:49], v2 offset:22528
  v_mul_f32 v170, v138, v170
  v_mfma_f32_16x16x32_bf16 v[68:71], v[32:35], a[164:167], v[68:71]
  ds_read_b64_tr_b16 v[50:51], v2 offset:22784
  v_mul_f32 v171, v139, v171
  v_mfma_f32_16x16x32_bf16 v[72:75], v[32:35], a[168:171], v[72:75]
  ds_read_b64_tr_b16 v[52:53], v3 offset:22528
  v_add_f32 v16, 1.0, v16
  v_mfma_f32_16x16x32_bf16 v[76:79], v[32:35], a[172:175], v[76:79]
  ds_read_b64_tr_b16 v[54:55], v3 offset:22784
  v_add_f32 v17, 1.0, v17
  v_mfma_f32_16x16x32_bf16 v[80:83], v[36:39], a[160:163], v[80:83]
  ds_read_b64_tr_b16 v[56:57], v4 offset:22528
  v_add_f32 v18, 1.0, v18
  v_mfma_f32_16x16x32_bf16 v[84:87], v[36:39], a[164:167], v[84:87]
  ds_read_b64_tr_b16 v[58:59], v4 offset:22784
  v_add_f32 v19, 1.0, v19
  v_mfma_f32_16x16x32_bf16 v[88:91], v[36:39], a[168:171], v[88:91]
  ds_read_b64_tr_b16 v[60:61], v5 offset:22528
  v_mfma_f32_16x16x32_bf16 v[92:95], v[36:39], a[172:175], v[92:95]
  ds_read_b64_tr_b16 v[62:63], v5 offset:22784
  v_mfma_f32_16x16x32_bf16 v[96:99], v[40:43], a[160:163], v[96:99]
  s_add_u32 m0, s31, 73728
  s_add_u32 s42, s40, 1032192
  v_rcp_f32 v16, v16
  v_mfma_f32_16x16x32_bf16 v[100:103], v[40:43], a[164:167], v[100:103]
  buffer_load_dwordx4 v10, s[12:15], s42 offen lds
  s_add_u32 m0, s31, 110592
  v_mfma_f32_16x16x32_bf16 v[104:107], v[40:43], a[168:171], v[104:107]
  buffer_load_dwordx4 v10, s[16:19], s42 offen lds
  v_mfma_f32_16x16x32_bf16 v[108:111], v[40:43], a[172:175], v[108:111]
  v_rcp_f32 v17, v17
  v_mfma_f32_16x16x32_bf16 v[112:115], v[44:47], a[160:163], v[112:115]
  v_rcp_f32 v18, v18
  v_mfma_f32_16x16x32_bf16 v[116:119], v[44:47], a[164:167], v[116:119]
  v_rcp_f32 v19, v19
  v_mfma_f32_16x16x32_bf16 v[120:123], v[44:47], a[168:171], v[120:123]
  v_mul_f32 v168, v168, v16
  v_mul_f32 v169, v169, v17
  v_mfma_f32_16x16x32_bf16 v[124:127], v[44:47], a[172:175], v[124:127]
  v_mul_f32 v170, v170, v18
  v_mul_f32 v171, v171, v19
  s_waitcnt lgkmcnt(0)
  v_mfma_f32_16x16x32_bf16 v[64:67], v[48:51], a[176:179], v[64:67]
  ds_read_b64_tr_b16 v[32:33], v2 offset:24576
  v_cvt_pk_bf16_f32 v24, v168, v169
  v_mfma_f32_16x16x32_bf16 v[68:71], v[48:51], a[180:183], v[68:71]
  ds_read_b64_tr_b16 v[34:35], v2 offset:24832
  v_cvt_pk_bf16_f32 v25, v170, v171
  v_mfma_f32_16x16x32_bf16 v[72:75], v[48:51], a[184:187], v[72:75]
  ds_read_b64_tr_b16 v[36:37], v3 offset:24576
  v_mul_f32 v20, v152, v152
  v_mfma_f32_16x16x32_bf16 v[76:79], v[48:51], a[188:191], v[76:79]
  ds_read_b64_tr_b16 v[38:39], v3 offset:24832
  v_mul_f32 v21, v153, v153
  v_mfma_f32_16x16x32_bf16 v[80:83], v[52:55], a[176:179], v[80:83]
  ds_read_b64_tr_b16 v[40:41], v4 offset:24576
  v_mul_f32 v22, v154, v154
  v_mfma_f32_16x16x32_bf16 v[84:87], v[52:55], a[180:183], v[84:87]
  ds_read_b64_tr_b16 v[42:43], v4 offset:24832
  v_mul_f32 v23, v155, v155
  v_mfma_f32_16x16x32_bf16 v[88:91], v[52:55], a[184:187], v[88:91]
  ds_read_b64_tr_b16 v[44:45], v5 offset:24576
  v_fmamk_f32 v20, v20, 0xbdd2d3e8, v12
  v_mfma_f32_16x16x32_bf16 v[92:95], v[52:55], a[188:191], v[92:95]
  ds_read_b64_tr_b16 v[46:47], v5 offset:24832
  v_fmamk_f32 v21, v21, 0xbdd2d3e8, v12
  v_mfma_f32_16x16x32_bf16 v[96:99], v[56:59], a[176:179], v[96:99]
  v_fmamk_f32 v22, v22, 0xbdd2d3e8, v12
  v_fmamk_f32 v23, v23, 0xbdd2d3e8, v12
  v_mfma_f32_16x16x32_bf16 v[100:103], v[56:59], a[180:183], v[100:103]
  v_mul_f32 v20, v20, v152
  v_mul_f32 v21, v21, v153
  v_mfma_f32_16x16x32_bf16 v[104:107], v[56:59], a[184:187], v[104:107]
  v_mul_f32 v22, v22, v154
  v_mul_f32 v23, v23, v155
  v_mfma_f32_16x16x32_bf16 v[108:111], v[56:59], a[188:191], v[108:111]
  v_exp_f32 v20, v20
  v_mfma_f32_16x16x32_bf16 v[112:115], v[60:63], a[176:179], v[112:115]
  v_exp_f32 v21, v21
  v_mfma_f32_16x16x32_bf16 v[116:119], v[60:63], a[180:183], v[116:119]
  v_exp_f32 v22, v22
  v_mfma_f32_16x16x32_bf16 v[120:123], v[60:63], a[184:187], v[120:123]
  v_exp_f32 v23, v23
  v_mfma_f32_16x16x32_bf16 v[124:127], v[60:63], a[188:191], v[124:127]
  v_mul_f32 v184, v152, v184
  v_mul_f32 v185, v153, v185
  s_waitcnt lgkmcnt(0)
  v_mfma_f32_16x16x32_bf16 v[64:67], v[32:35], a[192:195], v[64:67]
  ds_read_b64_tr_b16 v[48:49], v2 offset:26624
  v_mul_f32 v186, v154, v186
  v_mfma_f32_16x16x32_bf16 v[68:71], v[32:35], a[196:199], v[68:71]
  ds_read_b64_tr_b16 v[50:51], v2 offset:26880
  v_mul_f32 v187, v155, v187
  v_mfma_f32_16x16x32_bf16 v[72:75], v[32:35], a[200:203], v[72:75]
  ds_read_b64_tr_b16 v[52:53], v3 offset:26624
  v_add_f32 v20, 1.0, v20
  v_mfma_f32_16x16x32_bf16 v[76:79], v[32:35], a[204:207], v[76:79]
  ds_read_b64_tr_b16 v[54:55], v3 offset:26880
  v_add_f32 v21, 1.0, v21
  v_mfma_f32_16x16x32_bf16 v[80:83], v[36:39], a[192:195], v[80:83]
  ds_read_b64_tr_b16 v[56:57], v4 offset:26624
  v_add_f32 v22, 1.0, v22
  v_mfma_f32_16x16x32_bf16 v[84:87], v[36:39], a[196:199], v[84:87]
  ds_read_b64_tr_b16 v[58:59], v4 offset:26880
  v_add_f32 v23, 1.0, v23
  v_mfma_f32_16x16x32_bf16 v[88:91], v[36:39], a[200:203], v[88:91]
  ds_read_b64_tr_b16 v[60:61], v5 offset:26624
  v_mfma_f32_16x16x32_bf16 v[92:95], v[36:39], a[204:207], v[92:95]
  ds_read_b64_tr_b16 v[62:63], v5 offset:26880
  v_mfma_f32_16x16x32_bf16 v[96:99], v[40:43], a[192:195], v[96:99]
  s_add_u32 m0, s45, 73728
  s_add_u32 s42, s40, 1179648
  v_rcp_f32 v20, v20
  v_mfma_f32_16x16x32_bf16 v[100:103], v[40:43], a[196:199], v[100:103]
  buffer_load_dwordx4 v10, s[12:15], s42 offen lds
  s_add_u32 m0, s45, 110592
  v_mfma_f32_16x16x32_bf16 v[104:107], v[40:43], a[200:203], v[104:107]
  buffer_load_dwordx4 v10, s[16:19], s42 offen lds
  v_mfma_f32_16x16x32_bf16 v[108:111], v[40:43], a[204:207], v[108:111]
  v_rcp_f32 v21, v21
  v_mfma_f32_16x16x32_bf16 v[112:115], v[44:47], a[192:195], v[112:115]
  v_rcp_f32 v22, v22
  v_mfma_f32_16x16x32_bf16 v[116:119], v[44:47], a[196:199], v[116:119]
  v_rcp_f32 v23, v23
  v_mfma_f32_16x16x32_bf16 v[120:123], v[44:47], a[200:203], v[120:123]
  v_mul_f32 v184, v184, v20
  v_mul_f32 v185, v185, v21
  v_mfma_f32_16x16x32_bf16 v[124:127], v[44:47], a[204:207], v[124:127]
  v_mul_f32 v186, v186, v22
  v_mul_f32 v187, v187, v23
  s_waitcnt lgkmcnt(0)
  v_mfma_f32_16x16x32_bf16 v[64:67], v[48:51], a[208:211], v[64:67]
  ds_read_b64_tr_b16 v[32:33], v2 offset:28672
  v_cvt_pk_bf16_f32 v26, v184, v185
  v_mfma_f32_16x16x32_bf16 v[68:71], v[48:51], a[212:215], v[68:71]
  ds_read_b64_tr_b16 v[34:35], v2 offset:28928
  v_cvt_pk_bf16_f32 v27, v186, v187
  v_mfma_f32_16x16x32_bf16 v[72:75], v[48:51], a[216:219], v[72:75]
  ds_read_b64_tr_b16 v[36:37], v3 offset:28672
  buffer_store_dwordx4 v[24:27], v11, s[20:23], s38 offen sc1
  v_mfma_f32_16x16x32_bf16 v[76:79], v[48:51], a[220:223], v[76:79]
  ds_read_b64_tr_b16 v[38:39], v3 offset:28928
  v_mul_f32 v16, v140, v140
  v_mfma_f32_16x16x32_bf16 v[80:83], v[52:55], a[208:211], v[80:83]
  ds_read_b64_tr_b16 v[40:41], v4 offset:28672
  v_mul_f32 v17, v141, v141
  v_mfma_f32_16x16x32_bf16 v[84:87], v[52:55], a[212:215], v[84:87]
  ds_read_b64_tr_b16 v[42:43], v4 offset:28928
  v_mul_f32 v18, v142, v142
  v_mfma_f32_16x16x32_bf16 v[88:91], v[52:55], a[216:219], v[88:91]
  ds_read_b64_tr_b16 v[44:45], v5 offset:28672
  v_mul_f32 v19, v143, v143
  v_mfma_f32_16x16x32_bf16 v[92:95], v[52:55], a[220:223], v[92:95]
  ds_read_b64_tr_b16 v[46:47], v5 offset:28928
  v_fmamk_f32 v16, v16, 0xbdd2d3e8, v12
  v_mfma_f32_16x16x32_bf16 v[96:99], v[56:59], a[208:211], v[96:99]
  s_cmp_eq_u32 s82, 2
  s_cselect_b32 s78, 5308416, 0
  v_fmamk_f32 v17, v17, 0xbdd2d3e8, v12
  v_fmamk_f32 v18, v18, 0xbdd2d3e8, v12
  v_mfma_f32_16x16x32_bf16 v[100:103], v[56:59], a[212:215], v[100:103]
  buffer_load_dword v250, v252, s[76:79], s75 offen
  s_sub_u32 s69, s82, 2
  v_fmamk_f32 v19, v19, 0xbdd2d3e8, v12
  v_mfma_f32_16x16x32_bf16 v[104:107], v[56:59], a[216:219], v[104:107]
  s_max_u32 s91, s28, 2
  s_cmp_eq_u32 s82, 4
  v_mul_f32 v16, v16, v140
  v_mul_f32 v17, v17, v141
  v_mfma_f32_16x16x32_bf16 v[108:111], v[56:59], a[220:223], v[108:111]
  s_cselect_b32 s69, s91, s69
  s_cmp_eq_u32 s69, s28
  v_mul_f32 v18, v18, v142
  v_mul_f32 v19, v19, v143
  v_mfma_f32_16x16x32_bf16 v[112:115], v[60:63], a[208:211], v[112:115]
  s_cselect_b32 s58, 5308416, 0
  buffer_load_dword v250, v253, s[56:59], s88 offen
  v_mfma_f32_16x16x32_bf16 v[116:119], v[60:63], a[212:215], v[116:119]
  s_add_u32 s69, s88, 18432
  buffer_load_dword v250, v253, s[56:59], s69 offen
  v_mfma_f32_16x16x32_bf16 v[120:123], v[60:63], a[216:219], v[120:123]
  s_mov_b32 s58, 5308416
  s_add_u32 s82, s82, 1
  v_exp_f32 v16, v16
  v_mfma_f32_16x16x32_bf16 v[124:127], v[60:63], a[220:223], v[124:127]
  v_exp_f32 v17, v17
  s_waitcnt lgkmcnt(0)
  v_mfma_f32_16x16x32_bf16 v[64:67], v[32:35], a[224:227], v[64:67]
  ds_read_b64_tr_b16 v[48:49], v2 offset:30720
  v_mfma_f32_16x16x32_bf16 v[68:71], v[32:35], a[228:231], v[68:71]
  ds_read_b64_tr_b16 v[50:51], v2 offset:30976
  v_mfma_f32_16x16x32_bf16 v[72:75], v[32:35], a[232:235], v[72:75]
  ds_read_b64_tr_b16 v[52:53], v3 offset:30720
  v_mfma_f32_16x16x32_bf16 v[76:79], v[32:35], a[236:239], v[76:79]
  ds_read_b64_tr_b16 v[54:55], v3 offset:30976
  v_mfma_f32_16x16x32_bf16 v[80:83], v[36:39], a[224:227], v[80:83]
  ds_read_b64_tr_b16 v[56:57], v4 offset:30720
  v_mfma_f32_16x16x32_bf16 v[84:87], v[36:39], a[228:231], v[84:87]
  ds_read_b64_tr_b16 v[58:59], v4 offset:30976
  v_mfma_f32_16x16x32_bf16 v[88:91], v[36:39], a[232:235], v[88:91]
  ds_read_b64_tr_b16 v[60:61], v5 offset:30720
  v_mfma_f32_16x16x32_bf16 v[92:95], v[36:39], a[236:239], v[92:95]
  ds_read_b64_tr_b16 v[62:63], v5 offset:30976
  v_mfma_f32_16x16x32_bf16 v[96:99], v[40:43], a[224:227], v[96:99]
  v_exp_f32 v18, v18
  v_mfma_f32_16x16x32_bf16 v[100:103], v[40:43], a[228:231], v[100:103]
  v_exp_f32 v19, v19
  v_mfma_f32_16x16x32_bf16 v[104:107], v[40:43], a[232:235], v[104:107]
  v_mul_f32 v172, v140, v172
  v_mul_f32 v173, v141, v173
  v_mfma_f32_16x16x32_bf16 v[108:111], v[40:43], a[236:239], v[108:111]
  v_mul_f32 v174, v142, v174
  v_mul_f32 v175, v143, v175
  v_mfma_f32_16x16x32_bf16 v[112:115], v[44:47], a[224:227], v[112:115]
  v_add_f32 v16, 1.0, v16
  v_add_f32 v17, 1.0, v17
  v_mfma_f32_16x16x32_bf16 v[116:119], v[44:47], a[228:231], v[116:119]
  v_add_f32 v18, 1.0, v18
  v_add_f32 v19, 1.0, v19
  v_mfma_f32_16x16x32_bf16 v[120:123], v[44:47], a[232:235], v[120:123]
  v_rcp_f32 v16, v16
  v_mfma_f32_16x16x32_bf16 v[124:127], v[44:47], a[236:239], v[124:127]
  v_rcp_f32 v17, v17
  s_waitcnt lgkmcnt(0)
  v_mfma_f32_16x16x32_bf16 v[64:67], v[48:51], a[240:243], v[64:67]
  ds_read_b64_tr_b16 v[32:33], v2 offset:32768
  v_mfma_f32_16x16x32_bf16 v[68:71], v[48:51], a[244:247], v[68:71]
  ds_read_b64_tr_b16 v[34:35], v2 offset:33024
  v_mfma_f32_16x16x32_bf16 v[72:75], v[48:51], a[248:251], v[72:75]
  ds_read_b64_tr_b16 v[36:37], v3 offset:32768
  v_mfma_f32_16x16x32_bf16 v[76:79], v[48:51], a[252:255], v[76:79]
  ds_read_b64_tr_b16 v[38:39], v3 offset:33024
  v_mfma_f32_16x16x32_bf16 v[80:83], v[52:55], a[240:243], v[80:83]
  ds_read_b64_tr_b16 v[40:41], v4 offset:32768
  v_mfma_f32_16x16x32_bf16 v[84:87], v[52:55], a[244:247], v[84:87]
  ds_read_b64_tr_b16 v[42:43], v4 offset:33024
  v_mfma_f32_16x16x32_bf16 v[88:91], v[52:55], a[248:251], v[88:91]
  ds_read_b64_tr_b16 v[44:45], v5 offset:32768
  v_mfma_f32_16x16x32_bf16 v[92:95], v[52:55], a[252:255], v[92:95]
  ds_read_b64_tr_b16 v[46:47], v5 offset:33024
  v_mfma_f32_16x16x32_bf16 v[96:99], v[56:59], a[240:243], v[96:99]
  v_rcp_f32 v18, v18
  v_mfma_f32_16x16x32_bf16 v[100:103], v[56:59], a[244:247], v[100:103]
  v_rcp_f32 v19, v19
  v_mfma_f32_16x16x32_bf16 v[104:107], v[56:59], a[248:251], v[104:107]
  v_mul_f32 v172, v172, v16
  v_mul_f32 v173, v173, v17
  v_mfma_f32_16x16x32_bf16 v[108:111], v[56:59], a[252:255], v[108:111]
  v_mul_f32 v174, v174, v18
  v_mul_f32 v175, v175, v19
  v_mfma_f32_16x16x32_bf16 v[112:115], v[60:63], a[240:243], v[112:115]
  v_cvt_pk_bf16_f32 v28, v172, v173
  v_cvt_pk_bf16_f32 v29, v174, v175
  v_mfma_f32_16x16x32_bf16 v[116:119], v[60:63], a[244:247], v[116:119]
  v_mul_f32 v20, v156, v156
  v_mul_f32 v21, v157, v157
  v_mfma_f32_16x16x32_bf16 v[120:123], v[60:63], a[248:251], v[120:123]
  v_mul_f32 v22, v158, v158
  v_mul_f32 v23, v159, v159
  v_mfma_f32_16x16x32_bf16 v[124:127], v[60:63], a[252:255], v[124:127]
  v_fmamk_f32 v20, v20, 0xbdd2d3e8, v12
  v_fmamk_f32 v21, v21, 0xbdd2d3e8, v12
  s_waitcnt lgkmcnt(0)
  v_mfma_f32_16x16x32_bf16 v[64:67], v[32:35], v[192:195], v[64:67]
  ds_read_b64_tr_b16 v[48:49], v2 offset:34816
  v_fmamk_f32 v22, v22, 0xbdd2d3e8, v12
  v_mfma_f32_16x16x32_bf16 v[68:71], v[32:35], v[196:199], v[68:71]
  ds_read_b64_tr_b16 v[50:51], v2 offset:35072
  v_fmamk_f32 v23, v23, 0xbdd2d3e8, v12
  v_mfma_f32_16x16x32_bf16 v[72:75], v[32:35], v[200:203], v[72:75]
  ds_read_b64_tr_b16 v[52:53], v3 offset:34816
  v_mul_f32 v20, v20, v156
  v_mfma_f32_16x16x32_bf16 v[76:79], v[32:35], v[204:207], v[76:79]
  ds_read_b64_tr_b16 v[54:55], v3 offset:35072
  v_mul_f32 v21, v21, v157
  v_mfma_f32_16x16x32_bf16 v[80:83], v[36:39], v[192:195], v[80:83]
  ds_read_b64_tr_b16 v[56:57], v4 offset:34816
  v_mul_f32 v22, v22, v158
  v_mfma_f32_16x16x32_bf16 v[84:87], v[36:39], v[196:199], v[84:87]
  ds_read_b64_tr_b16 v[58:59], v4 offset:35072
  v_mul_f32 v23, v23, v159
  v_mfma_f32_16x16x32_bf16 v[88:91], v[36:39], v[200:203], v[88:91]
  ds_read_b64_tr_b16 v[60:61], v5 offset:34816
  v_mfma_f32_16x16x32_bf16 v[92:95], v[36:39], v[204:207], v[92:95]
  ds_read_b64_tr_b16 v[62:63], v5 offset:35072
  v_mfma_f32_16x16x32_bf16 v[96:99], v[40:43], v[192:195], v[96:99]
  v_exp_f32 v20, v20
  v_mfma_f32_16x16x32_bf16 v[100:103], v[40:43], v[196:199], v[100:103]
  v_exp_f32 v21, v21
  v_mfma_f32_16x16x32_bf16 v[104:107], v[40:43], v[200:203], v[104:107]
  v_exp_f32 v22, v22
  v_mfma_f32_16x16x32_bf16 v[108:111], v[40:43], v[204:207], v[108:111]
  v_exp_f32 v23, v23
  v_mfma_f32_16x16x32_bf16 v[112:115], v[44:47], v[192:195], v[112:115]
  v_mul_f32 v188, v156, v188
  v_mul_f32 v189, v157, v189
  v_mfma_f32_16x16x32_bf16 v[116:119], v[44:47], v[196:199], v[116:119]
  v_mul_f32 v190, v158, v190
  v_mul_f32 v191, v159, v191
  v_mfma_f32_16x16x32_bf16 v[120:123], v[44:47], v[200:203], v[120:123]
  v_add_f32 v20, 1.0, v20
  v_add_f32 v21, 1.0, v21
  v_mfma_f32_16x16x32_bf16 v[124:127], v[44:47], v[204:207], v[124:127]
  v_add_f32 v22, 1.0, v22
  v_add_f32 v23, 1.0, v23
  s_waitcnt vmcnt(4) lgkmcnt(0)
  s_barrier
  s_cmp_eq_u32 s43, 0
  s_cbranch_scc0 L_ffn_nosig1
  v_readfirstlane_b32 s73, v251
  s_cmp_ge_u32 s73, 64
  s_cbranch_scc1 L_ffn_zok
  v_mov_b32 v234, 0
L_ffn_zpoll:
  global_load_dword v235, v234, s[70:71] sc1
  s_waitcnt vmcnt(0)
  v_readfirstlane_b32 s73, v235
  s_cmp_ge_u32 s73, 64
  s_cbranch_scc1 L_ffn_zok
  s_sleep 4
  s_branch L_ffn_zpoll
L_ffn_zok:
  s_cmp_eq_u32 s28, 0
  s_cbranch_scc0 L_ffn_nosig1
  s_add_u32 s73, s72, 0
  s_lshl_b32 s73, s73, 7
  s_add_u32 s73, s73, 21430272
  v_mov_b32 v234, s73
  v_mov_b32 v235, 1
  s_mov_b64 s[80:81], exec
  s_mov_b64 exec, 1
  global_atomic_add v234, v235, s[54:55]
  s_mov_b64 exec, s[80:81]
L_ffn_nosig1:
  v_mfma_f32_16x16x32_bf16 v[64:67], v[48:51], v[208:211], v[64:67]
  ds_read_b64_tr_b16 v[32:33], v6 offset:0
  v_mfma_f32_16x16x32_bf16 v[68:71], v[48:51], v[212:215], v[68:71]
  ds_read_b64_tr_b16 v[34:35], v6 offset:256
  v_mfma_f32_16x16x32_bf16 v[72:75], v[48:51], v[216:219], v[72:75]
  ds_read_b64_tr_b16 v[36:37], v7 offset:0
  v_mfma_f32_16x16x32_bf16 v[76:79], v[48:51], v[220:223], v[76:79]
  ds_read_b64_tr_b16 v[38:39], v7 offset:256
  v_mfma_f32_16x16x32_bf16 v[80:83], v[52:55], v[208:211], v[80:83]
  ds_read_b64_tr_b16 v[40:41], v8 offset:0
  v_mfma_f32_16x16x32_bf16 v[84:87], v[52:55], v[212:215], v[84:87]
  ds_read_b64_tr_b16 v[42:43], v8 offset:256
  v_mfma_f32_16x16x32_bf16 v[88:91], v[52:55], v[216:219], v[88:91]
  ds_read_b64_tr_b16 v[44:45], v9 offset:0
  v_mfma_f32_16x16x32_bf16 v[92:95], v[52:55], v[220:223], v[92:95]
  ds_read_b64_tr_b16 v[46:47], v9 offset:256
  v_mfma_f32_16x16x32_bf16 v[96:99], v[56:59], v[208:211], v[96:99]
  v_rcp_f32 v20, v20
  v_mfma_f32_16x16x32_bf16 v[100:103], v[56:59], v[212:215], v[100:103]
  v_rcp_f32 v21, v21
  v_mfma_f32_16x16x32_bf16 v[104:107], v[56:59], v[216:219], v[104:107]
  v_rcp_f32 v22, v22
  v_mfma_f32_16x16x32_bf16 v[108:111], v[56:59], v[220:223], v[108:111]
  v_rcp_f32 v23, v23
  v_mfma_f32_16x16x32_bf16 v[112:115], v[60:63], v[208:211], v[112:115]
  v_mul_f32 v188, v188, v20
  v_mul_f32 v189, v189, v21
  v_mfma_f32_16x16x32_bf16 v[116:119], v[60:63], v[212:215], v[116:119]
  v_mul_f32 v190, v190, v22
  v_mul_f32 v191, v191, v23
  v_mfma_f32_16x16x32_bf16 v[120:123], v[60:63], v[216:219], v[120:123]
  v_cvt_pk_bf16_f32 v30, v188, v189
  v_cvt_pk_bf16_f32 v31, v190, v191
  v_mfma_f32_16x16x32_bf16 v[124:127], v[60:63], v[220:223], v[124:127]
  buffer_store_dwordx4 v[28:31], v11, s[20:23], s39 offen sc1
  s_add_u32 s40, s40, 64
  s_add_u32 s36, s36, 1024
  s_add_u32 s37, s37, 1024
  s_add_u32 s38, s38, 1024
  s_add_u32 s39, s39, 1024
  s_cmp_eq_u32 s43, 0
  s_cbranch_scc1 L_ffn_last
  s_waitcnt lgkmcnt(0)
  v_mfma_f32_16x16x32_bf16 v[128:131], v[32:35], a[0:3], 0
  ds_read_b64_tr_b16 v[48:49], v6 offset:2048
  v_mfma_f32_16x16x32_bf16 v[132:135], v[32:35], a[4:7], 0
  ds_read_b64_tr_b16 v[50:51], v6 offset:2304
  v_mfma_f32_16x16x32_bf16 v[136:139], v[32:35], a[8:11], 0
  ds_read_b64_tr_b16 v[52:53], v7 offset:2048
  v_mfma_f32_16x16x32_bf16 v[140:143], v[32:35], a[12:15], 0
  ds_read_b64_tr_b16 v[54:55], v7 offset:2304
  v_mfma_f32_16x16x32_bf16 v[144:147], v[36:39], a[0:3], 0
  ds_read_b64_tr_b16 v[56:57], v8 offset:2048
  v_mul_f32 v16, v64, v64
  v_mfma_f32_16x16x32_bf16 v[148:151], v[36:39], a[4:7], 0
  ds_read_b64_tr_b16 v[58:59], v8 offset:2304
  v_mul_f32 v17, v65, v65
  v_mfma_f32_16x16x32_bf16 v[152:155], v[36:39], a[8:11], 0
  ds_read_b64_tr_b16 v[60:61], v9 offset:2048
  v_mul_f32 v18, v66, v66
  v_mfma_f32_16x16x32_bf16 v[156:159], v[36:39], a[12:15], 0
  ds_read_b64_tr_b16 v[62:63], v9 offset:2304
  v_mul_f32 v19, v67, v67
  v_mfma_f32_16x16x32_bf16 v[160:163], v[40:43], a[0:3], 0
  s_add_u32 m0, s3, 0
  s_add_u32 s42, s40, 0
  v_fmamk_f32 v16, v16, 0xbdd2d3e8, v12
  v_fmamk_f32 v17, v17, 0xbdd2d3e8, v12
  v_mfma_f32_16x16x32_bf16 v[164:167], v[40:43], a[4:7], 0
  buffer_load_dwordx4 v10, s[12:15], s42 offen lds
  s_add_u32 m0, s3, 36864
  v_fmamk_f32 v18, v18, 0xbdd2d3e8, v12
  v_mfma_f32_16x16x32_bf16 v[168:171], v[40:43], a[8:11], 0
  buffer_load_dwordx4 v10, s[16:19], s42 offen lds
  v_fmamk_f32 v19, v19, 0xbdd2d3e8, v12
  v_mfma_f32_16x16x32_bf16 v[172:175], v[40:43], a[12:15], 0
  v_mul_f32 v16, v16, v64
  v_mul_f32 v17, v17, v65
  v_mfma_f32_16x16x32_bf16 v[176:179], v[44:47], a[0:3], 0
  v_mul_f32 v18, v18, v66
  v_mul_f32 v19, v19, v67
  v_mfma_f32_16x16x32_bf16 v[180:183], v[44:47], a[4:7], 0
  v_exp_f32 v16, v16
  v_mfma_f32_16x16x32_bf16 v[184:187], v[44:47], a[8:11], 0
  v_exp_f32 v17, v17
  v_mfma_f32_16x16x32_bf16 v[188:191], v[44:47], a[12:15], 0
  v_exp_f32 v18, v18
  s_waitcnt lgkmcnt(0)
  v_mfma_f32_16x16x32_bf16 v[128:131], v[48:51], a[16:19], v[128:131]
  ds_read_b64_tr_b16 v[32:33], v6 offset:4096
  v_mfma_f32_16x16x32_bf16 v[132:135], v[48:51], a[20:23], v[132:135]
  ds_read_b64_tr_b16 v[34:35], v6 offset:4352
  v_mfma_f32_16x16x32_bf16 v[136:139], v[48:51], a[24:27], v[136:139]
  ds_read_b64_tr_b16 v[36:37], v7 offset:4096
  v_mfma_f32_16x16x32_bf16 v[140:143], v[48:51], a[28:31], v[140:143]
  ds_read_b64_tr_b16 v[38:39], v7 offset:4352
  v_mfma_f32_16x16x32_bf16 v[144:147], v[52:55], a[16:19], v[144:147]
  ds_read_b64_tr_b16 v[40:41], v8 offset:4096
  v_mfma_f32_16x16x32_bf16 v[148:151], v[52:55], a[20:23], v[148:151]
  ds_read_b64_tr_b16 v[42:43], v8 offset:4352
  v_mfma_f32_16x16x32_bf16 v[152:155], v[52:55], a[24:27], v[152:155]
  ds_read_b64_tr_b16 v[44:45], v9 offset:4096
  v_mfma_f32_16x16x32_bf16 v[156:159], v[52:55], a[28:31], v[156:159]
  ds_read_b64_tr_b16 v[46:47], v9 offset:4352
  v_mfma_f32_16x16x32_bf16 v[160:163], v[56:59], a[16:19], v[160:163]
  s_add_u32 m0, s4, 0
  s_add_u32 s42, s40, 147456
  v_exp_f32 v19, v19
  v_mfma_f32_16x16x32_bf16 v[164:167], v[56:59], a[20:23], v[164:167]
  buffer_load_dwordx4 v10, s[12:15], s42 offen lds
  s_add_u32 m0, s4, 36864
  v_mul_f32 v96, v64, v96
  v_mfma_f32_16x16x32_bf16 v[168:171], v[56:59], a[24:27], v[168:171]
  buffer_load_dwordx4 v10, s[16:19], s42 offen lds
  v_mul_f32 v97, v65, v97
  v_mfma_f32_16x16x32_bf16 v[172:175], v[56:59], a[28:31], v[172:175]
  v_mul_f32 v98, v66, v98
  v_mul_f32 v99, v67, v99
  v_mfma_f32_16x16x32_bf16 v[176:179], v[60:63], a[16:19], v[176:179]
  v_add_f32 v16, 1.0, v16
  v_add_f32 v17, 1.0, v17
  v_mfma_f32_16x16x32_bf16 v[180:183], v[60:63], a[20:23], v[180:183]
  v_add_f32 v18, 1.0, v18
  v_add_f32 v19, 1.0, v19
  v_mfma_f32_16x16x32_bf16 v[184:187], v[60:63], a[24:27], v[184:187]
  v_rcp_f32 v16, v16
  v_mfma_f32_16x16x32_bf16 v[188:191], v[60:63], a[28:31], v[188:191]
  v_rcp_f32 v17, v17
  s_waitcnt lgkmcnt(0)
  v_mfma_f32_16x16x32_bf16 v[128:131], v[32:35], a[32:35], v[128:131]
  ds_read_b64_tr_b16 v[48:49], v6 offset:6144
  v_mfma_f32_16x16x32_bf16 v[132:135], v[32:35], a[36:39], v[132:135]
  ds_read_b64_tr_b16 v[50:51], v6 offset:6400
  v_mfma_f32_16x16x32_bf16 v[136:139], v[32:35], a[40:43], v[136:139]
  ds_read_b64_tr_b16 v[52:53], v7 offset:6144
  v_mfma_f32_16x16x32_bf16 v[140:143], v[32:35], a[44:47], v[140:143]
  ds_read_b64_tr_b16 v[54:55], v7 offset:6400
  v_mfma_f32_16x16x32_bf16 v[144:147], v[36:39], a[32:35], v[144:147]
  ds_read_b64_tr_b16 v[56:57], v8 offset:6144
  v_mfma_f32_16x16x32_bf16 v[148:151], v[36:39], a[36:39], v[148:151]
  ds_read_b64_tr_b16 v[58:59], v8 offset:6400
  v_mfma_f32_16x16x32_bf16 v[152:155], v[36:39], a[40:43], v[152:155]
  ds_read_b64_tr_b16 v[60:61], v9 offset:6144
  v_mfma_f32_16x16x32_bf16 v[156:159], v[36:39], a[44:47], v[156:159]
  ds_read_b64_tr_b16 v[62:63], v9 offset:6400
  v_mfma_f32_16x16x32_bf16 v[160:163], v[40:43], a[32:35], v[160:163]
  v_rcp_f32 v18, v18
  v_mfma_f32_16x16x32_bf16 v[164:167], v[40:43], a[36:39], v[164:167]
  v_rcp_f32 v19, v19
  v_mfma_f32_16x16x32_bf16 v[168:171], v[40:43], a[40:43], v[168:171]
  v_mul_f32 v96, v96, v16
  v_mul_f32 v97, v97, v17
  v_mfma_f32_16x16x32_bf16 v[172:175], v[40:43], a[44:47], v[172:175]
  v_mul_f32 v98, v98, v18
  v_mul_f32 v99, v99, v19
  v_mfma_f32_16x16x32_bf16 v[176:179], v[44:47], a[32:35], v[176:179]
  v_cvt_pk_bf16_f32 v24, v96, v97
  v_cvt_pk_bf16_f32 v25, v98, v99
  v_mfma_f32_16x16x32_bf16 v[180:183], v[44:47], a[36:39], v[180:183]
  v_mul_f32 v20, v80, v80
  v_mul_f32 v21, v81, v81
  v_mfma_f32_16x16x32_bf16 v[184:187], v[44:47], a[40:43], v[184:187]
  v_mul_f32 v22, v82, v82
  v_mul_f32 v23, v83, v83
  v_mfma_f32_16x16x32_bf16 v[188:191], v[44:47], a[44:47], v[188:191]
  v_fmamk_f32 v20, v20, 0xbdd2d3e8, v12
  v_fmamk_f32 v21, v21, 0xbdd2d3e8, v12
  s_waitcnt lgkmcnt(0)
  v_mfma_f32_16x16x32_bf16 v[128:131], v[48:51], a[48:51], v[128:131]
  ds_read_b64_tr_b16 v[32:33], v6 offset:8192
  v_fmamk_f32 v22, v22, 0xbdd2d3e8, v12
  v_mfma_f32_16x16x32_bf16 v[132:135], v[48:51], a[52:55], v[132:135]
  ds_read_b64_tr_b16 v[34:35], v6 offset:8448
  v_fmamk_f32 v23, v23, 0xbdd2d3e8, v12
  v_mfma_f32_16x16x32_bf16 v[136:139], v[48:51], a[56:59], v[136:139]
  ds_read_b64_tr_b16 v[36:37], v7 offset:8192
  v_mul_f32 v20, v20, v80
  v_mfma_f32_16x16x32_bf16 v[140:143], v[48:51], a[60:63], v[140:143]
  ds_read_b64_tr_b16 v[38:39], v7 offset:8448
  v_mul_f32 v21, v21, v81
  v_mfma_f32_16x16x32_bf16 v[144:147], v[52:55], a[48:51], v[144:147]
  ds_read_b64_tr_b16 v[40:41], v8 offset:8192
  v_mul_f32 v22, v22, v82
  v_mfma_f32_16x16x32_bf16 v[148:151], v[52:55], a[52:55], v[148:151]
  ds_read_b64_tr_b16 v[42:43], v8 offset:8448
  v_mul_f32 v23, v23, v83
  v_mfma_f32_16x16x32_bf16 v[152:155], v[52:55], a[56:59], v[152:155]
  ds_read_b64_tr_b16 v[44:45], v9 offset:8192
  v_mfma_f32_16x16x32_bf16 v[156:159], v[52:55], a[60:63], v[156:159]
  ds_read_b64_tr_b16 v[46:47], v9 offset:8448
  v_mfma_f32_16x16x32_bf16 v[160:163], v[56:59], a[48:51], v[160:163]
  s_add_u32 m0, s5, 0
  s_add_u32 s42, s40, 294912
  v_exp_f32 v20, v20
  v_mfma_f32_16x16x32_bf16 v[164:167], v[56:59], a[52:55], v[164:167]
  buffer_load_dwordx4 v10, s[12:15], s42 offen lds
  s_add_u32 m0, s5, 36864
  v_mfma_f32_16x16x32_bf16 v[168:171], v[56:59], a[56:59], v[168:171]
  buffer_load_dwordx4 v10, s[16:19], s42 offen lds
  v_mfma_f32_16x16x32_bf16 v[172:175], v[56:59], a[60:63], v[172:175]
  v_exp_f32 v21, v21
  v_mfma_f32_16x16x32_bf16 v[176:179], v[60:63], a[48:51], v[176:179]
  v_exp_f32 v22, v22
  v_mfma_f32_16x16x32_bf16 v[180:183], v[60:63], a[52:55], v[180:183]
  v_exp_f32 v23, v23
  v_mfma_f32_16x16x32_bf16 v[184:187], v[60:63], a[56:59], v[184:187]
  v_mul_f32 v112, v80, v112
  v_mul_f32 v113, v81, v113
  v_mfma_f32_16x16x32_bf16 v[188:191], v[60:63], a[60:63], v[188:191]
  v_mul_f32 v114, v82, v114
  v_mul_f32 v115, v83, v115
  s_waitcnt lgkmcnt(0)
  v_mfma_f32_16x16x32_bf16 v[128:131], v[32:35], a[64:67], v[128:131]
  ds_read_b64_tr_b16 v[48:49], v6 offset:10240
  v_add_f32 v20, 1.0, v20
  v_mfma_f32_16x16x32_bf16 v[132:135], v[32:35], a[68:71], v[132:135]
  ds_read_b64_tr_b16 v[50:51], v6 offset:10496
  v_add_f32 v21, 1.0, v21
  v_mfma_f32_16x16x32_bf16 v[136:139], v[32:35], a[72:75], v[136:139]
  ds_read_b64_tr_b16 v[52:53], v7 offset:10240
  v_add_f32 v22, 1.0, v22
  v_mfma_f32_16x16x32_bf16 v[140:143], v[32:35], a[76:79], v[140:143]
  ds_read_b64_tr_b16 v[54:55], v7 offset:10496
  v_add_f32 v23, 1.0, v23
  v_mfma_f32_16x16x32_bf16 v[144:147], v[36:39], a[64:67], v[144:147]
  ds_read_b64_tr_b16 v[56:57], v8 offset:10240
  v_mfma_f32_16x16x32_bf16 v[148:151], v[36:39], a[68:71], v[148:151]
  ds_read_b64_tr_b16 v[58:59], v8 offset:10496
  v_mfma_f32_16x16x32_bf16 v[152:155], v[36:39], a[72:75], v[152:155]
  ds_read_b64_tr_b16 v[60:61], v9 offset:10240
  v_mfma_f32_16x16x32_bf16 v[156:159], v[36:39], a[76:79], v[156:159]
  ds_read_b64_tr_b16 v[62:63], v9 offset:10496
  v_mfma_f32_16x16x32_bf16 v[160:163], v[40:43], a[64:67], v[160:163]
  s_add_u32 m0, s6, 0
  s_add_u32 s42, s40, 442368
  v_rcp_f32 v20, v20
  v_mfma_f32_16x16x32_bf16 v[164:167], v[40:43], a[68:71], v[164:167]
  buffer_load_dwordx4 v10, s[12:15], s42 offen lds
  s_add_u32 m0, s6, 36864
  v_mfma_f32_16x16x32_bf16 v[168:171], v[40:43], a[72:75], v[168:171]
  buffer_load_dwordx4 v10, s[16:19], s42 offen lds
  v_mfma_f32_16x16x32_bf16 v[172:175], v[40:43], a[76:79], v[172:175]
  v_rcp_f32 v21, v21
  v_mfma_f32_16x16x32_bf16 v[176:179], v[44:47], a[64:67], v[176:179]
  v_rcp_f32 v22, v22
  v_mfma_f32_16x16x32_bf16 v[180:183], v[44:47], a[68:71], v[180:183]
  v_rcp_f32 v23, v23
  v_mfma_f32_16x16x32_bf16 v[184:187], v[44:47], a[72:75], v[184:187]
  v_mul_f32 v112, v112, v20
  v_mul_f32 v113, v113, v21
  v_mfma_f32_16x16x32_bf16 v[188:191], v[44:47], a[76:79], v[188:191]
  v_mul_f32 v114, v114, v22
  v_mul_f32 v115, v115, v23
  s_waitcnt lgkmcnt(0)
  v_mfma_f32_16x16x32_bf16 v[128:131], v[48:51], a[80:83], v[128:131]
  ds_read_b64_tr_b16 v[32:33], v6 offset:12288
  v_cvt_pk_bf16_f32 v26, v112, v113
  v_mfma_f32_16x16x32_bf16 v[132:135], v[48:51], a[84:87], v[132:135]
  ds_read_b64_tr_b16 v[34:35], v6 offset:12544
  v_cvt_pk_bf16_f32 v27, v114, v115
  v_mfma_f32_16x16x32_bf16 v[136:139], v[48:51], a[88:91], v[136:139]
  ds_read_b64_tr_b16 v[36:37], v7 offset:12288
  buffer_store_dwordx4 v[24:27], v11, s[20:23], s36 offen sc1
  v_mfma_f32_16x16x32_bf16 v[140:143], v[48:51], a[92:95], v[140:143]
  ds_read_b64_tr_b16 v[38:39], v7 offset:12544
  v_mul_f32 v16, v68, v68
  v_mfma_f32_16x16x32_bf16 v[144:147], v[52:55], a[80:83], v[144:147]
  ds_read_b64_tr_b16 v[40:41], v8 offset:12288
  v_mul_f32 v17, v69, v69
  v_mfma_f32_16x16x32_bf16 v[148:151], v[52:55], a[84:87], v[148:151]
  ds_read_b64_tr_b16 v[42:43], v8 offset:12544
  v_mul_f32 v18, v70, v70
  v_mfma_f32_16x16x32_bf16 v[152:155], v[52:55], a[88:91], v[152:155]
  ds_read_b64_tr_b16 v[44:45], v9 offset:12288
  v_mul_f32 v19, v71, v71
  v_mfma_f32_16x16x32_bf16 v[156:159], v[52:55], a[92:95], v[156:159]
  ds_read_b64_tr_b16 v[46:47], v9 offset:12544
  v_fmamk_f32 v16, v16, 0xbdd2d3e8, v12
  v_mfma_f32_16x16x32_bf16 v[160:163], v[56:59], a[80:83], v[160:163]
  v_fmamk_f32 v17, v17, 0xbdd2d3e8, v12
  v_fmamk_f32 v18, v18, 0xbdd2d3e8, v12
  v_mfma_f32_16x16x32_bf16 v[164:167], v[56:59], a[84:87], v[164:167]
  v_fmamk_f32 v19, v19, 0xbdd2d3e8, v12
  v_mul_f32 v16, v16, v68
  v_mfma_f32_16x16x32_bf16 v[168:171], v[56:59], a[88:91], v[168:171]
  v_mul_f32 v17, v17, v69
  v_mul_f32 v18, v18, v70
  v_mfma_f32_16x16x32_bf16 v[172:175], v[56:59], a[92:95], v[172:175]
  v_mul_f32 v19, v19, v71
  v_mfma_f32_16x16x32_bf16 v[176:179], v[60:63], a[80:83], v[176:179]
  v_exp_f32 v16, v16
  v_mfma_f32_16x16x32_bf16 v[180:183], v[60:63], a[84:87], v[180:183]
  v_exp_f32 v17, v17
  v_mfma_f32_16x16x32_bf16 v[184:187], v[60:63], a[88:91], v[184:187]
  v_exp_f32 v18, v18
  v_mfma_f32_16x16x32_bf16 v[188:191], v[60:63], a[92:95], v[188:191]
  v_exp_f32 v19, v19
  s_waitcnt lgkmcnt(0)
  v_mfma_f32_16x16x32_bf16 v[128:131], v[32:35], a[96:99], v[128:131]
  ds_read_b64_tr_b16 v[48:49], v6 offset:14336
  v_mul_f32 v100, v68, v100
  v_mfma_f32_16x16x32_bf16 v[132:135], v[32:35], a[100:103], v[132:135]
  ds_read_b64_tr_b16 v[50:51], v6 offset:14592
  v_mul_f32 v101, v69, v101
  v_mfma_f32_16x16x32_bf16 v[136:139], v[32:35], a[104:107], v[136:139]
  ds_read_b64_tr_b16 v[52:53], v7 offset:14336
  v_mul_f32 v102, v70, v102
  v_mfma_f32_16x16x32_bf16 v[140:143], v[32:35], a[108:111], v[140:143]
  ds_read_b64_tr_b16 v[54:55], v7 offset:14592
  v_mul_f32 v103, v71, v103
  v_mfma_f32_16x16x32_bf16 v[144:147], v[36:39], a[96:99], v[144:147]
  ds_read_b64_tr_b16 v[56:57], v8 offset:14336
  v_add_f32 v16, 1.0, v16
  v_mfma_f32_16x16x32_bf16 v[148:151], v[36:39], a[100:103], v[148:151]
  ds_read_b64_tr_b16 v[58:59], v8 offset:14592
  v_add_f32 v17, 1.0, v17
  v_mfma_f32_16x16x32_bf16 v[152:155], v[36:39], a[104:107], v[152:155]
  ds_read_b64_tr_b16 v[60:61], v9 offset:14336
  v_add_f32 v18, 1.0, v18
  v_mfma_f32_16x16x32_bf16 v[156:159], v[36:39], a[108:111], v[156:159]
  ds_read_b64_tr_b16 v[62:63], v9 offset:14592
  v_add_f32 v19, 1.0, v19
  v_mfma_f32_16x16x32_bf16 v[160:163], v[40:43], a[96:99], v[160:163]
  s_add_u32 m0, s7, 0
  s_add_u32 s42, s40, 589824
  v_rcp_f32 v16, v16
  v_mfma_f32_16x16x32_bf16 v[164:167], v[40:43], a[100:103], v[164:167]
  buffer_load_dwordx4 v10, s[12:15], s42 offen lds
  s_add_u32 m0, s7, 36864
  v_mfma_f32_16x16x32_bf16 v[168:171], v[40:43], a[104:107], v[168:171]
  buffer_load_dwordx4 v10, s[16:19], s42 offen lds
  v_mfma_f32_16x16x32_bf16 v[172:175], v[40:43], a[108:111], v[172:175]
  v_rcp_f32 v17, v17
  v_mfma_f32_16x16x32_bf16 v[176:179], v[44:47], a[96:99], v[176:179]
  v_rcp_f32 v18, v18
  v_mfma_f32_16x16x32_bf16 v[180:183], v[44:47], a[100:103], v[180:183]
  v_rcp_f32 v19, v19
  v_mfma_f32_16x16x32_bf16 v[184:187], v[44:47], a[104:107], v[184:187]
  v_mul_f32 v100, v100, v16
  v_mul_f32 v101, v101, v17
  v_mfma_f32_16x16x32_bf16 v[188:191], v[44:47], a[108:111], v[188:191]
  v_mul_f32 v102, v102, v18
  v_mul_f32 v103, v103, v19
  s_waitcnt lgkmcnt(0)
  v_mfma_f32_16x16x32_bf16 v[128:131], v[48:51], a[112:115], v[128:131]
  ds_read_b64_tr_b16 v[32:33], v6 offset:16384
  v_cvt_pk_bf16_f32 v28, v100, v101
  v_mfma_f32_16x16x32_bf16 v[132:135], v[48:51], a[116:119], v[132:135]
  ds_read_b64_tr_b16 v[34:35], v6 offset:16640
  v_cvt_pk_bf16_f32 v29, v102, v103
  v_mfma_f32_16x16x32_bf16 v[136:139], v[48:51], a[120:123], v[136:139]
  ds_read_b64_tr_b16 v[36:37], v7 offset:16384
  v_mul_f32 v20, v84, v84
  v_mfma_f32_16x16x32_bf16 v[140:143], v[48:51], a[124:127], v[140:143]
  ds_read_b64_tr_b16 v[38:39], v7 offset:16640
  v_mul_f32 v21, v85, v85
  v_mfma_f32_16x16x32_bf16 v[144:147], v[52:55], a[112:115], v[144:147]
  ds_read_b64_tr_b16 v[40:41], v8 offset:16384
  v_mul_f32 v22, v86, v86
  v_mfma_f32_16x16x32_bf16 v[148:151], v[52:55], a[116:119], v[148:151]
  ds_read_b64_tr_b16 v[42:43], v8 offset:16640
  v_mul_f32 v23, v87, v87
  v_mfma_f32_16x16x32_bf16 v[152:155], v[52:55], a[120:123], v[152:155]
  ds_read_b64_tr_b16 v[44:45], v9 offset:16384
  v_fmamk_f32 v20, v20, 0xbdd2d3e8, v12
  v_mfma_f32_16x16x32_bf16 v[156:159], v[52:55], a[124:127], v[156:159]
  ds_read_b64_tr_b16 v[46:47], v9 offset:16640
  v_fmamk_f32 v21, v21, 0xbdd2d3e8, v12
  v_mfma_f32_16x16x32_bf16 v[160:163], v[56:59], a[112:115], v[160:163]
  s_add_u32 m0, s29, 0
  s_add_u32 s42, s40, 737280
  v_fmamk_f32 v22, v22, 0xbdd2d3e8, v12
  v_fmamk_f32 v23, v23, 0xbdd2d3e8, v12
  v_mfma_f32_16x16x32_bf16 v[164:167], v[56:59], a[116:119], v[164:167]
  buffer_load_dwordx4 v10, s[12:15], s42 offen lds
  s_add_u32 m0, s29, 36864
  v_mul_f32 v20, v20, v84
  v_mfma_f32_16x16x32_bf16 v[168:171], v[56:59], a[120:123], v[168:171]
  buffer_load_dwordx4 v10, s[16:19], s42 offen lds
  v_mul_f32 v21, v21, v85
  v_mfma_f32_16x16x32_bf16 v[172:175], v[56:59], a[124:127], v[172:175]
  v_mul_f32 v22, v22, v86
  v_mul_f32 v23, v23, v87
  v_mfma_f32_16x16x32_bf16 v[176:179], v[60:63], a[112:115], v[176:179]
  v_exp_f32 v20, v20
  v_mfma_f32_16x16x32_bf16 v[180:183], v[60:63], a[116:119], v[180:183]
  v_exp_f32 v21, v21
  v_mfma_f32_16x16x32_bf16 v[184:187], v[60:63], a[120:123], v[184:187]
  v_exp_f32 v22, v22
  v_mfma_f32_16x16x32_bf16 v[188:191], v[60:63], a[124:127], v[188:191]
  v_exp_f32 v23, v23
  s_waitcnt lgkmcnt(0)
  v_mfma_f32_16x16x32_bf16 v[128:131], v[32:35], a[128:131], v[128:131]
  ds_read_b64_tr_b16 v[48:49], v6 offset:18432
  v_mul_f32 v116, v84, v116
  v_mfma_f32_16x16x32_bf16 v[132:135], v[32:35], a[132:135], v[132:135]
  ds_read_b64_tr_b16 v[50:51], v6 offset:18688
  v_mul_f32 v117, v85, v117
  v_mfma_f32_16x16x32_bf16 v[136:139], v[32:35], a[136:139], v[136:139]
  ds_read_b64_tr_b16 v[52:53], v7 offset:18432
  v_mul_f32 v118, v86, v118
  v_mfma_f32_16x16x32_bf16 v[140:143], v[32:35], a[140:143], v[140:143]
  ds_read_b64_tr_b16 v[54:55], v7 offset:18688
  v_mul_f32 v119, v87, v119
  v_mfma_f32_16x16x32_bf16 v[144:147], v[36:39], a[128:131], v[144:147]
  ds_read_b64_tr_b16 v[56:57], v8 offset:18432
  v_add_f32 v20, 1.0, v20
  v_mfma_f32_16x16x32_bf16 v[148:151], v[36:39], a[132:135], v[148:151]
  ds_read_b64_tr_b16 v[58:59], v8 offset:18688
  v_add_f32 v21, 1.0, v21
  v_mfma_f32_16x16x32_bf16 v[152:155], v[36:39], a[136:139], v[152:155]
  ds_read_b64_tr_b16 v[60:61], v9 offset:18432
  v_add_f32 v22, 1.0, v22
  v_mfma_f32_16x16x32_bf16 v[156:159], v[36:39], a[140:143], v[156:159]
  ds_read_b64_tr_b16 v[62:63], v9 offset:18688
  v_add_f32 v23, 1.0, v23
  v_mfma_f32_16x16x32_bf16 v[160:163], v[40:43], a[128:131], v[160:163]
  v_rcp_f32 v20, v20
  v_mfma_f32_16x16x32_bf16 v[164:167], v[40:43], a[132:135], v[164:167]
  v_rcp_f32 v21, v21
  v_mfma_f32_16x16x32_bf16 v[168:171], v[40:43], a[136:139], v[168:171]
  v_rcp_f32 v22, v22
  v_mfma_f32_16x16x32_bf16 v[172:175], v[40:43], a[140:143], v[172:175]
  v_rcp_f32 v23, v23
  v_mfma_f32_16x16x32_bf16 v[176:179], v[44:47], a[128:131], v[176:179]
  v_mul_f32 v116, v116, v20
  v_mul_f32 v117, v117, v21
  v_mfma_f32_16x16x32_bf16 v[180:183], v[44:47], a[132:135], v[180:183]
  v_mul_f32 v118, v118, v22
  v_mul_f32 v119, v119, v23
  v_mfma_f32_16x16x32_bf16 v[184:187], v[44:47], a[136:139], v[184:187]
  v_cvt_pk_bf16_f32 v30, v116, v117
  v_cvt_pk_bf16_f32 v31, v118, v119
  v_mfma_f32_16x16x32_bf16 v[188:191], v[44:47], a[140:143], v[188:191]
  buffer_store_dwordx4 v[28:31], v11, s[20:23], s37 offen sc1
  v_mul_f32 v16, v72, v72
  s_waitcnt lgkmcnt(0)
  v_mfma_f32_16x16x32_bf16 v[128:131], v[48:51], a[144:147], v[128:131]
  ds_read_b64_tr_b16 v[32:33], v6 offset:20480
  v_mul_f32 v17, v73, v73
  v_mfma_f32_16x16x32_bf16 v[132:135], v[48:51], a[148:151], v[132:135]
  ds_read_b64_tr_b16 v[34:35], v6 offset:20736
  v_mul_f32 v18, v74, v74
  v_mfma_f32_16x16x32_bf16 v[136:139], v[48:51], a[152:155], v[136:139]
  ds_read_b64_tr_b16 v[36:37], v7 offset:20480
  v_mul_f32 v19, v75, v75
  v_mfma_f32_16x16x32_bf16 v[140:143], v[48:51], a[156:159], v[140:143]
  ds_read_b64_tr_b16 v[38:39], v7 offset:20736
  v_fmamk_f32 v16, v16, 0xbdd2d3e8, v12
  v_mfma_f32_16x16x32_bf16 v[144:147], v[52:55], a[144:147], v[144:147]
  ds_read_b64_tr_b16 v[40:41], v8 offset:20480
  v_fmamk_f32 v17, v17, 0xbdd2d3e8, v12
  v_mfma_f32_16x16x32_bf16 v[148:151], v[52:55], a[148:151], v[148:151]
  ds_read_b64_tr_b16 v[42:43], v8 offset:20736
  v_fmamk_f32 v18, v18, 0xbdd2d3e8, v12
  v_mfma_f32_16x16x32_bf16 v[152:155], v[52:55], a[152:155], v[152:155]
  ds_read_b64_tr_b16 v[44:45], v9 offset:20480
  v_fmamk_f32 v19, v19, 0xbdd2d3e8, v12
  v_mfma_f32_16x16x32_bf16 v[156:159], v[52:55], a[156:159], v[156:159]
  ds_read_b64_tr_b16 v[46:47], v9 offset:20736
  v_mul_f32 v16, v16, v72
  v_mfma_f32_16x16x32_bf16 v[160:163], v[56:59], a[144:147], v[160:163]
  s_add_u32 m0, s30, 0
  s_add_u32 s42, s40, 884736
  v_mul_f32 v17, v17, v73
  v_mul_f32 v18, v18, v74
  v_mfma_f32_16x16x32_bf16 v[164:167], v[56:59], a[148:151], v[164:167]
  buffer_load_dwordx4 v10, s[12:15], s42 offen lds
  s_add_u32 m0, s30, 36864
  v_mul_f32 v19, v19, v75
  v_mfma_f32_16x16x32_bf16 v[168:171], v[56:59], a[152:155], v[168:171]
  buffer_load_dwordx4 v10, s[16:19], s42 offen lds
  v_mfma_f32_16x16x32_bf16 v[172:175], v[56:59], a[156:159], v[172:175]
  v_exp_f32 v16, v16
  v_mfma_f32_16x16x32_bf16 v[176:179], v[60:63], a[144:147], v[176:179]
  v_exp_f32 v17, v17
  v_mfma_f32_16x16x32_bf16 v[180:183], v[60:63], a[148:151], v[180:183]
  v_exp_f32 v18, v18
  v_mfma_f32_16x16x32_bf16 v[184:187], v[60:63], a[152:155], v[184:187]
  v_exp_f32 v19, v19
  v_mfma_f32_16x16x32_bf16 v[188:191], v[60:63], a[156:159], v[188:191]
  v_mul_f32 v104, v72, v104
  v_mul_f32 v105, v73, v105
  s_waitcnt lgkmcnt(0)
  v_mfma_f32_16x16x32_bf16 v[128:131], v[32:35], a[160:163], v[128:131]
  ds_read_b64_tr_b16 v[48:49], v6 offset:22528
  v_mul_f32 v106, v74, v106
  v_mfma_f32_16x16x32_bf16 v[132:135], v[32:35], a[164:167], v[132:135]
  ds_read_b64_tr_b16 v[50:51], v6 offset:22784
  v_mul_f32 v107, v75, v107
  v_mfma_f32_16x16x32_bf16 v[136:139], v[32:35], a[168:171], v[136:139]
  ds_read_b64_tr_b16 v[52:53], v7 offset:22528
  v_add_f32 v16, 1.0, v16
  v_mfma_f32_16x16x32_bf16 v[140:143], v[32:35], a[172:175], v[140:143]
  ds_read_b64_tr_b16 v[54:55], v7 offset:22784
  v_add_f32 v17, 1.0, v17
  v_mfma_f32_16x16x32_bf16 v[144:147], v[36:39], a[160:163], v[144:147]
  ds_read_b64_tr_b16 v[56:57], v8 offset:22528
  v_add_f32 v18, 1.0, v18
  v_mfma_f32_16x16x32_bf16 v[148:151], v[36:39], a[164:167], v[148:151]
  ds_read_b64_tr_b16 v[58:59], v8 offset:22784
  v_add_f32 v19, 1.0, v19
  v_mfma_f32_16x16x32_bf16 v[152:155], v[36:39], a[168:171], v[152:155]
  ds_read_b64_tr_b16 v[60:61], v9 offset:22528
  v_mfma_f32_16x16x32_bf16 v[156:159], v[36:39], a[172:175], v[156:159]
  ds_read_b64_tr_b16 v[62:63], v9 offset:22784
  v_mfma_f32_16x16x32_bf16 v[160:163], v[40:43], a[160:163], v[160:163]
  s_add_u32 m0, s31, 0
  s_add_u32 s42, s40, 1032192
  v_rcp_f32 v16, v16
  v_mfma_f32_16x16x32_bf16 v[164:167], v[40:43], a[164:167], v[164:167]
  buffer_load_dwordx4 v10, s[12:15], s42 offen lds
  s_add_u32 m0, s31, 36864
  v_mfma_f32_16x16x32_bf16 v[168:171], v[40:43], a[168:171], v[168:171]
  buffer_load_dwordx4 v10, s[16:19], s42 offen lds
  v_mfma_f32_16x16x32_bf16 v[172:175], v[40:43], a[172:175], v[172:175]
  v_rcp_f32 v17, v17
  v_mfma_f32_16x16x32_bf16 v[176:179], v[44:47], a[160:163], v[176:179]
  v_rcp_f32 v18, v18
  v_mfma_f32_16x16x32_bf16 v[180:183], v[44:47], a[164:167], v[180:183]
  v_rcp_f32 v19, v19
  v_mfma_f32_16x16x32_bf16 v[184:187], v[44:47], a[168:171], v[184:187]
  v_mul_f32 v104, v104, v16
  v_mul_f32 v105, v105, v17
  v_mfma_f32_16x16x32_bf16 v[188:191], v[44:47], a[172:175], v[188:191]
  v_mul_f32 v106, v106, v18
  v_mul_f32 v107, v107, v19
  s_waitcnt lgkmcnt(0)
  v_mfma_f32_16x16x32_bf16 v[128:131], v[48:51], a[176:179], v[128:131]
  ds_read_b64_tr_b16 v[32:33], v6 offset:24576
  v_cvt_pk_bf16_f32 v24, v104, v105
  v_mfma_f32_16x16x32_bf16 v[132:135], v[48:51], a[180:183], v[132:135]
  ds_read_b64_tr_b16 v[34:35], v6 offset:24832
  v_cvt_pk_bf16_f32 v25, v106, v107
  v_mfma_f32_16x16x32_bf16 v[136:139], v[48:51], a[184:187], v[136:139]
  ds_read_b64_tr_b16 v[36:37], v7 offset:24576
  v_mul_f32 v20, v88, v88
  v_mfma_f32_16x16x32_bf16 v[140:143], v[48:51], a[188:191], v[140:143]
  ds_read_b64_tr_b16 v[38:39], v7 offset:24832
  v_mul_f32 v21, v89, v89
  v_mfma_f32_16x16x32_bf16 v[144:147], v[52:55], a[176:179], v[144:147]
  ds_read_b64_tr_b16 v[40:41], v8 offset:24576
  v_mul_f32 v22, v90, v90
  v_mfma_f32_16x16x32_bf16 v[148:151], v[52:55], a[180:183], v[148:151]
  ds_read_b64_tr_b16 v[42:43], v8 offset:24832
  v_mul_f32 v23, v91, v91
  v_mfma_f32_16x16x32_bf16 v[152:155], v[52:55], a[184:187], v[152:155]
  ds_read_b64_tr_b16 v[44:45], v9 offset:24576
  v_fmamk_f32 v20, v20, 0xbdd2d3e8, v12
  v_mfma_f32_16x16x32_bf16 v[156:159], v[52:55], a[188:191], v[156:159]
  ds_read_b64_tr_b16 v[46:47], v9 offset:24832
  v_fmamk_f32 v21, v21, 0xbdd2d3e8, v12
  v_mfma_f32_16x16x32_bf16 v[160:163], v[56:59], a[176:179], v[160:163]
  v_fmamk_f32 v22, v22, 0xbdd2d3e8, v12
  v_fmamk_f32 v23, v23, 0xbdd2d3e8, v12
  v_mfma_f32_16x16x32_bf16 v[164:167], v[56:59], a[180:183], v[164:167]
  v_mul_f32 v20, v20, v88
  v_mul_f32 v21, v21, v89
  v_mfma_f32_16x16x32_bf16 v[168:171], v[56:59], a[184:187], v[168:171]
  v_mul_f32 v22, v22, v90
  v_mul_f32 v23, v23, v91
  v_mfma_f32_16x16x32_bf16 v[172:175], v[56:59], a[188:191], v[172:175]
  v_exp_f32 v20, v20
  v_mfma_f32_16x16x32_bf16 v[176:179], v[60:63], a[176:179], v[176:179]
  v_exp_f32 v21, v21
  v_mfma_f32_16x16x32_bf16 v[180:183], v[60:63], a[180:183], v[180:183]
  v_exp_f32 v22, v22
  v_mfma_f32_16x16x32_bf16 v[184:187], v[60:63], a[184:187], v[184:187]
  v_exp_f32 v23, v23
  v_mfma_f32_16x16x32_bf16 v[188:191], v[60:63], a[188:191], v[188:191]
  v_mul_f32 v120, v88, v120
  v_mul_f32 v121, v89, v121
  s_waitcnt lgkmcnt(0)
  v_mfma_f32_16x16x32_bf16 v[128:131], v[32:35], a[192:195], v[128:131]
  ds_read_b64_tr_b16 v[48:49], v6 offset:26624
  v_mul_f32 v122, v90, v122
  v_mfma_f32_16x16x32_bf16 v[132:135], v[32:35], a[196:199], v[132:135]
  ds_read_b64_tr_b16 v[50:51], v6 offset:26880
  v_mul_f32 v123, v91, v123
  v_mfma_f32_16x16x32_bf16 v[136:139], v[32:35], a[200:203], v[136:139]
  ds_read_b64_tr_b16 v[52:53], v7 offset:26624
  v_add_f32 v20, 1.0, v20
  v_mfma_f32_16x16x32_bf16 v[140:143], v[32:35], a[204:207], v[140:143]
  ds_read_b64_tr_b16 v[54:55], v7 offset:26880
  v_add_f32 v21, 1.0, v21
  v_mfma_f32_16x16x32_bf16 v[144:147], v[36:39], a[192:195], v[144:147]
  ds_read_b64_tr_b16 v[56:57], v8 offset:26624
  v_add_f32 v22, 1.0, v22
  v_mfma_f32_16x16x32_bf16 v[148:151], v[36:39], a[196:199], v[148:151]
  ds_read_b64_tr_b16 v[58:59], v8 offset:26880
  v_add_f32 v23, 1.0, v23
  v_mfma_f32_16x16x32_bf16 v[152:155], v[36:39], a[200:203], v[152:155]
  ds_read_b64_tr_b16 v[60:61], v9 offset:26624
  v_mfma_f32_16x16x32_bf16 v[156:159], v[36:39], a[204:207], v[156:159]
  ds_read_b64_tr_b16 v[62:63], v9 offset:26880
  v_mfma_f32_16x16x32_bf16 v[160:163], v[40:43], a[192:195], v[160:163]
  s_add_u32 m0, s45, 0
  s_add_u32 s42, s40, 1179648
  v_rcp_f32 v20, v20
  v_mfma_f32_16x16x32_bf16 v[164:167], v[40:43], a[196:199], v[164:167]
  buffer_load_dwordx4 v10, s[12:15], s42 offen lds
  s_add_u32 m0, s45, 36864
  v_mfma_f32_16x16x32_bf16 v[168:171], v[40:43], a[200:203], v[168:171]
  buffer_load_dwordx4 v10, s[16:19], s42 offen lds
  v_mfma_f32_16x16x32_bf16 v[172:175], v[40:43], a[204:207], v[172:175]
  v_rcp_f32 v21, v21
  v_mfma_f32_16x16x32_bf16 v[176:179], v[44:47], a[192:195], v[176:179]
  v_rcp_f32 v22, v22
  v_mfma_f32_16x16x32_bf16 v[180:183], v[44:47], a[196:199], v[180:183]
  v_rcp_f32 v23, v23
  v_mfma_f32_16x16x32_bf16 v[184:187], v[44:47], a[200:203], v[184:187]
  v_mul_f32 v120, v120, v20
  v_mul_f32 v121, v121, v21
  v_mfma_f32_16x16x32_bf16 v[188:191], v[44:47], a[204:207], v[188:191]
  v_mul_f32 v122, v122, v22
  v_mul_f32 v123, v123, v23
  s_waitcnt lgkmcnt(0)
  v_mfma_f32_16x16x32_bf16 v[128:131], v[48:51], a[208:211], v[128:131]
  ds_read_b64_tr_b16 v[32:33], v6 offset:28672
  v_cvt_pk_bf16_f32 v26, v120, v121
  v_mfma_f32_16x16x32_bf16 v[132:135], v[48:51], a[212:215], v[132:135]
  ds_read_b64_tr_b16 v[34:35], v6 offset:28928
  v_cvt_pk_bf16_f32 v27, v122, v123
  v_mfma_f32_16x16x32_bf16 v[136:139], v[48:51], a[216:219], v[136:139]
  ds_read_b64_tr_b16 v[36:37], v7 offset:28672
  buffer_store_dwordx4 v[24:27], v11, s[20:23], s38 offen sc1
  v_mfma_f32_16x16x32_bf16 v[140:143], v[48:51], a[220:223], v[140:143]
  ds_read_b64_tr_b16 v[38:39], v7 offset:28928
  v_mul_f32 v16, v76, v76
  v_mfma_f32_16x16x32_bf16 v[144:147], v[52:55], a[208:211], v[144:147]
  ds_read_b64_tr_b16 v[40:41], v8 offset:28672
  v_mul_f32 v17, v77, v77
  v_mfma_f32_16x16x32_bf16 v[148:151], v[52:55], a[212:215], v[148:151]
  ds_read_b64_tr_b16 v[42:43], v8 offset:28928
  v_mul_f32 v18, v78, v78
  v_mfma_f32_16x16x32_bf16 v[152:155], v[52:55], a[216:219], v[152:155]
  ds_read_b64_tr_b16 v[44:45], v9 offset:28672
  v_mul_f32 v19, v79, v79
  v_mfma_f32_16x16x32_bf16 v[156:159], v[52:55], a[220:223], v[156:159]
  ds_read_b64_tr_b16 v[46:47], v9 offset:28928
  v_fmamk_f32 v16, v16, 0xbdd2d3e8, v12
  v_mfma_f32_16x16x32_bf16 v[160:163], v[56:59], a[208:211], v[160:163]
  s_cmp_eq_u32 s82, 2
  s_cselect_b32 s78, 5308416, 0
  v_fmamk_f32 v17, v17, 0xbdd2d3e8, v12
  v_fmamk_f32 v18, v18, 0xbdd2d3e8, v12
  v_mfma_f32_16x16x32_bf16 v[164:167], v[56:59], a[212:215], v[164:167]
  buffer_load_dword v250, v252, s[76:79], s75 offen
  s_sub_u32 s69, s82, 2
  v_fmamk_f32 v19, v19, 0xbdd2d3e8, v12
  v_mfma_f32_16x16x32_bf16 v[168:171], v[56:59], a[216:219], v[168:171]
  s_max_u32 s91, s28, 2
  s_cmp_eq_u32 s82, 4
  v_mul_f32 v16, v16, v76
  v_mul_f32 v17, v17, v77
  v_mfma_f32_16x16x32_bf16 v[172:175], v[56:59], a[220:223], v[172:175]
  s_cselect_b32 s69, s91, s69
  s_cmp_eq_u32 s69, s28
  v_mul_f32 v18, v18, v78
  v_mul_f32 v19, v19, v79
  v_mfma_f32_16x16x32_bf16 v[176:179], v[60:63], a[208:211], v[176:179]
  s_cselect_b32 s58, 5308416, 0
  buffer_load_dword v250, v253, s[56:59], s88 offen
  v_mfma_f32_16x16x32_bf16 v[180:183], v[60:63], a[212:215], v[180:183]
  s_add_u32 s69, s88, 18432
  buffer_load_dword v250, v253, s[56:59], s69 offen
  v_mfma_f32_16x16x32_bf16 v[184:187], v[60:63], a[216:219], v[184:187]
  s_mov_b32 s58, 5308416
  s_add_u32 s82, s82, 1
  v_exp_f32 v16, v16
  v_mfma_f32_16x16x32_bf16 v[188:191], v[60:63], a[220:223], v[188:191]
  v_exp_f32 v17, v17
  s_waitcnt lgkmcnt(0)
  v_mfma_f32_16x16x32_bf16 v[128:131], v[32:35], a[224:227], v[128:131]
  ds_read_b64_tr_b16 v[48:49], v6 offset:30720
  v_mfma_f32_16x16x32_bf16 v[132:135], v[32:35], a[228:231], v[132:135]
  ds_read_b64_tr_b16 v[50:51], v6 offset:30976
  v_mfma_f32_16x16x32_bf16 v[136:139], v[32:35], a[232:235], v[136:139]
  ds_read_b64_tr_b16 v[52:53], v7 offset:30720
  v_mfma_f32_16x16x32_bf16 v[140:143], v[32:35], a[236:239], v[140:143]
  ds_read_b64_tr_b16 v[54:55], v7 offset:30976
  v_mfma_f32_16x16x32_bf16 v[144:147], v[36:39], a[224:227], v[144:147]
  ds_read_b64_tr_b16 v[56:57], v8 offset:30720
  v_mfma_f32_16x16x32_bf16 v[148:151], v[36:39], a[228:231], v[148:151]
  ds_read_b64_tr_b16 v[58:59], v8 offset:30976
  v_mfma_f32_16x16x32_bf16 v[152:155], v[36:39], a[232:235], v[152:155]
  ds_read_b64_tr_b16 v[60:61], v9 offset:30720
  v_mfma_f32_16x16x32_bf16 v[156:159], v[36:39], a[236:239], v[156:159]
  ds_read_b64_tr_b16 v[62:63], v9 offset:30976
  v_mfma_f32_16x16x32_bf16 v[160:163], v[40:43], a[224:227], v[160:163]
  v_exp_f32 v18, v18
  v_mfma_f32_16x16x32_bf16 v[164:167], v[40:43], a[228:231], v[164:167]
  v_exp_f32 v19, v19
  v_mfma_f32_16x16x32_bf16 v[168:171], v[40:43], a[232:235], v[168:171]
  v_mul_f32 v108, v76, v108
  v_mul_f32 v109, v77, v109
  v_mfma_f32_16x16x32_bf16 v[172:175], v[40:43], a[236:239], v[172:175]
  v_mul_f32 v110, v78, v110
  v_mul_f32 v111, v79, v111
  v_mfma_f32_16x16x32_bf16 v[176:179], v[44:47], a[224:227], v[176:179]
  v_add_f32 v16, 1.0, v16
  v_add_f32 v17, 1.0, v17
  v_mfma_f32_16x16x32_bf16 v[180:183], v[44:47], a[228:231], v[180:183]
  v_add_f32 v18, 1.0, v18
  v_add_f32 v19, 1.0, v19
  v_mfma_f32_16x16x32_bf16 v[184:187], v[44:47], a[232:235], v[184:187]
  v_rcp_f32 v16, v16
  v_mfma_f32_16x16x32_bf16 v[188:191], v[44:47], a[236:239], v[188:191]
  v_rcp_f32 v17, v17
  s_waitcnt lgkmcnt(0)
  v_mfma_f32_16x16x32_bf16 v[128:131], v[48:51], a[240:243], v[128:131]
  ds_read_b64_tr_b16 v[32:33], v6 offset:32768
  v_mfma_f32_16x16x32_bf16 v[132:135], v[48:51], a[244:247], v[132:135]
  ds_read_b64_tr_b16 v[34:35], v6 offset:33024
  v_mfma_f32_16x16x32_bf16 v[136:139], v[48:51], a[248:251], v[136:139]
  ds_read_b64_tr_b16 v[36:37], v7 offset:32768
  v_mfma_f32_16x16x32_bf16 v[140:143], v[48:51], a[252:255], v[140:143]
  ds_read_b64_tr_b16 v[38:39], v7 offset:33024
  v_mfma_f32_16x16x32_bf16 v[144:147], v[52:55], a[240:243], v[144:147]
  ds_read_b64_tr_b16 v[40:41], v8 offset:32768
  v_mfma_f32_16x16x32_bf16 v[148:151], v[52:55], a[244:247], v[148:151]
  ds_read_b64_tr_b16 v[42:43], v8 offset:33024
  v_mfma_f32_16x16x32_bf16 v[152:155], v[52:55], a[248:251], v[152:155]
  ds_read_b64_tr_b16 v[44:45], v9 offset:32768
  v_mfma_f32_16x16x32_bf16 v[156:159], v[52:55], a[252:255], v[156:159]
  ds_read_b64_tr_b16 v[46:47], v9 offset:33024
  v_mfma_f32_16x16x32_bf16 v[160:163], v[56:59], a[240:243], v[160:163]
  v_rcp_f32 v18, v18
  v_mfma_f32_16x16x32_bf16 v[164:167], v[56:59], a[244:247], v[164:167]
  v_rcp_f32 v19, v19
  v_mfma_f32_16x16x32_bf16 v[168:171], v[56:59], a[248:251], v[168:171]
  v_mul_f32 v108, v108, v16
  v_mul_f32 v109, v109, v17
  v_mfma_f32_16x16x32_bf16 v[172:175], v[56:59], a[252:255], v[172:175]
  v_mul_f32 v110, v110, v18
  v_mul_f32 v111, v111, v19
  v_mfma_f32_16x16x32_bf16 v[176:179], v[60:63], a[240:243], v[176:179]
  v_cvt_pk_bf16_f32 v28, v108, v109
  v_cvt_pk_bf16_f32 v29, v110, v111
  v_mfma_f32_16x16x32_bf16 v[180:183], v[60:63], a[244:247], v[180:183]
  v_mul_f32 v20, v92, v92
  v_mul_f32 v21, v93, v93
  v_mfma_f32_16x16x32_bf16 v[184:187], v[60:63], a[248:251], v[184:187]
  v_mul_f32 v22, v94, v94
  v_mul_f32 v23, v95, v95
  v_mfma_f32_16x16x32_bf16 v[188:191], v[60:63], a[252:255], v[188:191]
  v_fmamk_f32 v20, v20, 0xbdd2d3e8, v12
  v_fmamk_f32 v21, v21, 0xbdd2d3e8, v12
  s_waitcnt lgkmcnt(0)
  v_mfma_f32_16x16x32_bf16 v[128:131], v[32:35], v[192:195], v[128:131]
  ds_read_b64_tr_b16 v[48:49], v6 offset:34816
  v_fmamk_f32 v22, v22, 0xbdd2d3e8, v12
  v_mfma_f32_16x16x32_bf16 v[132:135], v[32:35], v[196:199], v[132:135]
  ds_read_b64_tr_b16 v[50:51], v6 offset:35072
  v_fmamk_f32 v23, v23, 0xbdd2d3e8, v12
  v_mfma_f32_16x16x32_bf16 v[136:139], v[32:35], v[200:203], v[136:139]
  ds_read_b64_tr_b16 v[52:53], v7 offset:34816
  v_mul_f32 v20, v20, v92
  v_mfma_f32_16x16x32_bf16 v[140:143], v[32:35], v[204:207], v[140:143]
  ds_read_b64_tr_b16 v[54:55], v7 offset:35072
  v_mul_f32 v21, v21, v93
  v_mfma_f32_16x16x32_bf16 v[144:147], v[36:39], v[192:195], v[144:147]
  ds_read_b64_tr_b16 v[56:57], v8 offset:34816
  v_mul_f32 v22, v22, v94
  v_mfma_f32_16x16x32_bf16 v[148:151], v[36:39], v[196:199], v[148:151]
  ds_read_b64_tr_b16 v[58:59], v8 offset:35072
  v_mul_f32 v23, v23, v95
  v_mfma_f32_16x16x32_bf16 v[152:155], v[36:39], v[200:203], v[152:155]
  ds_read_b64_tr_b16 v[60:61], v9 offset:34816
  v_mfma_f32_16x16x32_bf16 v[156:159], v[36:39], v[204:207], v[156:159]
  ds_read_b64_tr_b16 v[62:63], v9 offset:35072
  v_mfma_f32_16x16x32_bf16 v[160:163], v[40:43], v[192:195], v[160:163]
  v_exp_f32 v20, v20
  v_mfma_f32_16x16x32_bf16 v[164:167], v[40:43], v[196:199], v[164:167]
  v_exp_f32 v21, v21
  v_mfma_f32_16x16x32_bf16 v[168:171], v[40:43], v[200:203], v[168:171]
  v_exp_f32 v22, v22
  v_mfma_f32_16x16x32_bf16 v[172:175], v[40:43], v[204:207], v[172:175]
  v_exp_f32 v23, v23
  v_mfma_f32_16x16x32_bf16 v[176:179], v[44:47], v[192:195], v[176:179]
  v_mul_f32 v124, v92, v124
  v_mul_f32 v125, v93, v125
  v_mfma_f32_16x16x32_bf16 v[180:183], v[44:47], v[196:199], v[180:183]
  v_mul_f32 v126, v94, v126
  v_mul_f32 v127, v95, v127
  v_mfma_f32_16x16x32_bf16 v[184:187], v[44:47], v[200:203], v[184:187]
  v_add_f32 v20, 1.0, v20
  v_add_f32 v21, 1.0, v21
  v_mfma_f32_16x16x32_bf16 v[188:191], v[44:47], v[204:207], v[188:191]
  v_add_f32 v22, 1.0, v22
  v_add_f32 v23, 1.0, v23
  s_waitcnt vmcnt(4) lgkmcnt(0)
  s_barrier
  v_mfma_f32_16x16x32_bf16 v[128:131], v[48:51], v[208:211], v[128:131]
  ds_read_b64_tr_b16 v[32:33], v2 offset:0
  v_mfma_f32_16x16x32_bf16 v[132:135], v[48:51], v[212:215], v[132:135]
  ds_read_b64_tr_b16 v[34:35], v2 offset:256
  v_mfma_f32_16x16x32_bf16 v[136:139], v[48:51], v[216:219], v[136:139]
  ds_read_b64_tr_b16 v[36:37], v3 offset:0
  v_mfma_f32_16x16x32_bf16 v[140:143], v[48:51], v[220:223], v[140:143]
  ds_read_b64_tr_b16 v[38:39], v3 offset:256
  v_mfma_f32_16x16x32_bf16 v[144:147], v[52:55], v[208:211], v[144:147]
  ds_read_b64_tr_b16 v[40:41], v4 offset:0
  v_mfma_f32_16x16x32_bf16 v[148:151], v[52:55], v[212:215], v[148:151]
  ds_read_b64_tr_b16 v[42:43], v4 offset:256
  v_mfma_f32_16x16x32_bf16 v[152:155], v[52:55], v[216:219], v[152:155]
  ds_read_b64_tr_b16 v[44:45], v5 offset:0
  v_mfma_f32_16x16x32_bf16 v[156:159], v[52:55], v[220:223], v[156:159]
  ds_read_b64_tr_b16 v[46:47], v5 offset:256
  v_mfma_f32_16x16x32_bf16 v[160:163], v[56:59], v[208:211], v[160:163]
  v_rcp_f32 v20, v20
  v_mfma_f32_16x16x32_bf16 v[164:167], v[56:59], v[212:215], v[164:167]
  v_rcp_f32 v21, v21
  v_mfma_f32_16x16x32_bf16 v[168:171], v[56:59], v[216:219], v[168:171]
  v_rcp_f32 v22, v22
  v_mfma_f32_16x16x32_bf16 v[172:175], v[56:59], v[220:223], v[172:175]
  v_rcp_f32 v23, v23
  v_mfma_f32_16x16x32_bf16 v[176:179], v[60:63], v[208:211], v[176:179]
  v_mul_f32 v124, v124, v20
  v_mul_f32 v125, v125, v21
  v_mfma_f32_16x16x32_bf16 v[180:183], v[60:63], v[212:215], v[180:183]
  v_mul_f32 v126, v126, v22
  v_mul_f32 v127, v127, v23
  v_mfma_f32_16x16x32_bf16 v[184:187], v[60:63], v[216:219], v[184:187]
  v_cvt_pk_bf16_f32 v30, v124, v125
  v_cvt_pk_bf16_f32 v31, v126, v127
  v_mfma_f32_16x16x32_bf16 v[188:191], v[60:63], v[220:223], v[188:191]
  buffer_store_dwordx4 v[28:31], v11, s[20:23], s39 offen sc1
  s_add_u32 s40, s40, 64
  s_add_u32 s36, s36, 1024
  s_add_u32 s37, s37, 1024
  s_add_u32 s38, s38, 1024
  s_add_u32 s39, s39, 1024
  s_sub_u32 s43, s43, 1
  s_branch L_ffn_even
L_ffn_last:
  s_waitcnt lgkmcnt(0)
  v_mfma_f32_16x16x32_bf16 v[128:131], v[32:35], a[0:3], 0
  ds_read_b64_tr_b16 v[48:49], v6 offset:2048
  s_add_u32 s40, s68, 0
  v_mfma_f32_16x16x32_bf16 v[132:135], v[32:35], a[4:7], 0
  ds_read_b64_tr_b16 v[50:51], v6 offset:2304
  s_lshl_b32 s40, s40, 7
  v_mfma_f32_16x16x32_bf16 v[136:139], v[32:35], a[8:11], 0
  ds_read_b64_tr_b16 v[52:53], v7 offset:2048
  s_add_u32 s40, s40, 21430272
  v_mfma_f32_16x16x32_bf16 v[140:143], v[32:35], a[12:15], 0
  ds_read_b64_tr_b16 v[54:55], v7 offset:2304
  v_mov_b32 v252, s40
  v_mfma_f32_16x16x32_bf16 v[144:147], v[36:39], a[0:3], 0
  ds_read_b64_tr_b16 v[56:57], v8 offset:2048
  global_load_dword v230, v252, s[54:55] sc1
  v_mfma_f32_16x16x32_bf16 v[148:151], v[36:39], a[4:7], 0
  ds_read_b64_tr_b16 v[58:59], v8 offset:2304
  s_add_u32 s40, s61, 0
  v_mfma_f32_16x16x32_bf16 v[152:155], v[36:39], a[8:11], 0
  ds_read_b64_tr_b16 v[60:61], v9 offset:2048
  s_add_u32 m0, s40, s86
  v_mfma_f32_16x16x32_bf16 v[156:159], v[36:39], a[12:15], 0
  ds_read_b64_tr_b16 v[62:63], v9 offset:2304
  s_nop 0
  v_mfma_f32_16x16x32_bf16 v[160:163], v[40:43], a[0:3], 0
  buffer_load_dwordx4 v236, s[56:59], s60 offen lds
  v_mul_f32 v16, v64, v64
  v_mfma_f32_16x16x32_bf16 v[164:167], v[40:43], a[4:7], 0
  s_add_u32 s40, s61, 4096
  v_mul_f32 v17, v65, v65
  v_mfma_f32_16x16x32_bf16 v[168:171], v[40:43], a[8:11], 0
  s_add_u32 m0, s40, s86
  v_mul_f32 v18, v66, v66
  v_mfma_f32_16x16x32_bf16 v[172:175], v[40:43], a[12:15], 0
  s_nop 0
  v_mul_f32 v19, v67, v67
  v_mfma_f32_16x16x32_bf16 v[176:179], v[44:47], a[0:3], 0
  buffer_load_dwordx4 v237, s[56:59], s60 offen lds
  v_fmamk_f32 v16, v16, 0xbdd2d3e8, v12
  v_mfma_f32_16x16x32_bf16 v[180:183], v[44:47], a[4:7], 0
  v_fmamk_f32 v17, v17, 0xbdd2d3e8, v12
  v_fmamk_f32 v18, v18, 0xbdd2d3e8, v12
  v_mfma_f32_16x16x32_bf16 v[184:187], v[44:47], a[8:11], 0
  v_fmamk_f32 v19, v19, 0xbdd2d3e8, v12
  v_mul_f32 v16, v16, v64
  v_mfma_f32_16x16x32_bf16 v[188:191], v[44:47], a[12:15], 0
  v_mul_f32 v17, v17, v65
  v_mul_f32 v18, v18, v66
  s_waitcnt lgkmcnt(0)
  v_mfma_f32_16x16x32_bf16 v[128:131], v[48:51], a[16:19], v[128:131]
  ds_read_b64_tr_b16 v[32:33], v6 offset:4096
  s_add_u32 s40, s61, 8192
  v_mfma_f32_16x16x32_bf16 v[132:135], v[48:51], a[20:23], v[132:135]
  ds_read_b64_tr_b16 v[34:35], v6 offset:4352
  s_add_u32 m0, s40, s86
  v_mfma_f32_16x16x32_bf16 v[136:139], v[48:51], a[24:27], v[136:139]
  ds_read_b64_tr_b16 v[36:37], v7 offset:4096
  s_nop 0
  v_mfma_f32_16x16x32_bf16 v[140:143], v[48:51], a[28:31], v[140:143]
  ds_read_b64_tr_b16 v[38:39], v7 offset:4352
  buffer_load_dwordx4 v238, s[56:59], s60 offen lds
  v_mfma_f32_16x16x32_bf16 v[144:147], v[52:55], a[16:19], v[144:147]
  ds_read_b64_tr_b16 v[40:41], v8 offset:4096
  s_add_u32 s40, s61, 12288
  v_mfma_f32_16x16x32_bf16 v[148:151], v[52:55], a[20:23], v[148:151]
  ds_read_b64_tr_b16 v[42:43], v8 offset:4352
  s_add_u32 m0, s40, s86
  v_mfma_f32_16x16x32_bf16 v[152:155], v[52:55], a[24:27], v[152:155]
  ds_read_b64_tr_b16 v[44:45], v9 offset:4096
  s_nop 0
  v_mfma_f32_16x16x32_bf16 v[156:159], v[52:55], a[28:31], v[156:159]
  ds_read_b64_tr_b16 v[46:47], v9 offset:4352
  buffer_load_dwordx4 v239, s[56:59], s60 offen lds
  v_mfma_f32_16x16x32_bf16 v[160:163], v[56:59], a[16:19], v[160:163]
  v_mul_f32 v19, v19, v67
  v_mfma_f32_16x16x32_bf16 v[164:167], v[56:59], a[20:23], v[164:167]
  v_exp_f32 v16, v16
  v_mfma_f32_16x16x32_bf16 v[168:171], v[56:59], a[24:27], v[168:171]
  v_exp_f32 v17, v17
  v_mfma_f32_16x16x32_bf16 v[172:175], v[56:59], a[28:31], v[172:175]
  v_exp_f32 v18, v18
  v_mfma_f32_16x16x32_bf16 v[176:179], v[60:63], a[16:19], v[176:179]
  v_exp_f32 v19, v19
  v_mfma_f32_16x16x32_bf16 v[180:183], v[60:63], a[20:23], v[180:183]
  v_mul_f32 v96, v64, v96
  v_mul_f32 v97, v65, v97
  v_mfma_f32_16x16x32_bf16 v[184:187], v[60:63], a[24:27], v[184:187]
  v_mul_f32 v98, v66, v98
  v_mul_f32 v99, v67, v99
  v_mfma_f32_16x16x32_bf16 v[188:191], v[60:63], a[28:31], v[188:191]
  v_add_f32 v16, 1.0, v16
  v_add_f32 v17, 1.0, v17
  s_waitcnt lgkmcnt(0)
  v_mfma_f32_16x16x32_bf16 v[128:131], v[32:35], a[32:35], v[128:131]
  ds_read_b64_tr_b16 v[48:49], v6 offset:6144
  s_add_u32 s40, s61, 16384
  v_mfma_f32_16x16x32_bf16 v[132:135], v[32:35], a[36:39], v[132:135]
  ds_read_b64_tr_b16 v[50:51], v6 offset:6400
  s_add_u32 m0, s40, s86
  v_mfma_f32_16x16x32_bf16 v[136:139], v[32:35], a[40:43], v[136:139]
  ds_read_b64_tr_b16 v[52:53], v7 offset:6144
  s_nop 0
  v_mfma_f32_16x16x32_bf16 v[140:143], v[32:35], a[44:47], v[140:143]
  ds_read_b64_tr_b16 v[54:55], v7 offset:6400
  buffer_load_dwordx4 v240, s[56:59], s60 offen lds
  v_mfma_f32_16x16x32_bf16 v[144:147], v[36:39], a[32:35], v[144:147]
  ds_read_b64_tr_b16 v[56:57], v8 offset:6144
  s_add_u32 s40, s61, 20480
  v_mfma_f32_16x16x32_bf16 v[148:151], v[36:39], a[36:39], v[148:151]
  ds_read_b64_tr_b16 v[58:59], v8 offset:6400
  s_add_u32 m0, s40, s86
  v_mfma_f32_16x16x32_bf16 v[152:155], v[36:39], a[40:43], v[152:155]
  ds_read_b64_tr_b16 v[60:61], v9 offset:6144
  s_nop 0
  v_mfma_f32_16x16x32_bf16 v[156:159], v[36:39], a[44:47], v[156:159]
  ds_read_b64_tr_b16 v[62:63], v9 offset:6400
  buffer_load_dwordx4 v241, s[56:59], s60 offen lds
  v_mfma_f32_16x16x32_bf16 v[160:163], v[40:43], a[32:35], v[160:163]
  v_add_f32 v18, 1.0, v18
  v_add_f32 v19, 1.0, v19
  v_mfma_f32_16x16x32_bf16 v[164:167], v[40:43], a[36:39], v[164:167]
  v_rcp_f32 v16, v16
  v_mfma_f32_16x16x32_bf16 v[168:171], v[40:43], a[40:43], v[168:171]
  v_rcp_f32 v17, v17
  v_mfma_f32_16x16x32_bf16 v[172:175], v[40:43], a[44:47], v[172:175]
  v_rcp_f32 v18, v18
  v_mfma_f32_16x16x32_bf16 v[176:179], v[44:47], a[32:35], v[176:179]
  v_rcp_f32 v19, v19
  v_mfma_f32_16x16x32_bf16 v[180:183], v[44:47], a[36:39], v[180:183]
  v_mul_f32 v96, v96, v16
  v_mul_f32 v97, v97, v17
  v_mfma_f32_16x16x32_bf16 v[184:187], v[44:47], a[40:43], v[184:187]
  v_mul_f32 v98, v98, v18
  v_mul_f32 v99, v99, v19
  v_mfma_f32_16x16x32_bf16 v[188:191], v[44:47], a[44:47], v[188:191]
  v_cvt_pk_bf16_f32 v24, v96, v97
  v_cvt_pk_bf16_f32 v25, v98, v99
  s_waitcnt lgkmcnt(0)
  v_mfma_f32_16x16x32_bf16 v[128:131], v[48:51], a[48:51], v[128:131]
  ds_read_b64_tr_b16 v[32:33], v6 offset:8192
  s_add_u32 s40, s61, 24576
  v_mfma_f32_16x16x32_bf16 v[132:135], v[48:51], a[52:55], v[132:135]
  ds_read_b64_tr_b16 v[34:35], v6 offset:8448
  s_add_u32 m0, s40, s86
  v_mfma_f32_16x16x32_bf16 v[136:139], v[48:51], a[56:59], v[136:139]
  ds_read_b64_tr_b16 v[36:37], v7 offset:8192
  s_nop 0
  v_mfma_f32_16x16x32_bf16 v[140:143], v[48:51], a[60:63], v[140:143]
  ds_read_b64_tr_b16 v[38:39], v7 offset:8448
  buffer_load_dwordx4 v242, s[56:59], s60 offen lds
  v_mfma_f32_16x16x32_bf16 v[144:147], v[52:55], a[48:51], v[144:147]
  ds_read_b64_tr_b16 v[40:41], v8 offset:8192
  s_add_u32 s61, s61, 28672
  v_mfma_f32_16x16x32_bf16 v[148:151], v[52:55], a[52:55], v[148:151]
  ds_read_b64_tr_b16 v[42:43], v8 offset:8448
  s_cmp_eq_u32 s61, 143360
  v_mfma_f32_16x16x32_bf16 v[152:155], v[52:55], a[56:59], v[152:155]
  ds_read_b64_tr_b16 v[44:45], v9 offset:8192
  s_cselect_b32 s61, 0, s61
  v_mfma_f32_16x16x32_bf16 v[156:159], v[52:55], a[60:63], v[156:159]
  ds_read_b64_tr_b16 v[46:47], v9 offset:8448
  s_add_u32 s60, s60, 221184
  v_mfma_f32_16x16x32_bf16 v[160:163], v[56:59], a[48:51], v[160:163]
  v_mul_f32 v20, v80, v80
  v_mul_f32 v21, v81, v81
  v_mfma_f32_16x16x32_bf16 v[164:167], v[56:59], a[52:55], v[164:167]
  v_mul_f32 v22, v82, v82
  v_mul_f32 v23, v83, v83
  v_mfma_f32_16x16x32_bf16 v[168:171], v[56:59], a[56:59], v[168:171]
  v_fmamk_f32 v20, v20, 0xbdd2d3e8, v12
  v_fmamk_f32 v21, v21, 0xbdd2d3e8, v12
  v_mfma_f32_16x16x32_bf16 v[172:175], v[56:59], a[60:63], v[172:175]
  v_fmamk_f32 v22, v22, 0xbdd2d3e8, v12
  v_fmamk_f32 v23, v23, 0xbdd2d3e8, v12
  v_mfma_f32_16x16x32_bf16 v[176:179], v[60:63], a[48:51], v[176:179]
  v_mul_f32 v20, v20, v80
  v_mul_f32 v21, v21, v81
  v_mfma_f32_16x16x32_bf16 v[180:183], v[60:63], a[52:55], v[180:183]
  v_mul_f32 v22, v22, v82
  v_mul_f32 v23, v23, v83
  v_mfma_f32_16x16x32_bf16 v[184:187], v[60:63], a[56:59], v[184:187]
  v_exp_f32 v20, v20
  v_mfma_f32_16x16x32_bf16 v[188:191], v[60:63], a[60:63], v[188:191]
  v_exp_f32 v21, v21
  s_waitcnt lgkmcnt(0)
  v_mfma_f32_16x16x32_bf16 v[128:131], v[32:35], a[64:67], v[128:131]
  ds_read_b64_tr_b16 v[48:49], v6 offset:10240
  s_add_u32 s40, s61, 0
  v_mfma_f32_16x16x32_bf16 v[132:135], v[32:35], a[68:71], v[132:135]
  ds_read_b64_tr_b16 v[50:51], v6 offset:10496
  s_add_u32 m0, s40, s86
  v_mfma_f32_16x16x32_bf16 v[136:139], v[32:35], a[72:75], v[136:139]
  ds_read_b64_tr_b16 v[52:53], v7 offset:10240
  s_nop 0
  v_mfma_f32_16x16x32_bf16 v[140:143], v[32:35], a[76:79], v[140:143]
  ds_read_b64_tr_b16 v[54:55], v7 offset:10496
  buffer_load_dwordx4 v236, s[56:59], s60 offen lds
  v_mfma_f32_16x16x32_bf16 v[144:147], v[36:39], a[64:67], v[144:147]
  ds_read_b64_tr_b16 v[56:57], v8 offset:10240
  s_add_u32 s40, s61, 4096
  v_mfma_f32_16x16x32_bf16 v[148:151], v[36:39], a[68:71], v[148:151]
  ds_read_b64_tr_b16 v[58:59], v8 offset:10496
  s_add_u32 m0, s40, s86
  v_mfma_f32_16x16x32_bf16 v[152:155], v[36:39], a[72:75], v[152:155]
  ds_read_b64_tr_b16 v[60:61], v9 offset:10240
  s_nop 0
  v_mfma_f32_16x16x32_bf16 v[156:159], v[36:39], a[76:79], v[156:159]
  ds_read_b64_tr_b16 v[62:63], v9 offset:10496
  buffer_load_dwordx4 v237, s[56:59], s60 offen lds
  v_mfma_f32_16x16x32_bf16 v[160:163], v[40:43], a[64:67], v[160:163]
  v_exp_f32 v22, v22
  v_mfma_f32_16x16x32_bf16 v[164:167], v[40:43], a[68:71], v[164:167]
  v_exp_f32 v23, v23
  v_mfma_f32_16x16x32_bf16 v[168:171], v[40:43], a[72:75], v[168:171]
  v_mul_f32 v112, v80, v112
  v_mul_f32 v113, v81, v113
  v_mfma_f32_16x16x32_bf16 v[172:175], v[40:43], a[76:79], v[172:175]
  v_mul_f32 v114, v82, v114
  v_mul_f32 v115, v83, v115
  v_mfma_f32_16x16x32_bf16 v[176:179], v[44:47], a[64:67], v[176:179]
  v_add_f32 v20, 1.0, v20
  v_add_f32 v21, 1.0, v21
  v_mfma_f32_16x16x32_bf16 v[180:183], v[44:47], a[68:71], v[180:183]
  v_add_f32 v22, 1.0, v22
  v_add_f32 v23, 1.0, v23
  v_mfma_f32_16x16x32_bf16 v[184:187], v[44:47], a[72:75], v[184:187]
  v_rcp_f32 v20, v20
  v_mfma_f32_16x16x32_bf16 v[188:191], v[44:47], a[76:79], v[188:191]
  v_rcp_f32 v21, v21
  s_waitcnt lgkmcnt(0)
  v_mfma_f32_16x16x32_bf16 v[128:131], v[48:51], a[80:83], v[128:131]
  ds_read_b64_tr_b16 v[32:33], v6 offset:12288
  s_add_u32 s40, s61, 8192
  v_mfma_f32_16x16x32_bf16 v[132:135], v[48:51], a[84:87], v[132:135]
  ds_read_b64_tr_b16 v[34:35], v6 offset:12544
  s_add_u32 m0, s40, s86
  v_mfma_f32_16x16x32_bf16 v[136:139], v[48:51], a[88:91], v[136:139]
  ds_read_b64_tr_b16 v[36:37], v7 offset:12288
  s_nop 0
  v_mfma_f32_16x16x32_bf16 v[140:143], v[48:51], a[92:95], v[140:143]
  ds_read_b64_tr_b16 v[38:39], v7 offset:12544
  buffer_load_dwordx4 v238, s[56:59], s60 offen lds
  v_mfma_f32_16x16x32_bf16 v[144:147], v[52:55], a[80:83], v[144:147]
  ds_read_b64_tr_b16 v[40:41], v8 offset:12288
  s_add_u32 s40, s61, 12288
  v_mfma_f32_16x16x32_bf16 v[148:151], v[52:55], a[84:87], v[148:151]
  ds_read_b64_tr_b16 v[42:43], v8 offset:12544
  s_add_u32 m0, s40, s86
  v_mfma_f32_16x16x32_bf16 v[152:155], v[52:55], a[88:91], v[152:155]
  ds_read_b64_tr_b16 v[44:45], v9 offset:12288
  s_nop 0
  v_mfma_f32_16x16x32_bf16 v[156:159], v[52:55], a[92:95], v[156:159]
  ds_read_b64_tr_b16 v[46:47], v9 offset:12544
  buffer_load_dwordx4 v239, s[56:59], s60 offen lds
  v_mfma_f32_16x16x32_bf16 v[160:163], v[56:59], a[80:83], v[160:163]
  v_rcp_f32 v22, v22
  v_mfma_f32_16x16x32_bf16 v[164:167], v[56:59], a[84:87], v[164:167]
  v_rcp_f32 v23, v23
  v_mfma_f32_16x16x32_bf16 v[168:171], v[56:59], a[88:91], v[168:171]
  v_mul_f32 v112, v112, v20
  v_mul_f32 v113, v113, v21
  v_mfma_f32_16x16x32_bf16 v[172:175], v[56:59], a[92:95], v[172:175]
  v_mul_f32 v114, v114, v22
  v_mul_f32 v115, v115, v23
  v_mfma_f32_16x16x32_bf16 v[176:179], v[60:63], a[80:83], v[176:179]
  v_cvt_pk_bf16_f32 v26, v112, v113
  v_cvt_pk_bf16_f32 v27, v114, v115
  v_mfma_f32_16x16x32_bf16 v[180:183], v[60:63], a[84:87], v[180:183]
  buffer_store_dwordx4 v[24:27], v11, s[20:23], s36 offen sc1
  v_mul_f32 v16, v68, v68
  v_mfma_f32_16x16x32_bf16 v[184:187], v[60:63], a[88:91], v[184:187]
  v_mul_f32 v17, v69, v69
  v_mul_f32 v18, v70, v70
  v_mfma_f32_16x16x32_bf16 v[188:191], v[60:63], a[92:95], v[188:191]
  v_mul_f32 v19, v71, v71
  v_fmamk_f32 v16, v16, 0xbdd2d3e8, v12
  s_waitcnt lgkmcnt(0)
  v_mfma_f32_16x16x32_bf16 v[128:131], v[32:35], a[96:99], v[128:131]
  ds_read_b64_tr_b16 v[48:49], v6 offset:14336
  s_add_u32 s40, s61, 16384
  v_mfma_f32_16x16x32_bf16 v[132:135], v[32:35], a[100:103], v[132:135]
  ds_read_b64_tr_b16 v[50:51], v6 offset:14592
  s_add_u32 m0, s40, s86
  v_mfma_f32_16x16x32_bf16 v[136:139], v[32:35], a[104:107], v[136:139]
  ds_read_b64_tr_b16 v[52:53], v7 offset:14336
  s_nop 0
  v_mfma_f32_16x16x32_bf16 v[140:143], v[32:35], a[108:111], v[140:143]
  ds_read_b64_tr_b16 v[54:55], v7 offset:14592
  buffer_load_dwordx4 v240, s[56:59], s60 offen lds
  v_mfma_f32_16x16x32_bf16 v[144:147], v[36:39], a[96:99], v[144:147]
  ds_read_b64_tr_b16 v[56:57], v8 offset:14336
  s_add_u32 s40, s61, 20480
  v_mfma_f32_16x16x32_bf16 v[148:151], v[36:39], a[100:103], v[148:151]
  ds_read_b64_tr_b16 v[58:59], v8 offset:14592
  s_add_u32 m0, s40, s86
  v_mfma_f32_16x16x32_bf16 v[152:155], v[36:39], a[104:107], v[152:155]
  ds_read_b64_tr_b16 v[60:61], v9 offset:14336
  s_nop 0
  v_mfma_f32_16x16x32_bf16 v[156:159], v[36:39], a[108:111], v[156:159]
  ds_read_b64_tr_b16 v[62:63], v9 offset:14592
  buffer_load_dwordx4 v241, s[56:59], s60 offen lds
  v_mfma_f32_16x16x32_bf16 v[160:163], v[40:43], a[96:99], v[160:163]
  v_fmamk_f32 v17, v17, 0xbdd2d3e8, v12
  v_fmamk_f32 v18, v18, 0xbdd2d3e8, v12
  v_mfma_f32_16x16x32_bf16 v[164:167], v[40:43], a[100:103], v[164:167]
  v_fmamk_f32 v19, v19, 0xbdd2d3e8, v12
  v_mul_f32 v16, v16, v68
  v_mfma_f32_16x16x32_bf16 v[168:171], v[40:43], a[104:107], v[168:171]
  v_mul_f32 v17, v17, v69
  v_mul_f32 v18, v18, v70
  v_mfma_f32_16x16x32_bf16 v[172:175], v[40:43], a[108:111], v[172:175]
  v_mul_f32 v19, v19, v71
  v_mfma_f32_16x16x32_bf16 v[176:179], v[44:47], a[96:99], v[176:179]
  v_exp_f32 v16, v16
  v_mfma_f32_16x16x32_bf16 v[180:183], v[44:47], a[100:103], v[180:183]
  v_exp_f32 v17, v17
  v_mfma_f32_16x16x32_bf16 v[184:187], v[44:47], a[104:107], v[184:187]
  v_exp_f32 v18, v18
  v_mfma_f32_16x16x32_bf16 v[188:191], v[44:47], a[108:111], v[188:191]
  v_exp_f32 v19, v19
  s_waitcnt lgkmcnt(0)
  v_mfma_f32_16x16x32_bf16 v[128:131], v[48:51], a[112:115], v[128:131]
  ds_read_b64_tr_b16 v[32:33], v6 offset:16384
  s_add_u32 s40, s61, 24576
  v_mfma_f32_16x16x32_bf16 v[132:135], v[48:51], a[116:119], v[132:135]
  ds_read_b64_tr_b16 v[34:35], v6 offset:16640
  s_add_u32 m0, s40, s86
  v_mfma_f32_16x16x32_bf16 v[136:139], v[48:51], a[120:123], v[136:139]
  ds_read_b64_tr_b16 v[36:37], v7 offset:16384
  s_nop 0
  v_mfma_f32_16x16x32_bf16 v[140:143], v[48:51], a[124:127], v[140:143]
  ds_read_b64_tr_b16 v[38:39], v7 offset:16640
  buffer_load_dwordx4 v242, s[56:59], s60 offen lds
  v_mfma_f32_16x16x32_bf16 v[144:147], v[52:55], a[112:115], v[144:147]
  ds_read_b64_tr_b16 v[40:41], v8 offset:16384
  s_add_u32 s61, s61, 28672
  v_mfma_f32_16x16x32_bf16 v[148:151], v[52:55], a[116:119], v[148:151]
  ds_read_b64_tr_b16 v[42:43], v8 offset:16640
  s_cmp_eq_u32 s61, 143360
  v_mfma_f32_16x16x32_bf16 v[152:155], v[52:55], a[120:123], v[152:155]
  ds_read_b64_tr_b16 v[44:45], v9 offset:16384
  s_cselect_b32 s61, 0, s61
  v_mfma_f32_16x16x32_bf16 v[156:159], v[52:55], a[124:127], v[156:159]
  ds_read_b64_tr_b16 v[46:47], v9 offset:16640
  s_add_u32 s60, s60, 221184
  v_mfma_f32_16x16x32_bf16 v[160:163], v[56:59], a[112:115], v[160:163]
  v_mul_f32 v100, v68, v100
  v_mul_f32 v101, v69, v101
  v_mfma_f32_16x16x32_bf16 v[164:167], v[56:59], a[116:119], v[164:167]
  v_mul_f32 v102, v70, v102
  v_mul_f32 v103, v71, v103
  v_mfma_f32_16x16x32_bf16 v[168:171], v[56:59], a[120:123], v[168:171]
  v_add_f32 v16, 1.0, v16
  v_add_f32 v17, 1.0, v17
  v_mfma_f32_16x16x32_bf16 v[172:175], v[56:59], a[124:127], v[172:175]
  v_add_f32 v18, 1.0, v18
  v_add_f32 v19, 1.0, v19
  v_mfma_f32_16x16x32_bf16 v[176:179], v[60:63], a[112:115], v[176:179]
  v_rcp_f32 v16, v16
  v_mfma_f32_16x16x32_bf16 v[180:183], v[60:63], a[116:119], v[180:183]
  v_rcp_f32 v17, v17
  v_mfma_f32_16x16x32_bf16 v[184:187], v[60:63], a[120:123], v[184:187]
  v_rcp_f32 v18, v18
  v_mfma_f32_16x16x32_bf16 v[188:191], v[60:63], a[124:127], v[188:191]
  v_rcp_f32 v19, v19
  s_waitcnt lgkmcnt(0)
  v_mfma_f32_16x16x32_bf16 v[128:131], v[32:35], a[128:131], v[128:131]
  ds_read_b64_tr_b16 v[48:49], v6 offset:18432
  v_mul_f32 v100, v100, v16
  v_mfma_f32_16x16x32_bf16 v[132:135], v[32:35], a[132:135], v[132:135]
  ds_read_b64_tr_b16 v[50:51], v6 offset:18688
  v_mul_f32 v101, v101, v17
  v_mfma_f32_16x16x32_bf16 v[136:139], v[32:35], a[136:139], v[136:139]
  ds_read_b64_tr_b16 v[52:53], v7 offset:18432
  v_mul_f32 v102, v102, v18
  v_mfma_f32_16x16x32_bf16 v[140:143], v[32:35], a[140:143], v[140:143]
  ds_read_b64_tr_b16 v[54:55], v7 offset:18688
  v_mul_f32 v103, v103, v19
  v_mfma_f32_16x16x32_bf16 v[144:147], v[36:39], a[128:131], v[144:147]
  ds_read_b64_tr_b16 v[56:57], v8 offset:18432
  v_cvt_pk_bf16_f32 v28, v100, v101
  v_mfma_f32_16x16x32_bf16 v[148:151], v[36:39], a[132:135], v[148:151]
  ds_read_b64_tr_b16 v[58:59], v8 offset:18688
  v_cvt_pk_bf16_f32 v29, v102, v103
  v_mfma_f32_16x16x32_bf16 v[152:155], v[36:39], a[136:139], v[152:155]
  ds_read_b64_tr_b16 v[60:61], v9 offset:18432
  v_mul_f32 v20, v84, v84
  v_mfma_f32_16x16x32_bf16 v[156:159], v[36:39], a[140:143], v[156:159]
  ds_read_b64_tr_b16 v[62:63], v9 offset:18688
  v_mul_f32 v21, v85, v85
  v_mfma_f32_16x16x32_bf16 v[160:163], v[40:43], a[128:131], v[160:163]
  v_mul_f32 v22, v86, v86
  v_mul_f32 v23, v87, v87
  v_mfma_f32_16x16x32_bf16 v[164:167], v[40:43], a[132:135], v[164:167]
  v_fmamk_f32 v20, v20, 0xbdd2d3e8, v12
  v_fmamk_f32 v21, v21, 0xbdd2d3e8, v12
  v_mfma_f32_16x16x32_bf16 v[168:171], v[40:43], a[136:139], v[168:171]
  v_fmamk_f32 v22, v22, 0xbdd2d3e8, v12
  v_fmamk_f32 v23, v23, 0xbdd2d3e8, v12
  v_mfma_f32_16x16x32_bf16 v[172:175], v[40:43], a[140:143], v[172:175]
  v_mul_f32 v20, v20, v84
  v_mul_f32 v21, v21, v85
  v_mfma_f32_16x16x32_bf16 v[176:179], v[44:47], a[128:131], v[176:179]
  v_mul_f32 v22, v22, v86
  v_mul_f32 v23, v23, v87
  v_mfma_f32_16x16x32_bf16 v[180:183], v[44:47], a[132:135], v[180:183]
  v_exp_f32 v20, v20
  v_mfma_f32_16x16x32_bf16 v[184:187], v[44:47], a[136:139], v[184:187]
  v_exp_f32 v21, v21
  v_mfma_f32_16x16x32_bf16 v[188:191], v[44:47], a[140:143], v[188:191]
  v_exp_f32 v22, v22
  s_waitcnt vmcnt(15)
  v_readfirstlane_b32 s40, v230
  s_mul_i32 s41, s83, 24576
  s_add_u32 s32, s65, s41
  s_add_u32 s33, s32, 165888
  s_add_u32 s34, s32, 331776
  s_add_u32 s35, s32, 497664
  s_cmp_ge_u32 s40, 4
  s_cbranch_scc1 L_dn_h1ok
  s_add_u32 s40, s68, 0
  s_lshl_b32 s40, s40, 7
  s_add_u32 s40, s40, 21430272
  v_mov_b32 v252, s40
L_poll_h1:
  global_load_dword v253, v252, s[54:55] sc1
  s_waitcnt vmcnt(0)
  v_readfirstlane_b32 s40, v253
  s_cmp_ge_u32 s40, 4
  s_cbranch_scc1 L_polld_h1
  s_sleep 4
  s_branch L_poll_h1
L_polld_h1:
L_dn_h1ok:
  s_waitcnt lgkmcnt(0)
  v_mfma_f32_16x16x32_bf16 v[128:131], v[48:51], a[144:147], v[128:131]
  ds_read_b64_tr_b16 v[32:33], v6 offset:20480
  v_mfma_f32_16x16x32_bf16 v[132:135], v[48:51], a[148:151], v[132:135]
  ds_read_b64_tr_b16 v[34:35], v6 offset:20736
  v_mfma_f32_16x16x32_bf16 v[136:139], v[48:51], a[152:155], v[136:139]
  ds_read_b64_tr_b16 v[36:37], v7 offset:20480
  v_mfma_f32_16x16x32_bf16 v[140:143], v[48:51], a[156:159], v[140:143]
  ds_read_b64_tr_b16 v[38:39], v7 offset:20736
  v_mfma_f32_16x16x32_bf16 v[144:147], v[52:55], a[144:147], v[144:147]
  ds_read_b64_tr_b16 v[40:41], v8 offset:20480
  v_mfma_f32_16x16x32_bf16 v[148:151], v[52:55], a[148:151], v[148:151]
  ds_read_b64_tr_b16 v[42:43], v8 offset:20736
  v_mfma_f32_16x16x32_bf16 v[152:155], v[52:55], a[152:155], v[152:155]
  ds_read_b64_tr_b16 v[44:45], v9 offset:20480
  v_mfma_f32_16x16x32_bf16 v[156:159], v[52:55], a[156:159], v[156:159]
  ds_read_b64_tr_b16 v[46:47], v9 offset:20736
  v_mfma_f32_16x16x32_bf16 v[160:163], v[56:59], a[144:147], v[160:163]
  v_exp_f32 v23, v23
  v_mfma_f32_16x16x32_bf16 v[164:167], v[56:59], a[148:151], v[164:167]
  v_mul_f32 v116, v84, v116
  v_mul_f32 v117, v85, v117
  v_mfma_f32_16x16x32_bf16 v[168:171], v[56:59], a[152:155], v[168:171]
  v_mul_f32 v118, v86, v118
  v_mul_f32 v119, v87, v119
  v_mfma_f32_16x16x32_bf16 v[172:175], v[56:59], a[156:159], v[172:175]
  v_add_f32 v20, 1.0, v20
  v_add_f32 v21, 1.0, v21
  v_mfma_f32_16x16x32_bf16 v[176:179], v[60:63], a[144:147], v[176:179]
  v_add_f32 v22, 1.0, v22
  v_add_f32 v23, 1.0, v23
  v_mfma_f32_16x16x32_bf16 v[180:183], v[60:63], a[148:151], v[180:183]
  v_rcp_f32 v20, v20
  v_mfma_f32_16x16x32_bf16 v[184:187], v[60:63], a[152:155], v[184:187]
  v_rcp_f32 v21, v21
  v_mfma_f32_16x16x32_bf16 v[188:191], v[60:63], a[156:159], v[188:191]
  v_rcp_f32 v22, v22
  s_waitcnt lgkmcnt(0)
  v_mfma_f32_16x16x32_bf16 v[128:131], v[32:35], a[160:163], v[128:131]
  ds_read_b64_tr_b16 v[48:49], v6 offset:22528
  buffer_load_dwordx4 a[0:3], v11, s[20:23], s32 offen offset:0 sc1
  v_mfma_f32_16x16x32_bf16 v[132:135], v[32:35], a[164:167], v[132:135]
  ds_read_b64_tr_b16 v[50:51], v6 offset:22784
  buffer_load_dwordx4 a[4:7], v11, s[20:23], s33 offen offset:0 sc1
  v_mfma_f32_16x16x32_bf16 v[136:139], v[32:35], a[168:171], v[136:139]
  ds_read_b64_tr_b16 v[52:53], v7 offset:22528
  buffer_load_dwordx4 a[8:11], v11, s[20:23], s34 offen offset:0 sc1
  v_mfma_f32_16x16x32_bf16 v[140:143], v[32:35], a[172:175], v[140:143]
  ds_read_b64_tr_b16 v[54:55], v7 offset:22784
  buffer_load_dwordx4 a[12:15], v11, s[20:23], s35 offen offset:0 sc1
  v_mfma_f32_16x16x32_bf16 v[144:147], v[36:39], a[160:163], v[144:147]
  ds_read_b64_tr_b16 v[56:57], v8 offset:22528
  buffer_load_dwordx4 a[16:19], v11, s[20:23], s32 offen offset:1024 sc1
  v_mfma_f32_16x16x32_bf16 v[148:151], v[36:39], a[164:167], v[148:151]
  ds_read_b64_tr_b16 v[58:59], v8 offset:22784
  v_mfma_f32_16x16x32_bf16 v[152:155], v[36:39], a[168:171], v[152:155]
  ds_read_b64_tr_b16 v[60:61], v9 offset:22528
  v_mfma_f32_16x16x32_bf16 v[156:159], v[36:39], a[172:175], v[156:159]
  ds_read_b64_tr_b16 v[62:63], v9 offset:22784
  v_mfma_f32_16x16x32_bf16 v[160:163], v[40:43], a[160:163], v[160:163]
  v_rcp_f32 v23, v23
  v_mfma_f32_16x16x32_bf16 v[164:167], v[40:43], a[164:167], v[164:167]
  v_mul_f32 v116, v116, v20
  v_mul_f32 v117, v117, v21
  v_mfma_f32_16x16x32_bf16 v[168:171], v[40:43], a[168:171], v[168:171]
  v_mul_f32 v118, v118, v22
  v_mul_f32 v119, v119, v23
  v_mfma_f32_16x16x32_bf16 v[172:175], v[40:43], a[172:175], v[172:175]
  v_cvt_pk_bf16_f32 v30, v116, v117
  v_cvt_pk_bf16_f32 v31, v118, v119
  v_mfma_f32_16x16x32_bf16 v[176:179], v[44:47], a[160:163], v[176:179]
  buffer_store_dwordx4 v[28:31], v11, s[20:23], s37 offen sc1
  v_mul_f32 v16, v72, v72
  v_mfma_f32_16x16x32_bf16 v[180:183], v[44:47], a[164:167], v[180:183]
  v_mul_f32 v17, v73, v73
  v_mul_f32 v18, v74, v74
  v_mfma_f32_16x16x32_bf16 v[184:187], v[44:47], a[168:171], v[184:187]
  v_mul_f32 v19, v75, v75
  v_fmamk_f32 v16, v16, 0xbdd2d3e8, v12
  v_mfma_f32_16x16x32_bf16 v[188:191], v[44:47], a[172:175], v[188:191]
  v_fmamk_f32 v17, v17, 0xbdd2d3e8, v12
  v_fmamk_f32 v18, v18, 0xbdd2d3e8, v12
  s_waitcnt lgkmcnt(0)
  v_mfma_f32_16x16x32_bf16 v[128:131], v[48:51], a[176:179], v[128:131]
  ds_read_b64_tr_b16 v[32:33], v6 offset:24576
  buffer_load_dwordx4 a[20:23], v11, s[20:23], s33 offen offset:1024 sc1
  v_mfma_f32_16x16x32_bf16 v[132:135], v[48:51], a[180:183], v[132:135]
  ds_read_b64_tr_b16 v[34:35], v6 offset:24832
  buffer_load_dwordx4 a[24:27], v11, s[20:23], s34 offen offset:1024 sc1
  v_mfma_f32_16x16x32_bf16 v[136:139], v[48:51], a[184:187], v[136:139]
  ds_read_b64_tr_b16 v[36:37], v7 offset:24576
  buffer_load_dwordx4 a[28:31], v11, s[20:23], s35 offen offset:1024 sc1
  v_mfma_f32_16x16x32_bf16 v[140:143], v[48:51], a[188:191], v[140:143]
  ds_read_b64_tr_b16 v[38:39], v7 offset:24832
  buffer_load_dwordx4 a[32:35], v11, s[20:23], s32 offen offset:2048 sc1
  v_mfma_f32_16x16x32_bf16 v[144:147], v[52:55], a[176:179], v[144:147]
  ds_read_b64_tr_b16 v[40:41], v8 offset:24576
  buffer_load_dwordx4 a[36:39], v11, s[20:23], s33 offen offset:2048 sc1
  v_mfma_f32_16x16x32_bf16 v[148:151], v[52:55], a[180:183], v[148:151]
  ds_read_b64_tr_b16 v[42:43], v8 offset:24832
  v_fmamk_f32 v19, v19, 0xbdd2d3e8, v12
  v_mfma_f32_16x16x32_bf16 v[152:155], v[52:55], a[184:187], v[152:155]
  ds_read_b64_tr_b16 v[44:45], v9 offset:24576
  v_mul_f32 v16, v16, v72
  v_mfma_f32_16x16x32_bf16 v[156:159], v[52:55], a[188:191], v[156:159]
  ds_read_b64_tr_b16 v[46:47], v9 offset:24832
  v_mul_f32 v17, v17, v73
  v_mfma_f32_16x16x32_bf16 v[160:163], v[56:59], a[176:179], v[160:163]
  v_mul_f32 v18, v18, v74
  v_mul_f32 v19, v19, v75
  v_mfma_f32_16x16x32_bf16 v[164:167], v[56:59], a[180:183], v[164:167]
  v_exp_f32 v16, v16
  v_mfma_f32_16x16x32_bf16 v[168:171], v[56:59], a[184:187], v[168:171]
  v_exp_f32 v17, v17
  v_mfma_f32_16x16x32_bf16 v[172:175], v[56:59], a[188:191], v[172:175]
  v_exp_f32 v18, v18
  v_mfma_f32_16x16x32_bf16 v[176:179], v[60:63], a[176:179], v[176:179]
  v_exp_f32 v19, v19
  v_mfma_f32_16x16x32_bf16 v[180:183], v[60:63], a[180:183], v[180:183]
  v_mul_f32 v104, v72, v104
  v_mul_f32 v105, v73, v105
  v_mfma_f32_16x16x32_bf16 v[184:187], v[60:63], a[184:187], v[184:187]
  v_mul_f32 v106, v74, v106
  v_mul_f32 v107, v75, v107
  v_mfma_f32_16x16x32_bf16 v[188:191], v[60:63], a[188:191], v[188:191]
  v_add_f32 v16, 1.0, v16
  v_add_f32 v17, 1.0, v17
  s_waitcnt lgkmcnt(0)
  v_mfma_f32_16x16x32_bf16 v[128:131], v[32:35], a[192:195], v[128:131]
  ds_read_b64_tr_b16 v[48:49], v6 offset:26624
  buffer_load_dwordx4 a[40:43], v11, s[20:23], s34 offen offset:2048 sc1
  v_mfma_f32_16x16x32_bf16 v[132:135], v[32:35], a[196:199], v[132:135]
  ds_read_b64_tr_b16 v[50:51], v6 offset:26880
  buffer_load_dwordx4 a[44:47], v11, s[20:23], s35 offen offset:2048 sc1
  v_mfma_f32_16x16x32_bf16 v[136:139], v[32:35], a[200:203], v[136:139]
  ds_read_b64_tr_b16 v[52:53], v7 offset:26624
  s_add_u32 s32, s32, 6144
  v_mfma_f32_16x16x32_bf16 v[140:143], v[32:35], a[204:207], v[140:143]
  ds_read_b64_tr_b16 v[54:55], v7 offset:26880
  s_add_u32 s33, s33, 6144
  v_mfma_f32_16x16x32_bf16 v[144:147], v[36:39], a[192:195], v[144:147]
  ds_read_b64_tr_b16 v[56:57], v8 offset:26624
  s_add_u32 s34, s34, 6144
  v_mfma_f32_16x16x32_bf16 v[148:151], v[36:39], a[196:199], v[148:151]
  ds_read_b64_tr_b16 v[58:59], v8 offset:26880
  v_add_f32 v18, 1.0, v18
  v_mfma_f32_16x16x32_bf16 v[152:155], v[36:39], a[200:203], v[152:155]
  ds_read_b64_tr_b16 v[60:61], v9 offset:26624
  v_add_f32 v19, 1.0, v19
  v_mfma_f32_16x16x32_bf16 v[156:159], v[36:39], a[204:207], v[156:159]
  ds_read_b64_tr_b16 v[62:63], v9 offset:26880
  v_mfma_f32_16x16x32_bf16 v[160:163], v[40:43], a[192:195], v[160:163]
  v_rcp_f32 v16, v16
  v_mfma_f32_16x16x32_bf16 v[164:167], v[40:43], a[196:199], v[164:167]
  v_rcp_f32 v17, v17
  v_mfma_f32_16x16x32_bf16 v[168:171], v[40:43], a[200:203], v[168:171]
  v_rcp_f32 v18, v18
  v_mfma_f32_16x16x32_bf16 v[172:175], v[40:43], a[204:207], v[172:175]
  v_rcp_f32 v19, v19
  v_mfma_f32_16x16x32_bf16 v[176:179], v[44:47], a[192:195], v[176:179]
  v_mul_f32 v104, v104, v16
  v_mul_f32 v105, v105, v17
  v_mfma_f32_16x16x32_bf16 v[180:183], v[44:47], a[196:199], v[180:183]
  v_mul_f32 v106, v106, v18
  v_mul_f32 v107, v107, v19
  v_mfma_f32_16x16x32_bf16 v[184:187], v[44:47], a[200:203], v[184:187]
  v_cvt_pk_bf16_f32 v24, v104, v105
  v_cvt_pk_bf16_f32 v25, v106, v107
  v_mfma_f32_16x16x32_bf16 v[188:191], v[44:47], a[204:207], v[188:191]
  v_mul_f32 v20, v88, v88
  v_mul_f32 v21, v89, v89
  s_waitcnt lgkmcnt(0)
  v_mfma_f32_16x16x32_bf16 v[128:131], v[48:51], a[208:211], v[128:131]
  ds_read_b64_tr_b16 v[32:33], v6 offset:28672
  s_add_u32 s35, s35, 6144
  v_mfma_f32_16x16x32_bf16 v[132:135], v[48:51], a[212:215], v[132:135]
  ds_read_b64_tr_b16 v[34:35], v6 offset:28928
  buffer_load_dwordx4 a[48:51], v11, s[20:23], s32 offen offset:0 sc1
  v_mfma_f32_16x16x32_bf16 v[136:139], v[48:51], a[216:219], v[136:139]
  ds_read_b64_tr_b16 v[36:37], v7 offset:28672
  buffer_load_dwordx4 a[52:55], v11, s[20:23], s33 offen offset:0 sc1
  v_mfma_f32_16x16x32_bf16 v[140:143], v[48:51], a[220:223], v[140:143]
  ds_read_b64_tr_b16 v[38:39], v7 offset:28928
  buffer_load_dwordx4 a[56:59], v11, s[20:23], s34 offen offset:0 sc1
  v_mfma_f32_16x16x32_bf16 v[144:147], v[52:55], a[208:211], v[144:147]
  ds_read_b64_tr_b16 v[40:41], v8 offset:28672
  buffer_load_dwordx4 a[60:63], v11, s[20:23], s35 offen offset:0 sc1
  v_mfma_f32_16x16x32_bf16 v[148:151], v[52:55], a[212:215], v[148:151]
  ds_read_b64_tr_b16 v[42:43], v8 offset:28928
  v_mul_f32 v22, v90, v90
  v_mfma_f32_16x16x32_bf16 v[152:155], v[52:55], a[216:219], v[152:155]
  ds_read_b64_tr_b16 v[44:45], v9 offset:28672
  v_mul_f32 v23, v91, v91
  v_mfma_f32_16x16x32_bf16 v[156:159], v[52:55], a[220:223], v[156:159]
  ds_read_b64_tr_b16 v[46:47], v9 offset:28928
  v_fmamk_f32 v20, v20, 0xbdd2d3e8, v12
  v_mfma_f32_16x16x32_bf16 v[160:163], v[56:59], a[208:211], v[160:163]
  v_fmamk_f32 v21, v21, 0xbdd2d3e8, v12
  v_fmamk_f32 v22, v22, 0xbdd2d3e8, v12
  v_mfma_f32_16x16x32_bf16 v[164:167], v[56:59], a[212:215], v[164:167]
  v_fmamk_f32 v23, v23, 0xbdd2d3e8, v12
  v_mul_f32 v20, v20, v88
  v_mfma_f32_16x16x32_bf16 v[168:171], v[56:59], a[216:219], v[168:171]
  v_mul_f32 v21, v21, v89
  v_mul_f32 v22, v22, v90
  v_mfma_f32_16x16x32_bf16 v[172:175], v[56:59], a[220:223], v[172:175]
  v_mul_f32 v23, v23, v91
  v_mfma_f32_16x16x32_bf16 v[176:179], v[60:63], a[208:211], v[176:179]
  v_exp_f32 v20, v20
  v_mfma_f32_16x16x32_bf16 v[180:183], v[60:63], a[212:215], v[180:183]
  v_exp_f32 v21, v21
  v_mfma_f32_16x16x32_bf16 v[184:187], v[60:63], a[216:219], v[184:187]
  v_exp_f32 v22, v22
  v_mfma_f32_16x16x32_bf16 v[188:191], v[60:63], a[220:223], v[188:191]
  v_exp_f32 v23, v23
  s_waitcnt lgkmcnt(0)
  v_mfma_f32_16x16x32_bf16 v[128:131], v[32:35], a[224:227], v[128:131]
  ds_read_b64_tr_b16 v[48:49], v6 offset:30720
  buffer_load_dwordx4 a[64:67], v11, s[20:23], s32 offen offset:1024 sc1
  v_mfma_f32_16x16x32_bf16 v[132:135], v[32:35], a[228:231], v[132:135]
  ds_read_b64_tr_b16 v[50:51], v6 offset:30976
  buffer_load_dwordx4 a[68:71], v11, s[20:23], s33 offen offset:1024 sc1
  v_mfma_f32_16x16x32_bf16 v[136:139], v[32:35], a[232:235], v[136:139]
  ds_read_b64_tr_b16 v[52:53], v7 offset:30720
  buffer_load_dwordx4 a[72:75], v11, s[20:23], s34 offen offset:1024 sc1
  v_mfma_f32_16x16x32_bf16 v[140:143], v[32:35], a[236:239], v[140:143]
  ds_read_b64_tr_b16 v[54:55], v7 offset:30976
  buffer_load_dwordx4 a[76:79], v11, s[20:23], s35 offen offset:1024 sc1
  v_mfma_f32_16x16x32_bf16 v[144:147], v[36:39], a[224:227], v[144:147]
  ds_read_b64_tr_b16 v[56:57], v8 offset:30720
  buffer_load_dwordx4 a[80:83], v11, s[20:23], s32 offen offset:2048 sc1
  v_mfma_f32_16x16x32_bf16 v[148:151], v[36:39], a[228:231], v[148:151]
  ds_read_b64_tr_b16 v[58:59], v8 offset:30976
  v_mul_f32 v120, v88, v120
  v_mfma_f32_16x16x32_bf16 v[152:155], v[36:39], a[232:235], v[152:155]
  ds_read_b64_tr_b16 v[60:61], v9 offset:30720
  v_mul_f32 v121, v89, v121
  v_mfma_f32_16x16x32_bf16 v[156:159], v[36:39], a[236:239], v[156:159]
  ds_read_b64_tr_b16 v[62:63], v9 offset:30976
  v_mul_f32 v122, v90, v122
  v_mfma_f32_16x16x32_bf16 v[160:163], v[40:43], a[224:227], v[160:163]
  v_mul_f32 v123, v91, v123
  v_add_f32 v20, 1.0, v20
  v_mfma_f32_16x16x32_bf16 v[164:167], v[40:43], a[228:231], v[164:167]
  v_add_f32 v21, 1.0, v21
  v_add_f32 v22, 1.0, v22
  v_mfma_f32_16x16x32_bf16 v[168:171], v[40:43], a[232:235], v[168:171]
  v_add_f32 v23, 1.0, v23
  v_mfma_f32_16x16x32_bf16 v[172:175], v[40:43], a[236:239], v[172:175]
  v_rcp_f32 v20, v20
  v_mfma_f32_16x16x32_bf16 v[176:179], v[44:47], a[224:227], v[176:179]
  v_rcp_f32 v21, v21
  v_mfma_f32_16x16x32_bf16 v[180:183], v[44:47], a[228:231], v[180:183]
  v_rcp_f32 v22, v22
  v_mfma_f32_16x16x32_bf16 v[184:187], v[44:47], a[232:235], v[184:187]
  v_rcp_f32 v23, v23
  v_mfma_f32_16x16x32_bf16 v[188:191], v[44:47], a[236:239], v[188:191]
  v_mul_f32 v120, v120, v20
  v_mul_f32 v121, v121, v21
  s_waitcnt lgkmcnt(0)
  v_mfma_f32_16x16x32_bf16 v[128:131], v[48:51], a[240:243], v[128:131]
  ds_read_b64_tr_b16 v[32:33], v6 offset:32768
  buffer_load_dwordx4 a[84:87], v11, s[20:23], s33 offen offset:2048 sc1
  v_mfma_f32_16x16x32_bf16 v[132:135], v[48:51], a[244:247], v[132:135]
  ds_read_b64_tr_b16 v[34:35], v6 offset:33024
  buffer_load_dwordx4 a[88:91], v11, s[20:23], s34 offen offset:2048 sc1
  v_mfma_f32_16x16x32_bf16 v[136:139], v[48:51], a[248:251], v[136:139]
  ds_read_b64_tr_b16 v[36:37], v7 offset:32768
  buffer_load_dwordx4 a[92:95], v11, s[20:23], s35 offen offset:2048 sc1
  v_mfma_f32_16x16x32_bf16 v[140:143], v[48:51], a[252:255], v[140:143]
  ds_read_b64_tr_b16 v[38:39], v7 offset:33024
  s_add_u32 s32, s32, 6144
  v_mfma_f32_16x16x32_bf16 v[144:147], v[52:55], a[240:243], v[144:147]
  ds_read_b64_tr_b16 v[40:41], v8 offset:32768
  s_add_u32 s33, s33, 6144
  v_mfma_f32_16x16x32_bf16 v[148:151], v[52:55], a[244:247], v[148:151]
  ds_read_b64_tr_b16 v[42:43], v8 offset:33024
  v_mul_f32 v122, v122, v22
  v_mfma_f32_16x16x32_bf16 v[152:155], v[52:55], a[248:251], v[152:155]
  ds_read_b64_tr_b16 v[44:45], v9 offset:32768
  v_mul_f32 v123, v123, v23
  v_mfma_f32_16x16x32_bf16 v[156:159], v[52:55], a[252:255], v[156:159]
  ds_read_b64_tr_b16 v[46:47], v9 offset:33024
  v_cvt_pk_bf16_f32 v26, v120, v121
  v_mfma_f32_16x16x32_bf16 v[160:163], v[56:59], a[240:243], v[160:163]
  v_cvt_pk_bf16_f32 v27, v122, v123
  buffer_store_dwordx4 v[24:27], v11, s[20:23], s38 offen sc1
  v_mfma_f32_16x16x32_bf16 v[164:167], v[56:59], a[244:247], v[164:167]
  v_mul_f32 v16, v76, v76
  v_mul_f32 v17, v77, v77
  v_mfma_f32_16x16x32_bf16 v[168:171], v[56:59], a[248:251], v[168:171]
  v_mul_f32 v18, v78, v78
  v_mul_f32 v19, v79, v79
  v_mfma_f32_16x16x32_bf16 v[172:175], v[56:59], a[252:255], v[172:175]
  v_fmamk_f32 v16, v16, 0xbdd2d3e8, v12
  v_fmamk_f32 v17, v17, 0xbdd2d3e8, v12
  v_mfma_f32_16x16x32_bf16 v[176:179], v[60:63], a[240:243], v[176:179]
  v_fmamk_f32 v18, v18, 0xbdd2d3e8, v12
  v_fmamk_f32 v19, v19, 0xbdd2d3e8, v12
  v_mfma_f32_16x16x32_bf16 v[180:183], v[60:63], a[244:247], v[180:183]
  v_mul_f32 v16, v16, v76
  v_mul_f32 v17, v17, v77
  v_mfma_f32_16x16x32_bf16 v[184:187], v[60:63], a[248:251], v[184:187]
  v_mul_f32 v18, v18, v78
  v_mul_f32 v19, v19, v79
  v_mfma_f32_16x16x32_bf16 v[188:191], v[60:63], a[252:255], v[188:191]
  v_exp_f32 v16, v16
  s_waitcnt lgkmcnt(0)
  v_mfma_f32_16x16x32_bf16 v[128:131], v[32:35], v[192:195], v[128:131]
  ds_read_b64_tr_b16 v[48:49], v6 offset:34816
  s_add_u32 s34, s34, 6144
  v_mfma_f32_16x16x32_bf16 v[132:135], v[32:35], v[196:199], v[132:135]
  ds_read_b64_tr_b16 v[50:51], v6 offset:35072
  s_add_u32 s35, s35, 6144
  v_mfma_f32_16x16x32_bf16 v[136:139], v[32:35], v[200:203], v[136:139]
  ds_read_b64_tr_b16 v[52:53], v7 offset:34816
  v_mfma_f32_16x16x32_bf16 v[140:143], v[32:35], v[204:207], v[140:143]
  ds_read_b64_tr_b16 v[54:55], v7 offset:35072
  v_mfma_f32_16x16x32_bf16 v[144:147], v[36:39], v[192:195], v[144:147]
  ds_read_b64_tr_b16 v[56:57], v8 offset:34816
  v_mfma_f32_16x16x32_bf16 v[148:151], v[36:39], v[196:199], v[148:151]
  ds_read_b64_tr_b16 v[58:59], v8 offset:35072
  v_mfma_f32_16x16x32_bf16 v[152:155], v[36:39], v[200:203], v[152:155]
  ds_read_b64_tr_b16 v[60:61], v9 offset:34816
  v_mfma_f32_16x16x32_bf16 v[156:159], v[36:39], v[204:207], v[156:159]
  ds_read_b64_tr_b16 v[62:63], v9 offset:35072
  v_mfma_f32_16x16x32_bf16 v[160:163], v[40:43], v[192:195], v[160:163]
  v_exp_f32 v17, v17
  v_mfma_f32_16x16x32_bf16 v[164:167], v[40:43], v[196:199], v[164:167]
  v_exp_f32 v18, v18
  v_mfma_f32_16x16x32_bf16 v[168:171], v[40:43], v[200:203], v[168:171]
  v_exp_f32 v19, v19
  v_mfma_f32_16x16x32_bf16 v[172:175], v[40:43], v[204:207], v[172:175]
  v_mul_f32 v108, v76, v108
  v_mul_f32 v109, v77, v109
  v_mfma_f32_16x16x32_bf16 v[176:179], v[44:47], v[192:195], v[176:179]
  v_mul_f32 v110, v78, v110
  v_mul_f32 v111, v79, v111
  v_mfma_f32_16x16x32_bf16 v[180:183], v[44:47], v[196:199], v[180:183]
  v_add_f32 v16, 1.0, v16
  v_add_f32 v17, 1.0, v17
  v_mfma_f32_16x16x32_bf16 v[184:187], v[44:47], v[200:203], v[184:187]
  v_add_f32 v18, 1.0, v18
  v_add_f32 v19, 1.0, v19
  v_mfma_f32_16x16x32_bf16 v[188:191], v[44:47], v[204:207], v[188:191]
  v_rcp_f32 v16, v16
  s_waitcnt lgkmcnt(0)
  v_mfma_f32_16x16x32_bf16 v[128:131], v[48:51], v[208:211], v[128:131]
  s_nop 0
  v_mfma_f32_16x16x32_bf16 v[132:135], v[48:51], v[212:215], v[132:135]
  s_nop 0
  v_mfma_f32_16x16x32_bf16 v[136:139], v[48:51], v[216:219], v[136:139]
  s_nop 0
  v_mfma_f32_16x16x32_bf16 v[140:143], v[48:51], v[220:223], v[140:143]
  s_nop 0
  v_mfma_f32_16x16x32_bf16 v[144:147], v[52:55], v[208:211], v[144:147]
  s_nop 0
  v_mfma_f32_16x16x32_bf16 v[148:151], v[52:55], v[212:215], v[148:151]
  s_nop 0
  v_mfma_f32_16x16x32_bf16 v[152:155], v[52:55], v[216:219], v[152:155]
  s_nop 0
  v_mfma_f32_16x16x32_bf16 v[156:159], v[52:55], v[220:223], v[156:159]
  s_nop 0
  v_mfma_f32_16x16x32_bf16 v[160:163], v[56:59], v[208:211], v[160:163]
  v_rcp_f32 v17, v17
  v_mfma_f32_16x16x32_bf16 v[164:167], v[56:59], v[212:215], v[164:167]
  v_rcp_f32 v18, v18
  v_mfma_f32_16x16x32_bf16 v[168:171], v[56:59], v[216:219], v[168:171]
  v_rcp_f32 v19, v19
  v_mfma_f32_16x16x32_bf16 v[172:175], v[56:59], v[220:223], v[172:175]
  v_mul_f32 v108, v108, v16
  v_mul_f32 v109, v109, v17
  v_mfma_f32_16x16x32_bf16 v[176:179], v[60:63], v[208:211], v[176:179]
  v_mul_f32 v110, v110, v18
  v_mul_f32 v111, v111, v19
  v_mfma_f32_16x16x32_bf16 v[180:183], v[60:63], v[212:215], v[180:183]
  v_cvt_pk_bf16_f32 v28, v108, v109
  v_cvt_pk_bf16_f32 v29, v110, v111
  v_mfma_f32_16x16x32_bf16 v[184:187], v[60:63], v[216:219], v[184:187]
  v_mul_f32 v20, v92, v92
  v_mul_f32 v21, v93, v93
  v_mfma_f32_16x16x32_bf16 v[188:191], v[60:63], v[220:223], v[188:191]
  v_mul_f32 v22, v94, v94
  v_mul_f32 v23, v95, v95
  v_fmamk_f32 v20, v20, 0xbdd2d3e8, v12
  v_fmamk_f32 v21, v21, 0xbdd2d3e8, v12
  v_fmamk_f32 v22, v22, 0xbdd2d3e8, v12
  v_fmamk_f32 v23, v23, 0xbdd2d3e8, v12
  v_mul_f32 v20, v20, v92
  v_mul_f32 v21, v21, v93
  v_mul_f32 v22, v22, v94
  v_mul_f32 v23, v23, v95
  v_exp_f32 v20, v20
  v_exp_f32 v21, v21
  v_exp_f32 v22, v22
  v_exp_f32 v23, v23
  v_mul_f32 v124, v92, v124
  v_mul_f32 v125, v93, v125
  v_mul_f32 v126, v94, v126
  v_mul_f32 v127, v95, v127
  v_add_f32 v20, 1.0, v20
  v_add_f32 v21, 1.0, v21
  v_add_f32 v22, 1.0, v22
  v_add_f32 v23, 1.0, v23
  v_rcp_f32 v20, v20
  v_rcp_f32 v21, v21
  v_rcp_f32 v22, v22
  v_rcp_f32 v23, v23
  v_mul_f32 v124, v124, v20
  v_mul_f32 v125, v125, v21
  v_mul_f32 v126, v126, v22
  v_mul_f32 v127, v127, v23
  v_cvt_pk_bf16_f32 v30, v124, v125
  v_cvt_pk_bf16_f32 v31, v126, v127
  buffer_store_dwordx4 v[28:31], v11, s[20:23], s39 offen sc1
  s_add_u32 s36, s36, 1024
  s_add_u32 s37, s37, 1024
  s_add_u32 s38, s38, 1024
  s_add_u32 s39, s39, 1024
  s_nop 7
  s_nop 7
  s_mov_b32 s96, 0xbdd2d3e8
  s_mov_b32 s97, 0xbdd2d3e8
  v_pk_mul_f32 v[16:17], v[128:129], v[128:129]
  v_pk_mul_f32 v[18:19], v[130:131], v[130:131]
  v_pk_mul_f32 v[20:21], v[144:145], v[144:145]
  v_pk_mul_f32 v[22:23], v[146:147], v[146:147]
  v_pk_fma_f32 v[16:17], v[16:17], s[96:97], v[12:13] op_sel_hi:[1,1,0]
  v_pk_fma_f32 v[18:19], v[18:19], s[96:97], v[12:13] op_sel_hi:[1,1,0]
  v_pk_fma_f32 v[20:21], v[20:21], s[96:97], v[12:13] op_sel_hi:[1,1,0]
  v_pk_fma_f32 v[22:23], v[22:23], s[96:97], v[12:13] op_sel_hi:[1,1,0]
  v_pk_mul_f32 v[16:17], v[16:17], v[128:129]
  v_pk_mul_f32 v[18:19], v[18:19], v[130:131]
  v_pk_mul_f32 v[20:21], v[20:21], v[144:145]
  v_pk_mul_f32 v[22:23], v[22:23], v[146:147]
  v_exp_f32 v16, v16
  v_exp_f32 v17, v17
  v_exp_f32 v18, v18
  v_exp_f32 v19, v19
  v_exp_f32 v20, v20
  v_exp_f32 v21, v21
  v_exp_f32 v22, v22
  v_exp_f32 v23, v23
  v_pk_mul_f32 v[160:161], v[128:129], v[160:161]
  v_pk_mul_f32 v[162:163], v[130:131], v[162:163]
  v_pk_mul_f32 v[176:177], v[144:145], v[176:177]
  v_pk_mul_f32 v[178:179], v[146:147], v[178:179]
  v_pk_add_f32 v[16:17], v[16:17], 1.0 op_sel_hi:[1,0]
  v_pk_add_f32 v[18:19], v[18:19], 1.0 op_sel_hi:[1,0]
  v_pk_add_f32 v[20:21], v[20:21], 1.0 op_sel_hi:[1,0]
  v_pk_add_f32 v[22:23], v[22:23], 1.0 op_sel_hi:[1,0]
  v_rcp_f32 v16, v16
  v_rcp_f32 v17, v17
  v_rcp_f32 v18, v18
  v_rcp_f32 v19, v19
  v_rcp_f32 v20, v20
  v_rcp_f32 v21, v21
  v_rcp_f32 v22, v22
  v_rcp_f32 v23, v23
  v_pk_mul_f32 v[160:161], v[160:161], v[16:17]
  v_pk_mul_f32 v[162:163], v[162:163], v[18:19]
  v_pk_mul_f32 v[176:177], v[176:177], v[20:21]
  v_pk_mul_f32 v[178:179], v[178:179], v[22:23]
  v_cvt_pk_bf16_f32 v24, v160, v161
  v_cvt_pk_bf16_f32 v25, v162, v163
  v_cvt_pk_bf16_f32 v26, v176, v177
  v_cvt_pk_bf16_f32 v27, v178, v179
  buffer_store_dwordx4 v[24:27], v11, s[20:23], s36 offen sc1
  v_pk_mul_f32 v[16:17], v[132:133], v[132:133]
  v_pk_mul_f32 v[18:19], v[134:135], v[134:135]
  v_pk_mul_f32 v[20:21], v[148:149], v[148:149]
  v_pk_mul_f32 v[22:23], v[150:151], v[150:151]
  v_pk_fma_f32 v[16:17], v[16:17], s[96:97], v[12:13] op_sel_hi:[1,1,0]
  v_pk_fma_f32 v[18:19], v[18:19], s[96:97], v[12:13] op_sel_hi:[1,1,0]
  v_pk_fma_f32 v[20:21], v[20:21], s[96:97], v[12:13] op_sel_hi:[1,1,0]
  v_pk_fma_f32 v[22:23], v[22:23], s[96:97], v[12:13] op_sel_hi:[1,1,0]
  v_pk_mul_f32 v[16:17], v[16:17], v[132:133]
  v_pk_mul_f32 v[18:19], v[18:19], v[134:135]
  v_pk_mul_f32 v[20:21], v[20:21], v[148:149]
  v_pk_mul_f32 v[22:23], v[22:23], v[150:151]
  v_exp_f32 v16, v16
  v_exp_f32 v17, v17
  v_exp_f32 v18, v18
  v_exp_f32 v19, v19
  v_exp_f32 v20, v20
  v_exp_f32 v21, v21
  v_exp_f32 v22, v22
  v_exp_f32 v23, v23
  v_pk_mul_f32 v[164:165], v[132:133], v[164:165]
  v_pk_mul_f32 v[166:167], v[134:135], v[166:167]
  v_pk_mul_f32 v[180:181], v[148:149], v[180:181]
  v_pk_mul_f32 v[182:183], v[150:151], v[182:183]
  v_pk_add_f32 v[16:17], v[16:17], 1.0 op_sel_hi:[1,0]
  v_pk_add_f32 v[18:19], v[18:19], 1.0 op_sel_hi:[1,0]
  v_pk_add_f32 v[20:21], v[20:21], 1.0 op_sel_hi:[1,0]
  v_pk_add_f32 v[22:23], v[22:23], 1.0 op_sel_hi:[1,0]
  v_rcp_f32 v16, v16
  v_rcp_f32 v17, v17
  v_rcp_f32 v18, v18
  v_rcp_f32 v19, v19
  v_rcp_f32 v20, v20
  v_rcp_f32 v21, v21
  v_rcp_f32 v22, v22
  v_rcp_f32 v23, v23
  v_pk_mul_f32 v[164:165], v[164:165], v[16:17]
  v_pk_mul_f32 v[166:167], v[166:167], v[18:19]
  v_pk_mul_f32 v[180:181], v[180:181], v[20:21]
  v_pk_mul_f32 v[182:183], v[182:183], v[22:23]
  v_cvt_pk_bf16_f32 v28, v164, v165
  v_cvt_pk_bf16_f32 v29, v166, v167
  v_cvt_pk_bf16_f32 v30, v180, v181
  v_cvt_pk_bf16_f32 v31, v182, v183
  buffer_store_dwordx4 v[28:31], v11, s[20:23], s37 offen sc1
  v_pk_mul_f32 v[16:17], v[136:137], v[136:137]
  v_pk_mul_f32 v[18:19], v[138:139], v[138:139]
  v_pk_mul_f32 v[20:21], v[152:153], v[152:153]
  v_pk_mul_f32 v[22:23], v[154:155], v[154:155]
  v_pk_fma_f32 v[16:17], v[16:17], s[96:97], v[12:13] op_sel_hi:[1,1,0]
  v_pk_fma_f32 v[18:19], v[18:19], s[96:97], v[12:13] op_sel_hi:[1,1,0]
  v_pk_fma_f32 v[20:21], v[20:21], s[96:97], v[12:13] op_sel_hi:[1,1,0]
  v_pk_fma_f32 v[22:23], v[22:23], s[96:97], v[12:13] op_sel_hi:[1,1,0]
  v_pk_mul_f32 v[16:17], v[16:17], v[136:137]
  v_pk_mul_f32 v[18:19], v[18:19], v[138:139]
  v_pk_mul_f32 v[20:21], v[20:21], v[152:153]
  v_pk_mul_f32 v[22:23], v[22:23], v[154:155]
  v_exp_f32 v16, v16
  v_exp_f32 v17, v17
  v_exp_f32 v18, v18
  v_exp_f32 v19, v19
  v_exp_f32 v20, v20
  v_exp_f32 v21, v21
  v_exp_f32 v22, v22
  v_exp_f32 v23, v23
  v_pk_mul_f32 v[168:169], v[136:137], v[168:169]
  v_pk_mul_f32 v[170:171], v[138:139], v[170:171]
  v_pk_mul_f32 v[184:185], v[152:153], v[184:185]
  v_pk_mul_f32 v[186:187], v[154:155], v[186:187]
  v_pk_add_f32 v[16:17], v[16:17], 1.0 op_sel_hi:[1,0]
  v_pk_add_f32 v[18:19], v[18:19], 1.0 op_sel_hi:[1,0]
  v_pk_add_f32 v[20:21], v[20:21], 1.0 op_sel_hi:[1,0]
  v_pk_add_f32 v[22:23], v[22:23], 1.0 op_sel_hi:[1,0]
  v_rcp_f32 v16, v16
  v_rcp_f32 v17, v17
  v_rcp_f32 v18, v18
  v_rcp_f32 v19, v19
  v_rcp_f32 v20, v20
  v_rcp_f32 v21, v21
  v_rcp_f32 v22, v22
  v_rcp_f32 v23, v23
  v_pk_mul_f32 v[168:169], v[168:169], v[16:17]
  v_pk_mul_f32 v[170:171], v[170:171], v[18:19]
  v_pk_mul_f32 v[184:185], v[184:185], v[20:21]
  v_pk_mul_f32 v[186:187], v[186:187], v[22:23]
  v_cvt_pk_bf16_f32 v24, v168, v169
  v_cvt_pk_bf16_f32 v25, v170, v171
  v_cvt_pk_bf16_f32 v26, v184, v185
  v_cvt_pk_bf16_f32 v27, v186, v187
  buffer_store_dwordx4 v[24:27], v11, s[20:23], s38 offen sc1
  v_pk_mul_f32 v[16:17], v[140:141], v[140:141]
  v_pk_mul_f32 v[18:19], v[142:143], v[142:143]
  v_pk_mul_f32 v[20:21], v[156:157], v[156:157]
  v_pk_mul_f32 v[22:23], v[158:159], v[158:159]
  v_pk_fma_f32 v[16:17], v[16:17], s[96:97], v[12:13] op_sel_hi:[1,1,0]
  v_pk_fma_f32 v[18:19], v[18:19], s[96:97], v[12:13] op_sel_hi:[1,1,0]
  v_pk_fma_f32 v[20:21], v[20:21], s[96:97], v[12:13] op_sel_hi:[1,1,0]
  v_pk_fma_f32 v[22:23], v[22:23], s[96:97], v[12:13] op_sel_hi:[1,1,0]
  v_pk_mul_f32 v[16:17], v[16:17], v[140:141]
  v_pk_mul_f32 v[18:19], v[18:19], v[142:143]
  v_pk_mul_f32 v[20:21], v[20:21], v[156:157]
  v_pk_mul_f32 v[22:23], v[22:23], v[158:159]
  v_exp_f32 v16, v16
  v_exp_f32 v17, v17
  v_exp_f32 v18, v18
  v_exp_f32 v19, v19
  v_exp_f32 v20, v20
  v_exp_f32 v21, v21
  v_exp_f32 v22, v22
  v_exp_f32 v23, v23
  v_pk_mul_f32 v[172:173], v[140:141], v[172:173]
  v_pk_mul_f32 v[174:175], v[142:143], v[174:175]
  v_pk_mul_f32 v[188:189], v[156:157], v[188:189]
  v_pk_mul_f32 v[190:191], v[158:159], v[190:191]
  v_pk_add_f32 v[16:17], v[16:17], 1.0 op_sel_hi:[1,0]
  v_pk_add_f32 v[18:19], v[18:19], 1.0 op_sel_hi:[1,0]
  v_pk_add_f32 v[20:21], v[20:21], 1.0 op_sel_hi:[1,0]
  v_pk_add_f32 v[22:23], v[22:23], 1.0 op_sel_hi:[1,0]
  v_rcp_f32 v16, v16
  v_rcp_f32 v17, v17
  v_rcp_f32 v18, v18
  v_rcp_f32 v19, v19
  v_rcp_f32 v20, v20
  v_rcp_f32 v21, v21
  v_rcp_f32 v22, v22
  v_rcp_f32 v23, v23
  v_pk_mul_f32 v[172:173], v[172:173], v[16:17]
  v_pk_mul_f32 v[174:175], v[174:175], v[18:19]
  v_pk_mul_f32 v[188:189], v[188:189], v[20:21]
  v_pk_mul_f32 v[190:191], v[190:191], v[22:23]
  v_cvt_pk_bf16_f32 v28, v172, v173
  v_cvt_pk_bf16_f32 v29, v174, v175
  v_cvt_pk_bf16_f32 v30, v188, v189
  v_cvt_pk_bf16_f32 v31, v190, v191
  buffer_store_dwordx4 v[28:31], v11, s[20:23], s39 offen sc1
  v_and_b32 v211, 63, v0
  v_lshrrev_b32 v212, 4, v211
  v_bfe_u32 v208, v211, 2, 2
  v_lshl_add_u32 v208, v212, 2, v208
  v_mul_u32_u24 v14, 288, v208
  v_and_b32 v209, 3, v211
  v_lshl_add_u32 v14, v209, 3, v14
  s_load_dwordx2 s[50:51], s[0:1], 24
  s_add_u32 s8, s54, 21495808
  s_addc_u32 s9, s55, 0
  s_and_b32 s9, s9, 0xffff
  s_mov_b32 s10, 14155776
  s_mov_b32 s11, 0x00020000
  s_waitcnt vmcnt(0) lgkmcnt(0)
  s_mov_b32 s16, s50
  s_and_b32 s17, s51, 0xffff
  s_mov_b32 s18, 663552
  s_mov_b32 s19, 0x00020000
  s_barrier
  s_cmp_eq_u32 s28, 0
  s_cbranch_scc0 L_dn_nosig
  s_add_u32 s40, s66, 48
  s_lshl_b32 s40, s40, 7
  s_add_u32 s40, s40, 21430272
  v_mov_b32 v208, s40
  v_mov_b32 v209, 1
  s_mov_b64 s[80:81], exec
  s_mov_b64 exec, 1
  global_atomic_add v208, v209, s[54:55]
  s_mov_b64 exec, s[80:81]
L_dn_nosig:
  s_mov_b32 s63, 0
  s_mov_b32 s62, 0
  v_mov_b32 v15, v14
  ds_read_b64_tr_b16 v[24:25], v15 offset:0
  ds_read_b64_tr_b16 v[26:27], v15 offset:4608
  ds_read_b64_tr_b16 v[28:29], v15 offset:32
  ds_read_b64_tr_b16 v[30:31], v15 offset:4640
  ds_read_b64_tr_b16 v[32:33], v15 offset:64
  ds_read_b64_tr_b16 v[34:35], v15 offset:4672
  ds_read_b64_tr_b16 v[36:37], v15 offset:96
  ds_read_b64_tr_b16 v[38:39], v15 offset:4704
  s_waitcnt vmcnt(19)
  s_waitcnt lgkmcnt(6)
  v_mfma_f32_16x16x32_bf16 v[64:67], v[24:27], a[0:3], 0
  ds_read_b64_tr_b16 v[40:41], v15 offset:128
  ds_read_b64_tr_b16 v[42:43], v15 offset:4736
  v_mfma_f32_16x16x32_bf16 v[68:71], v[24:27], a[4:7], 0
  s_add_u32 s40, s61, 0
  s_add_u32 m0, s40, s86
  v_mfma_f32_16x16x32_bf16 v[72:75], v[24:27], a[8:11], 0
  s_nop 0
  v_mfma_f32_16x16x32_bf16 v[76:79], v[24:27], a[12:15], 0
  buffer_load_dwordx4 v236, s[56:59], s60 offen lds
  s_waitcnt lgkmcnt(6)
  v_mfma_f32_16x16x32_bf16 v[80:83], v[28:31], a[0:3], 0
  ds_read_b64_tr_b16 v[44:45], v15 offset:160
  ds_read_b64_tr_b16 v[46:47], v15 offset:4768
  v_mfma_f32_16x16x32_bf16 v[84:87], v[28:31], a[4:7], 0
  s_add_u32 s40, s61, 4096
  s_add_u32 m0, s40, s86
  v_mfma_f32_16x16x32_bf16 v[88:91], v[28:31], a[8:11], 0
  s_nop 0
  v_mfma_f32_16x16x32_bf16 v[92:95], v[28:31], a[12:15], 0
  buffer_load_dwordx4 v237, s[56:59], s60 offen lds
  s_waitcnt lgkmcnt(6)
  v_mfma_f32_16x16x32_bf16 v[96:99], v[32:35], a[0:3], 0
  ds_read_b64_tr_b16 v[48:49], v15 offset:192
  ds_read_b64_tr_b16 v[50:51], v15 offset:4800
  v_mfma_f32_16x16x32_bf16 v[100:103], v[32:35], a[4:7], 0
  s_add_u32 s40, s61, 8192
  s_add_u32 m0, s40, s86
  v_mfma_f32_16x16x32_bf16 v[104:107], v[32:35], a[8:11], 0
  s_nop 0
  v_mfma_f32_16x16x32_bf16 v[108:111], v[32:35], a[12:15], 0
  buffer_load_dwordx4 v238, s[56:59], s60 offen lds
  s_waitcnt lgkmcnt(6)
  v_mfma_f32_16x16x32_bf16 v[112:115], v[36:39], a[0:3], 0
  ds_read_b64_tr_b16 v[52:53], v15 offset:224
  ds_read_b64_tr_b16 v[54:55], v15 offset:4832
  v_mfma_f32_16x16x32_bf16 v[116:119], v[36:39], a[4:7], 0
  s_add_u32 s40, s61, 12288
  s_add_u32 m0, s40, s86
  v_mfma_f32_16x16x32_bf16 v[120:123], v[36:39], a[8:11], 0
  s_nop 0
  v_mfma_f32_16x16x32_bf16 v[124:127], v[36:39], a[12:15], 0
  buffer_load_dwordx4 v239, s[56:59], s60 offen lds
  s_waitcnt lgkmcnt(6)
  v_mfma_f32_16x16x32_bf16 v[128:131], v[40:43], a[0:3], 0
  ds_read_b64_tr_b16 v[56:57], v15 offset:256
  ds_read_b64_tr_b16 v[58:59], v15 offset:4864
  v_mfma_f32_16x16x32_bf16 v[132:135], v[40:43], a[4:7], 0
  s_add_u32 s40, s61, 16384
  s_add_u32 m0, s40, s86
  v_mfma_f32_16x16x32_bf16 v[136:139], v[40:43], a[8:11], 0
  s_nop 0
  v_mfma_f32_16x16x32_bf16 v[140:143], v[40:43], a[12:15], 0
  buffer_load_dwordx4 v240, s[56:59], s60 offen lds
  s_waitcnt lgkmcnt(6)
  v_mfma_f32_16x16x32_bf16 v[144:147], v[44:47], a[0:3], 0
  ds_read_b64_tr_b16 v[24:25], v15 offset:9216
  ds_read_b64_tr_b16 v[26:27], v15 offset:13824
  v_mfma_f32_16x16x32_bf16 v[148:151], v[44:47], a[4:7], 0
  s_add_u32 s40, s61, 20480
  s_add_u32 m0, s40, s86
  v_mfma_f32_16x16x32_bf16 v[152:155], v[44:47], a[8:11], 0
  s_nop 0
  v_mfma_f32_16x16x32_bf16 v[156:159], v[44:47], a[12:15], 0
  buffer_load_dwordx4 v241, s[56:59], s60 offen lds
  s_waitcnt lgkmcnt(6)
  v_mfma_f32_16x16x32_bf16 v[160:163], v[48:51], a[0:3], 0
  ds_read_b64_tr_b16 v[28:29], v15 offset:9248
  ds_read_b64_tr_b16 v[30:31], v15 offset:13856
  s_add_u32 s40, s61, 24576
  v_mfma_f32_16x16x32_bf16 v[164:167], v[48:51], a[4:7], 0
  s_add_u32 m0, s40, s86
  s_nop 0
  buffer_load_dwordx4 v242, s[56:59], s60 offen lds
  v_mfma_f32_16x16x32_bf16 v[168:171], v[48:51], a[8:11], 0
  s_add_u32 s61, s61, 28672
  s_cmp_eq_u32 s61, 143360
  v_mfma_f32_16x16x32_bf16 v[172:175], v[48:51], a[12:15], 0
  s_cselect_b32 s61, 0, s61
  s_add_u32 s60, s60, 221184
  s_waitcnt lgkmcnt(6)
  v_mfma_f32_16x16x32_bf16 v[176:179], v[52:55], a[0:3], 0
  ds_read_b64_tr_b16 v[32:33], v15 offset:9280
  v_mfma_f32_16x16x32_bf16 v[180:183], v[52:55], a[4:7], 0
  ds_read_b64_tr_b16 v[34:35], v15 offset:13888
  v_mfma_f32_16x16x32_bf16 v[184:187], v[52:55], a[8:11], 0
  buffer_load_dwordx4 a[96:99], v11, s[20:23], s32 offen offset:0 sc1
  v_mfma_f32_16x16x32_bf16 v[188:191], v[52:55], a[12:15], 0
  s_waitcnt lgkmcnt(6)
  v_mfma_f32_16x16x32_bf16 v[192:195], v[56:59], a[0:3], 0
  ds_read_b64_tr_b16 v[36:37], v15 offset:9312
  v_mfma_f32_16x16x32_bf16 v[196:199], v[56:59], a[4:7], 0
  ds_read_b64_tr_b16 v[38:39], v15 offset:13920
  v_mfma_f32_16x16x32_bf16 v[200:203], v[56:59], a[8:11], 0
  buffer_load_dwordx4 a[100:103], v11, s[20:23], s33 offen offset:0 sc1
  v_mfma_f32_16x16x32_bf16 v[204:207], v[56:59], a[12:15], 0
  s_waitcnt lgkmcnt(6)
  v_mfma_f32_16x16x32_bf16 v[64:67], v[24:27], a[16:19], v[64:67]
  ds_read_b64_tr_b16 v[40:41], v15 offset:9344
  v_mfma_f32_16x16x32_bf16 v[68:71], v[24:27], a[20:23], v[68:71]
  ds_read_b64_tr_b16 v[42:43], v15 offset:13952
  v_mfma_f32_16x16x32_bf16 v[72:75], v[24:27], a[24:27], v[72:75]
  buffer_load_dwordx4 a[104:107], v11, s[20:23], s34 offen offset:0 sc1
  v_mfma_f32_16x16x32_bf16 v[76:79], v[24:27], a[28:31], v[76:79]
  s_waitcnt lgkmcnt(6)
  v_mfma_f32_16x16x32_bf16 v[80:83], v[28:31], a[16:19], v[80:83]
  ds_read_b64_tr_b16 v[44:45], v15 offset:9376
  v_mfma_f32_16x16x32_bf16 v[84:87], v[28:31], a[20:23], v[84:87]
  ds_read_b64_tr_b16 v[46:47], v15 offset:13984
  v_mfma_f32_16x16x32_bf16 v[88:91], v[28:31], a[24:27], v[88:91]
  buffer_load_dwordx4 a[108:111], v11, s[20:23], s35 offen offset:0 sc1
  v_mfma_f32_16x16x32_bf16 v[92:95], v[28:31], a[28:31], v[92:95]
  s_waitcnt lgkmcnt(6)
  v_mfma_f32_16x16x32_bf16 v[96:99], v[32:35], a[16:19], v[96:99]
  ds_read_b64_tr_b16 v[48:49], v15 offset:9408
  v_mfma_f32_16x16x32_bf16 v[100:103], v[32:35], a[20:23], v[100:103]
  ds_read_b64_tr_b16 v[50:51], v15 offset:14016
  v_mfma_f32_16x16x32_bf16 v[104:107], v[32:35], a[24:27], v[104:107]
  buffer_load_dwordx4 a[112:115], v11, s[20:23], s32 offen offset:1024 sc1
  v_mfma_f32_16x16x32_bf16 v[108:111], v[32:35], a[28:31], v[108:111]
  s_waitcnt lgkmcnt(6)
  v_mfma_f32_16x16x32_bf16 v[112:115], v[36:39], a[16:19], v[112:115]
  ds_read_b64_tr_b16 v[52:53], v15 offset:9440
  v_mfma_f32_16x16x32_bf16 v[116:119], v[36:39], a[20:23], v[116:119]
  ds_read_b64_tr_b16 v[54:55], v15 offset:14048
  v_mfma_f32_16x16x32_bf16 v[120:123], v[36:39], a[24:27], v[120:123]
  buffer_load_dwordx4 a[116:119], v11, s[20:23], s33 offen offset:1024 sc1
  v_mfma_f32_16x16x32_bf16 v[124:127], v[36:39], a[28:31], v[124:127]
  s_waitcnt lgkmcnt(6)
  v_mfma_f32_16x16x32_bf16 v[128:131], v[40:43], a[16:19], v[128:131]
  ds_read_b64_tr_b16 v[56:57], v15 offset:9472
  v_mfma_f32_16x16x32_bf16 v[132:135], v[40:43], a[20:23], v[132:135]
  ds_read_b64_tr_b16 v[58:59], v15 offset:14080
  v_mfma_f32_16x16x32_bf16 v[136:139], v[40:43], a[24:27], v[136:139]
  buffer_load_dwordx4 a[120:123], v11, s[20:23], s34 offen offset:1024 sc1
  v_mfma_f32_16x16x32_bf16 v[140:143], v[40:43], a[28:31], v[140:143]
  s_waitcnt lgkmcnt(6)
  v_mfma_f32_16x16x32_bf16 v[144:147], v[44:47], a[16:19], v[144:147]
  ds_read_b64_tr_b16 v[24:25], v15 offset:18432
  v_mfma_f32_16x16x32_bf16 v[148:151], v[44:47], a[20:23], v[148:151]
  ds_read_b64_tr_b16 v[26:27], v15 offset:23040
  v_mfma_f32_16x16x32_bf16 v[152:155], v[44:47], a[24:27], v[152:155]
  buffer_load_dwordx4 a[124:127], v11, s[20:23], s35 offen offset:1024 sc1
  v_mfma_f32_16x16x32_bf16 v[156:159], v[44:47], a[28:31], v[156:159]
  s_waitcnt lgkmcnt(6)
  v_mfma_f32_16x16x32_bf16 v[160:163], v[48:51], a[16:19], v[160:163]
  ds_read_b64_tr_b16 v[28:29], v15 offset:18464
  v_mfma_f32_16x16x32_bf16 v[164:167], v[48:51], a[20:23], v[164:167]
  ds_read_b64_tr_b16 v[30:31], v15 offset:23072
  v_mfma_f32_16x16x32_bf16 v[168:171], v[48:51], a[24:27], v[168:171]
  buffer_load_dwordx4 a[128:131], v11, s[20:23], s32 offen offset:2048 sc1
  v_mfma_f32_16x16x32_bf16 v[172:175], v[48:51], a[28:31], v[172:175]
  s_waitcnt lgkmcnt(6)
  v_mfma_f32_16x16x32_bf16 v[176:179], v[52:55], a[16:19], v[176:179]
  ds_read_b64_tr_b16 v[32:33], v15 offset:18496
  v_mfma_f32_16x16x32_bf16 v[180:183], v[52:55], a[20:23], v[180:183]
  ds_read_b64_tr_b16 v[34:35], v15 offset:23104
  v_mfma_f32_16x16x32_bf16 v[184:187], v[52:55], a[24:27], v[184:187]
  buffer_load_dwordx4 a[132:135], v11, s[20:23], s33 offen offset:2048 sc1
  v_mfma_f32_16x16x32_bf16 v[188:191], v[52:55], a[28:31], v[188:191]
  s_waitcnt lgkmcnt(6)
  v_mfma_f32_16x16x32_bf16 v[192:195], v[56:59], a[16:19], v[192:195]
  ds_read_b64_tr_b16 v[36:37], v15 offset:18528
  v_mfma_f32_16x16x32_bf16 v[196:199], v[56:59], a[20:23], v[196:199]
  ds_read_b64_tr_b16 v[38:39], v15 offset:23136
  v_mfma_f32_16x16x32_bf16 v[200:203], v[56:59], a[24:27], v[200:203]
  buffer_load_dwordx4 a[136:139], v11, s[20:23], s34 offen offset:2048 sc1
  v_mfma_f32_16x16x32_bf16 v[204:207], v[56:59], a[28:31], v[204:207]
  s_barrier
  s_waitcnt lgkmcnt(6)
  v_mfma_f32_16x16x32_bf16 v[64:67], v[24:27], a[32:35], v[64:67]
  ds_read_b64_tr_b16 v[40:41], v15 offset:18560
  v_mfma_f32_16x16x32_bf16 v[68:71], v[24:27], a[36:39], v[68:71]
  ds_read_b64_tr_b16 v[42:43], v15 offset:23168
  v_mfma_f32_16x16x32_bf16 v[72:75], v[24:27], a[40:43], v[72:75]
  buffer_load_dwordx4 a[140:143], v11, s[20:23], s35 offen offset:2048 sc1
  v_mfma_f32_16x16x32_bf16 v[76:79], v[24:27], a[44:47], v[76:79]
  s_waitcnt lgkmcnt(6)
  v_mfma_f32_16x16x32_bf16 v[80:83], v[28:31], a[32:35], v[80:83]
  ds_read_b64_tr_b16 v[44:45], v15 offset:18592
  ds_read_b64_tr_b16 v[46:47], v15 offset:23200
  s_add_u32 s40, s61, 0
  v_mfma_f32_16x16x32_bf16 v[84:87], v[28:31], a[36:39], v[84:87]
  s_add_u32 m0, s40, s86
  s_nop 0
  v_mfma_f32_16x16x32_bf16 v[88:91], v[28:31], a[40:43], v[88:91]
  buffer_load_dwordx4 v236, s[56:59], s60 offen lds
  s_add_u32 s62, s62, 28672
  v_mfma_f32_16x16x32_bf16 v[92:95], v[28:31], a[44:47], v[92:95]
  s_cmp_eq_u32 s62, 143360
  s_cselect_b32 s62, 0, s62
  s_waitcnt lgkmcnt(6)
  v_mfma_f32_16x16x32_bf16 v[96:99], v[32:35], a[32:35], v[96:99]
  ds_read_b64_tr_b16 v[48:49], v15 offset:18624
  ds_read_b64_tr_b16 v[50:51], v15 offset:23232
  v_mfma_f32_16x16x32_bf16 v[100:103], v[32:35], a[36:39], v[100:103]
  s_add_u32 s40, s61, 4096
  s_add_u32 m0, s40, s86
  v_mfma_f32_16x16x32_bf16 v[104:107], v[32:35], a[40:43], v[104:107]
  s_nop 0
  buffer_load_dwordx4 v237, s[56:59], s60 offen lds
  v_mfma_f32_16x16x32_bf16 v[108:111], v[32:35], a[44:47], v[108:111]
  v_add_u32 v9, s62, v14
  s_waitcnt lgkmcnt(6)
  v_mfma_f32_16x16x32_bf16 v[112:115], v[36:39], a[32:35], v[112:115]
  ds_read_b64_tr_b16 v[52:53], v15 offset:18656
  ds_read_b64_tr_b16 v[54:55], v15 offset:23264
  v_mfma_f32_16x16x32_bf16 v[116:119], v[36:39], a[36:39], v[116:119]
  s_add_u32 s40, s61, 8192
  s_add_u32 m0, s40, s86
  v_mfma_f32_16x16x32_bf16 v[120:123], v[36:39], a[40:43], v[120:123]
  s_nop 0
  v_mfma_f32_16x16x32_bf16 v[124:127], v[36:39], a[44:47], v[124:127]
  buffer_load_dwordx4 v238, s[56:59], s60 offen lds
  s_waitcnt lgkmcnt(6)
  v_mfma_f32_16x16x32_bf16 v[128:131], v[40:43], a[32:35], v[128:131]
  ds_read_b64_tr_b16 v[56:57], v15 offset:18688
  ds_read_b64_tr_b16 v[58:59], v15 offset:23296
  v_mfma_f32_16x16x32_bf16 v[132:135], v[40:43], a[36:39], v[132:135]
  s_add_u32 s40, s61, 12288
  s_add_u32 m0, s40, s86
  v_mfma_f32_16x16x32_bf16 v[136:139], v[40:43], a[40:43], v[136:139]
  s_nop 0
  v_mfma_f32_16x16x32_bf16 v[140:143], v[40:43], a[44:47], v[140:143]
  buffer_load_dwordx4 v239, s[56:59], s60 offen lds
  s_waitcnt lgkmcnt(6)
  v_mfma_f32_16x16x32_bf16 v[144:147], v[44:47], a[32:35], v[144:147]
  ds_read_b64_tr_b16 v[24:25], v9 offset:0
  ds_read_b64_tr_b16 v[26:27], v9 offset:4608
  v_mfma_f32_16x16x32_bf16 v[148:151], v[44:47], a[36:39], v[148:151]
  s_add_u32 s40, s61, 16384
  s_add_u32 m0, s40, s86
  v_mfma_f32_16x16x32_bf16 v[152:155], v[44:47], a[40:43], v[152:155]
  s_nop 0
  v_mfma_f32_16x16x32_bf16 v[156:159], v[44:47], a[44:47], v[156:159]
  buffer_load_dwordx4 v240, s[56:59], s60 offen lds
  s_waitcnt lgkmcnt(6)
  v_mfma_f32_16x16x32_bf16 v[160:163], v[48:51], a[32:35], v[160:163]
  ds_read_b64_tr_b16 v[28:29], v9 offset:32
  ds_read_b64_tr_b16 v[30:31], v9 offset:4640
  v_mfma_f32_16x16x32_bf16 v[164:167], v[48:51], a[36:39], v[164:167]
  s_add_u32 s40, s61, 20480
  s_add_u32 m0, s40, s86
  v_mfma_f32_16x16x32_bf16 v[168:171], v[48:51], a[40:43], v[168:171]
  s_nop 0
  v_mfma_f32_16x16x32_bf16 v[172:175], v[48:51], a[44:47], v[172:175]
  buffer_load_dwordx4 v241, s[56:59], s60 offen lds
  s_waitcnt lgkmcnt(6)
  v_mfma_f32_16x16x32_bf16 v[176:179], v[52:55], a[32:35], v[176:179]
  ds_read_b64_tr_b16 v[32:33], v9 offset:64
  ds_read_b64_tr_b16 v[34:35], v9 offset:4672
  v_mfma_f32_16x16x32_bf16 v[180:183], v[52:55], a[36:39], v[180:183]
  s_add_u32 s40, s61, 24576
  s_add_u32 m0, s40, s86
  v_mfma_f32_16x16x32_bf16 v[184:187], v[52:55], a[40:43], v[184:187]
  s_nop 0
  v_mfma_f32_16x16x32_bf16 v[188:191], v[52:55], a[44:47], v[188:191]
  buffer_load_dwordx4 v242, s[56:59], s60 offen lds
  s_waitcnt lgkmcnt(6)
  v_mfma_f32_16x16x32_bf16 v[192:195], v[56:59], a[32:35], v[192:195]
  ds_read_b64_tr_b16 v[36:37], v9 offset:96
  ds_read_b64_tr_b16 v[38:39], v9 offset:4704
  s_add_u32 s61, s61, 28672
  v_mfma_f32_16x16x32_bf16 v[196:199], v[56:59], a[36:39], v[196:199]
  s_cmp_eq_u32 s61, 143360
  s_cselect_b32 s61, 0, s61
  s_add_u32 s60, s60, 221184
  v_mfma_f32_16x16x32_bf16 v[200:203], v[56:59], a[40:43], v[200:203]
  s_add_u32 s32, s32, 6144
  s_add_u32 s33, s33, 6144
  s_add_u32 s34, s34, 6144
  v_mfma_f32_16x16x32_bf16 v[204:207], v[56:59], a[44:47], v[204:207]
  s_add_u32 s35, s35, 6144
  s_add_u32 s63, s63, 1
  v_mov_b32 v15, v9
  s_sub_u32 s60, s60, 774144
  s_add_u32 s40, s68, 48
  s_lshl_b32 s40, s40, 7
  s_add_u32 s40, s40, 21430272
  v_mov_b32 v208, s40
  global_load_dword v230, v208, s[54:55] sc1
  s_branch L_dn_s1
.p2align 6
L_dn_loop:
  s_waitcnt vmcnt(19)
  s_waitcnt lgkmcnt(6)
  v_mfma_f32_16x16x32_bf16 v[64:67], v[24:27], a[0:3], v[64:67]
  ds_read_b64_tr_b16 v[40:41], v15 offset:128
  v_mfma_f32_16x16x32_bf16 v[68:71], v[24:27], a[4:7], v[68:71]
  ds_read_b64_tr_b16 v[42:43], v15 offset:4736
  v_mfma_f32_16x16x32_bf16 v[72:75], v[24:27], a[8:11], v[72:75]
  buffer_load_dwordx4 a[96:99], v11, s[20:23], s32 offen offset:0 sc1
  v_mfma_f32_16x16x32_bf16 v[76:79], v[24:27], a[12:15], v[76:79]
  s_waitcnt lgkmcnt(6)
  v_mfma_f32_16x16x32_bf16 v[80:83], v[28:31], a[0:3], v[80:83]
  ds_read_b64_tr_b16 v[44:45], v15 offset:160
  v_mfma_f32_16x16x32_bf16 v[84:87], v[28:31], a[4:7], v[84:87]
  ds_read_b64_tr_b16 v[46:47], v15 offset:4768
  v_mfma_f32_16x16x32_bf16 v[88:91], v[28:31], a[8:11], v[88:91]
  buffer_load_dwordx4 a[100:103], v11, s[20:23], s33 offen offset:0 sc1
  v_mfma_f32_16x16x32_bf16 v[92:95], v[28:31], a[12:15], v[92:95]
  s_waitcnt lgkmcnt(6)
  v_mfma_f32_16x16x32_bf16 v[96:99], v[32:35], a[0:3], v[96:99]
  ds_read_b64_tr_b16 v[48:49], v15 offset:192
  v_mfma_f32_16x16x32_bf16 v[100:103], v[32:35], a[4:7], v[100:103]
  ds_read_b64_tr_b16 v[50:51], v15 offset:4800
  v_mfma_f32_16x16x32_bf16 v[104:107], v[32:35], a[8:11], v[104:107]
  buffer_load_dwordx4 a[104:107], v11, s[20:23], s34 offen offset:0 sc1
  v_mfma_f32_16x16x32_bf16 v[108:111], v[32:35], a[12:15], v[108:111]
  s_waitcnt lgkmcnt(6)
  v_mfma_f32_16x16x32_bf16 v[112:115], v[36:39], a[0:3], v[112:115]
  ds_read_b64_tr_b16 v[52:53], v15 offset:224
  v_mfma_f32_16x16x32_bf16 v[116:119], v[36:39], a[4:7], v[116:119]
  ds_read_b64_tr_b16 v[54:55], v15 offset:4832
  v_mfma_f32_16x16x32_bf16 v[120:123], v[36:39], a[8:11], v[120:123]
  buffer_load_dwordx4 a[108:111], v11, s[20:23], s35 offen offset:0 sc1
  v_mfma_f32_16x16x32_bf16 v[124:127], v[36:39], a[12:15], v[124:127]
  s_waitcnt lgkmcnt(6)
  v_mfma_f32_16x16x32_bf16 v[128:131], v[40:43], a[0:3], v[128:131]
  ds_read_b64_tr_b16 v[56:57], v15 offset:256
  v_mfma_f32_16x16x32_bf16 v[132:135], v[40:43], a[4:7], v[132:135]
  ds_read_b64_tr_b16 v[58:59], v15 offset:4864
  v_mfma_f32_16x16x32_bf16 v[136:139], v[40:43], a[8:11], v[136:139]
  buffer_load_dwordx4 a[112:115], v11, s[20:23], s32 offen offset:1024 sc1
  v_mfma_f32_16x16x32_bf16 v[140:143], v[40:43], a[12:15], v[140:143]
  s_waitcnt lgkmcnt(6)
  v_mfma_f32_16x16x32_bf16 v[144:147], v[44:47], a[0:3], v[144:147]
  ds_read_b64_tr_b16 v[24:25], v15 offset:9216
  v_mfma_f32_16x16x32_bf16 v[148:151], v[44:47], a[4:7], v[148:151]
  ds_read_b64_tr_b16 v[26:27], v15 offset:13824
  v_mfma_f32_16x16x32_bf16 v[152:155], v[44:47], a[8:11], v[152:155]
  buffer_load_dwordx4 a[116:119], v11, s[20:23], s33 offen offset:1024 sc1
  v_mfma_f32_16x16x32_bf16 v[156:159], v[44:47], a[12:15], v[156:159]
  s_waitcnt lgkmcnt(6)
  v_mfma_f32_16x16x32_bf16 v[160:163], v[48:51], a[0:3], v[160:163]
  ds_read_b64_tr_b16 v[28:29], v15 offset:9248
  v_mfma_f32_16x16x32_bf16 v[164:167], v[48:51], a[4:7], v[164:167]
  ds_read_b64_tr_b16 v[30:31], v15 offset:13856
  v_mfma_f32_16x16x32_bf16 v[168:171], v[48:51], a[8:11], v[168:171]
  buffer_load_dwordx4 a[120:123], v11, s[20:23], s34 offen offset:1024 sc1
  v_mfma_f32_16x16x32_bf16 v[172:175], v[48:51], a[12:15], v[172:175]
  s_waitcnt lgkmcnt(6)
  v_mfma_f32_16x16x32_bf16 v[176:179], v[52:55], a[0:3], v[176:179]
  ds_read_b64_tr_b16 v[32:33], v15 offset:9280
  v_mfma_f32_16x16x32_bf16 v[180:183], v[52:55], a[4:7], v[180:183]
  ds_read_b64_tr_b16 v[34:35], v15 offset:13888
  v_mfma_f32_16x16x32_bf16 v[184:187], v[52:55], a[8:11], v[184:187]
  buffer_load_dwordx4 a[124:127], v11, s[20:23], s35 offen offset:1024 sc1
  v_mfma_f32_16x16x32_bf16 v[188:191], v[52:55], a[12:15], v[188:191]
  s_waitcnt lgkmcnt(6)
  v_mfma_f32_16x16x32_bf16 v[192:195], v[56:59], a[0:3], v[192:195]
  ds_read_b64_tr_b16 v[36:37], v15 offset:9312
  v_mfma_f32_16x16x32_bf16 v[196:199], v[56:59], a[4:7], v[196:199]
  ds_read_b64_tr_b16 v[38:39], v15 offset:13920
  v_mfma_f32_16x16x32_bf16 v[200:203], v[56:59], a[8:11], v[200:203]
  buffer_load_dwordx4 a[128:131], v11, s[20:23], s32 offen offset:2048 sc1
  v_mfma_f32_16x16x32_bf16 v[204:207], v[56:59], a[12:15], v[204:207]
  s_waitcnt lgkmcnt(6)
  v_mfma_f32_16x16x32_bf16 v[64:67], v[24:27], a[16:19], v[64:67]
  ds_read_b64_tr_b16 v[40:41], v15 offset:9344
  v_mfma_f32_16x16x32_bf16 v[68:71], v[24:27], a[20:23], v[68:71]
  ds_read_b64_tr_b16 v[42:43], v15 offset:13952
  v_mfma_f32_16x16x32_bf16 v[72:75], v[24:27], a[24:27], v[72:75]
  buffer_load_dwordx4 a[132:135], v11, s[20:23], s33 offen offset:2048 sc1
  v_mfma_f32_16x16x32_bf16 v[76:79], v[24:27], a[28:31], v[76:79]
  s_waitcnt lgkmcnt(6)
  v_mfma_f32_16x16x32_bf16 v[80:83], v[28:31], a[16:19], v[80:83]
  ds_read_b64_tr_b16 v[44:45], v15 offset:9376
  v_mfma_f32_16x16x32_bf16 v[84:87], v[28:31], a[20:23], v[84:87]
  ds_read_b64_tr_b16 v[46:47], v15 offset:13984
  v_mfma_f32_16x16x32_bf16 v[88:91], v[28:31], a[24:27], v[88:91]
  buffer_load_dwordx4 a[136:139], v11, s[20:23], s34 offen offset:2048 sc1
  v_mfma_f32_16x16x32_bf16 v[92:95], v[28:31], a[28:31], v[92:95]
  s_waitcnt lgkmcnt(6)
  v_mfma_f32_16x16x32_bf16 v[96:99], v[32:35], a[16:19], v[96:99]
  ds_read_b64_tr_b16 v[48:49], v15 offset:9408
  v_mfma_f32_16x16x32_bf16 v[100:103], v[32:35], a[20:23], v[100:103]
  ds_read_b64_tr_b16 v[50:51], v15 offset:14016
  v_mfma_f32_16x16x32_bf16 v[104:107], v[32:35], a[24:27], v[104:107]
  buffer_load_dwordx4 a[140:143], v11, s[20:23], s35 offen offset:2048 sc1
  v_mfma_f32_16x16x32_bf16 v[108:111], v[32:35], a[28:31], v[108:111]
  s_waitcnt lgkmcnt(6)
  v_mfma_f32_16x16x32_bf16 v[112:115], v[36:39], a[16:19], v[112:115]
  ds_read_b64_tr_b16 v[52:53], v15 offset:9440
  ds_read_b64_tr_b16 v[54:55], v15 offset:14048
  v_mfma_f32_16x16x32_bf16 v[116:119], v[36:39], a[20:23], v[116:119]
  s_add_u32 s40, s61, 0
  s_add_u32 m0, s40, s86
  v_mfma_f32_16x16x32_bf16 v[120:123], v[36:39], a[24:27], v[120:123]
  s_nop 0
  v_mfma_f32_16x16x32_bf16 v[124:127], v[36:39], a[28:31], v[124:127]
  buffer_load_dwordx4 v236, s[56:59], s60 offen lds
  s_waitcnt lgkmcnt(6)
  v_mfma_f32_16x16x32_bf16 v[128:131], v[40:43], a[16:19], v[128:131]
  ds_read_b64_tr_b16 v[56:57], v15 offset:9472
  ds_read_b64_tr_b16 v[58:59], v15 offset:14080
  v_mfma_f32_16x16x32_bf16 v[132:135], v[40:43], a[20:23], v[132:135]
  s_add_u32 s40, s61, 4096
  s_add_u32 m0, s40, s86
  v_mfma_f32_16x16x32_bf16 v[136:139], v[40:43], a[24:27], v[136:139]
  s_nop 0
  v_mfma_f32_16x16x32_bf16 v[140:143], v[40:43], a[28:31], v[140:143]
  buffer_load_dwordx4 v237, s[56:59], s60 offen lds
  s_waitcnt lgkmcnt(6)
  v_mfma_f32_16x16x32_bf16 v[144:147], v[44:47], a[16:19], v[144:147]
  ds_read_b64_tr_b16 v[24:25], v15 offset:18432
  ds_read_b64_tr_b16 v[26:27], v15 offset:23040
  v_mfma_f32_16x16x32_bf16 v[148:151], v[44:47], a[20:23], v[148:151]
  s_add_u32 s40, s61, 8192
  s_add_u32 m0, s40, s86
  v_mfma_f32_16x16x32_bf16 v[152:155], v[44:47], a[24:27], v[152:155]
  s_nop 0
  v_mfma_f32_16x16x32_bf16 v[156:159], v[44:47], a[28:31], v[156:159]
  buffer_load_dwordx4 v238, s[56:59], s60 offen lds
  s_waitcnt lgkmcnt(6)
  v_mfma_f32_16x16x32_bf16 v[160:163], v[48:51], a[16:19], v[160:163]
  ds_read_b64_tr_b16 v[28:29], v15 offset:18464
  ds_read_b64_tr_b16 v[30:31], v15 offset:23072
  v_mfma_f32_16x16x32_bf16 v[164:167], v[48:51], a[20:23], v[164:167]
  s_add_u32 s40, s61, 12288
  s_add_u32 m0, s40, s86
  v_mfma_f32_16x16x32_bf16 v[168:171], v[48:51], a[24:27], v[168:171]
  s_nop 0
  v_mfma_f32_16x16x32_bf16 v[172:175], v[48:51], a[28:31], v[172:175]
  buffer_load_dwordx4 v239, s[56:59], s60 offen lds
  s_waitcnt lgkmcnt(6)
  v_mfma_f32_16x16x32_bf16 v[176:179], v[52:55], a[16:19], v[176:179]
  ds_read_b64_tr_b16 v[32:33], v15 offset:18496
  ds_read_b64_tr_b16 v[34:35], v15 offset:23104
  v_mfma_f32_16x16x32_bf16 v[180:183], v[52:55], a[20:23], v[180:183]
  s_add_u32 s40, s61, 16384
  s_add_u32 m0, s40, s86
  v_mfma_f32_16x16x32_bf16 v[184:187], v[52:55], a[24:27], v[184:187]
  s_nop 0
  v_mfma_f32_16x16x32_bf16 v[188:191], v[52:55], a[28:31], v[188:191]
  buffer_load_dwordx4 v240, s[56:59], s60 offen lds
  s_waitcnt lgkmcnt(6)
  v_mfma_f32_16x16x32_bf16 v[192:195], v[56:59], a[16:19], v[192:195]
  ds_read_b64_tr_b16 v[36:37], v15 offset:18528
  ds_read_b64_tr_b16 v[38:39], v15 offset:23136
  v_mfma_f32_16x16x32_bf16 v[196:199], v[56:59], a[20:23], v[196:199]
  s_add_u32 s40, s61, 20480
  s_add_u32 m0, s40, s86
  v_mfma_f32_16x16x32_bf16 v[200:203], v[56:59], a[24:27], v[200:203]
  s_nop 0
  v_mfma_f32_16x16x32_bf16 v[204:207], v[56:59], a[28:31], v[204:207]
  buffer_load_dwordx4 v241, s[56:59], s60 offen lds
  s_waitcnt vmcnt(37)
  s_barrier
  s_waitcnt lgkmcnt(6)
  v_mfma_f32_16x16x32_bf16 v[64:67], v[24:27], a[32:35], v[64:67]
  ds_read_b64_tr_b16 v[40:41], v15 offset:18560
  ds_read_b64_tr_b16 v[42:43], v15 offset:23168
  v_mfma_f32_16x16x32_bf16 v[68:71], v[24:27], a[36:39], v[68:71]
  s_add_u32 s40, s61, 24576
  s_add_u32 m0, s40, s86
  v_mfma_f32_16x16x32_bf16 v[72:75], v[24:27], a[40:43], v[72:75]
  s_nop 0
  v_mfma_f32_16x16x32_bf16 v[76:79], v[24:27], a[44:47], v[76:79]
  buffer_load_dwordx4 v242, s[56:59], s60 offen lds
  s_waitcnt lgkmcnt(6)
  v_mfma_f32_16x16x32_bf16 v[80:83], v[28:31], a[32:35], v[80:83]
  ds_read_b64_tr_b16 v[44:45], v15 offset:18592
  ds_read_b64_tr_b16 v[46:47], v15 offset:23200
  v_mfma_f32_16x16x32_bf16 v[84:87], v[28:31], a[36:39], v[84:87]
  s_add_u32 s62, s62, 28672
  v_mfma_f32_16x16x32_bf16 v[88:91], v[28:31], a[40:43], v[88:91]
  s_cmp_eq_u32 s62, 143360
  v_mfma_f32_16x16x32_bf16 v[92:95], v[28:31], a[44:47], v[92:95]
  s_cselect_b32 s62, 0, s62
  s_waitcnt lgkmcnt(6)
  v_mfma_f32_16x16x32_bf16 v[96:99], v[32:35], a[32:35], v[96:99]
  ds_read_b64_tr_b16 v[48:49], v15 offset:18624
  v_mfma_f32_16x16x32_bf16 v[100:103], v[32:35], a[36:39], v[100:103]
  ds_read_b64_tr_b16 v[50:51], v15 offset:23232
  v_mfma_f32_16x16x32_bf16 v[104:107], v[32:35], a[40:43], v[104:107]
  v_add_u32 v9, s62, v14
  v_mfma_f32_16x16x32_bf16 v[108:111], v[32:35], a[44:47], v[108:111]
  s_waitcnt lgkmcnt(6)
  v_mfma_f32_16x16x32_bf16 v[112:115], v[36:39], a[32:35], v[112:115]
  ds_read_b64_tr_b16 v[52:53], v15 offset:18656
  ds_read_b64_tr_b16 v[54:55], v15 offset:23264
  v_mfma_f32_16x16x32_bf16 v[116:119], v[36:39], a[36:39], v[116:119]
  s_add_u32 s61, s61, 28672
  v_mfma_f32_16x16x32_bf16 v[120:123], v[36:39], a[40:43], v[120:123]
  s_cmp_eq_u32 s61, 143360
  v_mfma_f32_16x16x32_bf16 v[124:127], v[36:39], a[44:47], v[124:127]
  s_cselect_b32 s61, 0, s61
  s_waitcnt lgkmcnt(6)
  v_mfma_f32_16x16x32_bf16 v[128:131], v[40:43], a[32:35], v[128:131]
  ds_read_b64_tr_b16 v[56:57], v15 offset:18688
  v_mfma_f32_16x16x32_bf16 v[132:135], v[40:43], a[36:39], v[132:135]
  ds_read_b64_tr_b16 v[58:59], v15 offset:23296
  v_mfma_f32_16x16x32_bf16 v[136:139], v[40:43], a[40:43], v[136:139]
  s_add_u32 s60, s60, 221184
  v_mfma_f32_16x16x32_bf16 v[140:143], v[40:43], a[44:47], v[140:143]
  s_add_u32 s32, s32, 6144
  s_waitcnt lgkmcnt(6)
  v_mfma_f32_16x16x32_bf16 v[144:147], v[44:47], a[32:35], v[144:147]
  ds_read_b64_tr_b16 v[24:25], v9 offset:0
  v_mfma_f32_16x16x32_bf16 v[148:151], v[44:47], a[36:39], v[148:151]
  ds_read_b64_tr_b16 v[26:27], v9 offset:4608
  v_mfma_f32_16x16x32_bf16 v[152:155], v[44:47], a[40:43], v[152:155]
  s_add_u32 s33, s33, 6144
  v_mfma_f32_16x16x32_bf16 v[156:159], v[44:47], a[44:47], v[156:159]
  s_add_u32 s34, s34, 6144
  s_waitcnt lgkmcnt(6)
  v_mfma_f32_16x16x32_bf16 v[160:163], v[48:51], a[32:35], v[160:163]
  ds_read_b64_tr_b16 v[28:29], v9 offset:32
  v_mfma_f32_16x16x32_bf16 v[164:167], v[48:51], a[36:39], v[164:167]
  ds_read_b64_tr_b16 v[30:31], v9 offset:4640
  v_mfma_f32_16x16x32_bf16 v[168:171], v[48:51], a[40:43], v[168:171]
  s_add_u32 s35, s35, 6144
  v_mfma_f32_16x16x32_bf16 v[172:175], v[48:51], a[44:47], v[172:175]
  s_add_u32 s63, s63, 1
  s_waitcnt lgkmcnt(6)
  v_mfma_f32_16x16x32_bf16 v[176:179], v[52:55], a[32:35], v[176:179]
  ds_read_b64_tr_b16 v[32:33], v9 offset:64
  v_mfma_f32_16x16x32_bf16 v[180:183], v[52:55], a[36:39], v[180:183]
  ds_read_b64_tr_b16 v[34:35], v9 offset:4672
  v_mfma_f32_16x16x32_bf16 v[184:187], v[52:55], a[40:43], v[184:187]
  v_mfma_f32_16x16x32_bf16 v[188:191], v[52:55], a[44:47], v[188:191]
  s_waitcnt lgkmcnt(6)
  v_mfma_f32_16x16x32_bf16 v[192:195], v[56:59], a[32:35], v[192:195]
  ds_read_b64_tr_b16 v[36:37], v9 offset:96
  v_mfma_f32_16x16x32_bf16 v[196:199], v[56:59], a[36:39], v[196:199]
  ds_read_b64_tr_b16 v[38:39], v9 offset:4704
  v_mfma_f32_16x16x32_bf16 v[200:203], v[56:59], a[40:43], v[200:203]
  v_mfma_f32_16x16x32_bf16 v[204:207], v[56:59], a[44:47], v[204:207]
  v_mov_b32 v15, v9
  s_cmp_lg_u32 s63, 4
  s_cbranch_scc1 L_dn_rare0
L_dn_back0:
L_dn_s1:
  s_waitcnt vmcnt(19)
  s_waitcnt lgkmcnt(6)
  v_mfma_f32_16x16x32_bf16 v[64:67], v[24:27], a[48:51], v[64:67]
  ds_read_b64_tr_b16 v[40:41], v15 offset:128
  v_mfma_f32_16x16x32_bf16 v[68:71], v[24:27], a[52:55], v[68:71]
  ds_read_b64_tr_b16 v[42:43], v15 offset:4736
  v_mfma_f32_16x16x32_bf16 v[72:75], v[24:27], a[56:59], v[72:75]
  buffer_load_dwordx4 a[0:3], v11, s[20:23], s32 offen offset:0 sc1
  v_mfma_f32_16x16x32_bf16 v[76:79], v[24:27], a[60:63], v[76:79]
  s_waitcnt lgkmcnt(6)
  v_mfma_f32_16x16x32_bf16 v[80:83], v[28:31], a[48:51], v[80:83]
  ds_read_b64_tr_b16 v[44:45], v15 offset:160
  v_mfma_f32_16x16x32_bf16 v[84:87], v[28:31], a[52:55], v[84:87]
  ds_read_b64_tr_b16 v[46:47], v15 offset:4768
  v_mfma_f32_16x16x32_bf16 v[88:91], v[28:31], a[56:59], v[88:91]
  buffer_load_dwordx4 a[4:7], v11, s[20:23], s33 offen offset:0 sc1
  v_mfma_f32_16x16x32_bf16 v[92:95], v[28:31], a[60:63], v[92:95]
  s_waitcnt lgkmcnt(6)
  v_mfma_f32_16x16x32_bf16 v[96:99], v[32:35], a[48:51], v[96:99]
  ds_read_b64_tr_b16 v[48:49], v15 offset:192
  v_mfma_f32_16x16x32_bf16 v[100:103], v[32:35], a[52:55], v[100:103]
  ds_read_b64_tr_b16 v[50:51], v15 offset:4800
  v_mfma_f32_16x16x32_bf16 v[104:107], v[32:35], a[56:59], v[104:107]
  buffer_load_dwordx4 a[8:11], v11, s[20:23], s34 offen offset:0 sc1
  v_mfma_f32_16x16x32_bf16 v[108:111], v[32:35], a[60:63], v[108:111]
  s_waitcnt lgkmcnt(6)
  v_mfma_f32_16x16x32_bf16 v[112:115], v[36:39], a[48:51], v[112:115]
  ds_read_b64_tr_b16 v[52:53], v15 offset:224
  v_mfma_f32_16x16x32_bf16 v[116:119], v[36:39], a[52:55], v[116:119]
  ds_read_b64_tr_b16 v[54:55], v15 offset:4832
  v_mfma_f32_16x16x32_bf16 v[120:123], v[36:39], a[56:59], v[120:123]
  buffer_load_dwordx4 a[12:15], v11, s[20:23], s35 offen offset:0 sc1
  v_mfma_f32_16x16x32_bf16 v[124:127], v[36:39], a[60:63], v[124:127]
  s_waitcnt lgkmcnt(6)
  v_mfma_f32_16x16x32_bf16 v[128:131], v[40:43], a[48:51], v[128:131]
  ds_read_b64_tr_b16 v[56:57], v15 offset:256
  v_mfma_f32_16x16x32_bf16 v[132:135], v[40:43], a[52:55], v[132:135]
  ds_read_b64_tr_b16 v[58:59], v15 offset:4864
  v_mfma_f32_16x16x32_bf16 v[136:139], v[40:43], a[56:59], v[136:139]
  buffer_load_dwordx4 a[16:19], v11, s[20:23], s32 offen offset:1024 sc1
  v_mfma_f32_16x16x32_bf16 v[140:143], v[40:43], a[60:63], v[140:143]
  s_waitcnt lgkmcnt(6)
  v_mfma_f32_16x16x32_bf16 v[144:147], v[44:47], a[48:51], v[144:147]
  ds_read_b64_tr_b16 v[24:25], v15 offset:9216
  v_mfma_f32_16x16x32_bf16 v[148:151], v[44:47], a[52:55], v[148:151]
  ds_read_b64_tr_b16 v[26:27], v15 offset:13824
  v_mfma_f32_16x16x32_bf16 v[152:155], v[44:47], a[56:59], v[152:155]
  buffer_load_dwordx4 a[20:23], v11, s[20:23], s33 offen offset:1024 sc1
  v_mfma_f32_16x16x32_bf16 v[156:159], v[44:47], a[60:63], v[156:159]
  s_waitcnt lgkmcnt(6)
  v_mfma_f32_16x16x32_bf16 v[160:163], v[48:51], a[48:51], v[160:163]
  ds_read_b64_tr_b16 v[28:29], v15 offset:9248
  v_mfma_f32_16x16x32_bf16 v[164:167], v[48:51], a[52:55], v[164:167]
  ds_read_b64_tr_b16 v[30:31], v15 offset:13856
  v_mfma_f32_16x16x32_bf16 v[168:171], v[48:51], a[56:59], v[168:171]
  buffer_load_dwordx4 a[24:27], v11, s[20:23], s34 offen offset:1024 sc1
  v_mfma_f32_16x16x32_bf16 v[172:175], v[48:51], a[60:63], v[172:175]
  s_waitcnt lgkmcnt(6)
  v_mfma_f32_16x16x32_bf16 v[176:179], v[52:55], a[48:51], v[176:179]
  ds_read_b64_tr_b16 v[32:33], v15 offset:9280
  v_mfma_f32_16x16x32_bf16 v[180:183], v[52:55], a[52:55], v[180:183]
  ds_read_b64_tr_b16 v[34:35], v15 offset:13888
  v_mfma_f32_16x16x32_bf16 v[184:187], v[52:55], a[56:59], v[184:187]
  buffer_load_dwordx4 a[28:31], v11, s[20:23], s35 offen offset:1024 sc1
  v_mfma_f32_16x16x32_bf16 v[188:191], v[52:55], a[60:63], v[188:191]
  s_waitcnt lgkmcnt(6)
  v_mfma_f32_16x16x32_bf16 v[192:195], v[56:59], a[48:51], v[192:195]
  ds_read_b64_tr_b16 v[36:37], v15 offset:9312
  v_mfma_f32_16x16x32_bf16 v[196:199], v[56:59], a[52:55], v[196:199]
  ds_read_b64_tr_b16 v[38:39], v15 offset:13920
  v_mfma_f32_16x16x32_bf16 v[200:203], v[56:59], a[56:59], v[200:203]
  buffer_load_dwordx4 a[32:35], v11, s[20:23], s32 offen offset:2048 sc1
  v_mfma_f32_16x16x32_bf16 v[204:207], v[56:59], a[60:63], v[204:207]
  s_waitcnt lgkmcnt(6)
  v_mfma_f32_16x16x32_bf16 v[64:67], v[24:27], a[64:67], v[64:67]
  ds_read_b64_tr_b16 v[40:41], v15 offset:9344
  v_mfma_f32_16x16x32_bf16 v[68:71], v[24:27], a[68:71], v[68:71]
  ds_read_b64_tr_b16 v[42:43], v15 offset:13952
  v_mfma_f32_16x16x32_bf16 v[72:75], v[24:27], a[72:75], v[72:75]
  buffer_load_dwordx4 a[36:39], v11, s[20:23], s33 offen offset:2048 sc1
  v_mfma_f32_16x16x32_bf16 v[76:79], v[24:27], a[76:79], v[76:79]
  s_waitcnt lgkmcnt(6)
  v_mfma_f32_16x16x32_bf16 v[80:83], v[28:31], a[64:67], v[80:83]
  ds_read_b64_tr_b16 v[44:45], v15 offset:9376
  v_mfma_f32_16x16x32_bf16 v[84:87], v[28:31], a[68:71], v[84:87]
  ds_read_b64_tr_b16 v[46:47], v15 offset:13984
  v_mfma_f32_16x16x32_bf16 v[88:91], v[28:31], a[72:75], v[88:91]
  buffer_load_dwordx4 a[40:43], v11, s[20:23], s34 offen offset:2048 sc1
  v_mfma_f32_16x16x32_bf16 v[92:95], v[28:31], a[76:79], v[92:95]
  s_waitcnt lgkmcnt(6)
  v_mfma_f32_16x16x32_bf16 v[96:99], v[32:35], a[64:67], v[96:99]
  ds_read_b64_tr_b16 v[48:49], v15 offset:9408
  v_mfma_f32_16x16x32_bf16 v[100:103], v[32:35], a[68:71], v[100:103]
  ds_read_b64_tr_b16 v[50:51], v15 offset:14016
  v_mfma_f32_16x16x32_bf16 v[104:107], v[32:35], a[72:75], v[104:107]
  buffer_load_dwordx4 a[44:47], v11, s[20:23], s35 offen offset:2048 sc1
  v_mfma_f32_16x16x32_bf16 v[108:111], v[32:35], a[76:79], v[108:111]
  s_waitcnt lgkmcnt(6)
  v_mfma_f32_16x16x32_bf16 v[112:115], v[36:39], a[64:67], v[112:115]
  ds_read_b64_tr_b16 v[52:53], v15 offset:9440
  ds_read_b64_tr_b16 v[54:55], v15 offset:14048
  v_mfma_f32_16x16x32_bf16 v[116:119], v[36:39], a[68:71], v[116:119]
  s_add_u32 s40, s61, 0
  s_add_u32 m0, s40, s86
  v_mfma_f32_16x16x32_bf16 v[120:123], v[36:39], a[72:75], v[120:123]
  s_nop 0
  v_mfma_f32_16x16x32_bf16 v[124:127], v[36:39], a[76:79], v[124:127]
  buffer_load_dwordx4 v236, s[56:59], s60 offen lds
  s_waitcnt lgkmcnt(6)
  v_mfma_f32_16x16x32_bf16 v[128:131], v[40:43], a[64:67], v[128:131]
  ds_read_b64_tr_b16 v[56:57], v15 offset:9472
  ds_read_b64_tr_b16 v[58:59], v15 offset:14080
  v_mfma_f32_16x16x32_bf16 v[132:135], v[40:43], a[68:71], v[132:135]
  s_add_u32 s40, s61, 4096
  s_add_u32 m0, s40, s86
  v_mfma_f32_16x16x32_bf16 v[136:139], v[40:43], a[72:75], v[136:139]
  s_nop 0
  v_mfma_f32_16x16x32_bf16 v[140:143], v[40:43], a[76:79], v[140:143]
  buffer_load_dwordx4 v237, s[56:59], s60 offen lds
  s_waitcnt lgkmcnt(6)
  v_mfma_f32_16x16x32_bf16 v[144:147], v[44:47], a[64:67], v[144:147]
  ds_read_b64_tr_b16 v[24:25], v15 offset:18432
  ds_read_b64_tr_b16 v[26:27], v15 offset:23040
  v_mfma_f32_16x16x32_bf16 v[148:151], v[44:47], a[68:71], v[148:151]
  s_add_u32 s40, s61, 8192
  s_add_u32 m0, s40, s86
  v_mfma_f32_16x16x32_bf16 v[152:155], v[44:47], a[72:75], v[152:155]
  s_nop 0
  v_mfma_f32_16x16x32_bf16 v[156:159], v[44:47], a[76:79], v[156:159]
  buffer_load_dwordx4 v238, s[56:59], s60 offen lds
  s_waitcnt lgkmcnt(6)
  v_mfma_f32_16x16x32_bf16 v[160:163], v[48:51], a[64:67], v[160:163]
  ds_read_b64_tr_b16 v[28:29], v15 offset:18464
  ds_read_b64_tr_b16 v[30:31], v15 offset:23072
  v_mfma_f32_16x16x32_bf16 v[164:167], v[48:51], a[68:71], v[164:167]
  s_add_u32 s40, s61, 12288
  s_add_u32 m0, s40, s86
  v_mfma_f32_16x16x32_bf16 v[168:171], v[48:51], a[72:75], v[168:171]
  s_nop 0
  v_mfma_f32_16x16x32_bf16 v[172:175], v[48:51], a[76:79], v[172:175]
  buffer_load_dwordx4 v239, s[56:59], s60 offen lds
  s_waitcnt lgkmcnt(6)
  v_mfma_f32_16x16x32_bf16 v[176:179], v[52:55], a[64:67], v[176:179]
  ds_read_b64_tr_b16 v[32:33], v15 offset:18496
  ds_read_b64_tr_b16 v[34:35], v15 offset:23104
  v_mfma_f32_16x16x32_bf16 v[180:183], v[52:55], a[68:71], v[180:183]
  s_add_u32 s40, s61, 16384
  s_add_u32 m0, s40, s86
  v_mfma_f32_16x16x32_bf16 v[184:187], v[52:55], a[72:75], v[184:187]
  s_nop 0
  v_mfma_f32_16x16x32_bf16 v[188:191], v[52:55], a[76:79], v[188:191]
  buffer_load_dwordx4 v240, s[56:59], s60 offen lds
  s_waitcnt lgkmcnt(6)
  v_mfma_f32_16x16x32_bf16 v[192:195], v[56:59], a[64:67], v[192:195]
  ds_read_b64_tr_b16 v[36:37], v15 offset:18528
  ds_read_b64_tr_b16 v[38:39], v15 offset:23136
  v_mfma_f32_16x16x32_bf16 v[196:199], v[56:59], a[68:71], v[196:199]
  s_add_u32 s40, s61, 20480
  s_add_u32 m0, s40, s86
  v_mfma_f32_16x16x32_bf16 v[200:203], v[56:59], a[72:75], v[200:203]
  s_nop 0
  v_mfma_f32_16x16x32_bf16 v[204:207], v[56:59], a[76:79], v[204:207]
  buffer_load_dwordx4 v241, s[56:59], s60 offen lds
  s_waitcnt vmcnt(37)
  s_barrier
  s_waitcnt lgkmcnt(6)
  v_mfma_f32_16x16x32_bf16 v[64:67], v[24:27], a[80:83], v[64:67]
  ds_read_b64_tr_b16 v[40:41], v15 offset:18560
  ds_read_b64_tr_b16 v[42:43], v15 offset:23168
  v_mfma_f32_16x16x32_bf16 v[68:71], v[24:27], a[84:87], v[68:71]
  s_add_u32 s40, s61, 24576
  s_add_u32 m0, s40, s86
  v_mfma_f32_16x16x32_bf16 v[72:75], v[24:27], a[88:91], v[72:75]
  s_nop 0
  v_mfma_f32_16x16x32_bf16 v[76:79], v[24:27], a[92:95], v[76:79]
  buffer_load_dwordx4 v242, s[56:59], s60 offen lds
  s_waitcnt lgkmcnt(6)
  v_mfma_f32_16x16x32_bf16 v[80:83], v[28:31], a[80:83], v[80:83]
  ds_read_b64_tr_b16 v[44:45], v15 offset:18592
  ds_read_b64_tr_b16 v[46:47], v15 offset:23200
  v_mfma_f32_16x16x32_bf16 v[84:87], v[28:31], a[84:87], v[84:87]
  s_add_u32 s62, s62, 28672
  v_mfma_f32_16x16x32_bf16 v[88:91], v[28:31], a[88:91], v[88:91]
  s_cmp_eq_u32 s62, 143360
  v_mfma_f32_16x16x32_bf16 v[92:95], v[28:31], a[92:95], v[92:95]
  s_cselect_b32 s62, 0, s62
  s_waitcnt lgkmcnt(6)
  v_mfma_f32_16x16x32_bf16 v[96:99], v[32:35], a[80:83], v[96:99]
  ds_read_b64_tr_b16 v[48:49], v15 offset:18624
  v_mfma_f32_16x16x32_bf16 v[100:103], v[32:35], a[84:87], v[100:103]
  ds_read_b64_tr_b16 v[50:51], v15 offset:23232
  v_mfma_f32_16x16x32_bf16 v[104:107], v[32:35], a[88:91], v[104:107]
  v_add_u32 v9, s62, v14
  v_mfma_f32_16x16x32_bf16 v[108:111], v[32:35], a[92:95], v[108:111]
  s_waitcnt lgkmcnt(6)
  v_mfma_f32_16x16x32_bf16 v[112:115], v[36:39], a[80:83], v[112:115]
  ds_read_b64_tr_b16 v[52:53], v15 offset:18656
  ds_read_b64_tr_b16 v[54:55], v15 offset:23264
  v_mfma_f32_16x16x32_bf16 v[116:119], v[36:39], a[84:87], v[116:119]
  s_add_u32 s61, s61, 28672
  v_mfma_f32_16x16x32_bf16 v[120:123], v[36:39], a[88:91], v[120:123]
  s_cmp_eq_u32 s61, 143360
  v_mfma_f32_16x16x32_bf16 v[124:127], v[36:39], a[92:95], v[124:127]
  s_cselect_b32 s61, 0, s61
  s_waitcnt lgkmcnt(6)
  v_mfma_f32_16x16x32_bf16 v[128:131], v[40:43], a[80:83], v[128:131]
  ds_read_b64_tr_b16 v[56:57], v15 offset:18688
  v_mfma_f32_16x16x32_bf16 v[132:135], v[40:43], a[84:87], v[132:135]
  ds_read_b64_tr_b16 v[58:59], v15 offset:23296
  v_mfma_f32_16x16x32_bf16 v[136:139], v[40:43], a[88:91], v[136:139]
  s_add_u32 s60, s60, 221184
  v_mfma_f32_16x16x32_bf16 v[140:143], v[40:43], a[92:95], v[140:143]
  s_add_u32 s32, s32, 6144
  s_waitcnt lgkmcnt(6)
  v_mfma_f32_16x16x32_bf16 v[144:147], v[44:47], a[80:83], v[144:147]
  ds_read_b64_tr_b16 v[24:25], v9 offset:0
  v_mfma_f32_16x16x32_bf16 v[148:151], v[44:47], a[84:87], v[148:151]
  ds_read_b64_tr_b16 v[26:27], v9 offset:4608
  v_mfma_f32_16x16x32_bf16 v[152:155], v[44:47], a[88:91], v[152:155]
  s_add_u32 s33, s33, 6144
  v_mfma_f32_16x16x32_bf16 v[156:159], v[44:47], a[92:95], v[156:159]
  s_add_u32 s34, s34, 6144
  s_waitcnt lgkmcnt(6)
  v_mfma_f32_16x16x32_bf16 v[160:163], v[48:51], a[80:83], v[160:163]
  ds_read_b64_tr_b16 v[28:29], v9 offset:32
  v_mfma_f32_16x16x32_bf16 v[164:167], v[48:51], a[84:87], v[164:167]
  ds_read_b64_tr_b16 v[30:31], v9 offset:4640
  v_mfma_f32_16x16x32_bf16 v[168:171], v[48:51], a[88:91], v[168:171]
  s_add_u32 s35, s35, 6144
  v_mfma_f32_16x16x32_bf16 v[172:175], v[48:51], a[92:95], v[172:175]
  s_add_u32 s63, s63, 1
  s_waitcnt lgkmcnt(6)
  v_mfma_f32_16x16x32_bf16 v[176:179], v[52:55], a[80:83], v[176:179]
  ds_read_b64_tr_b16 v[32:33], v9 offset:64
  v_mfma_f32_16x16x32_bf16 v[180:183], v[52:55], a[84:87], v[180:183]
  ds_read_b64_tr_b16 v[34:35], v9 offset:4672
  v_mfma_f32_16x16x32_bf16 v[184:187], v[52:55], a[88:91], v[184:187]
  v_mfma_f32_16x16x32_bf16 v[188:191], v[52:55], a[92:95], v[188:191]
  s_waitcnt lgkmcnt(6)
  v_mfma_f32_16x16x32_bf16 v[192:195], v[56:59], a[80:83], v[192:195]
  ds_read_b64_tr_b16 v[36:37], v9 offset:96
  v_mfma_f32_16x16x32_bf16 v[196:199], v[56:59], a[84:87], v[196:199]
  ds_read_b64_tr_b16 v[38:39], v9 offset:4704
  v_mfma_f32_16x16x32_bf16 v[200:203], v[56:59], a[88:91], v[200:203]
  v_mfma_f32_16x16x32_bf16 v[204:207], v[56:59], a[92:95], v[204:207]
  v_mov_b32 v15, v9
  s_cmp_lg_u32 s63, 8
  s_cbranch_scc1 L_dn_rare1
L_dn_back1:
  s_cmp_eq_u32 s63, 8
  s_cbranch_scc1 L_dn_last
  s_waitcnt vmcnt(19)
  s_waitcnt lgkmcnt(6)
  v_mfma_f32_16x16x32_bf16 v[64:67], v[24:27], a[96:99], v[64:67]
  ds_read_b64_tr_b16 v[40:41], v15 offset:128
  v_mfma_f32_16x16x32_bf16 v[68:71], v[24:27], a[100:103], v[68:71]
  ds_read_b64_tr_b16 v[42:43], v15 offset:4736
  v_mfma_f32_16x16x32_bf16 v[72:75], v[24:27], a[104:107], v[72:75]
  buffer_load_dwordx4 a[48:51], v11, s[20:23], s32 offen offset:0 sc1
  v_mfma_f32_16x16x32_bf16 v[76:79], v[24:27], a[108:111], v[76:79]
  s_waitcnt lgkmcnt(6)
  v_mfma_f32_16x16x32_bf16 v[80:83], v[28:31], a[96:99], v[80:83]
  ds_read_b64_tr_b16 v[44:45], v15 offset:160
  v_mfma_f32_16x16x32_bf16 v[84:87], v[28:31], a[100:103], v[84:87]
  ds_read_b64_tr_b16 v[46:47], v15 offset:4768
  v_mfma_f32_16x16x32_bf16 v[88:91], v[28:31], a[104:107], v[88:91]
  buffer_load_dwordx4 a[52:55], v11, s[20:23], s33 offen offset:0 sc1
  v_mfma_f32_16x16x32_bf16 v[92:95], v[28:31], a[108:111], v[92:95]
  s_waitcnt lgkmcnt(6)
  v_mfma_f32_16x16x32_bf16 v[96:99], v[32:35], a[96:99], v[96:99]
  ds_read_b64_tr_b16 v[48:49], v15 offset:192
  v_mfma_f32_16x16x32_bf16 v[100:103], v[32:35], a[100:103], v[100:103]
  ds_read_b64_tr_b16 v[50:51], v15 offset:4800
  v_mfma_f32_16x16x32_bf16 v[104:107], v[32:35], a[104:107], v[104:107]
  buffer_load_dwordx4 a[56:59], v11, s[20:23], s34 offen offset:0 sc1
  v_mfma_f32_16x16x32_bf16 v[108:111], v[32:35], a[108:111], v[108:111]
  s_waitcnt lgkmcnt(6)
  v_mfma_f32_16x16x32_bf16 v[112:115], v[36:39], a[96:99], v[112:115]
  ds_read_b64_tr_b16 v[52:53], v15 offset:224
  v_mfma_f32_16x16x32_bf16 v[116:119], v[36:39], a[100:103], v[116:119]
  ds_read_b64_tr_b16 v[54:55], v15 offset:4832
  v_mfma_f32_16x16x32_bf16 v[120:123], v[36:39], a[104:107], v[120:123]
  buffer_load_dwordx4 a[60:63], v11, s[20:23], s35 offen offset:0 sc1
  v_mfma_f32_16x16x32_bf16 v[124:127], v[36:39], a[108:111], v[124:127]
  s_waitcnt lgkmcnt(6)
  v_mfma_f32_16x16x32_bf16 v[128:131], v[40:43], a[96:99], v[128:131]
  ds_read_b64_tr_b16 v[56:57], v15 offset:256
  v_mfma_f32_16x16x32_bf16 v[132:135], v[40:43], a[100:103], v[132:135]
  ds_read_b64_tr_b16 v[58:59], v15 offset:4864
  v_mfma_f32_16x16x32_bf16 v[136:139], v[40:43], a[104:107], v[136:139]
  buffer_load_dwordx4 a[64:67], v11, s[20:23], s32 offen offset:1024 sc1
  v_mfma_f32_16x16x32_bf16 v[140:143], v[40:43], a[108:111], v[140:143]
  s_waitcnt lgkmcnt(6)
  v_mfma_f32_16x16x32_bf16 v[144:147], v[44:47], a[96:99], v[144:147]
  ds_read_b64_tr_b16 v[24:25], v15 offset:9216
  v_mfma_f32_16x16x32_bf16 v[148:151], v[44:47], a[100:103], v[148:151]
  ds_read_b64_tr_b16 v[26:27], v15 offset:13824
  v_mfma_f32_16x16x32_bf16 v[152:155], v[44:47], a[104:107], v[152:155]
  buffer_load_dwordx4 a[68:71], v11, s[20:23], s33 offen offset:1024 sc1
  v_mfma_f32_16x16x32_bf16 v[156:159], v[44:47], a[108:111], v[156:159]
  s_waitcnt lgkmcnt(6)
  v_mfma_f32_16x16x32_bf16 v[160:163], v[48:51], a[96:99], v[160:163]
  ds_read_b64_tr_b16 v[28:29], v15 offset:9248
  v_mfma_f32_16x16x32_bf16 v[164:167], v[48:51], a[100:103], v[164:167]
  ds_read_b64_tr_b16 v[30:31], v15 offset:13856
  v_mfma_f32_16x16x32_bf16 v[168:171], v[48:51], a[104:107], v[168:171]
  buffer_load_dwordx4 a[72:75], v11, s[20:23], s34 offen offset:1024 sc1
  v_mfma_f32_16x16x32_bf16 v[172:175], v[48:51], a[108:111], v[172:175]
  s_waitcnt lgkmcnt(6)
  v_mfma_f32_16x16x32_bf16 v[176:179], v[52:55], a[96:99], v[176:179]
  ds_read_b64_tr_b16 v[32:33], v15 offset:9280
  v_mfma_f32_16x16x32_bf16 v[180:183], v[52:55], a[100:103], v[180:183]
  ds_read_b64_tr_b16 v[34:35], v15 offset:13888
  v_mfma_f32_16x16x32_bf16 v[184:187], v[52:55], a[104:107], v[184:187]
  buffer_load_dwordx4 a[76:79], v11, s[20:23], s35 offen offset:1024 sc1
  v_mfma_f32_16x16x32_bf16 v[188:191], v[52:55], a[108:111], v[188:191]
  s_waitcnt lgkmcnt(6)
  v_mfma_f32_16x16x32_bf16 v[192:195], v[56:59], a[96:99], v[192:195]
  ds_read_b64_tr_b16 v[36:37], v15 offset:9312
  v_mfma_f32_16x16x32_bf16 v[196:199], v[56:59], a[100:103], v[196:199]
  ds_read_b64_tr_b16 v[38:39], v15 offset:13920
  v_mfma_f32_16x16x32_bf16 v[200:203], v[56:59], a[104:107], v[200:203]
  buffer_load_dwordx4 a[80:83], v11, s[20:23], s32 offen offset:2048 sc1
  v_mfma_f32_16x16x32_bf16 v[204:207], v[56:59], a[108:111], v[204:207]
  s_waitcnt lgkmcnt(6)
  v_mfma_f32_16x16x32_bf16 v[64:67], v[24:27], a[112:115], v[64:67]
  ds_read_b64_tr_b16 v[40:41], v15 offset:9344
  v_mfma_f32_16x16x32_bf16 v[68:71], v[24:27], a[116:119], v[68:71]
  ds_read_b64_tr_b16 v[42:43], v15 offset:13952
  v_mfma_f32_16x16x32_bf16 v[72:75], v[24:27], a[120:123], v[72:75]
  buffer_load_dwordx4 a[84:87], v11, s[20:23], s33 offen offset:2048 sc1
  v_mfma_f32_16x16x32_bf16 v[76:79], v[24:27], a[124:127], v[76:79]
  s_waitcnt lgkmcnt(6)
  v_mfma_f32_16x16x32_bf16 v[80:83], v[28:31], a[112:115], v[80:83]
  ds_read_b64_tr_b16 v[44:45], v15 offset:9376
  v_mfma_f32_16x16x32_bf16 v[84:87], v[28:31], a[116:119], v[84:87]
  ds_read_b64_tr_b16 v[46:47], v15 offset:13984
  v_mfma_f32_16x16x32_bf16 v[88:91], v[28:31], a[120:123], v[88:91]
  buffer_load_dwordx4 a[88:91], v11, s[20:23], s34 offen offset:2048 sc1
  v_mfma_f32_16x16x32_bf16 v[92:95], v[28:31], a[124:127], v[92:95]
  s_waitcnt lgkmcnt(6)
  v_mfma_f32_16x16x32_bf16 v[96:99], v[32:35], a[112:115], v[96:99]
  ds_read_b64_tr_b16 v[48:49], v15 offset:9408
  v_mfma_f32_16x16x32_bf16 v[100:103], v[32:35], a[116:119], v[100:103]
  ds_read_b64_tr_b16 v[50:51], v15 offset:14016
  v_mfma_f32_16x16x32_bf16 v[104:107], v[32:35], a[120:123], v[104:107]
  buffer_load_dwordx4 a[92:95], v11, s[20:23], s35 offen offset:2048 sc1
  v_mfma_f32_16x16x32_bf16 v[108:111], v[32:35], a[124:127], v[108:111]
  s_waitcnt lgkmcnt(6)
  v_mfma_f32_16x16x32_bf16 v[112:115], v[36:39], a[112:115], v[112:115]
  ds_read_b64_tr_b16 v[52:53], v15 offset:9440
  ds_read_b64_tr_b16 v[54:55], v15 offset:14048
  v_mfma_f32_16x16x32_bf16 v[116:119], v[36:39], a[116:119], v[116:119]
  s_add_u32 s40, s61, 0
  s_add_u32 m0, s40, s86
  v_mfma_f32_16x16x32_bf16 v[120:123], v[36:39], a[120:123], v[120:123]
  s_nop 0
  v_mfma_f32_16x16x32_bf16 v[124:127], v[36:39], a[124:127], v[124:127]
  buffer_load_dwordx4 v236, s[56:59], s60 offen lds
  s_waitcnt lgkmcnt(6)
  v_mfma_f32_16x16x32_bf16 v[128:131], v[40:43], a[112:115], v[128:131]
  ds_read_b64_tr_b16 v[56:57], v15 offset:9472
  ds_read_b64_tr_b16 v[58:59], v15 offset:14080
  v_mfma_f32_16x16x32_bf16 v[132:135], v[40:43], a[116:119], v[132:135]
  s_add_u32 s40, s61, 4096
  s_add_u32 m0, s40, s86
  v_mfma_f32_16x16x32_bf16 v[136:139], v[40:43], a[120:123], v[136:139]
  s_nop 0
  v_mfma_f32_16x16x32_bf16 v[140:143], v[40:43], a[124:127], v[140:143]
  buffer_load_dwordx4 v237, s[56:59], s60 offen lds
  s_waitcnt lgkmcnt(6)
  v_mfma_f32_16x16x32_bf16 v[144:147], v[44:47], a[112:115], v[144:147]
  ds_read_b64_tr_b16 v[24:25], v15 offset:18432
  ds_read_b64_tr_b16 v[26:27], v15 offset:23040
  v_mfma_f32_16x16x32_bf16 v[148:151], v[44:47], a[116:119], v[148:151]
  s_add_u32 s40, s61, 8192
  s_add_u32 m0, s40, s86
  v_mfma_f32_16x16x32_bf16 v[152:155], v[44:47], a[120:123], v[152:155]
  s_nop 0
  v_mfma_f32_16x16x32_bf16 v[156:159], v[44:47], a[124:127], v[156:159]
  buffer_load_dwordx4 v238, s[56:59], s60 offen lds
  s_waitcnt lgkmcnt(6)
  v_mfma_f32_16x16x32_bf16 v[160:163], v[48:51], a[112:115], v[160:163]
  ds_read_b64_tr_b16 v[28:29], v15 offset:18464
  ds_read_b64_tr_b16 v[30:31], v15 offset:23072
  v_mfma_f32_16x16x32_bf16 v[164:167], v[48:51], a[116:119], v[164:167]
  s_add_u32 s40, s61, 12288
  s_add_u32 m0, s40, s86
  v_mfma_f32_16x16x32_bf16 v[168:171], v[48:51], a[120:123], v[168:171]
  s_nop 0
  v_mfma_f32_16x16x32_bf16 v[172:175], v[48:51], a[124:127], v[172:175]
  buffer_load_dwordx4 v239, s[56:59], s60 offen lds
  s_waitcnt lgkmcnt(6)
  v_mfma_f32_16x16x32_bf16 v[176:179], v[52:55], a[112:115], v[176:179]
  ds_read_b64_tr_b16 v[32:33], v15 offset:18496
  ds_read_b64_tr_b16 v[34:35], v15 offset:23104
  v_mfma_f32_16x16x32_bf16 v[180:183], v[52:55], a[116:119], v[180:183]
  s_add_u32 s40, s61, 16384
  s_add_u32 m0, s40, s86
  v_mfma_f32_16x16x32_bf16 v[184:187], v[52:55], a[120:123], v[184:187]
  s_nop 0
  v_mfma_f32_16x16x32_bf16 v[188:191], v[52:55], a[124:127], v[188:191]
  buffer_load_dwordx4 v240, s[56:59], s60 offen lds
  s_waitcnt lgkmcnt(6)
  v_mfma_f32_16x16x32_bf16 v[192:195], v[56:59], a[112:115], v[192:195]
  ds_read_b64_tr_b16 v[36:37], v15 offset:18528
  ds_read_b64_tr_b16 v[38:39], v15 offset:23136
  v_mfma_f32_16x16x32_bf16 v[196:199], v[56:59], a[116:119], v[196:199]
  s_add_u32 s40, s61, 20480
  s_add_u32 m0, s40, s86
  v_mfma_f32_16x16x32_bf16 v[200:203], v[56:59], a[120:123], v[200:203]
  s_nop 0
  v_mfma_f32_16x16x32_bf16 v[204:207], v[56:59], a[124:127], v[204:207]
  buffer_load_dwordx4 v241, s[56:59], s60 offen lds
  s_waitcnt vmcnt(37)
  s_barrier
  s_waitcnt lgkmcnt(6)
  v_mfma_f32_16x16x32_bf16 v[64:67], v[24:27], a[128:131], v[64:67]
  ds_read_b64_tr_b16 v[40:41], v15 offset:18560
  ds_read_b64_tr_b16 v[42:43], v15 offset:23168
  v_mfma_f32_16x16x32_bf16 v[68:71], v[24:27], a[132:135], v[68:71]
  s_add_u32 s40, s61, 24576
  s_add_u32 m0, s40, s86
  v_mfma_f32_16x16x32_bf16 v[72:75], v[24:27], a[136:139], v[72:75]
  s_nop 0
  v_mfma_f32_16x16x32_bf16 v[76:79], v[24:27], a[140:143], v[76:79]
  buffer_load_dwordx4 v242, s[56:59], s60 offen lds
  s_waitcnt lgkmcnt(6)
  v_mfma_f32_16x16x32_bf16 v[80:83], v[28:31], a[128:131], v[80:83]
  ds_read_b64_tr_b16 v[44:45], v15 offset:18592
  ds_read_b64_tr_b16 v[46:47], v15 offset:23200
  v_mfma_f32_16x16x32_bf16 v[84:87], v[28:31], a[132:135], v[84:87]
  s_add_u32 s62, s62, 28672
  v_mfma_f32_16x16x32_bf16 v[88:91], v[28:31], a[136:139], v[88:91]
  s_cmp_eq_u32 s62, 143360
  v_mfma_f32_16x16x32_bf16 v[92:95], v[28:31], a[140:143], v[92:95]
  s_cselect_b32 s62, 0, s62
  s_waitcnt lgkmcnt(6)
  v_mfma_f32_16x16x32_bf16 v[96:99], v[32:35], a[128:131], v[96:99]
  ds_read_b64_tr_b16 v[48:49], v15 offset:18624
  v_mfma_f32_16x16x32_bf16 v[100:103], v[32:35], a[132:135], v[100:103]
  ds_read_b64_tr_b16 v[50:51], v15 offset:23232
  v_mfma_f32_16x16x32_bf16 v[104:107], v[32:35], a[136:139], v[104:107]
  v_add_u32 v9, s62, v14
  v_mfma_f32_16x16x32_bf16 v[108:111], v[32:35], a[140:143], v[108:111]
  s_waitcnt lgkmcnt(6)
  v_mfma_f32_16x16x32_bf16 v[112:115], v[36:39], a[128:131], v[112:115]
  ds_read_b64_tr_b16 v[52:53], v15 offset:18656
  ds_read_b64_tr_b16 v[54:55], v15 offset:23264
  v_mfma_f32_16x16x32_bf16 v[116:119], v[36:39], a[132:135], v[116:119]
  s_add_u32 s61, s61, 28672
  v_mfma_f32_16x16x32_bf16 v[120:123], v[36:39], a[136:139], v[120:123]
  s_cmp_eq_u32 s61, 143360
  v_mfma_f32_16x16x32_bf16 v[124:127], v[36:39], a[140:143], v[124:127]
  s_cselect_b32 s61, 0, s61
  s_waitcnt lgkmcnt(6)
  v_mfma_f32_16x16x32_bf16 v[128:131], v[40:43], a[128:131], v[128:131]
  ds_read_b64_tr_b16 v[56:57], v15 offset:18688
  v_mfma_f32_16x16x32_bf16 v[132:135], v[40:43], a[132:135], v[132:135]
  ds_read_b64_tr_b16 v[58:59], v15 offset:23296
  v_mfma_f32_16x16x32_bf16 v[136:139], v[40:43], a[136:139], v[136:139]
  s_add_u32 s60, s60, 221184
  v_mfma_f32_16x16x32_bf16 v[140:143], v[40:43], a[140:143], v[140:143]
  s_add_u32 s32, s32, 6144
  s_waitcnt lgkmcnt(6)
  v_mfma_f32_16x16x32_bf16 v[144:147], v[44:47], a[128:131], v[144:147]
  ds_read_b64_tr_b16 v[24:25], v9 offset:0
  v_mfma_f32_16x16x32_bf16 v[148:151], v[44:47], a[132:135], v[148:151]
  ds_read_b64_tr_b16 v[26:27], v9 offset:4608
  v_mfma_f32_16x16x32_bf16 v[152:155], v[44:47], a[136:139], v[152:155]
  s_add_u32 s33, s33, 6144
  v_mfma_f32_16x16x32_bf16 v[156:159], v[44:47], a[140:143], v[156:159]
  s_add_u32 s34, s34, 6144
  s_waitcnt lgkmcnt(6)
  v_mfma_f32_16x16x32_bf16 v[160:163], v[48:51], a[128:131], v[160:163]
  ds_read_b64_tr_b16 v[28:29], v9 offset:32
  v_mfma_f32_16x16x32_bf16 v[164:167], v[48:51], a[132:135], v[164:167]
  ds_read_b64_tr_b16 v[30:31], v9 offset:4640
  v_mfma_f32_16x16x32_bf16 v[168:171], v[48:51], a[136:139], v[168:171]
  s_add_u32 s35, s35, 6144
  v_mfma_f32_16x16x32_bf16 v[172:175], v[48:51], a[140:143], v[172:175]
  s_add_u32 s63, s63, 1
  s_waitcnt lgkmcnt(6)
  v_mfma_f32_16x16x32_bf16 v[176:179], v[52:55], a[128:131], v[176:179]
  ds_read_b64_tr_b16 v[32:33], v9 offset:64
  v_mfma_f32_16x16x32_bf16 v[180:183], v[52:55], a[132:135], v[180:183]
  ds_read_b64_tr_b16 v[34:35], v9 offset:4672
  v_mfma_f32_16x16x32_bf16 v[184:187], v[52:55], a[136:139], v[184:187]
  v_mfma_f32_16x16x32_bf16 v[188:191], v[52:55], a[140:143], v[188:191]
  s_waitcnt lgkmcnt(6)
  v_mfma_f32_16x16x32_bf16 v[192:195], v[56:59], a[128:131], v[192:195]
  ds_read_b64_tr_b16 v[36:37], v9 offset:96
  v_mfma_f32_16x16x32_bf16 v[196:199], v[56:59], a[132:135], v[196:199]
  ds_read_b64_tr_b16 v[38:39], v9 offset:4704
  v_mfma_f32_16x16x32_bf16 v[200:203], v[56:59], a[136:139], v[200:203]
  v_mfma_f32_16x16x32_bf16 v[204:207], v[56:59], a[140:143], v[204:207]
  v_mov_b32 v15, v9
  s_cmp_eq_u32 s63, 6
  s_cbranch_scc1 L_dn_rare2
L_dn_back2:
  s_branch L_dn_loop
L_dn_rare0:
  s_cmp_eq_u32 s63, 1
  s_cbranch_scc0 L_dn_r0b
  s_sub_u32 s60, s60, 774144
  s_add_u32 s40, s68, 48
  s_lshl_b32 s40, s40, 7
  s_add_u32 s40, s40, 21430272
  v_mov_b32 v208, s40
  global_load_dword v230, v208, s[54:55] sc1
  s_branch L_dn_back0
L_dn_r0b:
  s_waitcnt vmcnt(19)
  v_readfirstlane_b32 s40, v230
  s_mov_b32 s87, 0
  s_cmp_ge_u32 s40, 8
  s_cbranch_scc1 L_dn_r0go
  s_add_u32 s40, s84, 96
  s_lshl_b32 s40, s40, 7
  s_add_u32 s40, s40, 21430272
  v_mov_b32 v208, s40
  global_load_dword v230, v208, s[54:55] sc1
  s_branch L_dn_back0
L_dn_r0go:
  s_mov_b32 s87, 1
  s_mov_b32 s22, 21233664
  s_mul_i32 s40, s83, 3
  s_add_u32 s40, s40, 144
  s_lshl_b32 s40, s40, 10
  s_add_u32 s32, s65, s40
  s_add_u32 s33, s32, 165888
  s_add_u32 s34, s32, 331776
  s_add_u32 s35, s32, 497664
  s_lshl_b32 s40, s84, 2
  s_add_u32 s40, s40, s28
  s_lshl_b32 s40, s40, 8
  v_and_b32 v208, 15, v211
  v_lshlrev_b32 v208, 2, v208
  v_add_u32 v208, s40, v208
  v_add_u32 v208, 21463040, v208
  global_load_dword v20, v208, s[54:55] offset:0 sc1
  global_load_dword v21, v208, s[54:55] offset:64 sc1
  global_load_dword v22, v208, s[54:55] offset:128 sc1
  global_load_dword v23, v208, s[54:55] offset:192 sc1
  s_branch L_dn_back0
L_dn_rare1:
  s_cmp_eq_u32 s63, 2
  s_cbranch_scc0 L_dn_r1b
  s_sub_u32 s32, s32, 21504
  s_sub_u32 s33, s33, 21504
  s_sub_u32 s34, s34, 21504
  s_sub_u32 s35, s35, 21504
  s_waitcnt vmcnt(19)
  v_readfirstlane_b32 s40, v230
  s_cmp_ge_u32 s40, 4
  s_cbranch_scc1 L_dn_back1
  s_add_u32 s40, s68, 48
  s_lshl_b32 s40, s40, 7
  s_add_u32 s40, s40, 21430272
  v_mov_b32 v208, s40
L_poll_h2:
  global_load_dword v209, v208, s[54:55] sc1
  s_waitcnt vmcnt(0)
  v_readfirstlane_b32 s40, v209
  s_cmp_ge_u32 s40, 4
  s_cbranch_scc1 L_polld_h2
  s_sleep 4
  s_branch L_poll_h2
L_polld_h2:
  s_branch L_dn_back1
L_dn_r1b:
  s_mov_b32 s56, s16
  s_mov_b32 s57, s17
  s_mov_b32 s58, s18
  s_mov_b32 s59, s19
  s_mov_b32 s60, s64
  v_mov_b32 v236, v243
  v_mov_b32 v237, v244
  v_mov_b32 v238, v245
  v_mov_b32 v239, v246
  v_mov_b32 v240, v247
  v_mov_b32 v241, v248
  v_mov_b32 v242, v249
  s_branch L_dn_back1
L_dn_rare2:
  s_mov_b32 s58, 0
  s_mov_b32 s22, 0
  s_add_u32 s40, s84, 96
  s_lshl_b32 s40, s40, 7
  s_add_u32 s40, s40, 21430272
  v_mov_b32 v208, s40
  global_load_dword v230, v208, s[54:55] sc1
  s_branch L_dn_back2
L_dn_last:
  s_cmp_eq_u32 s87, 1
  s_cbranch_scc1 L_dn_ohave
  s_waitcnt vmcnt(19)
  v_readfirstlane_b32 s40, v230
  s_cmp_ge_u32 s40, 8
  s_cbranch_scc1 L_dn_ogo
  s_add_u32 s40, s84, 96
  s_lshl_b32 s40, s40, 7
  s_add_u32 s40, s40, 21430272
  v_mov_b32 v208, s40
L_poll_o:
  global_load_dword v209, v208, s[54:55] sc1
  s_waitcnt vmcnt(0)
  v_readfirstlane_b32 s40, v209
  s_cmp_ge_u32 s40, 8
  s_cbranch_scc1 L_polld_o
  s_sleep 2
  s_branch L_poll_o
L_polld_o:
L_dn_ogo:
  s_mov_b32 s22, 21233664
  s_mul_i32 s40, s83, 3
  s_add_u32 s40, s40, 144
  s_lshl_b32 s40, s40, 10
  s_add_u32 s32, s65, s40
  s_add_u32 s33, s32, 165888
  s_add_u32 s34, s32, 331776
  s_add_u32 s35, s32, 497664
  buffer_load_dwordx4 a[0:3], v11, s[20:23], s32 offen offset:0 sc1
  buffer_load_dwordx4 a[4:7], v11, s[20:23], s33 offen offset:0 sc1
  buffer_load_dwordx4 a[8:11], v11, s[20:23], s34 offen offset:0 sc1
  buffer_load_dwordx4 a[12:15], v11, s[20:23], s35 offen offset:0 sc1
  buffer_load_dwordx4 a[16:19], v11, s[20:23], s32 offen offset:1024 sc1
  buffer_load_dwordx4 a[20:23], v11, s[20:23], s33 offen offset:1024 sc1
  buffer_load_dwordx4 a[24:27], v11, s[20:23], s34 offen offset:1024 sc1
  buffer_load_dwordx4 a[28:31], v11, s[20:23], s35 offen offset:1024 sc1
  buffer_load_dwordx4 a[32:35], v11, s[20:23], s32 offen offset:2048 sc1
  buffer_load_dwordx4 a[36:39], v11, s[20:23], s33 offen offset:2048 sc1
  buffer_load_dwordx4 a[40:43], v11, s[20:23], s34 offen offset:2048 sc1
  buffer_load_dwordx4 a[44:47], v11, s[20:23], s35 offen offset:2048 sc1
  s_lshl_b32 s40, s84, 2
  s_add_u32 s40, s40, s28
  s_lshl_b32 s40, s40, 8
  v_and_b32 v208, 15, v211
  v_lshlrev_b32 v208, 2, v208
  v_add_u32 v208, s40, v208
  v_add_u32 v208, 21463040, v208
  global_load_dword v20, v208, s[54:55] offset:0 sc1
  global_load_dword v21, v208, s[54:55] offset:64 sc1
  global_load_dword v22, v208, s[54:55] offset:128 sc1
  global_load_dword v23, v208, s[54:55] offset:192 sc1
L_dn_ohave:
  s_waitcnt vmcnt(0)
  s_lshl_b32 s67, s84, 2
  s_add_u32 s67, s67, s85
  s_lshl_b32 s40, s83, 5
  s_add_u32 s40, s40, s67
  s_lshl_b32 s40, s40, 2
  s_add_u32 s40, s40, s28
  s_mul_i32 s69, s40, 18432
  s_add_u32 s70, s69, 4608
  s_add_u32 s71, s69, 9216
  s_add_u32 s72, s69, 13824
  v_lshrrev_b32 v210, 1, v11
  s_waitcnt lgkmcnt(0)
  ds_read_b64_tr_b16 v[24:25], v15 offset:0
  ds_read_b64_tr_b16 v[26:27], v15 offset:4608
  ds_read_b64_tr_b16 v[28:29], v15 offset:9216
  ds_read_b64_tr_b16 v[30:31], v15 offset:13824
  ds_read_b64_tr_b16 v[32:33], v15 offset:18432
  ds_read_b64_tr_b16 v[34:35], v15 offset:23040
  ds_read_b64_tr_b16 v[36:37], v15 offset:32
  ds_read_b64_tr_b16 v[38:39], v15 offset:4640
  ds_read_b64_tr_b16 v[40:41], v15 offset:9248
  ds_read_b64_tr_b16 v[42:43], v15 offset:13856
  v_pk_mul_f32 v[64:65], v[64:65], v[20:21] op_sel:[0,0] op_sel_hi:[1,0]
  v_pk_mul_f32 v[66:67], v[66:67], v[20:21] op_sel:[0,0] op_sel_hi:[1,0]
  v_pk_mul_f32 v[68:69], v[68:69], v[20:21] op_sel:[0,1] op_sel_hi:[1,1]
  v_pk_mul_f32 v[70:71], v[70:71], v[20:21] op_sel:[0,1] op_sel_hi:[1,1]
  v_pk_mul_f32 v[72:73], v[72:73], v[22:23] op_sel:[0,0] op_sel_hi:[1,0]
  v_pk_mul_f32 v[74:75], v[74:75], v[22:23] op_sel:[0,0] op_sel_hi:[1,0]
  v_pk_mul_f32 v[76:77], v[76:77], v[22:23] op_sel:[0,1] op_sel_hi:[1,1]
  v_pk_mul_f32 v[78:79], v[78:79], v[22:23] op_sel:[0,1] op_sel_hi:[1,1]
  s_waitcnt lgkmcnt(8)
  s_nop 0
  v_mfma_f32_16x16x32_bf16 v[64:67], v[24:27], a[0:3], v[64:67]
  ds_read_b64_tr_b16 v[44:45], v15 offset:18464
  v_mfma_f32_16x16x32_bf16 v[68:71], v[24:27], a[4:7], v[68:71]
  ds_read_b64_tr_b16 v[46:47], v15 offset:23072
  v_mfma_f32_16x16x32_bf16 v[72:75], v[24:27], a[8:11], v[72:75]
  v_mfma_f32_16x16x32_bf16 v[76:79], v[24:27], a[12:15], v[76:79]
  s_waitcnt lgkmcnt(8)
  v_mfma_f32_16x16x32_bf16 v[64:67], v[28:31], a[16:19], v[64:67]
  ds_read_b64_tr_b16 v[48:49], v15 offset:64
  v_mfma_f32_16x16x32_bf16 v[68:71], v[28:31], a[20:23], v[68:71]
  ds_read_b64_tr_b16 v[50:51], v15 offset:4672
  v_mfma_f32_16x16x32_bf16 v[72:75], v[28:31], a[24:27], v[72:75]
  v_mfma_f32_16x16x32_bf16 v[76:79], v[28:31], a[28:31], v[76:79]
  s_waitcnt lgkmcnt(8)
  v_mfma_f32_16x16x32_bf16 v[64:67], v[32:35], a[32:35], v[64:67]
  ds_read_b64_tr_b16 v[52:53], v15 offset:9280
  v_mfma_f32_16x16x32_bf16 v[68:71], v[32:35], a[36:39], v[68:71]
  ds_read_b64_tr_b16 v[54:55], v15 offset:13888
  v_mfma_f32_16x16x32_bf16 v[72:75], v[32:35], a[40:43], v[72:75]
  v_mfma_f32_16x16x32_bf16 v[76:79], v[32:35], a[44:47], v[76:79]
  v_pk_mul_f32 v[80:81], v[80:81], v[20:21] op_sel:[0,0] op_sel_hi:[1,0]
  v_pk_mul_f32 v[82:83], v[82:83], v[20:21] op_sel:[0,0] op_sel_hi:[1,0]
  v_pk_mul_f32 v[84:85], v[84:85], v[20:21] op_sel:[0,1] op_sel_hi:[1,1]
  v_pk_mul_f32 v[86:87], v[86:87], v[20:21] op_sel:[0,1] op_sel_hi:[1,1]
  v_pk_mul_f32 v[88:89], v[88:89], v[22:23] op_sel:[0,0] op_sel_hi:[1,0]
  v_pk_mul_f32 v[90:91], v[90:91], v[22:23] op_sel:[0,0] op_sel_hi:[1,0]
  v_pk_mul_f32 v[92:93], v[92:93], v[22:23] op_sel:[0,1] op_sel_hi:[1,1]
  v_pk_mul_f32 v[94:95], v[94:95], v[22:23] op_sel:[0,1] op_sel_hi:[1,1]
  s_waitcnt lgkmcnt(8)
  s_nop 0
  v_mfma_f32_16x16x32_bf16 v[80:83], v[36:39], a[0:3], v[80:83]
  ds_read_b64_tr_b16 v[56:57], v15 offset:18496
  v_mfma_f32_16x16x32_bf16 v[84:87], v[36:39], a[4:7], v[84:87]
  ds_read_b64_tr_b16 v[58:59], v15 offset:23104
  v_mfma_f32_16x16x32_bf16 v[88:91], v[36:39], a[8:11], v[88:91]
  v_mfma_f32_16x16x32_bf16 v[92:95], v[36:39], a[12:15], v[92:95]
  s_waitcnt lgkmcnt(8)
  v_mfma_f32_16x16x32_bf16 v[80:83], v[40:43], a[16:19], v[80:83]
  ds_read_b64_tr_b16 v[24:25], v15 offset:96
  v_mfma_f32_16x16x32_bf16 v[84:87], v[40:43], a[20:23], v[84:87]
  ds_read_b64_tr_b16 v[26:27], v15 offset:4704
  v_mfma_f32_16x16x32_bf16 v[88:91], v[40:43], a[24:27], v[88:91]
  v_mfma_f32_16x16x32_bf16 v[92:95], v[40:43], a[28:31], v[92:95]
  s_waitcnt lgkmcnt(8)
  v_mfma_f32_16x16x32_bf16 v[80:83], v[44:47], a[32:35], v[80:83]
  ds_read_b64_tr_b16 v[28:29], v15 offset:9312
  v_mfma_f32_16x16x32_bf16 v[84:87], v[44:47], a[36:39], v[84:87]
  ds_read_b64_tr_b16 v[30:31], v15 offset:13920
  v_mfma_f32_16x16x32_bf16 v[88:91], v[44:47], a[40:43], v[88:91]
  v_mfma_f32_16x16x32_bf16 v[92:95], v[44:47], a[44:47], v[92:95]
  v_pk_mul_f32 v[96:97], v[96:97], v[20:21] op_sel:[0,0] op_sel_hi:[1,0]
  v_pk_mul_f32 v[98:99], v[98:99], v[20:21] op_sel:[0,0] op_sel_hi:[1,0]
  v_pk_mul_f32 v[100:101], v[100:101], v[20:21] op_sel:[0,1] op_sel_hi:[1,1]
  v_pk_mul_f32 v[102:103], v[102:103], v[20:21] op_sel:[0,1] op_sel_hi:[1,1]
  v_pk_mul_f32 v[104:105], v[104:105], v[22:23] op_sel:[0,0] op_sel_hi:[1,0]
  v_pk_mul_f32 v[106:107], v[106:107], v[22:23] op_sel:[0,0] op_sel_hi:[1,0]
  v_pk_mul_f32 v[108:109], v[108:109], v[22:23] op_sel:[0,1] op_sel_hi:[1,1]
  v_pk_mul_f32 v[110:111], v[110:111], v[22:23] op_sel:[0,1] op_sel_hi:[1,1]
  s_waitcnt lgkmcnt(8)
  s_nop 0
  v_mfma_f32_16x16x32_bf16 v[96:99], v[48:51], a[0:3], v[96:99]
  ds_read_b64_tr_b16 v[32:33], v15 offset:18528
  ds_read_b64_tr_b16 v[34:35], v15 offset:23136
  v_mfma_f32_16x16x32_bf16 v[100:103], v[48:51], a[4:7], v[100:103]
  s_nop 3
  v_cvt_pk_bf16_f32 v214, v64, v65
  v_mfma_f32_16x16x32_bf16 v[104:107], v[48:51], a[8:11], v[104:107]
  v_cvt_pk_bf16_f32 v215, v66, v67
  v_cvt_pk_bf16_f32 v216, v80, v81
  v_mfma_f32_16x16x32_bf16 v[108:111], v[48:51], a[12:15], v[108:111]
  v_cvt_pk_bf16_f32 v217, v82, v83
  buffer_store_dwordx4 v[214:217], v11, s[8:11], s69 offen offset:0 sc1
  s_waitcnt lgkmcnt(8)
  v_mfma_f32_16x16x32_bf16 v[96:99], v[52:55], a[16:19], v[96:99]
  ds_read_b64_tr_b16 v[36:37], v15 offset:128
  ds_read_b64_tr_b16 v[38:39], v15 offset:4736
  v_mfma_f32_16x16x32_bf16 v[100:103], v[52:55], a[20:23], v[100:103]
  v_cvt_pk_bf16_f32 v218, v68, v69
  v_cvt_pk_bf16_f32 v219, v70, v71
  v_mfma_f32_16x16x32_bf16 v[104:107], v[52:55], a[24:27], v[104:107]
  v_cvt_pk_bf16_f32 v220, v84, v85
  v_cvt_pk_bf16_f32 v221, v86, v87
  v_mfma_f32_16x16x32_bf16 v[108:111], v[52:55], a[28:31], v[108:111]
  buffer_store_dwordx4 v[218:221], v11, s[8:11], s70 offen offset:0 sc1
  v_cvt_pk_bf16_f32 v222, v72, v73
  s_waitcnt lgkmcnt(8)
  v_mfma_f32_16x16x32_bf16 v[96:99], v[56:59], a[32:35], v[96:99]
  ds_read_b64_tr_b16 v[40:41], v15 offset:9344
  ds_read_b64_tr_b16 v[42:43], v15 offset:13952
  v_mfma_f32_16x16x32_bf16 v[100:103], v[56:59], a[36:39], v[100:103]
  v_cvt_pk_bf16_f32 v223, v74, v75
  v_cvt_pk_bf16_f32 v224, v88, v89
  v_mfma_f32_16x16x32_bf16 v[104:107], v[56:59], a[40:43], v[104:107]
  v_cvt_pk_bf16_f32 v225, v90, v91
  buffer_store_dwordx4 v[222:225], v11, s[8:11], s71 offen offset:0 sc1
  v_mfma_f32_16x16x32_bf16 v[108:111], v[56:59], a[44:47], v[108:111]
  v_cvt_pk_bf16_f32 v226, v76, v77
  v_cvt_pk_bf16_f32 v227, v78, v79
  v_pk_mul_f32 v[112:113], v[112:113], v[20:21] op_sel:[0,0] op_sel_hi:[1,0]
  v_pk_mul_f32 v[114:115], v[114:115], v[20:21] op_sel:[0,0] op_sel_hi:[1,0]
  v_pk_mul_f32 v[116:117], v[116:117], v[20:21] op_sel:[0,1] op_sel_hi:[1,1]
  v_pk_mul_f32 v[118:119], v[118:119], v[20:21] op_sel:[0,1] op_sel_hi:[1,1]
  v_pk_mul_f32 v[120:121], v[120:121], v[22:23] op_sel:[0,0] op_sel_hi:[1,0]
  v_pk_mul_f32 v[122:123], v[122:123], v[22:23] op_sel:[0,0] op_sel_hi:[1,0]
  v_pk_mul_f32 v[124:125], v[124:125], v[22:23] op_sel:[0,1] op_sel_hi:[1,1]
  v_pk_mul_f32 v[126:127], v[126:127], v[22:23] op_sel:[0,1] op_sel_hi:[1,1]
  s_waitcnt lgkmcnt(8)
  s_nop 0
  v_mfma_f32_16x16x32_bf16 v[112:115], v[24:27], a[0:3], v[112:115]
  ds_read_b64_tr_b16 v[44:45], v15 offset:18560
  ds_read_b64_tr_b16 v[46:47], v15 offset:23168
  v_mfma_f32_16x16x32_bf16 v[116:119], v[24:27], a[4:7], v[116:119]
  v_cvt_pk_bf16_f32 v228, v92, v93
  v_mfma_f32_16x16x32_bf16 v[120:123], v[24:27], a[8:11], v[120:123]
  v_cvt_pk_bf16_f32 v229, v94, v95
  v_mfma_f32_16x16x32_bf16 v[124:127], v[24:27], a[12:15], v[124:127]
  buffer_store_dwordx4 v[226:229], v11, s[8:11], s72 offen offset:0 sc1
  s_waitcnt lgkmcnt(8)
  v_mfma_f32_16x16x32_bf16 v[112:115], v[28:31], a[16:19], v[112:115]
  ds_read_b64_tr_b16 v[48:49], v15 offset:160
  v_mfma_f32_16x16x32_bf16 v[116:119], v[28:31], a[20:23], v[116:119]
  ds_read_b64_tr_b16 v[50:51], v15 offset:4768
  v_mfma_f32_16x16x32_bf16 v[120:123], v[28:31], a[24:27], v[120:123]
  v_mfma_f32_16x16x32_bf16 v[124:127], v[28:31], a[28:31], v[124:127]
  s_waitcnt lgkmcnt(8)
  v_mfma_f32_16x16x32_bf16 v[112:115], v[32:35], a[32:35], v[112:115]
  ds_read_b64_tr_b16 v[52:53], v15 offset:9376
  v_mfma_f32_16x16x32_bf16 v[116:119], v[32:35], a[36:39], v[116:119]
  ds_read_b64_tr_b16 v[54:55], v15 offset:13984
  v_mfma_f32_16x16x32_bf16 v[120:123], v[32:35], a[40:43], v[120:123]
  v_mfma_f32_16x16x32_bf16 v[124:127], v[32:35], a[44:47], v[124:127]
  v_pk_mul_f32 v[128:129], v[128:129], v[20:21] op_sel:[0,0] op_sel_hi:[1,0]
  v_pk_mul_f32 v[130:131], v[130:131], v[20:21] op_sel:[0,0] op_sel_hi:[1,0]
  v_pk_mul_f32 v[132:133], v[132:133], v[20:21] op_sel:[0,1] op_sel_hi:[1,1]
  v_pk_mul_f32 v[134:135], v[134:135], v[20:21] op_sel:[0,1] op_sel_hi:[1,1]
  v_pk_mul_f32 v[136:137], v[136:137], v[22:23] op_sel:[0,0] op_sel_hi:[1,0]
  v_pk_mul_f32 v[138:139], v[138:139], v[22:23] op_sel:[0,0] op_sel_hi:[1,0]
  v_pk_mul_f32 v[140:141], v[140:141], v[22:23] op_sel:[0,1] op_sel_hi:[1,1]
  v_pk_mul_f32 v[142:143], v[142:143], v[22:23] op_sel:[0,1] op_sel_hi:[1,1]
  s_waitcnt lgkmcnt(8)
  s_nop 0
  v_mfma_f32_16x16x32_bf16 v[128:131], v[36:39], a[0:3], v[128:131]
  ds_read_b64_tr_b16 v[56:57], v15 offset:18592
  ds_read_b64_tr_b16 v[58:59], v15 offset:23200
  v_mfma_f32_16x16x32_bf16 v[132:135], v[36:39], a[4:7], v[132:135]
  s_nop 3
  v_cvt_pk_bf16_f32 v214, v96, v97
  v_mfma_f32_16x16x32_bf16 v[136:139], v[36:39], a[8:11], v[136:139]
  v_cvt_pk_bf16_f32 v215, v98, v99
  v_cvt_pk_bf16_f32 v216, v112, v113
  v_mfma_f32_16x16x32_bf16 v[140:143], v[36:39], a[12:15], v[140:143]
  v_cvt_pk_bf16_f32 v217, v114, v115
  buffer_store_dwordx4 v[214:217], v11, s[8:11], s69 offen offset:1024 sc1
  s_waitcnt lgkmcnt(8)
  v_mfma_f32_16x16x32_bf16 v[128:131], v[40:43], a[16:19], v[128:131]
  ds_read_b64_tr_b16 v[24:25], v15 offset:192
  ds_read_b64_tr_b16 v[26:27], v15 offset:4800
  v_mfma_f32_16x16x32_bf16 v[132:135], v[40:43], a[20:23], v[132:135]
  v_cvt_pk_bf16_f32 v218, v100, v101
  v_cvt_pk_bf16_f32 v219, v102, v103
  v_mfma_f32_16x16x32_bf16 v[136:139], v[40:43], a[24:27], v[136:139]
  v_cvt_pk_bf16_f32 v220, v116, v117
  v_cvt_pk_bf16_f32 v221, v118, v119
  v_mfma_f32_16x16x32_bf16 v[140:143], v[40:43], a[28:31], v[140:143]
  buffer_store_dwordx4 v[218:221], v11, s[8:11], s70 offen offset:1024 sc1
  v_cvt_pk_bf16_f32 v222, v104, v105
  s_waitcnt lgkmcnt(8)
  v_mfma_f32_16x16x32_bf16 v[128:131], v[44:47], a[32:35], v[128:131]
  ds_read_b64_tr_b16 v[28:29], v15 offset:9408
  ds_read_b64_tr_b16 v[30:31], v15 offset:14016
  v_mfma_f32_16x16x32_bf16 v[132:135], v[44:47], a[36:39], v[132:135]
  v_cvt_pk_bf16_f32 v223, v106, v107
  v_cvt_pk_bf16_f32 v224, v120, v121
  v_mfma_f32_16x16x32_bf16 v[136:139], v[44:47], a[40:43], v[136:139]
  v_cvt_pk_bf16_f32 v225, v122, v123
  buffer_store_dwordx4 v[222:225], v11, s[8:11], s71 offen offset:1024 sc1
  v_mfma_f32_16x16x32_bf16 v[140:143], v[44:47], a[44:47], v[140:143]
  v_cvt_pk_bf16_f32 v226, v108, v109
  v_cvt_pk_bf16_f32 v227, v110, v111
  v_pk_mul_f32 v[144:145], v[144:145], v[20:21] op_sel:[0,0] op_sel_hi:[1,0]
  v_pk_mul_f32 v[146:147], v[146:147], v[20:21] op_sel:[0,0] op_sel_hi:[1,0]
  v_pk_mul_f32 v[148:149], v[148:149], v[20:21] op_sel:[0,1] op_sel_hi:[1,1]
  v_pk_mul_f32 v[150:151], v[150:151], v[20:21] op_sel:[0,1] op_sel_hi:[1,1]
  v_pk_mul_f32 v[152:153], v[152:153], v[22:23] op_sel:[0,0] op_sel_hi:[1,0]
  v_pk_mul_f32 v[154:155], v[154:155], v[22:23] op_sel:[0,0] op_sel_hi:[1,0]
  v_pk_mul_f32 v[156:157], v[156:157], v[22:23] op_sel:[0,1] op_sel_hi:[1,1]
  v_pk_mul_f32 v[158:159], v[158:159], v[22:23] op_sel:[0,1] op_sel_hi:[1,1]
  s_waitcnt lgkmcnt(8)
  s_nop 0
  v_mfma_f32_16x16x32_bf16 v[144:147], v[48:51], a[0:3], v[144:147]
  ds_read_b64_tr_b16 v[32:33], v15 offset:18624
  ds_read_b64_tr_b16 v[34:35], v15 offset:23232
  v_mfma_f32_16x16x32_bf16 v[148:151], v[48:51], a[4:7], v[148:151]
  v_cvt_pk_bf16_f32 v228, v124, v125
  v_mfma_f32_16x16x32_bf16 v[152:155], v[48:51], a[8:11], v[152:155]
  v_cvt_pk_bf16_f32 v229, v126, v127
  v_mfma_f32_16x16x32_bf16 v[156:159], v[48:51], a[12:15], v[156:159]
  buffer_store_dwordx4 v[226:229], v11, s[8:11], s72 offen offset:1024 sc1
  s_waitcnt lgkmcnt(8)
  v_mfma_f32_16x16x32_bf16 v[144:147], v[52:55], a[16:19], v[144:147]
  ds_read_b64_tr_b16 v[36:37], v15 offset:224
  v_mfma_f32_16x16x32_bf16 v[148:151], v[52:55], a[20:23], v[148:151]
  ds_read_b64_tr_b16 v[38:39], v15 offset:4832
  v_mfma_f32_16x16x32_bf16 v[152:155], v[52:55], a[24:27], v[152:155]
  v_mfma_f32_16x16x32_bf16 v[156:159], v[52:55], a[28:31], v[156:159]
  s_waitcnt lgkmcnt(8)
  v_mfma_f32_16x16x32_bf16 v[144:147], v[56:59], a[32:35], v[144:147]
  ds_read_b64_tr_b16 v[40:41], v15 offset:9440
  v_mfma_f32_16x16x32_bf16 v[148:151], v[56:59], a[36:39], v[148:151]
  ds_read_b64_tr_b16 v[42:43], v15 offset:14048
  v_mfma_f32_16x16x32_bf16 v[152:155], v[56:59], a[40:43], v[152:155]
  v_mfma_f32_16x16x32_bf16 v[156:159], v[56:59], a[44:47], v[156:159]
  v_pk_mul_f32 v[160:161], v[160:161], v[20:21] op_sel:[0,0] op_sel_hi:[1,0]
  v_pk_mul_f32 v[162:163], v[162:163], v[20:21] op_sel:[0,0] op_sel_hi:[1,0]
  v_pk_mul_f32 v[164:165], v[164:165], v[20:21] op_sel:[0,1] op_sel_hi:[1,1]
  v_pk_mul_f32 v[166:167], v[166:167], v[20:21] op_sel:[0,1] op_sel_hi:[1,1]
  v_pk_mul_f32 v[168:169], v[168:169], v[22:23] op_sel:[0,0] op_sel_hi:[1,0]
  v_pk_mul_f32 v[170:171], v[170:171], v[22:23] op_sel:[0,0] op_sel_hi:[1,0]
  v_pk_mul_f32 v[172:173], v[172:173], v[22:23] op_sel:[0,1] op_sel_hi:[1,1]
  v_pk_mul_f32 v[174:175], v[174:175], v[22:23] op_sel:[0,1] op_sel_hi:[1,1]
  s_waitcnt lgkmcnt(8)
  s_nop 0
  v_mfma_f32_16x16x32_bf16 v[160:163], v[24:27], a[0:3], v[160:163]
  ds_read_b64_tr_b16 v[44:45], v15 offset:18656
  ds_read_b64_tr_b16 v[46:47], v15 offset:23264
  v_mfma_f32_16x16x32_bf16 v[164:167], v[24:27], a[4:7], v[164:167]
  s_nop 3
  v_cvt_pk_bf16_f32 v214, v128, v129
  v_mfma_f32_16x16x32_bf16 v[168:171], v[24:27], a[8:11], v[168:171]
  v_cvt_pk_bf16_f32 v215, v130, v131
  v_cvt_pk_bf16_f32 v216, v144, v145
  v_mfma_f32_16x16x32_bf16 v[172:175], v[24:27], a[12:15], v[172:175]
  v_cvt_pk_bf16_f32 v217, v146, v147
  buffer_store_dwordx4 v[214:217], v11, s[8:11], s69 offen offset:2048 sc1
  s_waitcnt lgkmcnt(8)
  v_mfma_f32_16x16x32_bf16 v[160:163], v[28:31], a[16:19], v[160:163]
  ds_read_b64_tr_b16 v[48:49], v15 offset:256
  ds_read_b64_tr_b16 v[50:51], v15 offset:4864
  v_mfma_f32_16x16x32_bf16 v[164:167], v[28:31], a[20:23], v[164:167]
  v_cvt_pk_bf16_f32 v218, v132, v133
  v_cvt_pk_bf16_f32 v219, v134, v135
  v_mfma_f32_16x16x32_bf16 v[168:171], v[28:31], a[24:27], v[168:171]
  v_cvt_pk_bf16_f32 v220, v148, v149
  v_cvt_pk_bf16_f32 v221, v150, v151
  v_mfma_f32_16x16x32_bf16 v[172:175], v[28:31], a[28:31], v[172:175]
  buffer_store_dwordx4 v[218:221], v11, s[8:11], s70 offen offset:2048 sc1
  v_cvt_pk_bf16_f32 v222, v136, v137
  s_waitcnt lgkmcnt(8)
  v_mfma_f32_16x16x32_bf16 v[160:163], v[32:35], a[32:35], v[160:163]
  ds_read_b64_tr_b16 v[52:53], v15 offset:9472
  ds_read_b64_tr_b16 v[54:55], v15 offset:14080
  v_mfma_f32_16x16x32_bf16 v[164:167], v[32:35], a[36:39], v[164:167]
  v_cvt_pk_bf16_f32 v223, v138, v139
  v_cvt_pk_bf16_f32 v224, v152, v153
  v_mfma_f32_16x16x32_bf16 v[168:171], v[32:35], a[40:43], v[168:171]
  v_cvt_pk_bf16_f32 v225, v154, v155
  buffer_store_dwordx4 v[222:225], v11, s[8:11], s71 offen offset:2048 sc1
  v_mfma_f32_16x16x32_bf16 v[172:175], v[32:35], a[44:47], v[172:175]
  v_cvt_pk_bf16_f32 v226, v140, v141
  v_cvt_pk_bf16_f32 v227, v142, v143
  v_pk_mul_f32 v[176:177], v[176:177], v[20:21] op_sel:[0,0] op_sel_hi:[1,0]
  v_pk_mul_f32 v[178:179], v[178:179], v[20:21] op_sel:[0,0] op_sel_hi:[1,0]
  v_pk_mul_f32 v[180:181], v[180:181], v[20:21] op_sel:[0,1] op_sel_hi:[1,1]
  v_pk_mul_f32 v[182:183], v[182:183], v[20:21] op_sel:[0,1] op_sel_hi:[1,1]
  v_pk_mul_f32 v[184:185], v[184:185], v[22:23] op_sel:[0,0] op_sel_hi:[1,0]
  v_pk_mul_f32 v[186:187], v[186:187], v[22:23] op_sel:[0,0] op_sel_hi:[1,0]
  v_pk_mul_f32 v[188:189], v[188:189], v[22:23] op_sel:[0,1] op_sel_hi:[1,1]
  v_pk_mul_f32 v[190:191], v[190:191], v[22:23] op_sel:[0,1] op_sel_hi:[1,1]
  s_waitcnt lgkmcnt(8)
  s_nop 0
  v_mfma_f32_16x16x32_bf16 v[176:179], v[36:39], a[0:3], v[176:179]
  ds_read_b64_tr_b16 v[56:57], v15 offset:18688
  ds_read_b64_tr_b16 v[58:59], v15 offset:23296
  v_mfma_f32_16x16x32_bf16 v[180:183], v[36:39], a[4:7], v[180:183]
  v_cvt_pk_bf16_f32 v228, v156, v157
  v_mfma_f32_16x16x32_bf16 v[184:187], v[36:39], a[8:11], v[184:187]
  v_cvt_pk_bf16_f32 v229, v158, v159
  v_mfma_f32_16x16x32_bf16 v[188:191], v[36:39], a[12:15], v[188:191]
  buffer_store_dwordx4 v[226:229], v11, s[8:11], s72 offen offset:2048 sc1
  s_waitcnt lgkmcnt(8)
  v_mfma_f32_16x16x32_bf16 v[176:179], v[40:43], a[16:19], v[176:179]
  v_mfma_f32_16x16x32_bf16 v[180:183], v[40:43], a[20:23], v[180:183]
  v_mfma_f32_16x16x32_bf16 v[184:187], v[40:43], a[24:27], v[184:187]
  v_mfma_f32_16x16x32_bf16 v[188:191], v[40:43], a[28:31], v[188:191]
  s_waitcnt lgkmcnt(6)
  v_mfma_f32_16x16x32_bf16 v[176:179], v[44:47], a[32:35], v[176:179]
  v_mfma_f32_16x16x32_bf16 v[180:183], v[44:47], a[36:39], v[180:183]
  v_mfma_f32_16x16x32_bf16 v[184:187], v[44:47], a[40:43], v[184:187]
  v_mfma_f32_16x16x32_bf16 v[188:191], v[44:47], a[44:47], v[188:191]
  v_pk_mul_f32 v[192:193], v[192:193], v[20:21] op_sel:[0,0] op_sel_hi:[1,0]
  v_pk_mul_f32 v[194:195], v[194:195], v[20:21] op_sel:[0,0] op_sel_hi:[1,0]
  v_pk_mul_f32 v[196:197], v[196:197], v[20:21] op_sel:[0,1] op_sel_hi:[1,1]
  v_pk_mul_f32 v[198:199], v[198:199], v[20:21] op_sel:[0,1] op_sel_hi:[1,1]
  v_pk_mul_f32 v[200:201], v[200:201], v[22:23] op_sel:[0,0] op_sel_hi:[1,0]
  v_pk_mul_f32 v[202:203], v[202:203], v[22:23] op_sel:[0,0] op_sel_hi:[1,0]
  v_pk_mul_f32 v[204:205], v[204:205], v[22:23] op_sel:[0,1] op_sel_hi:[1,1]
  v_pk_mul_f32 v[206:207], v[206:207], v[22:23] op_sel:[0,1] op_sel_hi:[1,1]
  s_waitcnt lgkmcnt(4)
  s_nop 0
  v_mfma_f32_16x16x32_bf16 v[192:195], v[48:51], a[0:3], v[192:195]
  s_nop 3
  v_cvt_pk_bf16_f32 v214, v160, v161
  v_mfma_f32_16x16x32_bf16 v[196:199], v[48:51], a[4:7], v[196:199]
  v_cvt_pk_bf16_f32 v215, v162, v163
  v_cvt_pk_bf16_f32 v216, v176, v177
  v_mfma_f32_16x16x32_bf16 v[200:203], v[48:51], a[8:11], v[200:203]
  v_cvt_pk_bf16_f32 v217, v178, v179
  v_mfma_f32_16x16x32_bf16 v[204:207], v[48:51], a[12:15], v[204:207]
  buffer_store_dwordx4 v[214:217], v11, s[8:11], s69 offen offset:3072 sc1
  s_waitcnt lgkmcnt(2)
  v_mfma_f32_16x16x32_bf16 v[192:195], v[52:55], a[16:19], v[192:195]
  v_cvt_pk_bf16_f32 v218, v164, v165
  v_cvt_pk_bf16_f32 v219, v166, v167
  v_mfma_f32_16x16x32_bf16 v[196:199], v[52:55], a[20:23], v[196:199]
  v_cvt_pk_bf16_f32 v220, v180, v181
  v_cvt_pk_bf16_f32 v221, v182, v183
  v_mfma_f32_16x16x32_bf16 v[200:203], v[52:55], a[24:27], v[200:203]
  buffer_store_dwordx4 v[218:221], v11, s[8:11], s70 offen offset:3072 sc1
  v_mfma_f32_16x16x32_bf16 v[204:207], v[52:55], a[28:31], v[204:207]
  v_cvt_pk_bf16_f32 v222, v168, v169
  s_waitcnt lgkmcnt(0)
  v_mfma_f32_16x16x32_bf16 v[192:195], v[56:59], a[32:35], v[192:195]
  v_cvt_pk_bf16_f32 v223, v170, v171
  v_cvt_pk_bf16_f32 v224, v184, v185
  v_mfma_f32_16x16x32_bf16 v[196:199], v[56:59], a[36:39], v[196:199]
  v_cvt_pk_bf16_f32 v225, v186, v187
  buffer_store_dwordx4 v[222:225], v11, s[8:11], s71 offen offset:3072 sc1
  v_mfma_f32_16x16x32_bf16 v[200:203], v[56:59], a[40:43], v[200:203]
  v_cvt_pk_bf16_f32 v226, v172, v173
  v_mfma_f32_16x16x32_bf16 v[204:207], v[56:59], a[44:47], v[204:207]
  v_cvt_pk_bf16_f32 v227, v174, v175
  s_nop 7
  v_cvt_pk_bf16_f32 v228, v188, v189
  v_cvt_pk_bf16_f32 v229, v190, v191
  buffer_store_dwordx4 v[226:229], v11, s[8:11], s72 offen offset:3072 sc1
  s_nop 3
  v_cvt_pk_bf16_f32 v214, v192, v193
  v_cvt_pk_bf16_f32 v215, v194, v195
  s_add_u32 s41, s69, 4096
  buffer_store_dwordx2 v[214:215], v210, s[8:11], s41 offen sc1
  v_cvt_pk_bf16_f32 v218, v196, v197
  v_cvt_pk_bf16_f32 v219, v198, v199
  s_add_u32 s41, s70, 4096
  buffer_store_dwordx2 v[218:219], v210, s[8:11], s41 offen sc1
  v_cvt_pk_bf16_f32 v222, v200, v201
  v_cvt_pk_bf16_f32 v223, v202, v203
  s_add_u32 s41, s71, 4096
  buffer_store_dwordx2 v[222:223], v210, s[8:11], s41 offen sc1
  v_cvt_pk_bf16_f32 v226, v204, v205
  v_cvt_pk_bf16_f32 v227, v206, v207
  s_add_u32 s41, s72, 4096
  buffer_store_dwordx2 v[226:227], v210, s[8:11], s41 offen sc1
  s_waitcnt vmcnt(0)
  s_barrier
  s_cmp_eq_u32 s28, 0
  s_cbranch_scc0 L_dn_nosig2
  s_add_u32 s40, s67, 104
  s_lshl_b32 s40, s40, 7
  s_add_u32 s40, s40, 21430272
  v_mov_b32 v208, s40
  v_mov_b32 v209, 1
  s_mov_b64 s[80:81], exec
  s_mov_b64 exec, 1
  global_atomic_add v208, v209, s[54:55]
  s_mov_b64 exec, s[80:81]
L_dn_nosig2:
  s_mov_b32 s30, s67
  s_mov_b32 s31, s83
  s_branch L_reduce
L_attn:
  s_load_dwordx4 s[60:63], s[0:1], 0
  s_load_dwordx2 s[64:65], s[0:1], 16
  s_load_dwordx2 s[66:67], s[0:1], 64
  s_load_dwordx4 s[68:71], s[0:1], 80
  s_getpc_b64 s[52:53]
L_at_pc:
  s_add_u32 s52, s52, L_at_table-L_at_pc
  s_addc_u32 s53, s53, 0
  s_and_b32 s32, s2, 7
  s_lshr_b32 s34, s2, 3
  s_sub_u32 s34, s34, 24
  v_lshrrev_b32 v4, 6, v0
  v_and_b32 v1, 63, v0
  v_readfirstlane_b32 s36, v4
  v_lshrrev_b32 v2, 4, v1
  v_and_b32 v3, 15, v1
  v_lshlrev_b32 v43, 4, v1
  v_lshrrev_b32 v4, 3, v1
  v_add_u32 v4, 0, v4
  v_mul_u32_u24 v9, 1152, v4
  v_and_b32 v4, 7, v1
  v_add_u32 v5, 0, v2
  v_xor_b32 v4, v4, v5
  v_lshl_add_u32 v9, v4, 4, v9
  v_lshrrev_b32 v4, 3, v1
  v_add_u32 v4, 8, v4
  v_mul_u32_u24 v10, 1152, v4
  v_and_b32 v4, 7, v1
  v_add_u32 v5, 4, v2
  v_xor_b32 v4, v4, v5
  v_lshl_add_u32 v10, v4, 4, v10
  s_lshl_b32 s47, s36, 14
  s_add_u32 s47, s47, 73728
  v_lshrrev_b32 v4, 1, v3
  v_add_u32 v5, 0, v2
  v_xor_b32 v4, v4, v5
  v_lshlrev_b32 v4, 4, v4
  v_lshl_add_u32 v4, v3, 7, v4
  v_add_u32 v11, s47, v4
  v_lshrrev_b32 v4, 1, v3
  v_add_u32 v5, 4, v2
  v_xor_b32 v4, v4, v5
  v_lshlrev_b32 v4, 4, v4
  v_lshl_add_u32 v4, v3, 7, v4
  v_add_u32 v12, s47, v4
  s_waitcnt lgkmcnt(0)
  s_mov_b32 s8, s60
  s_and_b32 s9, s61, 0xffff
  s_mov_b32 s10, 2359296
  s_mov_b32 s11, 0x00020000
  s_mov_b32 s12, s62
  s_and_b32 s13, s63, 0xffff
  s_mov_b32 s14, 1990656
  s_mov_b32 s15, 0x00020000
  s_lshl_b32 s44, s34, 2
  s_add_u32 s44, s44, s36
  s_mul_i32 s38, s44, 73728
  s_add_u32 s39, s38, 18432
  s_add_u32 s40, s38, 36864
  s_add_u32 s41, s38, 55296
  s_mul_i32 s88, s44, 663552
  s_add_u32 s89, s88, 165888
  s_add_u32 s90, s88, 331776
  s_add_u32 s91, s88, 497664
  s_add_u32 m0, s47, 0
  s_add_u32 s44, s38, 0
  buffer_load_dwordx4 v9, s[8:11], s44 offen lds
  s_add_u32 m0, s47, 1024
  s_nop 0
  buffer_load_dwordx4 v10, s[8:11], s44 offen lds
  s_add_u32 m0, s47, 2048
  s_add_u32 s44, s39, 0
  buffer_load_dwordx4 v9, s[8:11], s44 offen lds
  s_add_u32 m0, s47, 3072
  s_nop 0
  buffer_load_dwordx4 v10, s[8:11], s44 offen lds
  s_add_u32 m0, s47, 4096
  s_add_u32 s44, s40, 0
  buffer_load_dwordx4 v9, s[8:11], s44 offen lds
  s_add_u32 m0, s47, 5120
  s_nop 0
  buffer_load_dwordx4 v10, s[8:11], s44 offen lds
  s_add_u32 m0, s47, 6144
  s_add_u32 s44, s41, 0
  buffer_load_dwordx4 v9, s[8:11], s44 offen lds
  s_add_u32 m0, s47, 7168
  s_nop 0
  buffer_load_dwordx4 v10, s[8:11], s44 offen lds
  s_lshr_b32 s45, s36, 1
  s_lshl_b32 s45, s45, 2
  v_or_b32 v4, s45, v2
  v_lshlrev_b32 v4, 1, v4
  v_xor_b32 v4, v4, v3
  v_mul_u32_u24 v5, 52, v4
  v_lshrrev_b32 v5, 8, v5
  v_mul_u32_u24 v6, 5, v5
  v_sub_u32 v6, v4, v6
  v_mul_u32_u24 v8, 3456, v2
  v_mul_u32_u24 v5, 1152, v5
  v_add_u32 v8, v8, v5
  v_lshl_add_u32 v8, v6, 4, v8
  s_mul_i32 s42, s36, 13824
  s_mul_i32 s45, s32, 144
  s_add_u32 s42, s42, s45
  s_lshl_b32 s43, s36, 10
  s_mov_b32 s56, s42
  s_add_u32 m0, s43, 0
  s_add_u32 s44, s56, 0
  buffer_load_dwordx4 v8, s[12:15], s44 offen lds
  s_add_u32 m0, s43, 4096
  s_add_u32 s44, s56, 55296
  buffer_load_dwordx4 v8, s[12:15], s44 offen lds
  s_add_u32 m0, s43, 8192
  s_add_u32 s44, s56, 110592
  buffer_load_dwordx4 v8, s[12:15], s44 offen lds
  s_add_u32 m0, s43, 12288
  s_add_u32 s44, s56, 165888
  buffer_load_dwordx4 v8, s[12:15], s44 offen lds
  s_add_u32 m0, s43, 16384
  s_add_u32 s44, s56, 221184
  buffer_load_dwordx4 v8, s[12:15], s44 offen lds
  s_add_u32 m0, s43, 20480
  s_add_u32 s44, s56, 276480
  buffer_load_dwordx4 v8, s[12:15], s44 offen lds
  s_mul_i32 s44, s34, 72
  s_mul_i32 s45, s36, 18
  s_add_u32 s44, s44, s45
  s_mul_i32 s44, s44, 3456
  s_mul_i32 s45, s32, 144
  s_add_u32 s44, s44, s45
  v_add_u32 v4, 0, v1
  v_mul_u32_u24 v5, 171, v4
  v_lshrrev_b32 v5, 10, v5
  v_mul_u32_u24 v6, 6, v5
  v_sub_u32 v6, v4, v6
  v_mul_u32_u24 v5, 3456, v5
  v_lshrrev_b32 v7, 1, v6
  v_mul_u32_u24 v7, 1152, v7
  v_add_u32 v5, v5, v7
  v_and_b32 v6, 1, v6
  v_mul_u32_u24 v6, 140, v6
  v_add_u32 v5, v5, v6
  buffer_load_dword v242, v5, s[12:15], s44 offen
  v_add_u32 v4, 64, v1
  v_mul_u32_u24 v5, 171, v4
  v_lshrrev_b32 v5, 10, v5
  v_mul_u32_u24 v6, 6, v5
  v_sub_u32 v6, v4, v6
  v_mul_u32_u24 v5, 3456, v5
  v_lshrrev_b32 v7, 1, v6
  v_mul_u32_u24 v7, 1152, v7
  v_add_u32 v5, v5, v7
  v_and_b32 v6, 1, v6
  v_mul_u32_u24 v6, 140, v6
  v_add_u32 v5, v5, v6
  v_mov_b32 v6, 0x7f000000
  v_cmp_gt_u32 vcc, 108, v4
  s_nop 1
  v_cndmask_b32 v5, v6, v5, vcc
  buffer_load_dword v243, v5, s[12:15], s44 offen
  s_add_u32 s56, s56, 331776
  s_add_u32 m0, s47, 8192
  s_add_u32 s44, s38, 128
  buffer_load_dwordx4 v9, s[8:11], s44 offen lds
  s_add_u32 m0, s47, 9216
  s_nop 0
  buffer_load_dwordx4 v10, s[8:11], s44 offen lds
  s_add_u32 m0, s47, 10240
  s_add_u32 s44, s39, 128
  buffer_load_dwordx4 v9, s[8:11], s44 offen lds
  s_add_u32 m0, s47, 11264
  s_nop 0
  buffer_load_dwordx4 v10, s[8:11], s44 offen lds
  s_add_u32 m0, s47, 12288
  s_add_u32 s44, s40, 128
  buffer_load_dwordx4 v9, s[8:11], s44 offen lds
  s_add_u32 m0, s47, 13312
  s_nop 0
  buffer_load_dwordx4 v10, s[8:11], s44 offen lds
  s_add_u32 m0, s47, 14336
  s_add_u32 s44, s41, 128
  buffer_load_dwordx4 v9, s[8:11], s44 offen lds
  s_add_u32 m0, s47, 15360
  s_nop 0
  buffer_load_dwordx4 v10, s[8:11], s44 offen lds
  s_add_u32 m0, s43, 24576
  s_add_u32 s44, s56, 0
  buffer_load_dwordx4 v8, s[12:15], s44 offen lds
  s_add_u32 m0, s43, 28672
  s_add_u32 s44, s56, 55296
  buffer_load_dwordx4 v8, s[12:15], s44 offen lds
  s_add_u32 m0, s43, 32768
  s_add_u32 s44, s56, 110592
  buffer_load_dwordx4 v8, s[12:15], s44 offen lds
  s_add_u32 m0, s43, 36864
  s_add_u32 s44, s56, 165888
  buffer_load_dwordx4 v8, s[12:15], s44 offen lds
  s_add_u32 m0, s43, 40960
  s_add_u32 s44, s56, 221184
  buffer_load_dwordx4 v8, s[12:15], s44 offen lds
  s_add_u32 m0, s43, 45056
  s_add_u32 s44, s56, 276480
  buffer_load_dwordx4 v8, s[12:15], s44 offen lds
  s_add_u32 s56, s56, 331776
  s_mov_b32 s20, s66
  s_and_b32 s21, s67, 0xffff
  s_mov_b32 s22, 1152
  s_mov_b32 s23, 0x00020000
  s_and_b32 s44, s36, 1
  s_lshl_b32 s44, s44, 10
  v_lshlrev_b32 v4, 4, v1
  v_add_u32 v4, s44, v4
  s_add_u32 m0, s44, 148480
  s_nop 0
  buffer_load_dwordx4 v4, s[20:23], 0 offen lds
  s_mov_b32 s16, s64
  s_and_b32 s17, s65, 0xffff
  s_mov_b32 s18, 20736
  s_mov_b32 s19, 0x00020000
  s_mov_b32 s24, s70
  s_and_b32 s25, s71, 0xffff
  s_mov_b32 s26, 21233664
  s_mov_b32 s27, 0x00020000
  s_add_u32 s28, s70, 21233664
  s_addc_u32 s29, s71, 0
  s_and_b32 s29, s29, 0xffff
  s_mov_b32 s30, 217088
  s_mov_b32 s31, 0x00020000
  s_mov_b32 s50, s68
  s_mov_b32 s51, s69
  s_mov_b32 s58, 0x3fb8aa3b
  s_mov_b32 s59, 0x3fb8aa3b
  s_lshl_b32 s44, s34, 3
  s_add_u32 s44, s44, s32
  s_mul_i32 s44, s44, 3392
  v_lshlrev_b32 v4, 4, v0
  v_mov_b32 v244, 0
  v_mov_b32 v245, 0
  v_mov_b32 v246, 0
  v_mov_b32 v247, 0
  v_mov_b32 v5, 0x7f000000
  v_cmp_gt_u32 vcc, 212, v0
  s_nop 1
  v_cndmask_b32 v4, v5, v4, vcc
  buffer_store_dwordx4 v[244:247], v4, s[28:31], s44 offen sc0 sc1
  v_bfe_u32 v4, v1, 2, 2
  v_and_b32 v5, 1, v2
  v_lshl_add_u32 v5, v5, 2, v4
  v_lshlrev_b32 v5, 1, v5
  v_lshl_add_u32 v4, v2, 3, v4
  v_lshlrev_b32 v4, 8, v4
  v_and_b32 v6, 3, v1
  v_lshlrev_b32 v6, 3, v6
  v_mov_b32 v7, 0x03020100
  v_lshrrev_b32 v7, v6, v7
  v_and_b32 v7, 0xff, v7
  v_lshrrev_b32 v15, 1, v7
  v_xor_b32 v15, v15, v5
  v_lshl_add_u32 v15, v15, 4, v4
  v_and_b32 v7, 1, v7
  v_lshl_add_u32 v15, v7, 3, v15
  v_add_u32 v22, 49152, v15
  v_mov_b32 v7, 0x07060504
  v_lshrrev_b32 v7, v6, v7
  v_and_b32 v7, 0xff, v7
  v_lshrrev_b32 v16, 1, v7
  v_xor_b32 v16, v16, v5
  v_lshl_add_u32 v16, v16, 4, v4
  v_and_b32 v7, 1, v7
  v_lshl_add_u32 v16, v7, 3, v16
  v_add_u32 v23, 49152, v16
  v_mov_b32 v7, 0x16151408
  v_lshrrev_b32 v7, v6, v7
  v_and_b32 v7, 0xff, v7
  v_lshrrev_b32 v17, 1, v7
  v_xor_b32 v17, v17, v5
  v_lshl_add_u32 v17, v17, 4, v4
  v_and_b32 v7, 1, v7
  v_lshl_add_u32 v17, v7, 3, v17
  v_add_u32 v24, 49152, v17
  v_mov_b32 v7, 0x0d0c0b0a
  v_lshrrev_b32 v7, v6, v7
  v_and_b32 v7, 0xff, v7
  v_lshrrev_b32 v18, 1, v7
  v_xor_b32 v18, v18, v5
  v_lshl_add_u32 v18, v18, 4, v4
  v_and_b32 v7, 1, v7
  v_lshl_add_u32 v18, v7, 3, v18
  v_add_u32 v25, 49152, v18
  v_mov_b32 v7, 0x11100f0e
  v_lshrrev_b32 v7, v6, v7
  v_and_b32 v7, 0xff, v7
  v_lshrrev_b32 v19, 1, v7
  v_xor_b32 v19, v19, v5
  v_lshl_add_u32 v19, v19, 4, v4
  v_and_b32 v7, 1, v7
  v_lshl_add_u32 v19, v7, 3, v19
  v_add_u32 v26, 49152, v19
  v_mov_b32 v7, 0x19181712
  v_lshrrev_b32 v7, v6, v7
  v_and_b32 v7, 0xff, v7
  v_lshrrev_b32 v20, 1, v7
  v_xor_b32 v20, v20, v5
  v_lshl_add_u32 v20, v20, 4, v4
  v_and_b32 v7, 1, v7
  v_lshl_add_u32 v20, v7, 3, v20
  v_add_u32 v27, 49152, v20
  v_mov_b32 v7, 0x1c1c1b1a
  v_lshrrev_b32 v7, v6, v7
  v_and_b32 v7, 0xff, v7
  v_lshrrev_b32 v21, 1, v7
  v_xor_b32 v21, v21, v5
  v_lshl_add_u32 v21, v21, 4, v4
  v_and_b32 v7, 1, v7
  v_lshl_add_u32 v21, v7, 3, v21
  v_add_u32 v28, 49152, v21
  v_bfe_u32 v4, v1, 2, 2
  v_lshl_add_u32 v4, v2, 2, v4
  v_and_b32 v6, 3, v1
  v_mul_u32_u24 v33, 96, v4
  v_lshl_add_u32 v33, v6, 3, v33
  v_add_u32 v33, 139264, v33
  s_lshr_b32 s44, s36, 1
  s_and_b32 s45, s36, 1
  s_lshl_b32 s72, s44, 2
  v_add_u32 v5, s72, v6
  s_add_u32 s72, s72, 4
  v_mov_b32 v7, 9
  v_mov_b32 v39, s72
  v_cmp_eq_u32 vcc, 0, v6
  s_nop 1
  v_cndmask_b32 v7, v7, v39, vcc
  s_cmp_eq_u32 s45, 0
  s_cselect_b64 vcc, -1, 0
  s_nop 1
  v_cndmask_b32 v5, v7, v5, vcc
  v_mul_u32_u24 v38, 96, v4
  v_lshl_add_u32 v38, v5, 3, v38
  v_add_u32 v38, 114688, v38
  s_mul_i32 s72, s44, 80
  v_mul_u32_u24 v39, 160, v4
  v_lshl_add_u32 v39, v6, 3, v39
  v_add_u32 v39, s72, v39
  v_add_u32 v39, 73728, v39
  v_mul_u32_u24 v40, 768, v2
  v_lshl_add_u32 v40, v3, 2, v40
  s_mul_i32 s73, s44, 6144
  s_mul_i32 s72, s45, 3072
  s_add_u32 s73, s73, s72
  s_lshl_b32 s72, s36, 6
  v_add_u32 v4, s72, v3
  v_mul_u32_u24 v34, 160, v4
  v_mul_u32_u24 v6, 40, v2
  v_add_u32 v34, v34, v6
  v_add_u32 v34, 73728, v34
  v_mul_u32_u24 v6, 96, v4
  v_add_u32 v6, 114688, v6
  v_add_u32 v7, -1, v2
  v_cmp_eq_u32 vcc, 0, v2
  v_mov_b32 v35, 10
  s_nop 0
  v_cndmask_b32 v7, v7, v35, vcc
  v_lshl_add_u32 v35, v7, 3, v6
  v_add_u32 v7, 2, v2
  v_cmp_eq_u32 vcc, 0, v2
  v_mov_b32 v36, 10
  s_nop 0
  v_cndmask_b32 v7, v7, v36, vcc
  v_lshl_add_u32 v36, v7, 3, v6
  v_add_u32 v7, 6, v2
  v_cmp_eq_u32 vcc, 3, v2
  v_mov_b32 v37, 10
  s_nop 0
  v_cndmask_b32 v7, v7, v37, vcc
  v_lshl_add_u32 v37, v7, 3, v6
  v_lshrrev_b32 v4, 1, v2
  v_and_b32 v5, 1, v2
  v_lshl_add_u32 v6, v4, 1, v3
  v_mul_u32_u24 v41, 192, v6
  v_mul_u32_u24 v6, 6144, v4
  v_add_u32 v41, v41, v6
  v_mul_u32_u24 v6, 80, v5
  v_add_u32 v41, v41, v6
  v_and_b32 v6, 3, v3
  v_lshrrev_b32 v7, 2, v3
  v_cmp_gt_u32 vcc, 2, v6
  s_nop 1
  v_cndmask_b32 v42, v7, v6, vcc
  v_lshl_add_u32 v7, v7, 1, v6
  v_add_u32 v7, 14, v7
  v_mov_b32 v6, 20
  v_cndmask_b32 v7, v7, v6, vcc
  v_cmp_eq_u32 s[74:75], v42, v4
  v_min_u32 v42, 1, v42
  v_mul_u32_u24 v42, 6144, v42
  v_mul_u32_u24 v7, 192, v7
  v_add_u32 v42, v42, v7
  v_mul_u32_u24 v6, 80, v5
  v_add_u32 v42, v42, v6
  v_cmp_gt_u32 s[76:77], 2, v2
  v_cmp_eq_u32 s[78:79], 1, v2
  v_lshlrev_b32 v44, 4, v3
  v_lshl_add_u32 v44, v2, 2, v44
  v_lshlrev_b32 v4, 1, v0
  global_load_ushort v45, v4, s[52:53] offset:0
  global_load_ushort v46, v4, s[52:53] offset:512
  global_load_ushort v47, v4, s[52:53] offset:1024
  s_mul_i32 s44, s32, 2592
  v_lshlrev_b32 v5, 1, v0
  v_mov_b32 v7, 0x7f000000
  v_cmp_gt_u32 vcc, 136, v0
  v_add_u32 v6, 1024, v5
  s_nop 0
  v_cndmask_b32 v6, v7, v6, vcc
  buffer_load_ushort v248, v5, s[16:19], s44 offen
  buffer_load_ushort v249, v5, s[16:19], s44 offen offset:512
  buffer_load_ushort v250, v6, s[16:19], s44 offen
  s_add_u32 s44, s44, 1296
  buffer_load_ushort v251, v5, s[16:19], s44 offen
  buffer_load_ushort v252, v5, s[16:19], s44 offen offset:512
  buffer_load_ushort v253, v6, s[16:19], s44 offen
  v_mul_u32_u24 v7, 36, v0
  v_add_u32 v7, 139264, v7
  ds_write_b32 v7, v244 offset:0
  ds_write_b32 v7, v244 offset:4
  ds_write_b32 v7, v244 offset:8
  ds_write_b32 v7, v244 offset:12
  ds_write_b32 v7, v244 offset:16
  ds_write_b32 v7, v244 offset:20
  ds_write_b32 v7, v244 offset:24
  ds_write_b32 v7, v244 offset:28
  ds_write_b32 v7, v244 offset:32
  s_waitcnt vmcnt(33)
  ds_read_b128 a[0:3], v11 offset:0
  ds_read_b128 a[16:19], v12 offset:0
  ds_read_b128 a[4:7], v11 offset:2048
  ds_read_b128 a[20:23], v12 offset:2048
  ds_read_b128 a[8:11], v11 offset:4096
  ds_read_b128 a[24:27], v12 offset:4096
  ds_read_b128 a[12:15], v11 offset:6144
  ds_read_b128 a[28:31], v12 offset:6144
  s_waitcnt vmcnt(27)
  s_barrier
  ds_read_b64_tr_b16 v[48:49], v15 offset:0
  ds_read_b64_tr_b16 v[50:51], v15 offset:1024
  ds_read_b64_tr_b16 v[52:53], v16 offset:0
  ds_read_b64_tr_b16 v[54:55], v16 offset:1024
  ds_read_b64_tr_b16 v[56:57], v17 offset:0
  ds_read_b64_tr_b16 v[58:59], v17 offset:1024
  s_mov_b32 s46, 0
  s_waitcnt vmcnt(21)
  s_waitcnt lgkmcnt(4)
  v_mfma_f32_16x16x32_bf16 v[76:79], v[48:51], a[0:3], 0
  ds_read_b64_tr_b16 v[60:61], v18 offset:0
  ds_read_b64_tr_b16 v[62:63], v18 offset:1024
  v_mfma_f32_16x16x32_bf16 v[80:83], v[48:51], a[4:7], 0
  ds_read_b128 a[32:35], v11 offset:8192
  ds_read_b128 a[48:51], v12 offset:8192
  v_mfma_f32_16x16x32_bf16 v[84:87], v[48:51], a[8:11], 0
  ds_read_b128 a[36:39], v11 offset:10240
  v_mfma_f32_16x16x32_bf16 v[88:91], v[48:51], a[12:15], 0
  ds_read_b128 a[52:55], v12 offset:10240
  s_waitcnt lgkmcnt(4)
  v_mfma_f32_16x16x32_bf16 v[92:95], v[52:55], a[0:3], 0
  ds_read_b64_tr_b16 v[64:65], v19 offset:0
  ds_read_b64_tr_b16 v[66:67], v19 offset:1024
  v_mfma_f32_16x16x32_bf16 v[96:99], v[52:55], a[4:7], 0
  s_add_u32 m0, s47, 0
  s_add_u32 s44, s38, 256
  v_mfma_f32_16x16x32_bf16 v[100:103], v[52:55], a[8:11], 0
  buffer_load_dwordx4 v9, s[8:11], s44 offen lds
  s_add_u32 m0, s47, 1024
  v_mfma_f32_16x16x32_bf16 v[104:107], v[52:55], a[12:15], 0
  s_nop 0
  buffer_load_dwordx4 v10, s[8:11], s44 offen lds
  s_waitcnt lgkmcnt(4)
  v_mfma_f32_16x16x32_bf16 v[108:111], v[56:59], a[0:3], 0
  ds_read_b64_tr_b16 v[68:69], v20 offset:0
  ds_read_b64_tr_b16 v[70:71], v20 offset:1024
  v_mfma_f32_16x16x32_bf16 v[112:115], v[56:59], a[4:7], 0
  s_add_u32 m0, s47, 2048
  s_add_u32 s44, s39, 256
  v_mfma_f32_16x16x32_bf16 v[116:119], v[56:59], a[8:11], 0
  buffer_load_dwordx4 v9, s[8:11], s44 offen lds
  s_add_u32 m0, s47, 3072
  v_mfma_f32_16x16x32_bf16 v[120:123], v[56:59], a[12:15], 0
  s_nop 0
  buffer_load_dwordx4 v10, s[8:11], s44 offen lds
  s_waitcnt lgkmcnt(4)
  v_mfma_f32_16x16x32_bf16 v[124:127], v[60:63], a[0:3], 0
  ds_read_b64_tr_b16 v[72:73], v21 offset:0
  ds_read_b64_tr_b16 v[74:75], v21 offset:1024
  v_mfma_f32_16x16x32_bf16 v[128:131], v[60:63], a[4:7], 0
  s_add_u32 m0, s47, 4096
  s_add_u32 s44, s40, 256
  v_mfma_f32_16x16x32_bf16 v[132:135], v[60:63], a[8:11], 0
  buffer_load_dwordx4 v9, s[8:11], s44 offen lds
  s_add_u32 m0, s47, 5120
  v_mfma_f32_16x16x32_bf16 v[136:139], v[60:63], a[12:15], 0
  s_nop 0
  buffer_load_dwordx4 v10, s[8:11], s44 offen lds
  s_waitcnt lgkmcnt(4)
  v_mfma_f32_16x16x32_bf16 v[140:143], v[64:67], a[0:3], 0
  ds_read_b64_tr_b16 v[48:49], v15 offset:8192
  ds_read_b64_tr_b16 v[50:51], v15 offset:9216
  v_mfma_f32_16x16x32_bf16 v[144:147], v[64:67], a[4:7], 0
  s_add_u32 m0, s47, 6144
  s_add_u32 s44, s41, 256
  v_mfma_f32_16x16x32_bf16 v[148:151], v[64:67], a[8:11], 0
  buffer_load_dwordx4 v9, s[8:11], s44 offen lds
  s_add_u32 m0, s47, 7168
  v_mfma_f32_16x16x32_bf16 v[152:155], v[64:67], a[12:15], 0
  s_nop 0
  s_waitcnt lgkmcnt(4)
  v_mfma_f32_16x16x32_bf16 v[156:159], v[68:71], a[0:3], 0
  ds_read_b64_tr_b16 v[52:53], v16 offset:8192
  ds_read_b64_tr_b16 v[54:55], v16 offset:9216
  v_mfma_f32_16x16x32_bf16 v[160:163], v[68:71], a[4:7], 0
  buffer_load_dwordx4 v10, s[8:11], s44 offen lds
  s_add_u32 m0, s43, 49152
  v_mfma_f32_16x16x32_bf16 v[164:167], v[68:71], a[8:11], 0
  s_add_u32 s44, s56, 0
  buffer_load_dwordx4 v8, s[12:15], s44 offen lds
  v_mfma_f32_16x16x32_bf16 v[168:171], v[68:71], a[12:15], 0
  s_add_u32 m0, s43, 53248
  s_waitcnt lgkmcnt(4)
  v_mfma_f32_16x16x32_bf16 v[172:175], v[72:75], a[0:3], 0
  ds_read_b64_tr_b16 v[56:57], v17 offset:8192
  ds_read_b64_tr_b16 v[58:59], v17 offset:9216
  v_mfma_f32_16x16x32_bf16 v[176:179], v[72:75], a[4:7], 0
  s_add_u32 s44, s56, 55296
  buffer_load_dwordx4 v8, s[12:15], s44 offen lds
  v_mfma_f32_16x16x32_bf16 v[180:183], v[72:75], a[8:11], 0
  s_add_u32 m0, s43, 57344
  s_add_u32 s44, s56, 110592
  v_mfma_f32_16x16x32_bf16 v[184:187], v[72:75], a[12:15], 0
  buffer_load_dwordx4 v8, s[12:15], s44 offen lds
  s_waitcnt vmcnt(28)
  s_waitcnt lgkmcnt(4)
  v_mfma_f32_16x16x32_bf16 v[76:79], v[48:51], a[16:19], v[76:79]
  ds_read_b64_tr_b16 v[60:61], v18 offset:8192
  ds_read_b64_tr_b16 v[62:63], v18 offset:9216
  v_mfma_f32_16x16x32_bf16 v[80:83], v[48:51], a[20:23], v[80:83]
  ds_read_b128 a[40:43], v11 offset:12288
  ds_read_b128 a[56:59], v12 offset:12288
  v_mfma_f32_16x16x32_bf16 v[84:87], v[48:51], a[24:27], v[84:87]
  ds_read_b128 a[44:47], v11 offset:14336
  v_mfma_f32_16x16x32_bf16 v[88:91], v[48:51], a[28:31], v[88:91]
  ds_read_b128 a[60:63], v12 offset:14336
  s_waitcnt lgkmcnt(4)
  v_mfma_f32_16x16x32_bf16 v[92:95], v[52:55], a[16:19], v[92:95]
  ds_read_b64_tr_b16 v[64:65], v19 offset:8192
  ds_read_b64_tr_b16 v[66:67], v19 offset:9216
  v_mfma_f32_16x16x32_bf16 v[96:99], v[52:55], a[20:23], v[96:99]
  s_add_u32 m0, s47, 8192
  s_add_u32 s44, s38, 384
  v_mfma_f32_16x16x32_bf16 v[100:103], v[52:55], a[24:27], v[100:103]
  buffer_load_dwordx4 v9, s[8:11], s44 offen lds
  v_mfma_f32_16x16x32_bf16 v[104:107], v[52:55], a[28:31], v[104:107]
  s_add_u32 m0, s47, 9216
  s_waitcnt lgkmcnt(4)
  v_mfma_f32_16x16x32_bf16 v[108:111], v[56:59], a[16:19], v[108:111]
  ds_read_b64_tr_b16 v[68:69], v20 offset:8192
  ds_read_b64_tr_b16 v[70:71], v20 offset:9216
  v_mfma_f32_16x16x32_bf16 v[112:115], v[56:59], a[20:23], v[112:115]
  s_nop 0
  buffer_load_dwordx4 v10, s[8:11], s44 offen lds
  v_mfma_f32_16x16x32_bf16 v[116:119], v[56:59], a[24:27], v[116:119]
  s_add_u32 m0, s47, 10240
  v_mfma_f32_16x16x32_bf16 v[120:123], v[56:59], a[28:31], v[120:123]
  s_add_u32 s44, s39, 384
  s_waitcnt lgkmcnt(4)
  v_mfma_f32_16x16x32_bf16 v[124:127], v[60:63], a[16:19], v[124:127]
  ds_read_b64_tr_b16 v[72:73], v21 offset:8192
  ds_read_b64_tr_b16 v[74:75], v21 offset:9216
  v_mfma_f32_16x16x32_bf16 v[128:131], v[60:63], a[20:23], v[128:131]
  buffer_load_dwordx4 v9, s[8:11], s44 offen lds
  s_add_u32 m0, s47, 11264
  v_mfma_f32_16x16x32_bf16 v[132:135], v[60:63], a[24:27], v[132:135]
  s_nop 0
  v_mfma_f32_16x16x32_bf16 v[136:139], v[60:63], a[28:31], v[136:139]
  buffer_load_dwordx4 v10, s[8:11], s44 offen lds
  s_waitcnt lgkmcnt(4)
  v_mfma_f32_16x16x32_bf16 v[140:143], v[64:67], a[16:19], v[140:143]
  ds_read_b64_tr_b16 v[48:49], v15 offset:16384
  ds_read_b64_tr_b16 v[50:51], v15 offset:17408
  v_mfma_f32_16x16x32_bf16 v[144:147], v[64:67], a[20:23], v[144:147]
  s_add_u32 m0, s43, 61440
  s_add_u32 s44, s56, 165888
  v_mfma_f32_16x16x32_bf16 v[148:151], v[64:67], a[24:27], v[148:151]
  buffer_load_dwordx4 v8, s[12:15], s44 offen lds
  v_mfma_f32_16x16x32_bf16 v[152:155], v[64:67], a[28:31], v[152:155]
  s_add_u32 m0, s43, 65536
  s_waitcnt lgkmcnt(4)
  v_mfma_f32_16x16x32_bf16 v[156:159], v[68:71], a[16:19], v[156:159]
  ds_read_b64_tr_b16 v[52:53], v16 offset:16384
  ds_read_b64_tr_b16 v[54:55], v16 offset:17408
  v_mfma_f32_16x16x32_bf16 v[160:163], v[68:71], a[20:23], v[160:163]
  s_add_u32 s44, s56, 221184
  v_mfma_f32_16x16x32_bf16 v[164:167], v[68:71], a[24:27], v[164:167]
  buffer_load_dwordx4 v8, s[12:15], s44 offen lds
  v_mfma_f32_16x16x32_bf16 v[168:171], v[68:71], a[28:31], v[168:171]
  s_add_u32 m0, s43, 69632
  s_waitcnt lgkmcnt(4)
  v_mfma_f32_16x16x32_bf16 v[172:175], v[72:75], a[16:19], v[172:175]
  ds_read_b64_tr_b16 v[56:57], v17 offset:16384
  ds_read_b64_tr_b16 v[58:59], v17 offset:17408
  v_mfma_f32_16x16x32_bf16 v[176:179], v[72:75], a[20:23], v[176:179]
  s_add_u32 s44, s56, 276480
  v_mfma_f32_16x16x32_bf16 v[180:183], v[72:75], a[24:27], v[180:183]
  buffer_load_dwordx4 v8, s[12:15], s44 offen lds
  v_mfma_f32_16x16x32_bf16 v[184:187], v[72:75], a[28:31], v[184:187]
  s_add_u32 s56, s56, 331776
  s_waitcnt vmcnt(14)
  s_waitcnt lgkmcnt(4)
  v_mfma_f32_16x16x32_bf16 v[76:79], v[48:51], a[32:35], v[76:79]
  ds_read_b64_tr_b16 v[60:61], v18 offset:16384
  ds_read_b64_tr_b16 v[62:63], v18 offset:17408
  v_mfma_f32_16x16x32_bf16 v[80:83], v[48:51], a[36:39], v[80:83]
  ds_read_b128 a[64:67], v11 offset:0
  ds_read_b128 a[80:83], v12 offset:0
  v_mfma_f32_16x16x32_bf16 v[84:87], v[48:51], a[40:43], v[84:87]
  ds_read_b128 a[68:71], v11 offset:2048
  v_mfma_f32_16x16x32_bf16 v[88:91], v[48:51], a[44:47], v[88:91]
  ds_read_b128 a[84:87], v12 offset:2048
  s_waitcnt lgkmcnt(4)
  v_mfma_f32_16x16x32_bf16 v[92:95], v[52:55], a[32:35], v[92:95]
  ds_read_b64_tr_b16 v[64:65], v19 offset:16384
  v_mfma_f32_16x16x32_bf16 v[96:99], v[52:55], a[36:39], v[96:99]
  ds_read_b64_tr_b16 v[66:67], v19 offset:17408
  v_mfma_f32_16x16x32_bf16 v[100:103], v[52:55], a[40:43], v[100:103]
  s_add_u32 m0, s47, 12288
  v_mfma_f32_16x16x32_bf16 v[104:107], v[52:55], a[44:47], v[104:107]
  s_add_u32 s44, s40, 384
  s_waitcnt lgkmcnt(4)
  v_mfma_f32_16x16x32_bf16 v[108:111], v[56:59], a[32:35], v[108:111]
  ds_read_b64_tr_b16 v[68:69], v20 offset:16384
  v_mfma_f32_16x16x32_bf16 v[112:115], v[56:59], a[36:39], v[112:115]
  ds_read_b64_tr_b16 v[70:71], v20 offset:17408
  v_mfma_f32_16x16x32_bf16 v[116:119], v[56:59], a[40:43], v[116:119]
  buffer_load_dwordx4 v9, s[8:11], s44 offen lds
  v_mfma_f32_16x16x32_bf16 v[120:123], v[56:59], a[44:47], v[120:123]
  s_add_u32 m0, s47, 13312
  s_waitcnt lgkmcnt(4)
  v_mfma_f32_16x16x32_bf16 v[124:127], v[60:63], a[32:35], v[124:127]
  ds_read_b64_tr_b16 v[72:73], v21 offset:16384
  v_mfma_f32_16x16x32_bf16 v[128:131], v[60:63], a[36:39], v[128:131]
  ds_read_b64_tr_b16 v[74:75], v21 offset:17408
  v_mfma_f32_16x16x32_bf16 v[132:135], v[60:63], a[40:43], v[132:135]
  s_nop 0
  v_mfma_f32_16x16x32_bf16 v[136:139], v[60:63], a[44:47], v[136:139]
  buffer_load_dwordx4 v10, s[8:11], s44 offen lds
  s_waitcnt vmcnt(31)
  s_barrier
  s_waitcnt lgkmcnt(4)
  v_mfma_f32_16x16x32_bf16 v[140:143], v[64:67], a[32:35], v[140:143]
  ds_read_b64_tr_b16 v[48:49], v15 offset:24576
  v_mfma_f32_16x16x32_bf16 v[144:147], v[64:67], a[36:39], v[144:147]
  ds_read_b64_tr_b16 v[50:51], v15 offset:25600
  v_mfma_f32_16x16x32_bf16 v[148:151], v[64:67], a[40:43], v[148:151]
  s_add_u32 m0, s47, 14336
  v_mfma_f32_16x16x32_bf16 v[152:155], v[64:67], a[44:47], v[152:155]
  s_add_u32 s44, s41, 384
  s_waitcnt lgkmcnt(4)
  v_mfma_f32_16x16x32_bf16 v[156:159], v[68:71], a[32:35], v[156:159]
  ds_read_b64_tr_b16 v[52:53], v16 offset:24576
  v_mfma_f32_16x16x32_bf16 v[160:163], v[68:71], a[36:39], v[160:163]
  ds_read_b64_tr_b16 v[54:55], v16 offset:25600
  v_mfma_f32_16x16x32_bf16 v[164:167], v[68:71], a[40:43], v[164:167]
  buffer_load_dwordx4 v9, s[8:11], s44 offen lds
  v_mfma_f32_16x16x32_bf16 v[168:171], v[68:71], a[44:47], v[168:171]
  s_add_u32 m0, s47, 15360
  s_waitcnt lgkmcnt(4)
  v_mfma_f32_16x16x32_bf16 v[172:175], v[72:75], a[32:35], v[172:175]
  ds_read_b64_tr_b16 v[56:57], v17 offset:24576
  v_mfma_f32_16x16x32_bf16 v[176:179], v[72:75], a[36:39], v[176:179]
  ds_read_b64_tr_b16 v[58:59], v17 offset:25600
  v_mfma_f32_16x16x32_bf16 v[180:183], v[72:75], a[40:43], v[180:183]
  s_nop 0
  v_mfma_f32_16x16x32_bf16 v[184:187], v[72:75], a[44:47], v[184:187]
  buffer_load_dwordx4 v10, s[8:11], s44 offen lds
  s_waitcnt vmcnt(14)
  s_waitcnt lgkmcnt(4)
  v_mfma_f32_16x16x32_bf16 v[76:79], v[48:51], a[48:51], v[76:79]
  ds_read_b64_tr_b16 v[60:61], v18 offset:24576
  ds_read_b64_tr_b16 v[62:63], v18 offset:25600
  v_mfma_f32_16x16x32_bf16 v[80:83], v[48:51], a[52:55], v[80:83]
  ds_read_b128 a[72:75], v11 offset:4096
  ds_read_b128 a[88:91], v12 offset:4096
  v_mfma_f32_16x16x32_bf16 v[84:87], v[48:51], a[56:59], v[84:87]
  ds_read_b128 a[76:79], v11 offset:6144
  v_mfma_f32_16x16x32_bf16 v[88:91], v[48:51], a[60:63], v[88:91]
  ds_read_b128 a[92:95], v12 offset:6144
  s_waitcnt lgkmcnt(4)
  v_mfma_f32_16x16x32_bf16 v[92:95], v[52:55], a[48:51], v[92:95]
  ds_read_b64_tr_b16 v[64:65], v19 offset:24576
  ds_read_b64_tr_b16 v[66:67], v19 offset:25600
  v_mfma_f32_16x16x32_bf16 v[96:99], v[52:55], a[52:55], v[96:99]
  s_add_u32 m0, s47, 0
  s_add_u32 s44, s38, 512
  v_mfma_f32_16x16x32_bf16 v[100:103], v[52:55], a[56:59], v[100:103]
  buffer_load_dwordx4 v9, s[8:11], s44 offen lds
  v_mfma_f32_16x16x32_bf16 v[104:107], v[52:55], a[60:63], v[104:107]
  s_add_u32 m0, s47, 1024
  s_waitcnt lgkmcnt(4)
  v_mfma_f32_16x16x32_bf16 v[108:111], v[56:59], a[48:51], v[108:111]
  ds_read_b64_tr_b16 v[68:69], v20 offset:24576
  ds_read_b64_tr_b16 v[70:71], v20 offset:25600
  v_mfma_f32_16x16x32_bf16 v[112:115], v[56:59], a[52:55], v[112:115]
  s_nop 0
  buffer_load_dwordx4 v10, s[8:11], s44 offen lds
  v_mfma_f32_16x16x32_bf16 v[116:119], v[56:59], a[56:59], v[116:119]
  s_add_u32 m0, s47, 2048
  v_mfma_f32_16x16x32_bf16 v[120:123], v[56:59], a[60:63], v[120:123]
  s_add_u32 s44, s39, 512
  s_waitcnt lgkmcnt(4)
  v_mfma_f32_16x16x32_bf16 v[124:127], v[60:63], a[48:51], v[124:127]
  ds_read_b64_tr_b16 v[72:73], v21 offset:24576
  ds_read_b64_tr_b16 v[74:75], v21 offset:25600
  v_mfma_f32_16x16x32_bf16 v[128:131], v[60:63], a[52:55], v[128:131]
  buffer_load_dwordx4 v9, s[8:11], s44 offen lds
  s_add_u32 m0, s47, 3072
  v_mfma_f32_16x16x32_bf16 v[132:135], v[60:63], a[56:59], v[132:135]
  s_nop 0
  v_mfma_f32_16x16x32_bf16 v[136:139], v[60:63], a[60:63], v[136:139]
  buffer_load_dwordx4 v10, s[8:11], s44 offen lds
  s_waitcnt lgkmcnt(4)
  v_mfma_f32_16x16x32_bf16 v[140:143], v[64:67], a[48:51], v[140:143]
  ds_read_b64_tr_b16 v[48:49], v15 offset:32768
  ds_read_b64_tr_b16 v[50:51], v15 offset:33792
  v_mfma_f32_16x16x32_bf16 v[144:147], v[64:67], a[52:55], v[144:147]
  s_add_u32 m0, s43, 0
  v_mfma_f32_16x16x32_bf16 v[148:151], v[64:67], a[56:59], v[148:151]
  s_add_u32 s44, s56, 0
  v_mfma_f32_16x16x32_bf16 v[152:155], v[64:67], a[60:63], v[152:155]
  buffer_load_dwordx4 v8, s[12:15], s44 offen lds
  s_waitcnt lgkmcnt(4)
  v_mfma_f32_16x16x32_bf16 v[156:159], v[68:71], a[48:51], v[156:159]
  ds_read_b64_tr_b16 v[52:53], v16 offset:32768
  ds_read_b64_tr_b16 v[54:55], v16 offset:33792
  v_mfma_f32_16x16x32_bf16 v[160:163], v[68:71], a[52:55], v[160:163]
  s_add_u32 m0, s43, 4096
  v_mfma_f32_16x16x32_bf16 v[164:167], v[68:71], a[56:59], v[164:167]
  s_add_u32 s44, s56, 55296
  v_mfma_f32_16x16x32_bf16 v[168:171], v[68:71], a[60:63], v[168:171]
  buffer_load_dwordx4 v8, s[12:15], s44 offen lds
  s_waitcnt lgkmcnt(4)
  v_mfma_f32_16x16x32_bf16 v[172:175], v[72:75], a[48:51], v[172:175]
  ds_read_b64_tr_b16 v[56:57], v17 offset:32768
  ds_read_b64_tr_b16 v[58:59], v17 offset:33792
  v_mfma_f32_16x16x32_bf16 v[176:179], v[72:75], a[52:55], v[176:179]
  s_add_u32 m0, s43, 8192
  v_mfma_f32_16x16x32_bf16 v[180:183], v[72:75], a[56:59], v[180:183]
  s_add_u32 s44, s56, 110592
  v_mfma_f32_16x16x32_bf16 v[184:187], v[72:75], a[60:63], v[184:187]
  buffer_load_dwordx4 v8, s[12:15], s44 offen lds
  s_waitcnt vmcnt(14)
  s_waitcnt lgkmcnt(4)
  v_mfma_f32_16x16x32_bf16 v[76:79], v[48:51], a[64:67], v[76:79]
  ds_read_b64_tr_b16 v[60:61], v18 offset:32768
  ds_read_b64_tr_b16 v[62:63], v18 offset:33792
  v_mfma_f32_16x16x32_bf16 v[80:83], v[48:51], a[68:71], v[80:83]
  ds_read_b128 a[96:99], v11 offset:8192
  ds_read_b128 a[112:115], v12 offset:8192
  v_mfma_f32_16x16x32_bf16 v[84:87], v[48:51], a[72:75], v[84:87]
  ds_read_b128 a[100:103], v11 offset:10240
  v_mfma_f32_16x16x32_bf16 v[88:91], v[48:51], a[76:79], v[88:91]
  ds_read_b128 a[116:119], v12 offset:10240
  s_waitcnt lgkmcnt(4)
  v_mfma_f32_16x16x32_bf16 v[92:95], v[52:55], a[64:67], v[92:95]
  ds_read_b64_tr_b16 v[64:65], v19 offset:32768
  ds_read_b64_tr_b16 v[66:67], v19 offset:33792
  v_mfma_f32_16x16x32_bf16 v[96:99], v[52:55], a[68:71], v[96:99]
  s_add_u32 m0, s47, 4096
  s_add_u32 s44, s40, 512
  v_mfma_f32_16x16x32_bf16 v[100:103], v[52:55], a[72:75], v[100:103]
  buffer_load_dwordx4 v9, s[8:11], s44 offen lds
  v_mfma_f32_16x16x32_bf16 v[104:107], v[52:55], a[76:79], v[104:107]
  s_add_u32 m0, s47, 5120
  s_waitcnt lgkmcnt(4)
  v_mfma_f32_16x16x32_bf16 v[108:111], v[56:59], a[64:67], v[108:111]
  ds_read_b64_tr_b16 v[68:69], v20 offset:32768
  ds_read_b64_tr_b16 v[70:71], v20 offset:33792
  v_mfma_f32_16x16x32_bf16 v[112:115], v[56:59], a[68:71], v[112:115]
  s_nop 0
  buffer_load_dwordx4 v10, s[8:11], s44 offen lds
  v_mfma_f32_16x16x32_bf16 v[116:119], v[56:59], a[72:75], v[116:119]
  s_add_u32 m0, s47, 6144
  v_mfma_f32_16x16x32_bf16 v[120:123], v[56:59], a[76:79], v[120:123]
  s_add_u32 s44, s41, 512
  s_waitcnt lgkmcnt(4)
  v_mfma_f32_16x16x32_bf16 v[124:127], v[60:63], a[64:67], v[124:127]
  ds_read_b64_tr_b16 v[72:73], v21 offset:32768
  ds_read_b64_tr_b16 v[74:75], v21 offset:33792
  v_mfma_f32_16x16x32_bf16 v[128:131], v[60:63], a[68:71], v[128:131]
  buffer_load_dwordx4 v9, s[8:11], s44 offen lds
  s_add_u32 m0, s47, 7168
  v_mfma_f32_16x16x32_bf16 v[132:135], v[60:63], a[72:75], v[132:135]
  s_nop 0
  v_mfma_f32_16x16x32_bf16 v[136:139], v[60:63], a[76:79], v[136:139]
  buffer_load_dwordx4 v10, s[8:11], s44 offen lds
  s_waitcnt lgkmcnt(4)
  v_mfma_f32_16x16x32_bf16 v[140:143], v[64:67], a[64:67], v[140:143]
  ds_read_b64_tr_b16 v[48:49], v15 offset:40960
  ds_read_b64_tr_b16 v[50:51], v15 offset:41984
  v_mfma_f32_16x16x32_bf16 v[144:147], v[64:67], a[68:71], v[144:147]
  s_add_u32 m0, s43, 12288
  s_add_u32 s44, s56, 165888
  v_mfma_f32_16x16x32_bf16 v[148:151], v[64:67], a[72:75], v[148:151]
  buffer_load_dwordx4 v8, s[12:15], s44 offen lds
  v_mfma_f32_16x16x32_bf16 v[152:155], v[64:67], a[76:79], v[152:155]
  s_add_u32 m0, s43, 16384
  s_waitcnt lgkmcnt(4)
  v_mfma_f32_16x16x32_bf16 v[156:159], v[68:71], a[64:67], v[156:159]
  ds_read_b64_tr_b16 v[52:53], v16 offset:40960
  ds_read_b64_tr_b16 v[54:55], v16 offset:41984
  v_mfma_f32_16x16x32_bf16 v[160:163], v[68:71], a[68:71], v[160:163]
  s_add_u32 s44, s56, 221184
  v_mfma_f32_16x16x32_bf16 v[164:167], v[68:71], a[72:75], v[164:167]
  buffer_load_dwordx4 v8, s[12:15], s44 offen lds
  v_mfma_f32_16x16x32_bf16 v[168:171], v[68:71], a[76:79], v[168:171]
  s_add_u32 m0, s43, 20480
  s_waitcnt lgkmcnt(4)
  v_mfma_f32_16x16x32_bf16 v[172:175], v[72:75], a[64:67], v[172:175]
  ds_read_b64_tr_b16 v[56:57], v17 offset:40960
  ds_read_b64_tr_b16 v[58:59], v17 offset:41984
  v_mfma_f32_16x16x32_bf16 v[176:179], v[72:75], a[68:71], v[176:179]
  s_add_u32 s44, s56, 276480
  v_mfma_f32_16x16x32_bf16 v[180:183], v[72:75], a[72:75], v[180:183]
  buffer_load_dwordx4 v8, s[12:15], s44 offen lds
  v_mfma_f32_16x16x32_bf16 v[184:187], v[72:75], a[76:79], v[184:187]
  s_add_u32 s56, s56, 331776
  s_waitcnt vmcnt(14)
  s_waitcnt lgkmcnt(4)
  v_mfma_f32_16x16x32_bf16 v[76:79], v[48:51], a[80:83], v[76:79]
  ds_read_b64_tr_b16 v[60:61], v18 offset:40960
  ds_read_b64_tr_b16 v[62:63], v18 offset:41984
  v_mfma_f32_16x16x32_bf16 v[80:83], v[48:51], a[84:87], v[80:83]
  ds_read_b128 a[104:107], v11 offset:12288
  ds_read_b128 a[120:123], v12 offset:12288
  v_mfma_f32_16x16x32_bf16 v[84:87], v[48:51], a[88:91], v[84:87]
  ds_read_b128 a[108:111], v11 offset:14336
  v_mfma_f32_16x16x32_bf16 v[88:91], v[48:51], a[92:95], v[88:91]
  ds_read_b128 a[124:127], v12 offset:14336
  s_waitcnt lgkmcnt(4)
  v_mfma_f32_16x16x32_bf16 v[92:95], v[52:55], a[80:83], v[92:95]
  ds_read_b64_tr_b16 v[64:65], v19 offset:40960
  v_mfma_f32_16x16x32_bf16 v[96:99], v[52:55], a[84:87], v[96:99]
  ds_read_b64_tr_b16 v[66:67], v19 offset:41984
  v_mfma_f32_16x16x32_bf16 v[100:103], v[52:55], a[88:91], v[100:103]
  s_add_u32 m0, s47, 8192
  v_mfma_f32_16x16x32_bf16 v[104:107], v[52:55], a[92:95], v[104:107]
  s_add_u32 s44, s38, 640
  s_waitcnt lgkmcnt(4)
  v_mfma_f32_16x16x32_bf16 v[108:111], v[56:59], a[80:83], v[108:111]
  ds_read_b64_tr_b16 v[68:69], v20 offset:40960
  v_mfma_f32_16x16x32_bf16 v[112:115], v[56:59], a[84:87], v[112:115]
  ds_read_b64_tr_b16 v[70:71], v20 offset:41984
  v_mfma_f32_16x16x32_bf16 v[116:119], v[56:59], a[88:91], v[116:119]
  buffer_load_dwordx4 v9, s[8:11], s44 offen lds
  v_mfma_f32_16x16x32_bf16 v[120:123], v[56:59], a[92:95], v[120:123]
  s_add_u32 m0, s47, 9216
  s_waitcnt lgkmcnt(4)
  v_mfma_f32_16x16x32_bf16 v[124:127], v[60:63], a[80:83], v[124:127]
  ds_read_b64_tr_b16 v[72:73], v21 offset:40960
  v_mfma_f32_16x16x32_bf16 v[128:131], v[60:63], a[84:87], v[128:131]
  ds_read_b64_tr_b16 v[74:75], v21 offset:41984
  v_mfma_f32_16x16x32_bf16 v[132:135], v[60:63], a[88:91], v[132:135]
  s_nop 0
  v_mfma_f32_16x16x32_bf16 v[136:139], v[60:63], a[92:95], v[136:139]
  buffer_load_dwordx4 v10, s[8:11], s44 offen lds
  s_waitcnt vmcnt(20)
  s_barrier
  s_cmp_eq_u32 s36, 0
  s_cbranch_scc0 L_at_nosig0
  v_mov_b32 v4, 0
  v_mov_b32 v5, 1
  s_mov_b64 s[80:81], exec
  s_mov_b64 exec, 1
  global_atomic_add v4, v5, s[50:51]
  s_mov_b64 exec, s[80:81]
L_at_nosig0:
  s_waitcnt lgkmcnt(4)
  v_mfma_f32_16x16x32_bf16 v[140:143], v[64:67], a[80:83], v[140:143]
  ds_read_b64_tr_b16 v[48:49], v22 offset:0
  v_mfma_f32_16x16x32_bf16 v[144:147], v[64:67], a[84:87], v[144:147]
  ds_read_b64_tr_b16 v[50:51], v22 offset:1024
  v_mfma_f32_16x16x32_bf16 v[148:151], v[64:67], a[88:91], v[148:151]
  s_add_u32 m0, s47, 10240
  v_mfma_f32_16x16x32_bf16 v[152:155], v[64:67], a[92:95], v[152:155]
  s_add_u32 s44, s39, 640
  s_waitcnt lgkmcnt(4)
  v_mfma_f32_16x16x32_bf16 v[156:159], v[68:71], a[80:83], v[156:159]
  ds_read_b64_tr_b16 v[52:53], v23 offset:0
  v_mfma_f32_16x16x32_bf16 v[160:163], v[68:71], a[84:87], v[160:163]
  ds_read_b64_tr_b16 v[54:55], v23 offset:1024
  v_mfma_f32_16x16x32_bf16 v[164:167], v[68:71], a[88:91], v[164:167]
  buffer_load_dwordx4 v9, s[8:11], s44 offen lds
  v_mfma_f32_16x16x32_bf16 v[168:171], v[68:71], a[92:95], v[168:171]
  s_add_u32 m0, s47, 11264
  s_waitcnt lgkmcnt(4)
  v_mfma_f32_16x16x32_bf16 v[172:175], v[72:75], a[80:83], v[172:175]
  ds_read_b64_tr_b16 v[56:57], v24 offset:0
  v_mfma_f32_16x16x32_bf16 v[176:179], v[72:75], a[84:87], v[176:179]
  ds_read_b64_tr_b16 v[58:59], v24 offset:1024
  v_mfma_f32_16x16x32_bf16 v[180:183], v[72:75], a[88:91], v[180:183]
  s_nop 0
  v_mfma_f32_16x16x32_bf16 v[184:187], v[72:75], a[92:95], v[184:187]
  buffer_load_dwordx4 v10, s[8:11], s44 offen lds
  s_waitcnt vmcnt(14)
  s_waitcnt lgkmcnt(4)
  v_mfma_f32_16x16x32_bf16 v[76:79], v[48:51], a[96:99], v[76:79]
  ds_read_b64_tr_b16 v[60:61], v25 offset:0
  ds_read_b64_tr_b16 v[62:63], v25 offset:1024
  v_mfma_f32_16x16x32_bf16 v[80:83], v[48:51], a[100:103], v[80:83]
  ds_read_b128 a[128:131], v11 offset:0
  ds_read_b128 a[144:147], v12 offset:0
  v_mfma_f32_16x16x32_bf16 v[84:87], v[48:51], a[104:107], v[84:87]
  ds_read_b128 a[132:135], v11 offset:2048
  v_mfma_f32_16x16x32_bf16 v[88:91], v[48:51], a[108:111], v[88:91]
  ds_read_b128 a[148:151], v12 offset:2048
  s_waitcnt lgkmcnt(4)
  v_mfma_f32_16x16x32_bf16 v[92:95], v[52:55], a[96:99], v[92:95]
  ds_read_b64_tr_b16 v[64:65], v26 offset:0
  ds_read_b64_tr_b16 v[66:67], v26 offset:1024
  v_mfma_f32_16x16x32_bf16 v[96:99], v[52:55], a[100:103], v[96:99]
  s_add_u32 m0, s47, 12288
  s_add_u32 s44, s40, 640
  v_mfma_f32_16x16x32_bf16 v[100:103], v[52:55], a[104:107], v[100:103]
  buffer_load_dwordx4 v9, s[8:11], s44 offen lds
  v_mfma_f32_16x16x32_bf16 v[104:107], v[52:55], a[108:111], v[104:107]
  s_add_u32 m0, s47, 13312
  s_waitcnt lgkmcnt(4)
  v_mfma_f32_16x16x32_bf16 v[108:111], v[56:59], a[96:99], v[108:111]
  ds_read_b64_tr_b16 v[68:69], v27 offset:0
  ds_read_b64_tr_b16 v[70:71], v27 offset:1024
  v_mfma_f32_16x16x32_bf16 v[112:115], v[56:59], a[100:103], v[112:115]
  s_nop 0
  buffer_load_dwordx4 v10, s[8:11], s44 offen lds
  v_mfma_f32_16x16x32_bf16 v[116:119], v[56:59], a[104:107], v[116:119]
  s_add_u32 m0, s47, 14336
  v_mfma_f32_16x16x32_bf16 v[120:123], v[56:59], a[108:111], v[120:123]
  s_add_u32 s44, s41, 640
  s_waitcnt lgkmcnt(4)
  v_mfma_f32_16x16x32_bf16 v[124:127], v[60:63], a[96:99], v[124:127]
  ds_read_b64_tr_b16 v[72:73], v28 offset:0
  ds_read_b64_tr_b16 v[74:75], v28 offset:1024
  v_mfma_f32_16x16x32_bf16 v[128:131], v[60:63], a[100:103], v[128:131]
  buffer_load_dwordx4 v9, s[8:11], s44 offen lds
  s_add_u32 m0, s47, 15360
  v_mfma_f32_16x16x32_bf16 v[132:135], v[60:63], a[104:107], v[132:135]
  s_nop 0
  v_mfma_f32_16x16x32_bf16 v[136:139], v[60:63], a[108:111], v[136:139]
  buffer_load_dwordx4 v10, s[8:11], s44 offen lds
  s_waitcnt lgkmcnt(4)
  v_mfma_f32_16x16x32_bf16 v[140:143], v[64:67], a[96:99], v[140:143]
  ds_read_b64_tr_b16 v[48:49], v22 offset:8192
  ds_read_b64_tr_b16 v[50:51], v22 offset:9216
  v_mfma_f32_16x16x32_bf16 v[144:147], v[64:67], a[100:103], v[144:147]
  s_add_u32 m0, s43, 24576
  v_mfma_f32_16x16x32_bf16 v[148:151], v[64:67], a[104:107], v[148:151]
  s_add_u32 s44, s56, 0
  v_mfma_f32_16x16x32_bf16 v[152:155], v[64:67], a[108:111], v[152:155]
  buffer_load_dwordx4 v8, s[12:15], s44 offen lds
  s_waitcnt lgkmcnt(4)
  v_mfma_f32_16x16x32_bf16 v[156:159], v[68:71], a[96:99], v[156:159]
  ds_read_b64_tr_b16 v[52:53], v23 offset:8192
  ds_read_b64_tr_b16 v[54:55], v23 offset:9216
  v_mfma_f32_16x16x32_bf16 v[160:163], v[68:71], a[100:103], v[160:163]
  s_add_u32 m0, s43, 28672
  v_mfma_f32_16x16x32_bf16 v[164:167], v[68:71], a[104:107], v[164:167]
  s_add_u32 s44, s56, 55296
  v_mfma_f32_16x16x32_bf16 v[168:171], v[68:71], a[108:111], v[168:171]
  buffer_load_dwordx4 v8, s[12:15], s44 offen lds
  s_waitcnt lgkmcnt(4)
  v_mfma_f32_16x16x32_bf16 v[172:175], v[72:75], a[96:99], v[172:175]
  ds_read_b64_tr_b16 v[56:57], v24 offset:8192
  ds_read_b64_tr_b16 v[58:59], v24 offset:9216
  v_mfma_f32_16x16x32_bf16 v[176:179], v[72:75], a[100:103], v[176:179]
  s_add_u32 m0, s43, 32768
  v_mfma_f32_16x16x32_bf16 v[180:183], v[72:75], a[104:107], v[180:183]
  s_add_u32 s44, s56, 110592
  v_mfma_f32_16x16x32_bf16 v[184:187], v[72:75], a[108:111], v[184:187]
  buffer_load_dwordx4 v8, s[12:15], s44 offen lds
  s_waitcnt vmcnt(14)
  s_waitcnt lgkmcnt(4)
  v_mfma_f32_16x16x32_bf16 v[76:79], v[48:51], a[112:115], v[76:79]
  ds_read_b64_tr_b16 v[60:61], v25 offset:8192
  ds_read_b64_tr_b16 v[62:63], v25 offset:9216
  v_mfma_f32_16x16x32_bf16 v[80:83], v[48:51], a[116:119], v[80:83]
  ds_read_b128 a[136:139], v11 offset:4096
  ds_read_b128 a[152:155], v12 offset:4096
  v_mfma_f32_16x16x32_bf16 v[84:87], v[48:51], a[120:123], v[84:87]
  ds_read_b128 a[140:143], v11 offset:6144
  v_mfma_f32_16x16x32_bf16 v[88:91], v[48:51], a[124:127], v[88:91]
  ds_read_b128 a[156:159], v12 offset:6144
  s_waitcnt lgkmcnt(4)
  v_mfma_f32_16x16x32_bf16 v[92:95], v[52:55], a[112:115], v[92:95]
  ds_read_b64_tr_b16 v[64:65], v26 offset:8192
  ds_read_b64_tr_b16 v[66:67], v26 offset:9216
  v_mfma_f32_16x16x32_bf16 v[96:99], v[52:55], a[116:119], v[96:99]
  s_add_u32 m0, s47, 0
  s_add_u32 s44, s38, 768
  v_mfma_f32_16x16x32_bf16 v[100:103], v[52:55], a[120:123], v[100:103]
  buffer_load_dwordx4 v9, s[8:11], s44 offen lds
  v_mfma_f32_16x16x32_bf16 v[104:107], v[52:55], a[124:127], v[104:107]
  s_add_u32 m0, s47, 1024
  s_waitcnt lgkmcnt(4)
  v_mfma_f32_16x16x32_bf16 v[108:111], v[56:59], a[112:115], v[108:111]
  ds_read_b64_tr_b16 v[68:69], v27 offset:8192
  ds_read_b64_tr_b16 v[70:71], v27 offset:9216
  v_mfma_f32_16x16x32_bf16 v[112:115], v[56:59], a[116:119], v[112:115]
  s_nop 0
  buffer_load_dwordx4 v10, s[8:11], s44 offen lds
  v_mfma_f32_16x16x32_bf16 v[116:119], v[56:59], a[120:123], v[116:119]
  s_add_u32 m0, s47, 2048
  v_mfma_f32_16x16x32_bf16 v[120:123], v[56:59], a[124:127], v[120:123]
  s_add_u32 s44, s39, 768
  s_waitcnt lgkmcnt(4)
  v_mfma_f32_16x16x32_bf16 v[124:127], v[60:63], a[112:115], v[124:127]
  ds_read_b64_tr_b16 v[72:73], v28 offset:8192
  ds_read_b64_tr_b16 v[74:75], v28 offset:9216
  v_mfma_f32_16x16x32_bf16 v[128:131], v[60:63], a[116:119], v[128:131]
  buffer_load_dwordx4 v9, s[8:11], s44 offen lds
  s_add_u32 m0, s47, 3072
  v_mfma_f32_16x16x32_bf16 v[132:135], v[60:63], a[120:123], v[132:135]
  s_nop 0
  v_mfma_f32_16x16x32_bf16 v[136:139], v[60:63], a[124:127], v[136:139]
  buffer_load_dwordx4 v10, s[8:11], s44 offen lds
  s_waitcnt lgkmcnt(4)
  v_mfma_f32_16x16x32_bf16 v[140:143], v[64:67], a[112:115], v[140:143]
  ds_read_b64_tr_b16 v[48:49], v22 offset:16384
  ds_read_b64_tr_b16 v[50:51], v22 offset:17408
  v_mfma_f32_16x16x32_bf16 v[144:147], v[64:67], a[116:119], v[144:147]
  s_add_u32 m0, s43, 36864
  s_add_u32 s44, s56, 165888
  v_mfma_f32_16x16x32_bf16 v[148:151], v[64:67], a[120:123], v[148:151]
  buffer_load_dwordx4 v8, s[12:15], s44 offen lds
  v_mfma_f32_16x16x32_bf16 v[152:155], v[64:67], a[124:127], v[152:155]
  s_add_u32 m0, s43, 40960
  s_waitcnt lgkmcnt(4)
  v_mfma_f32_16x16x32_bf16 v[156:159], v[68:71], a[112:115], v[156:159]
  ds_read_b64_tr_b16 v[52:53], v23 offset:16384
  ds_read_b64_tr_b16 v[54:55], v23 offset:17408
  v_mfma_f32_16x16x32_bf16 v[160:163], v[68:71], a[116:119], v[160:163]
  s_add_u32 s44, s56, 221184
  v_mfma_f32_16x16x32_bf16 v[164:167], v[68:71], a[120:123], v[164:167]
  buffer_load_dwordx4 v8, s[12:15], s44 offen lds
  v_mfma_f32_16x16x32_bf16 v[168:171], v[68:71], a[124:127], v[168:171]
  s_add_u32 m0, s43, 45056
  s_waitcnt lgkmcnt(4)
  v_mfma_f32_16x16x32_bf16 v[172:175], v[72:75], a[112:115], v[172:175]
  ds_read_b64_tr_b16 v[56:57], v24 offset:16384
  ds_read_b64_tr_b16 v[58:59], v24 offset:17408
  v_mfma_f32_16x16x32_bf16 v[176:179], v[72:75], a[116:119], v[176:179]
  s_add_u32 s44, s56, 276480
  v_mfma_f32_16x16x32_bf16 v[180:183], v[72:75], a[120:123], v[180:183]
  buffer_load_dwordx4 v8, s[12:15], s44 offen lds
  v_mfma_f32_16x16x32_bf16 v[184:187], v[72:75], a[124:127], v[184:187]
  s_add_u32 s56, s56, 331776
  s_waitcnt vmcnt(14)
  s_waitcnt lgkmcnt(4)
  v_mfma_f32_16x16x32_bf16 v[76:79], v[48:51], a[128:131], v[76:79]
  ds_read_b64_tr_b16 v[60:61], v25 offset:16384
  ds_read_b64_tr_b16 v[62:63], v25 offset:17408
  v_mfma_f32_16x16x32_bf16 v[80:83], v[48:51], a[132:135], v[80:83]
  ds_read_b128 a[160:163], v11 offset:8192
  ds_read_b128 a[176:179], v12 offset:8192
  v_mfma_f32_16x16x32_bf16 v[84:87], v[48:51], a[136:139], v[84:87]
  ds_read_b128 a[164:167], v11 offset:10240
  v_mfma_f32_16x16x32_bf16 v[88:91], v[48:51], a[140:143], v[88:91]
  ds_read_b128 a[180:183], v12 offset:10240
  s_waitcnt lgkmcnt(4)
  v_mfma_f32_16x16x32_bf16 v[92:95], v[52:55], a[128:131], v[92:95]
  ds_read_b64_tr_b16 v[64:65], v26 offset:16384
  v_mfma_f32_16x16x32_bf16 v[96:99], v[52:55], a[132:135], v[96:99]
  ds_read_b64_tr_b16 v[66:67], v26 offset:17408
  v_mfma_f32_16x16x32_bf16 v[100:103], v[52:55], a[136:139], v[100:103]
  s_add_u32 m0, s47, 4096
  v_mfma_f32_16x16x32_bf16 v[104:107], v[52:55], a[140:143], v[104:107]
  s_add_u32 s44, s40, 768
  s_waitcnt lgkmcnt(4)
  v_mfma_f32_16x16x32_bf16 v[108:111], v[56:59], a[128:131], v[108:111]
  ds_read_b64_tr_b16 v[68:69], v27 offset:16384
  v_mfma_f32_16x16x32_bf16 v[112:115], v[56:59], a[132:135], v[112:115]
  ds_read_b64_tr_b16 v[70:71], v27 offset:17408
  v_mfma_f32_16x16x32_bf16 v[116:119], v[56:59], a[136:139], v[116:119]
  buffer_load_dwordx4 v9, s[8:11], s44 offen lds
  v_mfma_f32_16x16x32_bf16 v[120:123], v[56:59], a[140:143], v[120:123]
  s_add_u32 m0, s47, 5120
  s_waitcnt lgkmcnt(4)
  v_mfma_f32_16x16x32_bf16 v[124:127], v[60:63], a[128:131], v[124:127]
  ds_read_b64_tr_b16 v[72:73], v28 offset:16384
  v_mfma_f32_16x16x32_bf16 v[128:131], v[60:63], a[132:135], v[128:131]
  ds_read_b64_tr_b16 v[74:75], v28 offset:17408
  v_mfma_f32_16x16x32_bf16 v[132:135], v[60:63], a[136:139], v[132:135]
  s_nop 0
  v_mfma_f32_16x16x32_bf16 v[136:139], v[60:63], a[140:143], v[136:139]
  buffer_load_dwordx4 v10, s[8:11], s44 offen lds
  s_waitcnt vmcnt(20)
  s_barrier
  s_waitcnt lgkmcnt(4)
  v_mfma_f32_16x16x32_bf16 v[140:143], v[64:67], a[128:131], v[140:143]
  ds_read_b64_tr_b16 v[48:49], v15 offset:0
  v_mfma_f32_16x16x32_bf16 v[144:147], v[64:67], a[132:135], v[144:147]
  ds_read_b64_tr_b16 v[50:51], v15 offset:1024
  v_mfma_f32_16x16x32_bf16 v[148:151], v[64:67], a[136:139], v[148:151]
  s_add_u32 m0, s47, 6144
  v_mfma_f32_16x16x32_bf16 v[152:155], v[64:67], a[140:143], v[152:155]
  s_add_u32 s44, s41, 768
  s_waitcnt lgkmcnt(4)
  v_mfma_f32_16x16x32_bf16 v[156:159], v[68:71], a[128:131], v[156:159]
  ds_read_b64_tr_b16 v[52:53], v16 offset:0
  v_mfma_f32_16x16x32_bf16 v[160:163], v[68:71], a[132:135], v[160:163]
  ds_read_b64_tr_b16 v[54:55], v16 offset:1024
  v_mfma_f32_16x16x32_bf16 v[164:167], v[68:71], a[136:139], v[164:167]
  buffer_load_dwordx4 v9, s[8:11], s44 offen lds
  v_mfma_f32_16x16x32_bf16 v[168:171], v[68:71], a[140:143], v[168:171]
  s_add_u32 m0, s47, 7168
  s_waitcnt lgkmcnt(4)
  v_mfma_f32_16x16x32_bf16 v[172:175], v[72:75], a[128:131], v[172:175]
  ds_read_b64_tr_b16 v[56:57], v17 offset:0
  v_mfma_f32_16x16x32_bf16 v[176:179], v[72:75], a[132:135], v[176:179]
  ds_read_b64_tr_b16 v[58:59], v17 offset:1024
  v_mfma_f32_16x16x32_bf16 v[180:183], v[72:75], a[136:139], v[180:183]
  s_nop 0
  v_mfma_f32_16x16x32_bf16 v[184:187], v[72:75], a[140:143], v[184:187]
  buffer_load_dwordx4 v10, s[8:11], s44 offen lds
  s_waitcnt vmcnt(14)
  s_waitcnt lgkmcnt(4)
  v_mfma_f32_16x16x32_bf16 v[76:79], v[48:51], a[144:147], v[76:79]
  ds_read_b64_tr_b16 v[60:61], v18 offset:0
  ds_read_b64_tr_b16 v[62:63], v18 offset:1024
  v_mfma_f32_16x16x32_bf16 v[80:83], v[48:51], a[148:151], v[80:83]
  ds_read_b128 a[168:171], v11 offset:12288
  ds_read_b128 a[184:187], v12 offset:12288
  v_mfma_f32_16x16x32_bf16 v[84:87], v[48:51], a[152:155], v[84:87]
  ds_read_b128 a[172:175], v11 offset:14336
  v_mfma_f32_16x16x32_bf16 v[88:91], v[48:51], a[156:159], v[88:91]
  ds_read_b128 a[188:191], v12 offset:14336
  s_waitcnt lgkmcnt(4)
  v_mfma_f32_16x16x32_bf16 v[92:95], v[52:55], a[144:147], v[92:95]
  ds_read_b64_tr_b16 v[64:65], v19 offset:0
  ds_read_b64_tr_b16 v[66:67], v19 offset:1024
  v_mfma_f32_16x16x32_bf16 v[96:99], v[52:55], a[148:151], v[96:99]
  s_add_u32 m0, s47, 8192
  s_add_u32 s44, s38, 896
  v_mfma_f32_16x16x32_bf16 v[100:103], v[52:55], a[152:155], v[100:103]
  buffer_load_dwordx4 v9, s[8:11], s44 offen lds
  v_mfma_f32_16x16x32_bf16 v[104:107], v[52:55], a[156:159], v[104:107]
  s_add_u32 m0, s47, 9216
  s_waitcnt lgkmcnt(4)
  v_mfma_f32_16x16x32_bf16 v[108:111], v[56:59], a[144:147], v[108:111]
  ds_read_b64_tr_b16 v[68:69], v20 offset:0
  ds_read_b64_tr_b16 v[70:71], v20 offset:1024
  v_mfma_f32_16x16x32_bf16 v[112:115], v[56:59], a[148:151], v[112:115]
  s_nop 0
  buffer_load_dwordx4 v10, s[8:11], s44 offen lds
  v_mfma_f32_16x16x32_bf16 v[116:119], v[56:59], a[152:155], v[116:119]
  s_add_u32 m0, s47, 10240
  v_mfma_f32_16x16x32_bf16 v[120:123], v[56:59], a[156:159], v[120:123]
  s_add_u32 s44, s39, 896
  s_waitcnt lgkmcnt(4)
  v_mfma_f32_16x16x32_bf16 v[124:127], v[60:63], a[144:147], v[124:127]
  ds_read_b64_tr_b16 v[72:73], v21 offset:0
  ds_read_b64_tr_b16 v[74:75], v21 offset:1024
  v_mfma_f32_16x16x32_bf16 v[128:131], v[60:63], a[148:151], v[128:131]
  buffer_load_dwordx4 v9, s[8:11], s44 offen lds
  s_add_u32 m0, s47, 11264
  v_mfma_f32_16x16x32_bf16 v[132:135], v[60:63], a[152:155], v[132:135]
  s_nop 0
  v_mfma_f32_16x16x32_bf16 v[136:139], v[60:63], a[156:159], v[136:139]
  buffer_load_dwordx4 v10, s[8:11], s44 offen lds
  s_waitcnt lgkmcnt(4)
  v_mfma_f32_16x16x32_bf16 v[140:143], v[64:67], a[144:147], v[140:143]
  ds_read_b64_tr_b16 v[48:49], v15 offset:8192
  ds_read_b64_tr_b16 v[50:51], v15 offset:9216
  v_mfma_f32_16x16x32_bf16 v[144:147], v[64:67], a[148:151], v[144:147]
  s_add_u32 m0, s43, 49152
  v_mfma_f32_16x16x32_bf16 v[148:151], v[64:67], a[152:155], v[148:151]
  s_add_u32 s44, s56, 0
  v_mfma_f32_16x16x32_bf16 v[152:155], v[64:67], a[156:159], v[152:155]
  buffer_load_dwordx4 v8, s[12:15], s44 offen lds
  s_waitcnt lgkmcnt(4)
  v_mfma_f32_16x16x32_bf16 v[156:159], v[68:71], a[144:147], v[156:159]
  ds_read_b64_tr_b16 v[52:53], v16 offset:8192
  ds_read_b64_tr_b16 v[54:55], v16 offset:9216
  v_mfma_f32_16x16x32_bf16 v[160:163], v[68:71], a[148:151], v[160:163]
  s_add_u32 m0, s43, 53248
  v_mfma_f32_16x16x32_bf16 v[164:167], v[68:71], a[152:155], v[164:167]
  s_add_u32 s44, s56, 55296
  v_mfma_f32_16x16x32_bf16 v[168:171], v[68:71], a[156:159], v[168:171]
  buffer_load_dwordx4 v8, s[12:15], s44 offen lds
  s_waitcnt lgkmcnt(4)
  v_mfma_f32_16x16x32_bf16 v[172:175], v[72:75], a[144:147], v[172:175]
  ds_read_b64_tr_b16 v[56:57], v17 offset:8192
  ds_read_b64_tr_b16 v[58:59], v17 offset:9216
  v_mfma_f32_16x16x32_bf16 v[176:179], v[72:75], a[148:151], v[176:179]
  s_add_u32 m0, s43, 57344
  v_mfma_f32_16x16x32_bf16 v[180:183], v[72:75], a[152:155], v[180:183]
  s_add_u32 s44, s56, 110592
  v_mfma_f32_16x16x32_bf16 v[184:187], v[72:75], a[156:159], v[184:187]
  buffer_load_dwordx4 v8, s[12:15], s44 offen lds
  s_waitcnt vmcnt(14)
  s_waitcnt lgkmcnt(4)
  v_mfma_f32_16x16x32_bf16 v[76:79], v[48:51], a[160:163], v[76:79]
  ds_read_b64_tr_b16 v[60:61], v18 offset:8192
  ds_read_b64_tr_b16 v[62:63], v18 offset:9216
  v_mfma_f32_16x16x32_bf16 v[80:83], v[48:51], a[164:167], v[80:83]
  ds_read_b128 a[192:195], v11 offset:0
  ds_read_b128 a[208:211], v12 offset:0
  v_mfma_f32_16x16x32_bf16 v[84:87], v[48:51], a[168:171], v[84:87]
  ds_read_b128 a[196:199], v11 offset:2048
  v_mfma_f32_16x16x32_bf16 v[88:91], v[48:51], a[172:175], v[88:91]
  ds_read_b128 a[212:215], v12 offset:2048
  s_waitcnt lgkmcnt(4)
  v_mfma_f32_16x16x32_bf16 v[92:95], v[52:55], a[160:163], v[92:95]
  ds_read_b64_tr_b16 v[64:65], v19 offset:8192
  ds_read_b64_tr_b16 v[66:67], v19 offset:9216
  v_mfma_f32_16x16x32_bf16 v[96:99], v[52:55], a[164:167], v[96:99]
  s_add_u32 m0, s47, 12288
  s_add_u32 s44, s40, 896
  v_mfma_f32_16x16x32_bf16 v[100:103], v[52:55], a[168:171], v[100:103]
  buffer_load_dwordx4 v9, s[8:11], s44 offen lds
  v_mfma_f32_16x16x32_bf16 v[104:107], v[52:55], a[172:175], v[104:107]
  s_add_u32 m0, s47, 13312
  s_waitcnt lgkmcnt(4)
  v_mfma_f32_16x16x32_bf16 v[108:111], v[56:59], a[160:163], v[108:111]
  ds_read_b64_tr_b16 v[68:69], v20 offset:8192
  ds_read_b64_tr_b16 v[70:71], v20 offset:9216
  v_mfma_f32_16x16x32_bf16 v[112:115], v[56:59], a[164:167], v[112:115]
  s_nop 0
  buffer_load_dwordx4 v10, s[8:11], s44 offen lds
  v_mfma_f32_16x16x32_bf16 v[116:119], v[56:59], a[168:171], v[116:119]
  s_add_u32 m0, s47, 14336
  v_mfma_f32_16x16x32_bf16 v[120:123], v[56:59], a[172:175], v[120:123]
  s_add_u32 s44, s41, 896
  s_waitcnt lgkmcnt(4)
  v_mfma_f32_16x16x32_bf16 v[124:127], v[60:63], a[160:163], v[124:127]
  ds_read_b64_tr_b16 v[72:73], v21 offset:8192
  ds_read_b64_tr_b16 v[74:75], v21 offset:9216
  v_mfma_f32_16x16x32_bf16 v[128:131], v[60:63], a[164:167], v[128:131]
  buffer_load_dwordx4 v9, s[8:11], s44 offen lds
  s_add_u32 m0, s47, 15360
  v_mfma_f32_16x16x32_bf16 v[132:135], v[60:63], a[168:171], v[132:135]
  s_nop 0
  v_mfma_f32_16x16x32_bf16 v[136:139], v[60:63], a[172:175], v[136:139]
  buffer_load_dwordx4 v10, s[8:11], s44 offen lds
  s_waitcnt lgkmcnt(4)
  v_mfma_f32_16x16x32_bf16 v[140:143], v[64:67], a[160:163], v[140:143]
  ds_read_b64_tr_b16 v[48:49], v15 offset:16384
  ds_read_b64_tr_b16 v[50:51], v15 offset:17408
  v_mfma_f32_16x16x32_bf16 v[144:147], v[64:67], a[164:167], v[144:147]
  s_add_u32 m0, s43, 61440
  s_add_u32 s44, s56, 165888
  v_mfma_f32_16x16x32_bf16 v[148:151], v[64:67], a[168:171], v[148:151]
  buffer_load_dwordx4 v8, s[12:15], s44 offen lds
  v_mfma_f32_16x16x32_bf16 v[152:155], v[64:67], a[172:175], v[152:155]
  s_add_u32 m0, s43, 65536
  s_waitcnt lgkmcnt(4)
  v_mfma_f32_16x16x32_bf16 v[156:159], v[68:71], a[160:163], v[156:159]
  ds_read_b64_tr_b16 v[52:53], v16 offset:16384
  ds_read_b64_tr_b16 v[54:55], v16 offset:17408
  v_mfma_f32_16x16x32_bf16 v[160:163], v[68:71], a[164:167], v[160:163]
  s_add_u32 s44, s56, 221184
  v_mfma_f32_16x16x32_bf16 v[164:167], v[68:71], a[168:171], v[164:167]
  buffer_load_dwordx4 v8, s[12:15], s44 offen lds
  v_mfma_f32_16x16x32_bf16 v[168:171], v[68:71], a[172:175], v[168:171]
  s_add_u32 m0, s43, 69632
  s_waitcnt lgkmcnt(4)
  v_mfma_f32_16x16x32_bf16 v[172:175], v[72:75], a[160:163], v[172:175]
  ds_read_b64_tr_b16 v[56:57], v17 offset:16384
  ds_read_b64_tr_b16 v[58:59], v17 offset:17408
  v_mfma_f32_16x16x32_bf16 v[176:179], v[72:75], a[164:167], v[176:179]
  s_add_u32 s44, s56, 276480
  v_mfma_f32_16x16x32_bf16 v[180:183], v[72:75], a[168:171], v[180:183]
  buffer_load_dwordx4 v8, s[12:15], s44 offen lds
  v_mfma_f32_16x16x32_bf16 v[184:187], v[72:75], a[172:175], v[184:187]
  s_add_u32 s56, s56, 331776
  s_waitcnt vmcnt(14)
  s_waitcnt lgkmcnt(4)
  v_mfma_f32_16x16x32_bf16 v[76:79], v[48:51], a[176:179], v[76:79]
  ds_read_b64_tr_b16 v[60:61], v18 offset:16384
  ds_read_b64_tr_b16 v[62:63], v18 offset:17408
  v_mfma_f32_16x16x32_bf16 v[80:83], v[48:51], a[180:183], v[80:83]
  ds_read_b128 a[200:203], v11 offset:4096
  ds_read_b128 a[216:219], v12 offset:4096
  v_mfma_f32_16x16x32_bf16 v[84:87], v[48:51], a[184:187], v[84:87]
  ds_read_b128 a[204:207], v11 offset:6144
  v_mfma_f32_16x16x32_bf16 v[88:91], v[48:51], a[188:191], v[88:91]
  ds_read_b128 a[220:223], v12 offset:6144
  s_waitcnt lgkmcnt(4)
  v_mfma_f32_16x16x32_bf16 v[92:95], v[52:55], a[176:179], v[92:95]
  ds_read_b64_tr_b16 v[64:65], v19 offset:16384
  v_mfma_f32_16x16x32_bf16 v[96:99], v[52:55], a[180:183], v[96:99]
  ds_read_b64_tr_b16 v[66:67], v19 offset:17408
  v_mfma_f32_16x16x32_bf16 v[100:103], v[52:55], a[184:187], v[100:103]
  s_add_u32 m0, s47, 0
  v_mfma_f32_16x16x32_bf16 v[104:107], v[52:55], a[188:191], v[104:107]
  s_add_u32 s44, s38, 1024
  s_waitcnt lgkmcnt(4)
  v_mfma_f32_16x16x32_bf16 v[108:111], v[56:59], a[176:179], v[108:111]
  ds_read_b64_tr_b16 v[68:69], v20 offset:16384
  v_mfma_f32_16x16x32_bf16 v[112:115], v[56:59], a[180:183], v[112:115]
  ds_read_b64_tr_b16 v[70:71], v20 offset:17408
  v_mfma_f32_16x16x32_bf16 v[116:119], v[56:59], a[184:187], v[116:119]
  buffer_load_dwordx4 v9, s[8:11], s44 offen lds
  v_mfma_f32_16x16x32_bf16 v[120:123], v[56:59], a[188:191], v[120:123]
  s_add_u32 m0, s47, 1024
  s_waitcnt lgkmcnt(4)
  v_mfma_f32_16x16x32_bf16 v[124:127], v[60:63], a[176:179], v[124:127]
  ds_read_b64_tr_b16 v[72:73], v21 offset:16384
  v_mfma_f32_16x16x32_bf16 v[128:131], v[60:63], a[180:183], v[128:131]
  ds_read_b64_tr_b16 v[74:75], v21 offset:17408
  v_mfma_f32_16x16x32_bf16 v[132:135], v[60:63], a[184:187], v[132:135]
  s_nop 0
  v_mfma_f32_16x16x32_bf16 v[136:139], v[60:63], a[188:191], v[136:139]
  buffer_load_dwordx4 v10, s[8:11], s44 offen lds
  s_waitcnt vmcnt(20)
  s_barrier
  s_waitcnt lgkmcnt(4)
  v_mfma_f32_16x16x32_bf16 v[140:143], v[64:67], a[176:179], v[140:143]
  ds_read_b64_tr_b16 v[48:49], v15 offset:24576
  v_mfma_f32_16x16x32_bf16 v[144:147], v[64:67], a[180:183], v[144:147]
  ds_read_b64_tr_b16 v[50:51], v15 offset:25600
  v_mfma_f32_16x16x32_bf16 v[148:151], v[64:67], a[184:187], v[148:151]
  s_add_u32 m0, s47, 2048
  v_mfma_f32_16x16x32_bf16 v[152:155], v[64:67], a[188:191], v[152:155]
  s_add_u32 s44, s39, 1024
  s_waitcnt lgkmcnt(4)
  v_mfma_f32_16x16x32_bf16 v[156:159], v[68:71], a[176:179], v[156:159]
  ds_read_b64_tr_b16 v[52:53], v16 offset:24576
  v_mfma_f32_16x16x32_bf16 v[160:163], v[68:71], a[180:183], v[160:163]
  ds_read_b64_tr_b16 v[54:55], v16 offset:25600
  v_mfma_f32_16x16x32_bf16 v[164:167], v[68:71], a[184:187], v[164:167]
  buffer_load_dwordx4 v9, s[8:11], s44 offen lds
  v_mfma_f32_16x16x32_bf16 v[168:171], v[68:71], a[188:191], v[168:171]
  s_add_u32 m0, s47, 3072
  s_waitcnt lgkmcnt(4)
  v_mfma_f32_16x16x32_bf16 v[172:175], v[72:75], a[176:179], v[172:175]
  ds_read_b64_tr_b16 v[56:57], v17 offset:24576
  v_mfma_f32_16x16x32_bf16 v[176:179], v[72:75], a[180:183], v[176:179]
  ds_read_b64_tr_b16 v[58:59], v17 offset:25600
  v_mfma_f32_16x16x32_bf16 v[180:183], v[72:75], a[184:187], v[180:183]
  s_nop 0
  v_mfma_f32_16x16x32_bf16 v[184:187], v[72:75], a[188:191], v[184:187]
  buffer_load_dwordx4 v10, s[8:11], s44 offen lds
  s_waitcnt vmcnt(14)
  s_waitcnt lgkmcnt(4)
  v_mfma_f32_16x16x32_bf16 v[76:79], v[48:51], a[192:195], v[76:79]
  ds_read_b64_tr_b16 v[60:61], v18 offset:24576
  ds_read_b64_tr_b16 v[62:63], v18 offset:25600
  v_mfma_f32_16x16x32_bf16 v[80:83], v[48:51], a[196:199], v[80:83]
  ds_read_b128 a[224:227], v11 offset:8192
  ds_read_b128 a[240:243], v12 offset:8192
  v_mfma_f32_16x16x32_bf16 v[84:87], v[48:51], a[200:203], v[84:87]
  ds_read_b128 a[228:231], v11 offset:10240
  v_mfma_f32_16x16x32_bf16 v[88:91], v[48:51], a[204:207], v[88:91]
  ds_read_b128 a[244:247], v12 offset:10240
  s_waitcnt lgkmcnt(4)
  v_mfma_f32_16x16x32_bf16 v[92:95], v[52:55], a[192:195], v[92:95]
  ds_read_b64_tr_b16 v[64:65], v19 offset:24576
  ds_read_b64_tr_b16 v[66:67], v19 offset:25600
  v_mfma_f32_16x16x32_bf16 v[96:99], v[52:55], a[196:199], v[96:99]
  s_add_u32 m0, s47, 4096
  s_add_u32 s44, s40, 1024
  v_mfma_f32_16x16x32_bf16 v[100:103], v[52:55], a[200:203], v[100:103]
  buffer_load_dwordx4 v9, s[8:11], s44 offen lds
  v_mfma_f32_16x16x32_bf16 v[104:107], v[52:55], a[204:207], v[104:107]
  s_add_u32 m0, s47, 5120
  s_waitcnt lgkmcnt(4)
  v_mfma_f32_16x16x32_bf16 v[108:111], v[56:59], a[192:195], v[108:111]
  ds_read_b64_tr_b16 v[68:69], v20 offset:24576
  ds_read_b64_tr_b16 v[70:71], v20 offset:25600
  v_mfma_f32_16x16x32_bf16 v[112:115], v[56:59], a[196:199], v[112:115]
  s_nop 0
  buffer_load_dwordx4 v10, s[8:11], s44 offen lds
  v_mfma_f32_16x16x32_bf16 v[116:119], v[56:59], a[200:203], v[116:119]
  s_add_u32 m0, s47, 6144
  v_mfma_f32_16x16x32_bf16 v[120:123], v[56:59], a[204:207], v[120:123]
  s_add_u32 s44, s41, 1024
  s_waitcnt lgkmcnt(4)
  v_mfma_f32_16x16x32_bf16 v[124:127], v[60:63], a[192:195], v[124:127]
  ds_read_b64_tr_b16 v[72:73], v21 offset:24576
  ds_read_b64_tr_b16 v[74:75], v21 offset:25600
  v_mfma_f32_16x16x32_bf16 v[128:131], v[60:63], a[196:199], v[128:131]
  buffer_load_dwordx4 v9, s[8:11], s44 offen lds
  s_add_u32 m0, s47, 7168
  v_mfma_f32_16x16x32_bf16 v[132:135], v[60:63], a[200:203], v[132:135]
  s_nop 0
  v_mfma_f32_16x16x32_bf16 v[136:139], v[60:63], a[204:207], v[136:139]
  buffer_load_dwordx4 v10, s[8:11], s44 offen lds
  s_waitcnt lgkmcnt(4)
  v_mfma_f32_16x16x32_bf16 v[140:143], v[64:67], a[192:195], v[140:143]
  ds_read_b64_tr_b16 v[48:49], v15 offset:32768
  ds_read_b64_tr_b16 v[50:51], v15 offset:33792
  v_mfma_f32_16x16x32_bf16 v[144:147], v[64:67], a[196:199], v[144:147]
  s_add_u32 s56, s42, 72
  s_add_u32 m0, s43, 0
  v_mfma_f32_16x16x32_bf16 v[148:151], v[64:67], a[200:203], v[148:151]
  s_add_u32 s44, s56, 0
  v_mfma_f32_16x16x32_bf16 v[152:155], v[64:67], a[204:207], v[152:155]
  buffer_load_dwordx4 v8, s[12:15], s44 offen lds
  s_waitcnt lgkmcnt(4)
  v_mfma_f32_16x16x32_bf16 v[156:159], v[68:71], a[192:195], v[156:159]
  ds_read_b64_tr_b16 v[52:53], v16 offset:32768
  ds_read_b64_tr_b16 v[54:55], v16 offset:33792
  v_mfma_f32_16x16x32_bf16 v[160:163], v[68:71], a[196:199], v[160:163]
  s_add_u32 m0, s43, 4096
  v_mfma_f32_16x16x32_bf16 v[164:167], v[68:71], a[200:203], v[164:167]
  s_add_u32 s44, s56, 55296
  v_mfma_f32_16x16x32_bf16 v[168:171], v[68:71], a[204:207], v[168:171]
  buffer_load_dwordx4 v8, s[12:15], s44 offen lds
  s_waitcnt lgkmcnt(4)
  v_mfma_f32_16x16x32_bf16 v[172:175], v[72:75], a[192:195], v[172:175]
  ds_read_b64_tr_b16 v[56:57], v17 offset:32768
  ds_read_b64_tr_b16 v[58:59], v17 offset:33792
  v_mfma_f32_16x16x32_bf16 v[176:179], v[72:75], a[196:199], v[176:179]
  s_add_u32 m0, s43, 8192
  v_mfma_f32_16x16x32_bf16 v[180:183], v[72:75], a[200:203], v[180:183]
  s_add_u32 s44, s56, 110592
  v_mfma_f32_16x16x32_bf16 v[184:187], v[72:75], a[204:207], v[184:187]
  buffer_load_dwordx4 v8, s[12:15], s44 offen lds
  s_waitcnt vmcnt(14)
  s_waitcnt lgkmcnt(4)
  v_mfma_f32_16x16x32_bf16 v[76:79], v[48:51], a[208:211], v[76:79]
  ds_read_b64_tr_b16 v[60:61], v18 offset:32768
  ds_read_b64_tr_b16 v[62:63], v18 offset:33792
  v_mfma_f32_16x16x32_bf16 v[80:83], v[48:51], a[212:215], v[80:83]
  ds_read_b128 a[232:235], v11 offset:12288
  ds_read_b128 a[248:251], v12 offset:12288
  v_mfma_f32_16x16x32_bf16 v[84:87], v[48:51], a[216:219], v[84:87]
  ds_read_b128 a[236:239], v11 offset:14336
  v_mfma_f32_16x16x32_bf16 v[88:91], v[48:51], a[220:223], v[88:91]
  ds_read_b128 a[252:255], v12 offset:14336
  s_waitcnt lgkmcnt(4)
  v_mfma_f32_16x16x32_bf16 v[92:95], v[52:55], a[208:211], v[92:95]
  ds_read_b64_tr_b16 v[64:65], v19 offset:32768
  v_mfma_f32_16x16x32_bf16 v[96:99], v[52:55], a[212:215], v[96:99]
  ds_read_b64_tr_b16 v[66:67], v19 offset:33792
  v_mfma_f32_16x16x32_bf16 v[100:103], v[52:55], a[216:219], v[100:103]
  s_add_u32 m0, s43, 12288
  v_mfma_f32_16x16x32_bf16 v[104:107], v[52:55], a[220:223], v[104:107]
  s_add_u32 s44, s56, 165888
  s_waitcnt lgkmcnt(4)
  v_mfma_f32_16x16x32_bf16 v[108:111], v[56:59], a[208:211], v[108:111]
  ds_read_b64_tr_b16 v[68:69], v20 offset:32768
  v_mfma_f32_16x16x32_bf16 v[112:115], v[56:59], a[212:215], v[112:115]
  ds_read_b64_tr_b16 v[70:71], v20 offset:33792
  v_mfma_f32_16x16x32_bf16 v[116:119], v[56:59], a[216:219], v[116:119]
  buffer_load_dwordx4 v8, s[12:15], s44 offen lds
  v_mfma_f32_16x16x32_bf16 v[120:123], v[56:59], a[220:223], v[120:123]
  s_add_u32 m0, s43, 16384
  s_waitcnt lgkmcnt(4)
  v_mfma_f32_16x16x32_bf16 v[124:127], v[60:63], a[208:211], v[124:127]
  ds_read_b64_tr_b16 v[72:73], v21 offset:32768
  v_mfma_f32_16x16x32_bf16 v[128:131], v[60:63], a[212:215], v[128:131]
  ds_read_b64_tr_b16 v[74:75], v21 offset:33792
  v_mfma_f32_16x16x32_bf16 v[132:135], v[60:63], a[216:219], v[132:135]
  s_add_u32 s44, s56, 221184
  v_mfma_f32_16x16x32_bf16 v[136:139], v[60:63], a[220:223], v[136:139]
  buffer_load_dwordx4 v8, s[12:15], s44 offen lds
  s_waitcnt lgkmcnt(4)
  v_mfma_f32_16x16x32_bf16 v[140:143], v[64:67], a[208:211], v[140:143]
  ds_read_b64_tr_b16 v[48:49], v15 offset:40960
  v_mfma_f32_16x16x32_bf16 v[144:147], v[64:67], a[212:215], v[144:147]
  ds_read_b64_tr_b16 v[50:51], v15 offset:41984
  v_mfma_f32_16x16x32_bf16 v[148:151], v[64:67], a[216:219], v[148:151]
  s_add_u32 m0, s43, 20480
  v_mfma_f32_16x16x32_bf16 v[152:155], v[64:67], a[220:223], v[152:155]
  s_add_u32 s44, s56, 276480
  s_waitcnt lgkmcnt(4)
  v_mfma_f32_16x16x32_bf16 v[156:159], v[68:71], a[208:211], v[156:159]
  ds_read_b64_tr_b16 v[52:53], v16 offset:40960
  v_mfma_f32_16x16x32_bf16 v[160:163], v[68:71], a[212:215], v[160:163]
  ds_read_b64_tr_b16 v[54:55], v16 offset:41984
  v_mfma_f32_16x16x32_bf16 v[164:167], v[68:71], a[216:219], v[164:167]
  buffer_load_dwordx4 v8, s[12:15], s44 offen lds
  v_mfma_f32_16x16x32_bf16 v[168:171], v[68:71], a[220:223], v[168:171]
  s_waitcnt lgkmcnt(4)
  v_mfma_f32_16x16x32_bf16 v[172:175], v[72:75], a[208:211], v[172:175]
  ds_read_b64_tr_b16 v[56:57], v17 offset:40960
  v_mfma_f32_16x16x32_bf16 v[176:179], v[72:75], a[212:215], v[176:179]
  ds_read_b64_tr_b16 v[58:59], v17 offset:41984
  v_mfma_f32_16x16x32_bf16 v[180:183], v[72:75], a[216:219], v[180:183]
  s_add_u32 s56, s56, 331776
  v_mfma_f32_16x16x32_bf16 v[184:187], v[72:75], a[220:223], v[184:187]
  s_waitcnt vmcnt(10)
  s_waitcnt lgkmcnt(4)
  v_mfma_f32_16x16x32_bf16 v[76:79], v[48:51], a[224:227], v[76:79]
  ds_read_b64_tr_b16 v[60:61], v18 offset:40960
  ds_read_b64_tr_b16 v[62:63], v18 offset:41984
  v_mfma_f32_16x16x32_bf16 v[80:83], v[48:51], a[228:231], v[80:83]
  ds_read_b128 v[188:191], v11 offset:0
  ds_read_b128 v[204:207], v12 offset:0
  v_mfma_f32_16x16x32_bf16 v[84:87], v[48:51], a[232:235], v[84:87]
  ds_read_b128 v[192:195], v11 offset:2048
  v_mfma_f32_16x16x32_bf16 v[88:91], v[48:51], a[236:239], v[88:91]
  ds_read_b128 v[208:211], v12 offset:2048
  s_waitcnt lgkmcnt(4)
  v_mfma_f32_16x16x32_bf16 v[92:95], v[52:55], a[224:227], v[92:95]
  ds_read_b64_tr_b16 v[64:65], v19 offset:40960
  v_mfma_f32_16x16x32_bf16 v[96:99], v[52:55], a[228:231], v[96:99]
  ds_read_b64_tr_b16 v[66:67], v19 offset:41984
  v_mfma_f32_16x16x32_bf16 v[100:103], v[52:55], a[232:235], v[100:103]
  v_mfma_f32_16x16x32_bf16 v[104:107], v[52:55], a[236:239], v[104:107]
  s_waitcnt lgkmcnt(4)
  v_mfma_f32_16x16x32_bf16 v[108:111], v[56:59], a[224:227], v[108:111]
  ds_read_b64_tr_b16 v[68:69], v20 offset:40960
  v_mfma_f32_16x16x32_bf16 v[112:115], v[56:59], a[228:231], v[112:115]
  ds_read_b64_tr_b16 v[70:71], v20 offset:41984
  v_mfma_f32_16x16x32_bf16 v[116:119], v[56:59], a[232:235], v[116:119]
  v_mfma_f32_16x16x32_bf16 v[120:123], v[56:59], a[236:239], v[120:123]
  s_waitcnt lgkmcnt(4)
  v_mfma_f32_16x16x32_bf16 v[124:127], v[60:63], a[224:227], v[124:127]
  ds_read_b64_tr_b16 v[72:73], v21 offset:40960
  v_mfma_f32_16x16x32_bf16 v[128:131], v[60:63], a[228:231], v[128:131]
  ds_read_b64_tr_b16 v[74:75], v21 offset:41984
  v_mfma_f32_16x16x32_bf16 v[132:135], v[60:63], a[232:235], v[132:135]
  v_mfma_f32_16x16x32_bf16 v[136:139], v[60:63], a[236:239], v[136:139]
  s_waitcnt vmcnt(14)
  s_barrier
  s_waitcnt lgkmcnt(4)
  v_mfma_f32_16x16x32_bf16 v[140:143], v[64:67], a[224:227], v[140:143]
  ds_read_b64_tr_b16 v[48:49], v22 offset:0
  v_mfma_f32_16x16x32_bf16 v[144:147], v[64:67], a[228:231], v[144:147]
  ds_read_b64_tr_b16 v[50:51], v22 offset:1024
  v_mfma_f32_16x16x32_bf16 v[148:151], v[64:67], a[232:235], v[148:151]
  v_mfma_f32_16x16x32_bf16 v[152:155], v[64:67], a[236:239], v[152:155]
  s_waitcnt lgkmcnt(4)
  v_mfma_f32_16x16x32_bf16 v[156:159], v[68:71], a[224:227], v[156:159]
  ds_read_b64_tr_b16 v[52:53], v23 offset:0
  v_mfma_f32_16x16x32_bf16 v[160:163], v[68:71], a[228:231], v[160:163]
  ds_read_b64_tr_b16 v[54:55], v23 offset:1024
  v_mfma_f32_16x16x32_bf16 v[164:167], v[68:71], a[232:235], v[164:167]
  v_mfma_f32_16x16x32_bf16 v[168:171], v[68:71], a[236:239], v[168:171]
  s_waitcnt lgkmcnt(4)
  v_mfma_f32_16x16x32_bf16 v[172:175], v[72:75], a[224:227], v[172:175]
  ds_read_b64_tr_b16 v[56:57], v24 offset:0
  v_mfma_f32_16x16x32_bf16 v[176:179], v[72:75], a[228:231], v[176:179]
  ds_read_b64_tr_b16 v[58:59], v24 offset:1024
  v_mfma_f32_16x16x32_bf16 v[180:183], v[72:75], a[232:235], v[180:183]
  v_mfma_f32_16x16x32_bf16 v[184:187], v[72:75], a[236:239], v[184:187]
  s_waitcnt vmcnt(6)
  s_waitcnt lgkmcnt(4)
  v_mfma_f32_16x16x32_bf16 v[76:79], v[48:51], a[240:243], v[76:79]
  ds_read_b64_tr_b16 v[60:61], v25 offset:0
  ds_read_b64_tr_b16 v[62:63], v25 offset:1024
  v_mfma_f32_16x16x32_bf16 v[80:83], v[48:51], a[244:247], v[80:83]
  ds_read_b128 v[196:199], v11 offset:4096
  ds_read_b128 v[212:215], v12 offset:4096
  v_mfma_f32_16x16x32_bf16 v[84:87], v[48:51], a[248:251], v[84:87]
  ds_read_b128 v[200:203], v11 offset:6144
  v_mfma_f32_16x16x32_bf16 v[88:91], v[48:51], a[252:255], v[88:91]
  ds_read_b128 v[216:219], v12 offset:6144
  s_waitcnt lgkmcnt(4)
  v_mfma_f32_16x16x32_bf16 v[92:95], v[52:55], a[240:243], v[92:95]
  ds_read_b64_tr_b16 v[64:65], v26 offset:0
  v_mfma_f32_16x16x32_bf16 v[96:99], v[52:55], a[244:247], v[96:99]
  ds_read_b64_tr_b16 v[66:67], v26 offset:1024
  v_mfma_f32_16x16x32_bf16 v[100:103], v[52:55], a[248:251], v[100:103]
  s_add_u32 m0, s43, 24576
  v_mfma_f32_16x16x32_bf16 v[104:107], v[52:55], a[252:255], v[104:107]
  s_add_u32 s44, s56, 0
  s_waitcnt lgkmcnt(4)
  v_mfma_f32_16x16x32_bf16 v[108:111], v[56:59], a[240:243], v[108:111]
  ds_read_b64_tr_b16 v[68:69], v27 offset:0
  v_mfma_f32_16x16x32_bf16 v[112:115], v[56:59], a[244:247], v[112:115]
  ds_read_b64_tr_b16 v[70:71], v27 offset:1024
  v_mfma_f32_16x16x32_bf16 v[116:119], v[56:59], a[248:251], v[116:119]
  buffer_load_dwordx4 v8, s[12:15], s44 offen lds
  v_mfma_f32_16x16x32_bf16 v[120:123], v[56:59], a[252:255], v[120:123]
  s_add_u32 m0, s43, 28672
  s_waitcnt lgkmcnt(4)
  v_mfma_f32_16x16x32_bf16 v[124:127], v[60:63], a[240:243], v[124:127]
  ds_read_b64_tr_b16 v[72:73], v28 offset:0
  v_mfma_f32_16x16x32_bf16 v[128:131], v[60:63], a[244:247], v[128:131]
  ds_read_b64_tr_b16 v[74:75], v28 offset:1024
  v_mfma_f32_16x16x32_bf16 v[132:135], v[60:63], a[248:251], v[132:135]
  s_add_u32 s44, s56, 55296
  v_mfma_f32_16x16x32_bf16 v[136:139], v[60:63], a[252:255], v[136:139]
  buffer_load_dwordx4 v8, s[12:15], s44 offen lds
  s_waitcnt lgkmcnt(4)
  v_mfma_f32_16x16x32_bf16 v[140:143], v[64:67], a[240:243], v[140:143]
  ds_read_b64_tr_b16 v[48:49], v22 offset:8192
  v_mfma_f32_16x16x32_bf16 v[144:147], v[64:67], a[244:247], v[144:147]
  ds_read_b64_tr_b16 v[50:51], v22 offset:9216
  v_mfma_f32_16x16x32_bf16 v[148:151], v[64:67], a[248:251], v[148:151]
  s_add_u32 m0, s43, 32768
  v_mfma_f32_16x16x32_bf16 v[152:155], v[64:67], a[252:255], v[152:155]
  s_waitcnt lgkmcnt(4)
  v_mfma_f32_16x16x32_bf16 v[156:159], v[68:71], a[240:243], v[156:159]
  ds_read_b64_tr_b16 v[52:53], v23 offset:8192
  v_mfma_f32_16x16x32_bf16 v[160:163], v[68:71], a[244:247], v[160:163]
  ds_read_b64_tr_b16 v[54:55], v23 offset:9216
  v_mfma_f32_16x16x32_bf16 v[164:167], v[68:71], a[248:251], v[164:167]
  s_add_u32 s44, s56, 110592
  v_mfma_f32_16x16x32_bf16 v[168:171], v[68:71], a[252:255], v[168:171]
  s_waitcnt lgkmcnt(4)
  v_mfma_f32_16x16x32_bf16 v[172:175], v[72:75], a[240:243], v[172:175]
  ds_read_b64_tr_b16 v[56:57], v24 offset:8192
  v_mfma_f32_16x16x32_bf16 v[176:179], v[72:75], a[244:247], v[176:179]
  ds_read_b64_tr_b16 v[58:59], v24 offset:9216
  v_mfma_f32_16x16x32_bf16 v[180:183], v[72:75], a[248:251], v[180:183]
  buffer_load_dwordx4 v8, s[12:15], s44 offen lds
  v_mfma_f32_16x16x32_bf16 v[184:187], v[72:75], a[252:255], v[184:187]
  s_waitcnt lgkmcnt(4)
  v_mfma_f32_16x16x32_bf16 v[76:79], v[48:51], v[188:191], v[76:79]
  ds_read_b64_tr_b16 v[60:61], v25 offset:8192
  v_mfma_f32_16x16x32_bf16 v[80:83], v[48:51], v[192:195], v[80:83]
  ds_read_b64_tr_b16 v[62:63], v25 offset:9216
  v_mfma_f32_16x16x32_bf16 v[84:87], v[48:51], v[196:199], v[84:87]
  v_mfma_f32_16x16x32_bf16 v[88:91], v[48:51], v[200:203], v[88:91]
  s_waitcnt lgkmcnt(4)
  v_mfma_f32_16x16x32_bf16 v[92:95], v[52:55], v[188:191], v[92:95]
  ds_read_b64_tr_b16 v[64:65], v26 offset:8192
  v_mfma_f32_16x16x32_bf16 v[96:99], v[52:55], v[192:195], v[96:99]
  ds_read_b64_tr_b16 v[66:67], v26 offset:9216
  v_mfma_f32_16x16x32_bf16 v[100:103], v[52:55], v[196:199], v[100:103]
  s_add_u32 m0, s43, 36864
  v_mfma_f32_16x16x32_bf16 v[104:107], v[52:55], v[200:203], v[104:107]
  s_add_u32 s44, s56, 165888
  s_waitcnt lgkmcnt(4)
  v_mfma_f32_16x16x32_bf16 v[108:111], v[56:59], v[188:191], v[108:111]
  ds_read_b64_tr_b16 v[68:69], v27 offset:8192
  v_mfma_f32_16x16x32_bf16 v[112:115], v[56:59], v[192:195], v[112:115]
  ds_read_b64_tr_b16 v[70:71], v27 offset:9216
  v_mfma_f32_16x16x32_bf16 v[116:119], v[56:59], v[196:199], v[116:119]
  buffer_load_dwordx4 v8, s[12:15], s44 offen lds
  v_mfma_f32_16x16x32_bf16 v[120:123], v[56:59], v[200:203], v[120:123]
  s_add_u32 m0, s43, 40960
  s_waitcnt lgkmcnt(4)
  v_mfma_f32_16x16x32_bf16 v[124:127], v[60:63], v[188:191], v[124:127]
  ds_read_b64_tr_b16 v[72:73], v28 offset:8192
  v_mfma_f32_16x16x32_bf16 v[128:131], v[60:63], v[192:195], v[128:131]
  ds_read_b64_tr_b16 v[74:75], v28 offset:9216
  v_mfma_f32_16x16x32_bf16 v[132:135], v[60:63], v[196:199], v[132:135]
  s_add_u32 s44, s56, 221184
  v_mfma_f32_16x16x32_bf16 v[136:139], v[60:63], v[200:203], v[136:139]
  buffer_load_dwordx4 v8, s[12:15], s44 offen lds
  s_waitcnt lgkmcnt(4)
  v_mfma_f32_16x16x32_bf16 v[140:143], v[64:67], v[188:191], v[140:143]
  ds_read_b64_tr_b16 v[48:49], v22 offset:16384
  v_mfma_f32_16x16x32_bf16 v[144:147], v[64:67], v[192:195], v[144:147]
  ds_read_b64_tr_b16 v[50:51], v22 offset:17408
  v_mfma_f32_16x16x32_bf16 v[148:151], v[64:67], v[196:199], v[148:151]
  s_add_u32 m0, s43, 45056
  v_mfma_f32_16x16x32_bf16 v[152:155], v[64:67], v[200:203], v[152:155]
  s_add_u32 s44, s56, 276480
  s_waitcnt lgkmcnt(4)
  v_mfma_f32_16x16x32_bf16 v[156:159], v[68:71], v[188:191], v[156:159]
  ds_read_b64_tr_b16 v[52:53], v23 offset:16384
  v_mfma_f32_16x16x32_bf16 v[160:163], v[68:71], v[192:195], v[160:163]
  ds_read_b64_tr_b16 v[54:55], v23 offset:17408
  v_mfma_f32_16x16x32_bf16 v[164:167], v[68:71], v[196:199], v[164:167]
  buffer_load_dwordx4 v8, s[12:15], s44 offen lds
  v_mfma_f32_16x16x32_bf16 v[168:171], v[68:71], v[200:203], v[168:171]
  s_waitcnt lgkmcnt(4)
  v_mfma_f32_16x16x32_bf16 v[172:175], v[72:75], v[188:191], v[172:175]
  ds_read_b64_tr_b16 v[56:57], v24 offset:16384
  v_mfma_f32_16x16x32_bf16 v[176:179], v[72:75], v[192:195], v[176:179]
  ds_read_b64_tr_b16 v[58:59], v24 offset:17408
  v_mfma_f32_16x16x32_bf16 v[180:183], v[72:75], v[196:199], v[180:183]
  s_add_u32 s56, s56, 331776
  v_mfma_f32_16x16x32_bf16 v[184:187], v[72:75], v[200:203], v[184:187]
  s_waitcnt lgkmcnt(4)
  v_mfma_f32_16x16x32_bf16 v[76:79], v[48:51], v[204:207], v[76:79]
  ds_read_b64_tr_b16 v[60:61], v25 offset:16384
  v_mfma_f32_16x16x32_bf16 v[80:83], v[48:51], v[208:211], v[80:83]
  ds_read_b64_tr_b16 v[62:63], v25 offset:17408
  v_mfma_f32_16x16x32_bf16 v[84:87], v[48:51], v[212:215], v[84:87]
  v_mfma_f32_16x16x32_bf16 v[88:91], v[48:51], v[216:219], v[88:91]
  s_waitcnt lgkmcnt(4)
  v_mfma_f32_16x16x32_bf16 v[92:95], v[52:55], v[204:207], v[92:95]
  ds_read_b64_tr_b16 v[64:65], v26 offset:16384
  v_mfma_f32_16x16x32_bf16 v[96:99], v[52:55], v[208:211], v[96:99]
  ds_read_b64_tr_b16 v[66:67], v26 offset:17408
  v_mfma_f32_16x16x32_bf16 v[100:103], v[52:55], v[212:215], v[100:103]
  v_mfma_f32_16x16x32_bf16 v[104:107], v[52:55], v[216:219], v[104:107]
  s_waitcnt lgkmcnt(4)
  v_mfma_f32_16x16x32_bf16 v[108:111], v[56:59], v[204:207], v[108:111]
  ds_read_b64_tr_b16 v[68:69], v27 offset:16384
  v_mfma_f32_16x16x32_bf16 v[112:115], v[56:59], v[208:211], v[112:115]
  ds_read_b64_tr_b16 v[70:71], v27 offset:17408
  v_mfma_f32_16x16x32_bf16 v[116:119], v[56:59], v[212:215], v[116:119]
  v_mfma_f32_16x16x32_bf16 v[120:123], v[56:59], v[216:219], v[120:123]
  s_waitcnt lgkmcnt(4)
  v_mfma_f32_16x16x32_bf16 v[124:127], v[60:63], v[204:207], v[124:127]
  ds_read_b64_tr_b16 v[72:73], v28 offset:16384
  v_mfma_f32_16x16x32_bf16 v[128:131], v[60:63], v[208:211], v[128:131]
  ds_read_b64_tr_b16 v[74:75], v28 offset:17408
  v_mfma_f32_16x16x32_bf16 v[132:135], v[60:63], v[212:215], v[132:135]
  v_mfma_f32_16x16x32_bf16 v[136:139], v[60:63], v[216:219], v[136:139]
  s_waitcnt vmcnt(6)
  s_barrier
  s_waitcnt lgkmcnt(4)
  v_mfma_f32_16x16x32_bf16 v[140:143], v[64:67], v[204:207], v[140:143]
  ds_read_b64_tr_b16 v[48:49], v15 offset:0
  v_mfma_f32_16x16x32_bf16 v[144:147], v[64:67], v[208:211], v[144:147]
  ds_read_b64_tr_b16 v[50:51], v15 offset:1024
  v_mfma_f32_16x16x32_bf16 v[148:151], v[64:67], v[212:215], v[148:151]
  v_mfma_f32_16x16x32_bf16 v[152:155], v[64:67], v[216:219], v[152:155]
  s_waitcnt lgkmcnt(4)
  v_mfma_f32_16x16x32_bf16 v[156:159], v[68:71], v[204:207], v[156:159]
  ds_read_b64_tr_b16 v[52:53], v16 offset:0
  v_mfma_f32_16x16x32_bf16 v[160:163], v[68:71], v[208:211], v[160:163]
  ds_read_b64_tr_b16 v[54:55], v16 offset:1024
  v_mfma_f32_16x16x32_bf16 v[164:167], v[68:71], v[212:215], v[164:167]
  v_mfma_f32_16x16x32_bf16 v[168:171], v[68:71], v[216:219], v[168:171]
  s_waitcnt lgkmcnt(4)
  v_mfma_f32_16x16x32_bf16 v[172:175], v[72:75], v[204:207], v[172:175]
  ds_read_b64_tr_b16 v[56:57], v17 offset:0
  v_mfma_f32_16x16x32_bf16 v[176:179], v[72:75], v[208:211], v[176:179]
  ds_read_b64_tr_b16 v[58:59], v17 offset:1024
  v_mfma_f32_16x16x32_bf16 v[180:183], v[72:75], v[212:215], v[180:183]
  v_mfma_f32_16x16x32_bf16 v[184:187], v[72:75], v[216:219], v[184:187]
L_at_pair:
  s_add_u32 s42, s42, 72
  s_cmp_eq_u32 s46, 0
  s_cbranch_scc0 L_at_notfirst
  v_add_u32 v4, 139264, v45
  ds_write_b16 v4, v248
  v_add_u32 v4, 139264, v46
  ds_write_b16 v4, v249
  v_add_u32 v4, 139264, v47
  ds_write_b16 v4, v250
  v_add_u32 v4, 143872, v45
  ds_write_b16 v4, v251
  v_add_u32 v4, 143872, v46
  ds_write_b16 v4, v252
  v_add_u32 v4, 143872, v47
  ds_write_b16 v4, v253
  v_mov_b32 v4, 0
  global_load_dword v254, v4, s[50:51] sc1
  s_waitcnt lgkmcnt(0)
  s_barrier
  v_mul_u32_u24 v7, 96, v0
  v_add_u32 v7, 114760, v7
  v_mov_b32 v244, 0x3f80
  v_mov_b32 v245, 0
  ds_write_b64 v7, v[244:245]
L_at_notfirst:
  s_nop 4
  v_cvt_pk_bf16_f32 v76, v76, v77
  v_cvt_pk_bf16_f32 v77, v78, v79
  v_cvt_pk_bf16_f32 v78, v92, v93
  v_cvt_pk_bf16_f32 v79, v94, v95
  v_cvt_pk_bf16_f32 v108, v108, v109
  v_cvt_pk_bf16_f32 v109, v110, v111
  v_cvt_pk_bf16_f32 v124, v124, v125
  v_cvt_pk_bf16_f32 v125, v126, v127
  v_cvt_pk_bf16_f32 v126, v140, v141
  v_cvt_pk_bf16_f32 v127, v142, v143
  v_cvt_pk_bf16_f32 v156, v156, v157
  v_cvt_pk_bf16_f32 v157, v158, v159
  v_cvt_pk_bf16_f32 v172, v172, v173
  v_cvt_pk_bf16_f32 v173, v174, v175
  v_cvt_pk_bf16_f32 v80, v80, v81
  v_cvt_pk_bf16_f32 v81, v82, v83
  v_cvt_pk_bf16_f32 v82, v96, v97
  v_cvt_pk_bf16_f32 v83, v98, v99
  v_cvt_pk_bf16_f32 v112, v112, v113
  v_cvt_pk_bf16_f32 v113, v114, v115
  v_cvt_pk_bf16_f32 v128, v128, v129
  v_cvt_pk_bf16_f32 v129, v130, v131
  v_cvt_pk_bf16_f32 v130, v144, v145
  v_cvt_pk_bf16_f32 v131, v146, v147
  v_cvt_pk_bf16_f32 v160, v160, v161
  v_cvt_pk_bf16_f32 v161, v162, v163
  v_cvt_pk_bf16_f32 v176, v176, v177
  v_cvt_pk_bf16_f32 v177, v178, v179
  v_cvt_pk_bf16_f32 v84, v84, v85
  v_cvt_pk_bf16_f32 v85, v86, v87
  v_cvt_pk_bf16_f32 v86, v100, v101
  v_cvt_pk_bf16_f32 v87, v102, v103
  v_cvt_pk_bf16_f32 v116, v116, v117
  v_cvt_pk_bf16_f32 v117, v118, v119
  v_cvt_pk_bf16_f32 v132, v132, v133
  v_cvt_pk_bf16_f32 v133, v134, v135
  v_cvt_pk_bf16_f32 v134, v148, v149
  v_cvt_pk_bf16_f32 v135, v150, v151
  v_cvt_pk_bf16_f32 v164, v164, v165
  v_cvt_pk_bf16_f32 v165, v166, v167
  v_cvt_pk_bf16_f32 v180, v180, v181
  v_cvt_pk_bf16_f32 v181, v182, v183
  v_cvt_pk_bf16_f32 v88, v88, v89
  v_cvt_pk_bf16_f32 v89, v90, v91
  v_cvt_pk_bf16_f32 v90, v104, v105
  v_cvt_pk_bf16_f32 v91, v106, v107
  v_cvt_pk_bf16_f32 v120, v120, v121
  v_cvt_pk_bf16_f32 v121, v122, v123
  v_cvt_pk_bf16_f32 v136, v136, v137
  v_cvt_pk_bf16_f32 v137, v138, v139
  v_cvt_pk_bf16_f32 v138, v152, v153
  v_cvt_pk_bf16_f32 v139, v154, v155
  v_cvt_pk_bf16_f32 v168, v168, v169
  v_cvt_pk_bf16_f32 v169, v170, v171
  v_cvt_pk_bf16_f32 v184, v184, v185
  v_cvt_pk_bf16_f32 v185, v186, v187
  s_mul_i32 s44, s46, 4608
  v_add_u32 v244, s44, v33
  ds_read_b64_tr_b16 v[92:93], v244 offset:0
  ds_read_b64_tr_b16 v[94:95], v244 offset:1536
  ds_read_b64_tr_b16 v[104:105], v244 offset:3072
  ds_read_b64_tr_b16 v[96:97], v244 offset:32
  ds_read_b64_tr_b16 v[98:99], v244 offset:1568
  ds_read_b64_tr_b16 v[106:107], v244 offset:3104
  ds_read_b64_tr_b16 v[100:101], v244 offset:64
  ds_read_b64_tr_b16 v[102:103], v244 offset:1600
  ds_read_b64_tr_b16 v[140:141], v244 offset:3136
  s_waitcnt lgkmcnt(6)
  ds_write_b64 v35, v[108:109] offset:0
  ds_write_b64 v36, v[156:157] offset:0
  ds_write_b64 v37, v[172:173] offset:0
  ds_write_b64 v35, v[112:113] offset:1536
  ds_write_b64 v36, v[160:161] offset:1536
  s_waitcnt lgkmcnt(8)
  ds_write_b64 v37, v[176:177] offset:1536
  ds_write_b64 v35, v[116:117] offset:3072
  ds_write_b64 v36, v[164:165] offset:3072
  ds_write_b64 v37, v[180:181] offset:3072
  ds_write_b64 v35, v[120:121] offset:4608
  ds_write_b64 v36, v[168:169] offset:4608
  ds_write_b64 v37, v[184:185] offset:4608
  s_cmp_eq_u32 s46, 0
  s_cbranch_scc0 L_at_sq1
  v_mov_b32 v220, v76
  v_mov_b32 v221, v77
  v_mov_b32 v222, v78
  v_mov_b32 v223, v79
  v_mov_b32 v224, v108
  v_mov_b32 v225, v109
  v_mov_b32 v226, v80
  v_mov_b32 v227, v81
  v_mov_b32 v228, v82
  v_mov_b32 v229, v83
  v_mov_b32 v230, v112
  v_mov_b32 v231, v113
  v_mov_b32 v232, v84
  v_mov_b32 v233, v85
  v_mov_b32 v234, v86
  v_mov_b32 v235, v87
  v_mov_b32 v236, v116
  v_mov_b32 v237, v117
  v_mov_b32 v238, v88
  v_mov_b32 v239, v89
  v_mov_b32 v240, v90
  v_mov_b32 v241, v91
  v_mov_b32 v242, v120
  v_mov_b32 v243, v121
  s_branch L_at_sq2
L_at_sq1:
  v_mov_b32 v48, v76
  v_mov_b32 v49, v77
  v_mov_b32 v50, v78
  v_mov_b32 v51, v79
  v_mov_b32 v52, v108
  v_mov_b32 v53, v109
  v_mov_b32 v54, v80
  v_mov_b32 v55, v81
  v_mov_b32 v56, v82
  v_mov_b32 v57, v83
  v_mov_b32 v58, v112
  v_mov_b32 v59, v113
  v_mov_b32 v60, v84
  v_mov_b32 v61, v85
  v_mov_b32 v62, v86
  v_mov_b32 v63, v87
  v_mov_b32 v64, v116
  v_mov_b32 v65, v117
  v_mov_b32 v66, v88
  v_mov_b32 v67, v89
  v_mov_b32 v68, v90
  v_mov_b32 v69, v91
  v_mov_b32 v70, v120
  v_mov_b32 v71, v121
L_at_sq2:
  s_waitcnt lgkmcnt(0)
  s_getpc_b64 s[86:87]
L_at_pc2:
  s_add_u32 s86, s86, L_at_sm2-L_at_pc2
  s_addc_u32 s87, s87, 0
  v_mfma_f32_16x16x32_bf16 v[76:79], v[92:95], v[124:127], 0
  v_mfma_f32_16x16x32_bf16 v[80:83], v[96:99], v[124:127], 0
  v_mfma_f32_16x16x32_bf16 v[84:87], v[100:103], v[124:127], 0
  v_mfma_f32_16x16x32_bf16 v[172:175], v[92:95], v[128:131], 0
  v_mfma_f32_16x16x32_bf16 v[176:179], v[96:99], v[128:131], 0
  v_mfma_f32_16x16x32_bf16 v[180:183], v[100:103], v[128:131], 0
  s_nop 0
  v_mfma_f32_16x16x16_bf16 v[76:79], v[104:105], v[156:157], v[76:79]
  v_mfma_f32_16x16x16_bf16 v[80:83], v[106:107], v[156:157], v[80:83]
  v_mfma_f32_16x16x16_bf16 v[84:87], v[140:141], v[156:157], v[84:87]
  v_mfma_f32_16x16x16_bf16 v[172:175], v[104:105], v[160:161], v[172:175]
  v_mfma_f32_16x16x16_bf16 v[176:179], v[106:107], v[160:161], v[176:179]
  v_mfma_f32_16x16x16_bf16 v[180:183], v[140:141], v[160:161], v[180:183]
  s_swappc_b64 s[84:85], s[86:87]
  ds_write_b64 v34, v[76:77] offset:0
  ds_write_b64 v34, v[78:79] offset:8
  ds_write_b64 v34, v[80:81] offset:16
  ds_write_b64 v34, v[82:83] offset:24
  ds_write_b64 v34, v[84:85] offset:32
  ds_write_b64 v34, v[172:173] offset:2560
  ds_write_b64 v34, v[174:175] offset:2568
  ds_write_b64 v34, v[176:177] offset:2576
  ds_write_b64 v34, v[178:179] offset:2584
  ds_write_b64 v34, v[180:181] offset:2592
  v_mfma_f32_16x16x32_bf16 v[76:79], v[92:95], v[132:135], 0
  v_mfma_f32_16x16x32_bf16 v[80:83], v[96:99], v[132:135], 0
  v_mfma_f32_16x16x32_bf16 v[84:87], v[100:103], v[132:135], 0
  v_mfma_f32_16x16x32_bf16 v[172:175], v[92:95], v[136:139], 0
  v_mfma_f32_16x16x32_bf16 v[176:179], v[96:99], v[136:139], 0
  v_mfma_f32_16x16x32_bf16 v[180:183], v[100:103], v[136:139], 0
  s_nop 0
  v_mfma_f32_16x16x16_bf16 v[76:79], v[104:105], v[164:165], v[76:79]
  v_mfma_f32_16x16x16_bf16 v[80:83], v[106:107], v[164:165], v[80:83]
  v_mfma_f32_16x16x16_bf16 v[84:87], v[140:141], v[164:165], v[84:87]
  v_mfma_f32_16x16x16_bf16 v[172:175], v[104:105], v[168:169], v[172:175]
  v_mfma_f32_16x16x16_bf16 v[176:179], v[106:107], v[168:169], v[176:179]
  v_mfma_f32_16x16x16_bf16 v[180:183], v[140:141], v[168:169], v[180:183]
  s_swappc_b64 s[84:85], s[86:87]
  ds_write_b64 v34, v[76:77] offset:5120
  ds_write_b64 v34, v[78:79] offset:5128
  ds_write_b64 v34, v[80:81] offset:5136
  ds_write_b64 v34, v[82:83] offset:5144
  ds_write_b64 v34, v[84:85] offset:5152
  ds_write_b64 v34, v[172:173] offset:7680
  ds_write_b64 v34, v[174:175] offset:7688
  ds_write_b64 v34, v[176:177] offset:7696
  ds_write_b64 v34, v[178:179] offset:7704
  ds_write_b64 v34, v[180:181] offset:7712
  s_cmp_eq_u32 s46, 0
  s_cbranch_scc0 L_at_nopoll0
  s_cmp_eq_u32 s36, 0
  s_cbranch_scc0 L_at_nopoll0
  s_waitcnt vmcnt(0)
  v_readfirstlane_b32 s72, v254
  s_cmp_ge_u32 s72, 64
  s_cbranch_scc1 L_at_nopoll0
  v_mov_b32 v244, 0
L_at_poll0:
  global_load_dword v245, v244, s[50:51] sc1
  s_waitcnt vmcnt(0)
  v_readfirstlane_b32 s44, v245
  s_cmp_ge_u32 s44, 64
  s_cbranch_scc1 L_at_nopoll0
  s_sleep 2
  s_branch L_at_poll0
L_at_nopoll0:
  s_waitcnt lgkmcnt(0)
  s_barrier
  ds_read_b64_tr_b16 v[76:77], v38 offset:0
  ds_read_b64_tr_b16 v[78:79], v38 offset:1536
  ds_read_b64_tr_b16 v[80:81], v38 offset:3072
  ds_read_b64_tr_b16 v[82:83], v38 offset:4608
  ds_read_b64_tr_b16 v[84:85], v38 offset:6144
  ds_read_b64_tr_b16 v[86:87], v38 offset:7680
  ds_read_b64_tr_b16 v[88:89], v38 offset:9216
  ds_read_b64_tr_b16 v[90:91], v38 offset:10752
  s_waitcnt lgkmcnt(6)
  ds_read_b64_tr_b16 v[92:93], v38 offset:12288
  ds_read_b64_tr_b16 v[94:95], v38 offset:13824
  ds_read_b64_tr_b16 v[96:97], v38 offset:15360
  ds_read_b64_tr_b16 v[98:99], v38 offset:16896
  ds_read_b64_tr_b16 v[100:101], v38 offset:18432
  ds_read_b64_tr_b16 v[102:103], v38 offset:19968
  ds_read_b64_tr_b16 v[104:105], v38 offset:21504
  ds_read_b64_tr_b16 v[106:107], v38 offset:23040
  s_waitcnt lgkmcnt(8)
  ds_read_b64_tr_b16 v[108:109], v39 offset:0
  ds_read_b64_tr_b16 v[110:111], v39 offset:2560
  ds_read_b64_tr_b16 v[112:113], v39 offset:5120
  ds_read_b64_tr_b16 v[114:115], v39 offset:7680
  ds_read_b64_tr_b16 v[116:117], v39 offset:10240
  ds_read_b64_tr_b16 v[118:119], v39 offset:12800
  s_waitcnt lgkmcnt(8)
  ds_read_b64_tr_b16 v[120:121], v39 offset:15360
  ds_read_b64_tr_b16 v[122:123], v39 offset:17920
  ds_read_b64_tr_b16 v[124:125], v39 offset:20480
  ds_read_b64_tr_b16 v[126:127], v39 offset:23040
  ds_read_b64_tr_b16 v[128:129], v39 offset:25600
  ds_read_b64_tr_b16 v[130:131], v39 offset:28160
  s_waitcnt lgkmcnt(8)
  ds_read_b64_tr_b16 v[132:133], v39 offset:30720
  ds_read_b64_tr_b16 v[134:135], v39 offset:33280
  ds_read_b64_tr_b16 v[136:137], v39 offset:35840
  ds_read_b64_tr_b16 v[138:139], v39 offset:38400
  s_waitcnt lgkmcnt(8)
  ds_read_b64_tr_b16 v[140:141], v39 offset:32
  ds_read_b64_tr_b16 v[142:143], v39 offset:2592
  ds_read_b64_tr_b16 v[144:145], v39 offset:5152
  ds_read_b64_tr_b16 v[146:147], v39 offset:7712
  ds_read_b64_tr_b16 v[148:149], v39 offset:10272
  ds_read_b64_tr_b16 v[150:151], v39 offset:12832
  s_waitcnt lgkmcnt(8)
  ds_read_b64_tr_b16 v[152:153], v39 offset:15392
  ds_read_b64_tr_b16 v[154:155], v39 offset:17952
  ds_read_b64_tr_b16 v[156:157], v39 offset:20512
  ds_read_b64_tr_b16 v[158:159], v39 offset:23072
  ds_read_b64_tr_b16 v[160:161], v39 offset:25632
  ds_read_b64_tr_b16 v[162:163], v39 offset:28192
  s_waitcnt lgkmcnt(8)
  ds_read_b64_tr_b16 v[164:165], v39 offset:30752
  ds_read_b64_tr_b16 v[166:167], v39 offset:33312
  ds_read_b64_tr_b16 v[168:169], v39 offset:35872
  ds_read_b64_tr_b16 v[170:171], v39 offset:38432
  s_waitcnt lgkmcnt(15)
  s_waitcnt lgkmcnt(0)
  v_mfma_f32_16x16x32_bf16 v[172:175], v[76:79], v[108:111], 0
  v_mfma_f32_16x16x32_bf16 v[172:175], v[80:83], v[112:115], v[172:175]
  v_mfma_f32_16x16x32_bf16 v[172:175], v[84:87], v[116:119], v[172:175]
  v_mfma_f32_16x16x32_bf16 v[172:175], v[88:91], v[120:123], v[172:175]
  v_mfma_f32_16x16x32_bf16 v[172:175], v[92:95], v[124:127], v[172:175]
  v_mfma_f32_16x16x32_bf16 v[172:175], v[96:99], v[128:131], v[172:175]
  v_mfma_f32_16x16x32_bf16 v[172:175], v[100:103], v[132:135], v[172:175]
  v_mfma_f32_16x16x32_bf16 v[172:175], v[104:107], v[136:139], v[172:175]
  s_waitcnt lgkmcnt(8)
  ds_read_b64_tr_b16 v[108:109], v39 offset:64
  ds_read_b64_tr_b16 v[110:111], v39 offset:2624
  ds_read_b64_tr_b16 v[112:113], v39 offset:5184
  ds_read_b64_tr_b16 v[114:115], v39 offset:7744
  ds_read_b64_tr_b16 v[116:117], v39 offset:10304
  ds_read_b64_tr_b16 v[118:119], v39 offset:12864
  s_waitcnt lgkmcnt(8)
  ds_read_b64_tr_b16 v[120:121], v39 offset:15424
  ds_read_b64_tr_b16 v[122:123], v39 offset:17984
  ds_read_b64_tr_b16 v[124:125], v39 offset:20544
  ds_read_b64_tr_b16 v[126:127], v39 offset:23104
  ds_read_b64_tr_b16 v[128:129], v39 offset:25664
  ds_read_b64_tr_b16 v[130:131], v39 offset:28224
  s_waitcnt lgkmcnt(8)
  ds_read_b64_tr_b16 v[132:133], v39 offset:30784
  ds_read_b64_tr_b16 v[134:135], v39 offset:33344
  ds_read_b64_tr_b16 v[136:137], v39 offset:35904
  ds_read_b64_tr_b16 v[138:139], v39 offset:38464
  v_mfma_f32_16x16x32_bf16 v[176:179], v[76:79], v[140:143], 0
  v_mfma_f32_16x16x32_bf16 v[176:179], v[80:83], v[144:147], v[176:179]
  v_mfma_f32_16x16x32_bf16 v[176:179], v[84:87], v[148:151], v[176:179]
  v_mfma_f32_16x16x32_bf16 v[176:179], v[88:91], v[152:155], v[176:179]
  v_mfma_f32_16x16x32_bf16 v[176:179], v[92:95], v[156:159], v[176:179]
  v_mfma_f32_16x16x32_bf16 v[176:179], v[96:99], v[160:163], v[176:179]
  v_mfma_f32_16x16x32_bf16 v[176:179], v[100:103], v[164:167], v[176:179]
  v_mfma_f32_16x16x32_bf16 v[176:179], v[104:107], v[168:171], v[176:179]
  s_waitcnt lgkmcnt(0)
  s_barrier
  v_mfma_f32_16x16x32_bf16 v[180:183], v[76:79], v[108:111], 0
  v_mfma_f32_16x16x32_bf16 v[180:183], v[80:83], v[112:115], v[180:183]
  v_mfma_f32_16x16x32_bf16 v[180:183], v[84:87], v[116:119], v[180:183]
  v_mfma_f32_16x16x32_bf16 v[180:183], v[88:91], v[120:123], v[180:183]
  v_mfma_f32_16x16x32_bf16 v[180:183], v[92:95], v[124:127], v[180:183]
  v_mfma_f32_16x16x32_bf16 v[180:183], v[96:99], v[128:131], v[180:183]
  v_mfma_f32_16x16x32_bf16 v[180:183], v[100:103], v[132:135], v[180:183]
  v_mfma_f32_16x16x32_bf16 v[180:183], v[104:107], v[136:139], v[180:183]
  s_lshl_b32 s44, s32, 1
  s_add_u32 s44, s44, s46
  s_mul_i32 s44, s44, 12288
  s_add_u32 s49, s44, s73
  s_nop 7
  buffer_atomic_add_f32 v172, v40, s[28:31], s49 offen offset:0
  buffer_atomic_add_f32 v173, v40, s[28:31], s49 offen offset:192
  buffer_atomic_add_f32 v174, v40, s[28:31], s49 offen offset:384
  buffer_atomic_add_f32 v175, v40, s[28:31], s49 offen offset:576
  buffer_atomic_add_f32 v176, v40, s[28:31], s49 offen offset:64
  buffer_atomic_add_f32 v177, v40, s[28:31], s49 offen offset:256
  buffer_atomic_add_f32 v178, v40, s[28:31], s49 offen offset:448
  buffer_atomic_add_f32 v179, v40, s[28:31], s49 offen offset:640
  buffer_atomic_add_f32 v180, v40, s[28:31], s49 offen offset:128
  buffer_atomic_add_f32 v181, v40, s[28:31], s49 offen offset:320
  buffer_atomic_add_f32 v182, v40, s[28:31], s49 offen offset:512
  buffer_atomic_add_f32 v183, v40, s[28:31], s49 offen offset:704
  s_add_u32 s46, s46, 1
  s_cmp_lt_u32 s46, 2
  s_cbranch_scc0 L_at_pairs_done
  s_waitcnt lgkmcnt(4)
  v_mfma_f32_16x16x32_bf16 v[76:79], v[48:51], a[0:3], 0
  ds_read_b64_tr_b16 v[60:61], v18 offset:0
  v_mfma_f32_16x16x32_bf16 v[80:83], v[48:51], a[4:7], 0
  ds_read_b64_tr_b16 v[62:63], v18 offset:1024
  v_mfma_f32_16x16x32_bf16 v[84:87], v[48:51], a[8:11], 0
  v_mfma_f32_16x16x32_bf16 v[88:91], v[48:51], a[12:15], 0
  s_waitcnt lgkmcnt(4)
  v_mfma_f32_16x16x32_bf16 v[92:95], v[52:55], a[0:3], 0
  ds_read_b64_tr_b16 v[64:65], v19 offset:0
  v_mfma_f32_16x16x32_bf16 v[96:99], v[52:55], a[4:7], 0
  ds_read_b64_tr_b16 v[66:67], v19 offset:1024
  v_mfma_f32_16x16x32_bf16 v[100:103], v[52:55], a[8:11], 0
  s_add_u32 m0, s43, 49152
  v_mfma_f32_16x16x32_bf16 v[104:107], v[52:55], a[12:15], 0
  s_add_u32 s44, s56, 0
  s_waitcnt lgkmcnt(4)
  v_mfma_f32_16x16x32_bf16 v[108:111], v[56:59], a[0:3], 0
  ds_read_b64_tr_b16 v[68:69], v20 offset:0
  v_mfma_f32_16x16x32_bf16 v[112:115], v[56:59], a[4:7], 0
  ds_read_b64_tr_b16 v[70:71], v20 offset:1024
  v_mfma_f32_16x16x32_bf16 v[116:119], v[56:59], a[8:11], 0
  buffer_load_dwordx4 v8, s[12:15], s44 offen lds
  v_mfma_f32_16x16x32_bf16 v[120:123], v[56:59], a[12:15], 0
  s_add_u32 m0, s43, 53248
  s_waitcnt lgkmcnt(4)
  v_mfma_f32_16x16x32_bf16 v[124:127], v[60:63], a[0:3], 0
  ds_read_b64_tr_b16 v[72:73], v21 offset:0
  v_mfma_f32_16x16x32_bf16 v[128:131], v[60:63], a[4:7], 0
  ds_read_b64_tr_b16 v[74:75], v21 offset:1024
  v_mfma_f32_16x16x32_bf16 v[132:135], v[60:63], a[8:11], 0
  s_add_u32 s44, s56, 55296
  v_mfma_f32_16x16x32_bf16 v[136:139], v[60:63], a[12:15], 0
  buffer_load_dwordx4 v8, s[12:15], s44 offen lds
  s_waitcnt lgkmcnt(4)
  v_mfma_f32_16x16x32_bf16 v[140:143], v[64:67], a[0:3], 0
  ds_read_b64_tr_b16 v[48:49], v15 offset:8192
  v_mfma_f32_16x16x32_bf16 v[144:147], v[64:67], a[4:7], 0
  ds_read_b64_tr_b16 v[50:51], v15 offset:9216
  v_mfma_f32_16x16x32_bf16 v[148:151], v[64:67], a[8:11], 0
  s_add_u32 m0, s43, 57344
  v_mfma_f32_16x16x32_bf16 v[152:155], v[64:67], a[12:15], 0
  s_waitcnt lgkmcnt(4)
  v_mfma_f32_16x16x32_bf16 v[156:159], v[68:71], a[0:3], 0
  ds_read_b64_tr_b16 v[52:53], v16 offset:8192
  v_mfma_f32_16x16x32_bf16 v[160:163], v[68:71], a[4:7], 0
  ds_read_b64_tr_b16 v[54:55], v16 offset:9216
  v_mfma_f32_16x16x32_bf16 v[164:167], v[68:71], a[8:11], 0
  s_add_u32 s44, s56, 110592
  v_mfma_f32_16x16x32_bf16 v[168:171], v[68:71], a[12:15], 0
  s_waitcnt lgkmcnt(4)
  v_mfma_f32_16x16x32_bf16 v[172:175], v[72:75], a[0:3], 0
  ds_read_b64_tr_b16 v[56:57], v17 offset:8192
  v_mfma_f32_16x16x32_bf16 v[176:179], v[72:75], a[4:7], 0
  ds_read_b64_tr_b16 v[58:59], v17 offset:9216
  v_mfma_f32_16x16x32_bf16 v[180:183], v[72:75], a[8:11], 0
  buffer_load_dwordx4 v8, s[12:15], s44 offen lds
  v_mfma_f32_16x16x32_bf16 v[184:187], v[72:75], a[12:15], 0
  s_waitcnt lgkmcnt(4)
  v_mfma_f32_16x16x32_bf16 v[76:79], v[48:51], a[16:19], v[76:79]
  ds_read_b64_tr_b16 v[60:61], v18 offset:8192
  v_mfma_f32_16x16x32_bf16 v[80:83], v[48:51], a[20:23], v[80:83]
  ds_read_b64_tr_b16 v[62:63], v18 offset:9216
  v_mfma_f32_16x16x32_bf16 v[84:87], v[48:51], a[24:27], v[84:87]
  v_mfma_f32_16x16x32_bf16 v[88:91], v[48:51], a[28:31], v[88:91]
  s_waitcnt lgkmcnt(4)
  v_mfma_f32_16x16x32_bf16 v[92:95], v[52:55], a[16:19], v[92:95]
  ds_read_b64_tr_b16 v[64:65], v19 offset:8192
  v_mfma_f32_16x16x32_bf16 v[96:99], v[52:55], a[20:23], v[96:99]
  ds_read_b64_tr_b16 v[66:67], v19 offset:9216
  v_mfma_f32_16x16x32_bf16 v[100:103], v[52:55], a[24:27], v[100:103]
  s_add_u32 m0, s43, 61440
  v_mfma_f32_16x16x32_bf16 v[104:107], v[52:55], a[28:31], v[104:107]
  s_add_u32 s44, s56, 165888
  s_waitcnt lgkmcnt(4)
  v_mfma_f32_16x16x32_bf16 v[108:111], v[56:59], a[16:19], v[108:111]
  ds_read_b64_tr_b16 v[68:69], v20 offset:8192
  v_mfma_f32_16x16x32_bf16 v[112:115], v[56:59], a[20:23], v[112:115]
  ds_read_b64_tr_b16 v[70:71], v20 offset:9216
  v_mfma_f32_16x16x32_bf16 v[116:119], v[56:59], a[24:27], v[116:119]
  buffer_load_dwordx4 v8, s[12:15], s44 offen lds
  v_mfma_f32_16x16x32_bf16 v[120:123], v[56:59], a[28:31], v[120:123]
  s_add_u32 m0, s43, 65536
  s_waitcnt lgkmcnt(4)
  v_mfma_f32_16x16x32_bf16 v[124:127], v[60:63], a[16:19], v[124:127]
  ds_read_b64_tr_b16 v[72:73], v21 offset:8192
  v_mfma_f32_16x16x32_bf16 v[128:131], v[60:63], a[20:23], v[128:131]
  ds_read_b64_tr_b16 v[74:75], v21 offset:9216
  v_mfma_f32_16x16x32_bf16 v[132:135], v[60:63], a[24:27], v[132:135]
  s_add_u32 s44, s56, 221184
  v_mfma_f32_16x16x32_bf16 v[136:139], v[60:63], a[28:31], v[136:139]
  buffer_load_dwordx4 v8, s[12:15], s44 offen lds
  s_waitcnt lgkmcnt(4)
  v_mfma_f32_16x16x32_bf16 v[140:143], v[64:67], a[16:19], v[140:143]
  ds_read_b64_tr_b16 v[48:49], v15 offset:16384
  v_mfma_f32_16x16x32_bf16 v[144:147], v[64:67], a[20:23], v[144:147]
  ds_read_b64_tr_b16 v[50:51], v15 offset:17408
  v_mfma_f32_16x16x32_bf16 v[148:151], v[64:67], a[24:27], v[148:151]
  s_add_u32 m0, s43, 69632
  v_mfma_f32_16x16x32_bf16 v[152:155], v[64:67], a[28:31], v[152:155]
  s_add_u32 s44, s56, 276480
  s_waitcnt lgkmcnt(4)
  v_mfma_f32_16x16x32_bf16 v[156:159], v[68:71], a[16:19], v[156:159]
  ds_read_b64_tr_b16 v[52:53], v16 offset:16384
  v_mfma_f32_16x16x32_bf16 v[160:163], v[68:71], a[20:23], v[160:163]
  ds_read_b64_tr_b16 v[54:55], v16 offset:17408
  v_mfma_f32_16x16x32_bf16 v[164:167], v[68:71], a[24:27], v[164:167]
  buffer_load_dwordx4 v8, s[12:15], s44 offen lds
  v_mfma_f32_16x16x32_bf16 v[168:171], v[68:71], a[28:31], v[168:171]
  s_waitcnt lgkmcnt(4)
  v_mfma_f32_16x16x32_bf16 v[172:175], v[72:75], a[16:19], v[172:175]
  ds_read_b64_tr_b16 v[56:57], v17 offset:16384
  v_mfma_f32_16x16x32_bf16 v[176:179], v[72:75], a[20:23], v[176:179]
  ds_read_b64_tr_b16 v[58:59], v17 offset:17408
  v_mfma_f32_16x16x32_bf16 v[180:183], v[72:75], a[24:27], v[180:183]
  s_add_u32 s56, s56, 331776
  v_mfma_f32_16x16x32_bf16 v[184:187], v[72:75], a[28:31], v[184:187]
  s_waitcnt lgkmcnt(4)
  v_mfma_f32_16x16x32_bf16 v[76:79], v[48:51], a[32:35], v[76:79]
  ds_read_b64_tr_b16 v[60:61], v18 offset:16384
  v_mfma_f32_16x16x32_bf16 v[80:83], v[48:51], a[36:39], v[80:83]
  ds_read_b64_tr_b16 v[62:63], v18 offset:17408
  v_mfma_f32_16x16x32_bf16 v[84:87], v[48:51], a[40:43], v[84:87]
  v_mfma_f32_16x16x32_bf16 v[88:91], v[48:51], a[44:47], v[88:91]
  s_waitcnt lgkmcnt(4)
  v_mfma_f32_16x16x32_bf16 v[92:95], v[52:55], a[32:35], v[92:95]
  ds_read_b64_tr_b16 v[64:65], v19 offset:16384
  v_mfma_f32_16x16x32_bf16 v[96:99], v[52:55], a[36:39], v[96:99]
  ds_read_b64_tr_b16 v[66:67], v19 offset:17408
  v_mfma_f32_16x16x32_bf16 v[100:103], v[52:55], a[40:43], v[100:103]
  v_mfma_f32_16x16x32_bf16 v[104:107], v[52:55], a[44:47], v[104:107]
  s_waitcnt lgkmcnt(4)
  v_mfma_f32_16x16x32_bf16 v[108:111], v[56:59], a[32:35], v[108:111]
  ds_read_b64_tr_b16 v[68:69], v20 offset:16384
  v_mfma_f32_16x16x32_bf16 v[112:115], v[56:59], a[36:39], v[112:115]
  ds_read_b64_tr_b16 v[70:71], v20 offset:17408
  v_mfma_f32_16x16x32_bf16 v[116:119], v[56:59], a[40:43], v[116:119]
  v_mfma_f32_16x16x32_bf16 v[120:123], v[56:59], a[44:47], v[120:123]
  s_waitcnt lgkmcnt(4)
  v_mfma_f32_16x16x32_bf16 v[124:127], v[60:63], a[32:35], v[124:127]
  ds_read_b64_tr_b16 v[72:73], v21 offset:16384
  v_mfma_f32_16x16x32_bf16 v[128:131], v[60:63], a[36:39], v[128:131]
  ds_read_b64_tr_b16 v[74:75], v21 offset:17408
  v_mfma_f32_16x16x32_bf16 v[132:135], v[60:63], a[40:43], v[132:135]
  v_mfma_f32_16x16x32_bf16 v[136:139], v[60:63], a[44:47], v[136:139]
  s_waitcnt vmcnt(18)
  s_barrier
  s_waitcnt lgkmcnt(4)
  v_mfma_f32_16x16x32_bf16 v[140:143], v[64:67], a[32:35], v[140:143]
  ds_read_b64_tr_b16 v[48:49], v15 offset:24576
  v_mfma_f32_16x16x32_bf16 v[144:147], v[64:67], a[36:39], v[144:147]
  ds_read_b64_tr_b16 v[50:51], v15 offset:25600
  v_mfma_f32_16x16x32_bf16 v[148:151], v[64:67], a[40:43], v[148:151]
  v_mfma_f32_16x16x32_bf16 v[152:155], v[64:67], a[44:47], v[152:155]
  s_waitcnt lgkmcnt(4)
  v_mfma_f32_16x16x32_bf16 v[156:159], v[68:71], a[32:35], v[156:159]
  ds_read_b64_tr_b16 v[52:53], v16 offset:24576
  v_mfma_f32_16x16x32_bf16 v[160:163], v[68:71], a[36:39], v[160:163]
  ds_read_b64_tr_b16 v[54:55], v16 offset:25600
  v_mfma_f32_16x16x32_bf16 v[164:167], v[68:71], a[40:43], v[164:167]
  v_mfma_f32_16x16x32_bf16 v[168:171], v[68:71], a[44:47], v[168:171]
  s_waitcnt lgkmcnt(4)
  v_mfma_f32_16x16x32_bf16 v[172:175], v[72:75], a[32:35], v[172:175]
  ds_read_b64_tr_b16 v[56:57], v17 offset:24576
  v_mfma_f32_16x16x32_bf16 v[176:179], v[72:75], a[36:39], v[176:179]
  ds_read_b64_tr_b16 v[58:59], v17 offset:25600
  v_mfma_f32_16x16x32_bf16 v[180:183], v[72:75], a[40:43], v[180:183]
  v_mfma_f32_16x16x32_bf16 v[184:187], v[72:75], a[44:47], v[184:187]
  s_waitcnt lgkmcnt(4)
  v_mfma_f32_16x16x32_bf16 v[76:79], v[48:51], a[48:51], v[76:79]
  ds_read_b64_tr_b16 v[60:61], v18 offset:24576
  v_mfma_f32_16x16x32_bf16 v[80:83], v[48:51], a[52:55], v[80:83]
  ds_read_b64_tr_b16 v[62:63], v18 offset:25600
  v_mfma_f32_16x16x32_bf16 v[84:87], v[48:51], a[56:59], v[84:87]
  v_mfma_f32_16x16x32_bf16 v[88:91], v[48:51], a[60:63], v[88:91]
  s_waitcnt lgkmcnt(4)
  v_mfma_f32_16x16x32_bf16 v[92:95], v[52:55], a[48:51], v[92:95]
  ds_read_b64_tr_b16 v[64:65], v19 offset:24576
  v_mfma_f32_16x16x32_bf16 v[96:99], v[52:55], a[52:55], v[96:99]
  ds_read_b64_tr_b16 v[66:67], v19 offset:25600
  v_mfma_f32_16x16x32_bf16 v[100:103], v[52:55], a[56:59], v[100:103]
  s_add_u32 m0, s43, 0
  v_mfma_f32_16x16x32_bf16 v[104:107], v[52:55], a[60:63], v[104:107]
  s_add_u32 s44, s56, 0
  s_waitcnt lgkmcnt(4)
  v_mfma_f32_16x16x32_bf16 v[108:111], v[56:59], a[48:51], v[108:111]
  ds_read_b64_tr_b16 v[68:69], v20 offset:24576
  v_mfma_f32_16x16x32_bf16 v[112:115], v[56:59], a[52:55], v[112:115]
  ds_read_b64_tr_b16 v[70:71], v20 offset:25600
  v_mfma_f32_16x16x32_bf16 v[116:119], v[56:59], a[56:59], v[116:119]
  buffer_load_dwordx4 v8, s[12:15], s44 offen lds
  v_mfma_f32_16x16x32_bf16 v[120:123], v[56:59], a[60:63], v[120:123]
  s_add_u32 m0, s43, 4096
  s_waitcnt lgkmcnt(4)
  v_mfma_f32_16x16x32_bf16 v[124:127], v[60:63], a[48:51], v[124:127]
  ds_read_b64_tr_b16 v[72:73], v21 offset:24576
  v_mfma_f32_16x16x32_bf16 v[128:131], v[60:63], a[52:55], v[128:131]
  ds_read_b64_tr_b16 v[74:75], v21 offset:25600
  v_mfma_f32_16x16x32_bf16 v[132:135], v[60:63], a[56:59], v[132:135]
  s_add_u32 s44, s56, 55296
  v_mfma_f32_16x16x32_bf16 v[136:139], v[60:63], a[60:63], v[136:139]
  buffer_load_dwordx4 v8, s[12:15], s44 offen lds
  s_waitcnt lgkmcnt(4)
  v_mfma_f32_16x16x32_bf16 v[140:143], v[64:67], a[48:51], v[140:143]
  ds_read_b64_tr_b16 v[48:49], v15 offset:32768
  v_mfma_f32_16x16x32_bf16 v[144:147], v[64:67], a[52:55], v[144:147]
  ds_read_b64_tr_b16 v[50:51], v15 offset:33792
  v_mfma_f32_16x16x32_bf16 v[148:151], v[64:67], a[56:59], v[148:151]
  s_add_u32 m0, s43, 8192
  v_mfma_f32_16x16x32_bf16 v[152:155], v[64:67], a[60:63], v[152:155]
  s_waitcnt lgkmcnt(4)
  v_mfma_f32_16x16x32_bf16 v[156:159], v[68:71], a[48:51], v[156:159]
  ds_read_b64_tr_b16 v[52:53], v16 offset:32768
  v_mfma_f32_16x16x32_bf16 v[160:163], v[68:71], a[52:55], v[160:163]
  ds_read_b64_tr_b16 v[54:55], v16 offset:33792
  v_mfma_f32_16x16x32_bf16 v[164:167], v[68:71], a[56:59], v[164:167]
  s_add_u32 s44, s56, 110592
  v_mfma_f32_16x16x32_bf16 v[168:171], v[68:71], a[60:63], v[168:171]
  s_waitcnt lgkmcnt(4)
  v_mfma_f32_16x16x32_bf16 v[172:175], v[72:75], a[48:51], v[172:175]
  ds_read_b64_tr_b16 v[56:57], v17 offset:32768
  v_mfma_f32_16x16x32_bf16 v[176:179], v[72:75], a[52:55], v[176:179]
  ds_read_b64_tr_b16 v[58:59], v17 offset:33792
  v_mfma_f32_16x16x32_bf16 v[180:183], v[72:75], a[56:59], v[180:183]
  buffer_load_dwordx4 v8, s[12:15], s44 offen lds
  v_mfma_f32_16x16x32_bf16 v[184:187], v[72:75], a[60:63], v[184:187]
  s_waitcnt lgkmcnt(4)
  v_mfma_f32_16x16x32_bf16 v[76:79], v[48:51], a[64:67], v[76:79]
  ds_read_b64_tr_b16 v[60:61], v18 offset:32768
  v_mfma_f32_16x16x32_bf16 v[80:83], v[48:51], a[68:71], v[80:83]
  ds_read_b64_tr_b16 v[62:63], v18 offset:33792
  v_mfma_f32_16x16x32_bf16 v[84:87], v[48:51], a[72:75], v[84:87]
  v_mfma_f32_16x16x32_bf16 v[88:91], v[48:51], a[76:79], v[88:91]
  s_waitcnt lgkmcnt(4)
  v_mfma_f32_16x16x32_bf16 v[92:95], v[52:55], a[64:67], v[92:95]
  ds_read_b64_tr_b16 v[64:65], v19 offset:32768
  v_mfma_f32_16x16x32_bf16 v[96:99], v[52:55], a[68:71], v[96:99]
  ds_read_b64_tr_b16 v[66:67], v19 offset:33792
  v_mfma_f32_16x16x32_bf16 v[100:103], v[52:55], a[72:75], v[100:103]
  s_add_u32 m0, s43, 12288
  v_mfma_f32_16x16x32_bf16 v[104:107], v[52:55], a[76:79], v[104:107]
  s_add_u32 s44, s56, 165888
  s_waitcnt lgkmcnt(4)
  v_mfma_f32_16x16x32_bf16 v[108:111], v[56:59], a[64:67], v[108:111]
  ds_read_b64_tr_b16 v[68:69], v20 offset:32768
  v_mfma_f32_16x16x32_bf16 v[112:115], v[56:59], a[68:71], v[112:115]
  ds_read_b64_tr_b16 v[70:71], v20 offset:33792
  v_mfma_f32_16x16x32_bf16 v[116:119], v[56:59], a[72:75], v[116:119]
  buffer_load_dwordx4 v8, s[12:15], s44 offen lds
  v_mfma_f32_16x16x32_bf16 v[120:123], v[56:59], a[76:79], v[120:123]
  s_add_u32 m0, s43, 16384
  s_waitcnt lgkmcnt(4)
  v_mfma_f32_16x16x32_bf16 v[124:127], v[60:63], a[64:67], v[124:127]
  ds_read_b64_tr_b16 v[72:73], v21 offset:32768
  v_mfma_f32_16x16x32_bf16 v[128:131], v[60:63], a[68:71], v[128:131]
  ds_read_b64_tr_b16 v[74:75], v21 offset:33792
  v_mfma_f32_16x16x32_bf16 v[132:135], v[60:63], a[72:75], v[132:135]
  s_add_u32 s44, s56, 221184
  v_mfma_f32_16x16x32_bf16 v[136:139], v[60:63], a[76:79], v[136:139]
  buffer_load_dwordx4 v8, s[12:15], s44 offen lds
  s_waitcnt lgkmcnt(4)
  v_mfma_f32_16x16x32_bf16 v[140:143], v[64:67], a[64:67], v[140:143]
  ds_read_b64_tr_b16 v[48:49], v15 offset:40960
  v_mfma_f32_16x16x32_bf16 v[144:147], v[64:67], a[68:71], v[144:147]
  ds_read_b64_tr_b16 v[50:51], v15 offset:41984
  v_mfma_f32_16x16x32_bf16 v[148:151], v[64:67], a[72:75], v[148:151]
  s_add_u32 m0, s43, 20480
  v_mfma_f32_16x16x32_bf16 v[152:155], v[64:67], a[76:79], v[152:155]
  s_add_u32 s44, s56, 276480
  s_waitcnt lgkmcnt(4)
  v_mfma_f32_16x16x32_bf16 v[156:159], v[68:71], a[64:67], v[156:159]
  ds_read_b64_tr_b16 v[52:53], v16 offset:40960
  v_mfma_f32_16x16x32_bf16 v[160:163], v[68:71], a[68:71], v[160:163]
  ds_read_b64_tr_b16 v[54:55], v16 offset:41984
  v_mfma_f32_16x16x32_bf16 v[164:167], v[68:71], a[72:75], v[164:167]
  buffer_load_dwordx4 v8, s[12:15], s44 offen lds
  v_mfma_f32_16x16x32_bf16 v[168:171], v[68:71], a[76:79], v[168:171]
  s_waitcnt lgkmcnt(4)
  v_mfma_f32_16x16x32_bf16 v[172:175], v[72:75], a[64:67], v[172:175]
  ds_read_b64_tr_b16 v[56:57], v17 offset:40960
  v_mfma_f32_16x16x32_bf16 v[176:179], v[72:75], a[68:71], v[176:179]
  ds_read_b64_tr_b16 v[58:59], v17 offset:41984
  v_mfma_f32_16x16x32_bf16 v[180:183], v[72:75], a[72:75], v[180:183]
  s_add_u32 s56, s56, 331776
  v_mfma_f32_16x16x32_bf16 v[184:187], v[72:75], a[76:79], v[184:187]
  s_waitcnt lgkmcnt(4)
  v_mfma_f32_16x16x32_bf16 v[76:79], v[48:51], a[80:83], v[76:79]
  ds_read_b64_tr_b16 v[60:61], v18 offset:40960
  v_mfma_f32_16x16x32_bf16 v[80:83], v[48:51], a[84:87], v[80:83]
  ds_read_b64_tr_b16 v[62:63], v18 offset:41984
  v_mfma_f32_16x16x32_bf16 v[84:87], v[48:51], a[88:91], v[84:87]
  v_mfma_f32_16x16x32_bf16 v[88:91], v[48:51], a[92:95], v[88:91]
  s_waitcnt lgkmcnt(4)
  v_mfma_f32_16x16x32_bf16 v[92:95], v[52:55], a[80:83], v[92:95]
  ds_read_b64_tr_b16 v[64:65], v19 offset:40960
  v_mfma_f32_16x16x32_bf16 v[96:99], v[52:55], a[84:87], v[96:99]
  ds_read_b64_tr_b16 v[66:67], v19 offset:41984
  v_mfma_f32_16x16x32_bf16 v[100:103], v[52:55], a[88:91], v[100:103]
  v_mfma_f32_16x16x32_bf16 v[104:107], v[52:55], a[92:95], v[104:107]
  s_waitcnt lgkmcnt(4)
  v_mfma_f32_16x16x32_bf16 v[108:111], v[56:59], a[80:83], v[108:111]
  ds_read_b64_tr_b16 v[68:69], v20 offset:40960
  v_mfma_f32_16x16x32_bf16 v[112:115], v[56:59], a[84:87], v[112:115]
  ds_read_b64_tr_b16 v[70:71], v20 offset:41984
  v_mfma_f32_16x16x32_bf16 v[116:119], v[56:59], a[88:91], v[116:119]
  v_mfma_f32_16x16x32_bf16 v[120:123], v[56:59], a[92:95], v[120:123]
  s_waitcnt lgkmcnt(4)
  v_mfma_f32_16x16x32_bf16 v[124:127], v[60:63], a[80:83], v[124:127]
  ds_read_b64_tr_b16 v[72:73], v21 offset:40960
  v_mfma_f32_16x16x32_bf16 v[128:131], v[60:63], a[84:87], v[128:131]
  ds_read_b64_tr_b16 v[74:75], v21 offset:41984
  v_mfma_f32_16x16x32_bf16 v[132:135], v[60:63], a[88:91], v[132:135]
  v_mfma_f32_16x16x32_bf16 v[136:139], v[60:63], a[92:95], v[136:139]
  s_waitcnt vmcnt(6)
  s_barrier
  s_waitcnt lgkmcnt(4)
  v_mfma_f32_16x16x32_bf16 v[140:143], v[64:67], a[80:83], v[140:143]
  ds_read_b64_tr_b16 v[48:49], v22 offset:0
  v_mfma_f32_16x16x32_bf16 v[144:147], v[64:67], a[84:87], v[144:147]
  ds_read_b64_tr_b16 v[50:51], v22 offset:1024
  v_mfma_f32_16x16x32_bf16 v[148:151], v[64:67], a[88:91], v[148:151]
  v_mfma_f32_16x16x32_bf16 v[152:155], v[64:67], a[92:95], v[152:155]
  s_waitcnt lgkmcnt(4)
  v_mfma_f32_16x16x32_bf16 v[156:159], v[68:71], a[80:83], v[156:159]
  ds_read_b64_tr_b16 v[52:53], v23 offset:0
  v_mfma_f32_16x16x32_bf16 v[160:163], v[68:71], a[84:87], v[160:163]
  ds_read_b64_tr_b16 v[54:55], v23 offset:1024
  v_mfma_f32_16x16x32_bf16 v[164:167], v[68:71], a[88:91], v[164:167]
  v_mfma_f32_16x16x32_bf16 v[168:171], v[68:71], a[92:95], v[168:171]
  s_waitcnt lgkmcnt(4)
  v_mfma_f32_16x16x32_bf16 v[172:175], v[72:75], a[80:83], v[172:175]
  ds_read_b64_tr_b16 v[56:57], v24 offset:0
  v_mfma_f32_16x16x32_bf16 v[176:179], v[72:75], a[84:87], v[176:179]
  ds_read_b64_tr_b16 v[58:59], v24 offset:1024
  v_mfma_f32_16x16x32_bf16 v[180:183], v[72:75], a[88:91], v[180:183]
  v_mfma_f32_16x16x32_bf16 v[184:187], v[72:75], a[92:95], v[184:187]
  s_waitcnt lgkmcnt(4)
  v_mfma_f32_16x16x32_bf16 v[76:79], v[48:51], a[96:99], v[76:79]
  ds_read_b64_tr_b16 v[60:61], v25 offset:0
  v_mfma_f32_16x16x32_bf16 v[80:83], v[48:51], a[100:103], v[80:83]
  ds_read_b64_tr_b16 v[62:63], v25 offset:1024
  v_mfma_f32_16x16x32_bf16 v[84:87], v[48:51], a[104:107], v[84:87]
  v_mfma_f32_16x16x32_bf16 v[88:91], v[48:51], a[108:111], v[88:91]
  s_waitcnt lgkmcnt(4)
  v_mfma_f32_16x16x32_bf16 v[92:95], v[52:55], a[96:99], v[92:95]
  ds_read_b64_tr_b16 v[64:65], v26 offset:0
  v_mfma_f32_16x16x32_bf16 v[96:99], v[52:55], a[100:103], v[96:99]
  ds_read_b64_tr_b16 v[66:67], v26 offset:1024
  v_mfma_f32_16x16x32_bf16 v[100:103], v[52:55], a[104:107], v[100:103]
  s_add_u32 m0, s43, 24576
  v_mfma_f32_16x16x32_bf16 v[104:107], v[52:55], a[108:111], v[104:107]
  s_add_u32 s44, s56, 0
  s_waitcnt lgkmcnt(4)
  v_mfma_f32_16x16x32_bf16 v[108:111], v[56:59], a[96:99], v[108:111]
  ds_read_b64_tr_b16 v[68:69], v27 offset:0
  v_mfma_f32_16x16x32_bf16 v[112:115], v[56:59], a[100:103], v[112:115]
  ds_read_b64_tr_b16 v[70:71], v27 offset:1024
  v_mfma_f32_16x16x32_bf16 v[116:119], v[56:59], a[104:107], v[116:119]
  buffer_load_dwordx4 v8, s[12:15], s44 offen lds
  v_mfma_f32_16x16x32_bf16 v[120:123], v[56:59], a[108:111], v[120:123]
  s_add_u32 m0, s43, 28672
  s_waitcnt lgkmcnt(4)
  v_mfma_f32_16x16x32_bf16 v[124:127], v[60:63], a[96:99], v[124:127]
  ds_read_b64_tr_b16 v[72:73], v28 offset:0
  v_mfma_f32_16x16x32_bf16 v[128:131], v[60:63], a[100:103], v[128:131]
  ds_read_b64_tr_b16 v[74:75], v28 offset:1024
  v_mfma_f32_16x16x32_bf16 v[132:135], v[60:63], a[104:107], v[132:135]
  s_add_u32 s44, s56, 55296
  v_mfma_f32_16x16x32_bf16 v[136:139], v[60:63], a[108:111], v[136:139]
  buffer_load_dwordx4 v8, s[12:15], s44 offen lds
  s_waitcnt lgkmcnt(4)
  v_mfma_f32_16x16x32_bf16 v[140:143], v[64:67], a[96:99], v[140:143]
  ds_read_b64_tr_b16 v[48:49], v22 offset:8192
  v_mfma_f32_16x16x32_bf16 v[144:147], v[64:67], a[100:103], v[144:147]
  ds_read_b64_tr_b16 v[50:51], v22 offset:9216
  v_mfma_f32_16x16x32_bf16 v[148:151], v[64:67], a[104:107], v[148:151]
  s_add_u32 m0, s43, 32768
  v_mfma_f32_16x16x32_bf16 v[152:155], v[64:67], a[108:111], v[152:155]
  s_waitcnt lgkmcnt(4)
  v_mfma_f32_16x16x32_bf16 v[156:159], v[68:71], a[96:99], v[156:159]
  ds_read_b64_tr_b16 v[52:53], v23 offset:8192
  v_mfma_f32_16x16x32_bf16 v[160:163], v[68:71], a[100:103], v[160:163]
  ds_read_b64_tr_b16 v[54:55], v23 offset:9216
  v_mfma_f32_16x16x32_bf16 v[164:167], v[68:71], a[104:107], v[164:167]
  s_add_u32 s44, s56, 110592
  v_mfma_f32_16x16x32_bf16 v[168:171], v[68:71], a[108:111], v[168:171]
  s_waitcnt lgkmcnt(4)
  v_mfma_f32_16x16x32_bf16 v[172:175], v[72:75], a[96:99], v[172:175]
  ds_read_b64_tr_b16 v[56:57], v24 offset:8192
  v_mfma_f32_16x16x32_bf16 v[176:179], v[72:75], a[100:103], v[176:179]
  ds_read_b64_tr_b16 v[58:59], v24 offset:9216
  v_mfma_f32_16x16x32_bf16 v[180:183], v[72:75], a[104:107], v[180:183]
  buffer_load_dwordx4 v8, s[12:15], s44 offen lds
  v_mfma_f32_16x16x32_bf16 v[184:187], v[72:75], a[108:111], v[184:187]
  s_waitcnt lgkmcnt(4)
  v_mfma_f32_16x16x32_bf16 v[76:79], v[48:51], a[112:115], v[76:79]
  ds_read_b64_tr_b16 v[60:61], v25 offset:8192
  v_mfma_f32_16x16x32_bf16 v[80:83], v[48:51], a[116:119], v[80:83]
  ds_read_b64_tr_b16 v[62:63], v25 offset:9216
  v_mfma_f32_16x16x32_bf16 v[84:87], v[48:51], a[120:123], v[84:87]
  v_mfma_f32_16x16x32_bf16 v[88:91], v[48:51], a[124:127], v[88:91]
  s_waitcnt lgkmcnt(4)
  v_mfma_f32_16x16x32_bf16 v[92:95], v[52:55], a[112:115], v[92:95]
  ds_read_b64_tr_b16 v[64:65], v26 offset:8192
  v_mfma_f32_16x16x32_bf16 v[96:99], v[52:55], a[116:119], v[96:99]
  ds_read_b64_tr_b16 v[66:67], v26 offset:9216
  v_mfma_f32_16x16x32_bf16 v[100:103], v[52:55], a[120:123], v[100:103]
  s_add_u32 m0, s43, 36864
  v_mfma_f32_16x16x32_bf16 v[104:107], v[52:55], a[124:127], v[104:107]
  s_add_u32 s44, s56, 165888
  s_waitcnt lgkmcnt(4)
  v_mfma_f32_16x16x32_bf16 v[108:111], v[56:59], a[112:115], v[108:111]
  ds_read_b64_tr_b16 v[68:69], v27 offset:8192
  v_mfma_f32_16x16x32_bf16 v[112:115], v[56:59], a[116:119], v[112:115]
  ds_read_b64_tr_b16 v[70:71], v27 offset:9216
  v_mfma_f32_16x16x32_bf16 v[116:119], v[56:59], a[120:123], v[116:119]
  buffer_load_dwordx4 v8, s[12:15], s44 offen lds
  v_mfma_f32_16x16x32_bf16 v[120:123], v[56:59], a[124:127], v[120:123]
  s_add_u32 m0, s43, 40960
  s_waitcnt lgkmcnt(4)
  v_mfma_f32_16x16x32_bf16 v[124:127], v[60:63], a[112:115], v[124:127]
  ds_read_b64_tr_b16 v[72:73], v28 offset:8192
  v_mfma_f32_16x16x32_bf16 v[128:131], v[60:63], a[116:119], v[128:131]
  ds_read_b64_tr_b16 v[74:75], v28 offset:9216
  v_mfma_f32_16x16x32_bf16 v[132:135], v[60:63], a[120:123], v[132:135]
  s_add_u32 s44, s56, 221184
  v_mfma_f32_16x16x32_bf16 v[136:139], v[60:63], a[124:127], v[136:139]
  buffer_load_dwordx4 v8, s[12:15], s44 offen lds
  s_waitcnt lgkmcnt(4)
  v_mfma_f32_16x16x32_bf16 v[140:143], v[64:67], a[112:115], v[140:143]
  ds_read_b64_tr_b16 v[48:49], v22 offset:16384
  v_mfma_f32_16x16x32_bf16 v[144:147], v[64:67], a[116:119], v[144:147]
  ds_read_b64_tr_b16 v[50:51], v22 offset:17408
  v_mfma_f32_16x16x32_bf16 v[148:151], v[64:67], a[120:123], v[148:151]
  s_add_u32 m0, s43, 45056
  v_mfma_f32_16x16x32_bf16 v[152:155], v[64:67], a[124:127], v[152:155]
  s_add_u32 s44, s56, 276480
  s_waitcnt lgkmcnt(4)
  v_mfma_f32_16x16x32_bf16 v[156:159], v[68:71], a[112:115], v[156:159]
  ds_read_b64_tr_b16 v[52:53], v23 offset:16384
  v_mfma_f32_16x16x32_bf16 v[160:163], v[68:71], a[116:119], v[160:163]
  ds_read_b64_tr_b16 v[54:55], v23 offset:17408
  v_mfma_f32_16x16x32_bf16 v[164:167], v[68:71], a[120:123], v[164:167]
  buffer_load_dwordx4 v8, s[12:15], s44 offen lds
  v_mfma_f32_16x16x32_bf16 v[168:171], v[68:71], a[124:127], v[168:171]
  s_waitcnt lgkmcnt(4)
  v_mfma_f32_16x16x32_bf16 v[172:175], v[72:75], a[112:115], v[172:175]
  ds_read_b64_tr_b16 v[56:57], v24 offset:16384
  v_mfma_f32_16x16x32_bf16 v[176:179], v[72:75], a[116:119], v[176:179]
  ds_read_b64_tr_b16 v[58:59], v24 offset:17408
  v_mfma_f32_16x16x32_bf16 v[180:183], v[72:75], a[120:123], v[180:183]
  s_add_u32 s56, s56, 331776
  v_mfma_f32_16x16x32_bf16 v[184:187], v[72:75], a[124:127], v[184:187]
  s_waitcnt lgkmcnt(4)
  v_mfma_f32_16x16x32_bf16 v[76:79], v[48:51], a[128:131], v[76:79]
  ds_read_b64_tr_b16 v[60:61], v25 offset:16384
  v_mfma_f32_16x16x32_bf16 v[80:83], v[48:51], a[132:135], v[80:83]
  ds_read_b64_tr_b16 v[62:63], v25 offset:17408
  v_mfma_f32_16x16x32_bf16 v[84:87], v[48:51], a[136:139], v[84:87]
  v_mfma_f32_16x16x32_bf16 v[88:91], v[48:51], a[140:143], v[88:91]
  s_waitcnt lgkmcnt(4)
  v_mfma_f32_16x16x32_bf16 v[92:95], v[52:55], a[128:131], v[92:95]
  ds_read_b64_tr_b16 v[64:65], v26 offset:16384
  v_mfma_f32_16x16x32_bf16 v[96:99], v[52:55], a[132:135], v[96:99]
  ds_read_b64_tr_b16 v[66:67], v26 offset:17408
  v_mfma_f32_16x16x32_bf16 v[100:103], v[52:55], a[136:139], v[100:103]
  v_mfma_f32_16x16x32_bf16 v[104:107], v[52:55], a[140:143], v[104:107]
  s_waitcnt lgkmcnt(4)
  v_mfma_f32_16x16x32_bf16 v[108:111], v[56:59], a[128:131], v[108:111]
  ds_read_b64_tr_b16 v[68:69], v27 offset:16384
  v_mfma_f32_16x16x32_bf16 v[112:115], v[56:59], a[132:135], v[112:115]
  ds_read_b64_tr_b16 v[70:71], v27 offset:17408
  v_mfma_f32_16x16x32_bf16 v[116:119], v[56:59], a[136:139], v[116:119]
  v_mfma_f32_16x16x32_bf16 v[120:123], v[56:59], a[140:143], v[120:123]
  s_waitcnt lgkmcnt(4)
  v_mfma_f32_16x16x32_bf16 v[124:127], v[60:63], a[128:131], v[124:127]
  ds_read_b64_tr_b16 v[72:73], v28 offset:16384
  v_mfma_f32_16x16x32_bf16 v[128:131], v[60:63], a[132:135], v[128:131]
  ds_read_b64_tr_b16 v[74:75], v28 offset:17408
  v_mfma_f32_16x16x32_bf16 v[132:135], v[60:63], a[136:139], v[132:135]
  v_mfma_f32_16x16x32_bf16 v[136:139], v[60:63], a[140:143], v[136:139]
  s_waitcnt vmcnt(6)
  s_barrier
  s_waitcnt lgkmcnt(4)
  v_mfma_f32_16x16x32_bf16 v[140:143], v[64:67], a[128:131], v[140:143]
  ds_read_b64_tr_b16 v[48:49], v15 offset:0
  v_mfma_f32_16x16x32_bf16 v[144:147], v[64:67], a[132:135], v[144:147]
  ds_read_b64_tr_b16 v[50:51], v15 offset:1024
  v_mfma_f32_16x16x32_bf16 v[148:151], v[64:67], a[136:139], v[148:151]
  v_mfma_f32_16x16x32_bf16 v[152:155], v[64:67], a[140:143], v[152:155]
  s_waitcnt lgkmcnt(4)
  v_mfma_f32_16x16x32_bf16 v[156:159], v[68:71], a[128:131], v[156:159]
  ds_read_b64_tr_b16 v[52:53], v16 offset:0
  v_mfma_f32_16x16x32_bf16 v[160:163], v[68:71], a[132:135], v[160:163]
  ds_read_b64_tr_b16 v[54:55], v16 offset:1024
  v_mfma_f32_16x16x32_bf16 v[164:167], v[68:71], a[136:139], v[164:167]
  v_mfma_f32_16x16x32_bf16 v[168:171], v[68:71], a[140:143], v[168:171]
  s_waitcnt lgkmcnt(4)
  v_mfma_f32_16x16x32_bf16 v[172:175], v[72:75], a[128:131], v[172:175]
  ds_read_b64_tr_b16 v[56:57], v17 offset:0
  v_mfma_f32_16x16x32_bf16 v[176:179], v[72:75], a[132:135], v[176:179]
  ds_read_b64_tr_b16 v[58:59], v17 offset:1024
  v_mfma_f32_16x16x32_bf16 v[180:183], v[72:75], a[136:139], v[180:183]
  v_mfma_f32_16x16x32_bf16 v[184:187], v[72:75], a[140:143], v[184:187]
  s_waitcnt lgkmcnt(4)
  v_mfma_f32_16x16x32_bf16 v[76:79], v[48:51], a[144:147], v[76:79]
  ds_read_b64_tr_b16 v[60:61], v18 offset:0
  v_mfma_f32_16x16x32_bf16 v[80:83], v[48:51], a[148:151], v[80:83]
  ds_read_b64_tr_b16 v[62:63], v18 offset:1024
  v_mfma_f32_16x16x32_bf16 v[84:87], v[48:51], a[152:155], v[84:87]
  v_mfma_f32_16x16x32_bf16 v[88:91], v[48:51], a[156:159], v[88:91]
  s_waitcnt lgkmcnt(4)
  v_mfma_f32_16x16x32_bf16 v[92:95], v[52:55], a[144:147], v[92:95]
  ds_read_b64_tr_b16 v[64:65], v19 offset:0
  v_mfma_f32_16x16x32_bf16 v[96:99], v[52:55], a[148:151], v[96:99]
  ds_read_b64_tr_b16 v[66:67], v19 offset:1024
  v_mfma_f32_16x16x32_bf16 v[100:103], v[52:55], a[152:155], v[100:103]
  s_add_u32 m0, s43, 49152
  v_mfma_f32_16x16x32_bf16 v[104:107], v[52:55], a[156:159], v[104:107]
  s_add_u32 s44, s56, 0
  s_waitcnt lgkmcnt(4)
  v_mfma_f32_16x16x32_bf16 v[108:111], v[56:59], a[144:147], v[108:111]
  ds_read_b64_tr_b16 v[68:69], v20 offset:0
  v_mfma_f32_16x16x32_bf16 v[112:115], v[56:59], a[148:151], v[112:115]
  ds_read_b64_tr_b16 v[70:71], v20 offset:1024
  v_mfma_f32_16x16x32_bf16 v[116:119], v[56:59], a[152:155], v[116:119]
  buffer_load_dwordx4 v8, s[12:15], s44 offen lds
  v_mfma_f32_16x16x32_bf16 v[120:123], v[56:59], a[156:159], v[120:123]
  s_add_u32 m0, s43, 53248
  s_waitcnt lgkmcnt(4)
  v_mfma_f32_16x16x32_bf16 v[124:127], v[60:63], a[144:147], v[124:127]
  ds_read_b64_tr_b16 v[72:73], v21 offset:0
  v_mfma_f32_16x16x32_bf16 v[128:131], v[60:63], a[148:151], v[128:131]
  ds_read_b64_tr_b16 v[74:75], v21 offset:1024
  v_mfma_f32_16x16x32_bf16 v[132:135], v[60:63], a[152:155], v[132:135]
  s_add_u32 s44, s56, 55296
  v_mfma_f32_16x16x32_bf16 v[136:139], v[60:63], a[156:159], v[136:139]
  buffer_load_dwordx4 v8, s[12:15], s44 offen lds
  s_waitcnt lgkmcnt(4)
  v_mfma_f32_16x16x32_bf16 v[140:143], v[64:67], a[144:147], v[140:143]
  ds_read_b64_tr_b16 v[48:49], v15 offset:8192
  v_mfma_f32_16x16x32_bf16 v[144:147], v[64:67], a[148:151], v[144:147]
  ds_read_b64_tr_b16 v[50:51], v15 offset:9216
  v_mfma_f32_16x16x32_bf16 v[148:151], v[64:67], a[152:155], v[148:151]
  s_add_u32 m0, s43, 57344
  v_mfma_f32_16x16x32_bf16 v[152:155], v[64:67], a[156:159], v[152:155]
  s_waitcnt lgkmcnt(4)
  v_mfma_f32_16x16x32_bf16 v[156:159], v[68:71], a[144:147], v[156:159]
  ds_read_b64_tr_b16 v[52:53], v16 offset:8192
  v_mfma_f32_16x16x32_bf16 v[160:163], v[68:71], a[148:151], v[160:163]
  ds_read_b64_tr_b16 v[54:55], v16 offset:9216
  v_mfma_f32_16x16x32_bf16 v[164:167], v[68:71], a[152:155], v[164:167]
  s_add_u32 s44, s56, 110592
  v_mfma_f32_16x16x32_bf16 v[168:171], v[68:71], a[156:159], v[168:171]
  s_waitcnt lgkmcnt(4)
  v_mfma_f32_16x16x32_bf16 v[172:175], v[72:75], a[144:147], v[172:175]
  ds_read_b64_tr_b16 v[56:57], v17 offset:8192
  v_mfma_f32_16x16x32_bf16 v[176:179], v[72:75], a[148:151], v[176:179]
  ds_read_b64_tr_b16 v[58:59], v17 offset:9216
  v_mfma_f32_16x16x32_bf16 v[180:183], v[72:75], a[152:155], v[180:183]
  buffer_load_dwordx4 v8, s[12:15], s44 offen lds
  v_mfma_f32_16x16x32_bf16 v[184:187], v[72:75], a[156:159], v[184:187]
  s_waitcnt lgkmcnt(4)
  v_mfma_f32_16x16x32_bf16 v[76:79], v[48:51], a[160:163], v[76:79]
  ds_read_b64_tr_b16 v[60:61], v18 offset:8192
  v_mfma_f32_16x16x32_bf16 v[80:83], v[48:51], a[164:167], v[80:83]
  ds_read_b64_tr_b16 v[62:63], v18 offset:9216
  v_mfma_f32_16x16x32_bf16 v[84:87], v[48:51], a[168:171], v[84:87]
  v_mfma_f32_16x16x32_bf16 v[88:91], v[48:51], a[172:175], v[88:91]
  s_waitcnt lgkmcnt(4)
  v_mfma_f32_16x16x32_bf16 v[92:95], v[52:55], a[160:163], v[92:95]
  ds_read_b64_tr_b16 v[64:65], v19 offset:8192
  v_mfma_f32_16x16x32_bf16 v[96:99], v[52:55], a[164:167], v[96:99]
  ds_read_b64_tr_b16 v[66:67], v19 offset:9216
  v_mfma_f32_16x16x32_bf16 v[100:103], v[52:55], a[168:171], v[100:103]
  s_add_u32 m0, s43, 61440
  v_mfma_f32_16x16x32_bf16 v[104:107], v[52:55], a[172:175], v[104:107]
  s_add_u32 s44, s56, 165888
  s_waitcnt lgkmcnt(4)
  v_mfma_f32_16x16x32_bf16 v[108:111], v[56:59], a[160:163], v[108:111]
  ds_read_b64_tr_b16 v[68:69], v20 offset:8192
  v_mfma_f32_16x16x32_bf16 v[112:115], v[56:59], a[164:167], v[112:115]
  ds_read_b64_tr_b16 v[70:71], v20 offset:9216
  v_mfma_f32_16x16x32_bf16 v[116:119], v[56:59], a[168:171], v[116:119]
  buffer_load_dwordx4 v8, s[12:15], s44 offen lds
  v_mfma_f32_16x16x32_bf16 v[120:123], v[56:59], a[172:175], v[120:123]
  s_add_u32 m0, s43, 65536
  s_waitcnt lgkmcnt(4)
  v_mfma_f32_16x16x32_bf16 v[124:127], v[60:63], a[160:163], v[124:127]
  ds_read_b64_tr_b16 v[72:73], v21 offset:8192
  v_mfma_f32_16x16x32_bf16 v[128:131], v[60:63], a[164:167], v[128:131]
  ds_read_b64_tr_b16 v[74:75], v21 offset:9216
  v_mfma_f32_16x16x32_bf16 v[132:135], v[60:63], a[168:171], v[132:135]
  s_add_u32 s44, s56, 221184
  v_mfma_f32_16x16x32_bf16 v[136:139], v[60:63], a[172:175], v[136:139]
  buffer_load_dwordx4 v8, s[12:15], s44 offen lds
  s_waitcnt lgkmcnt(4)
  v_mfma_f32_16x16x32_bf16 v[140:143], v[64:67], a[160:163], v[140:143]
  ds_read_b64_tr_b16 v[48:49], v15 offset:16384
  v_mfma_f32_16x16x32_bf16 v[144:147], v[64:67], a[164:167], v[144:147]
  ds_read_b64_tr_b16 v[50:51], v15 offset:17408
  v_mfma_f32_16x16x32_bf16 v[148:151], v[64:67], a[168:171], v[148:151]
  s_add_u32 m0, s43, 69632
  v_mfma_f32_16x16x32_bf16 v[152:155], v[64:67], a[172:175], v[152:155]
  s_add_u32 s44, s56, 276480
  s_waitcnt lgkmcnt(4)
  v_mfma_f32_16x16x32_bf16 v[156:159], v[68:71], a[160:163], v[156:159]
  ds_read_b64_tr_b16 v[52:53], v16 offset:16384
  v_mfma_f32_16x16x32_bf16 v[160:163], v[68:71], a[164:167], v[160:163]
  ds_read_b64_tr_b16 v[54:55], v16 offset:17408
  v_mfma_f32_16x16x32_bf16 v[164:167], v[68:71], a[168:171], v[164:167]
  buffer_load_dwordx4 v8, s[12:15], s44 offen lds
  v_mfma_f32_16x16x32_bf16 v[168:171], v[68:71], a[172:175], v[168:171]
  s_waitcnt lgkmcnt(4)
  v_mfma_f32_16x16x32_bf16 v[172:175], v[72:75], a[160:163], v[172:175]
  ds_read_b64_tr_b16 v[56:57], v17 offset:16384
  v_mfma_f32_16x16x32_bf16 v[176:179], v[72:75], a[164:167], v[176:179]
  ds_read_b64_tr_b16 v[58:59], v17 offset:17408
  v_mfma_f32_16x16x32_bf16 v[180:183], v[72:75], a[168:171], v[180:183]
  s_add_u32 s56, s56, 331776
  v_mfma_f32_16x16x32_bf16 v[184:187], v[72:75], a[172:175], v[184:187]
  s_waitcnt lgkmcnt(4)
  v_mfma_f32_16x16x32_bf16 v[76:79], v[48:51], a[176:179], v[76:79]
  ds_read_b64_tr_b16 v[60:61], v18 offset:16384
  v_mfma_f32_16x16x32_bf16 v[80:83], v[48:51], a[180:183], v[80:83]
  ds_read_b64_tr_b16 v[62:63], v18 offset:17408
  v_mfma_f32_16x16x32_bf16 v[84:87], v[48:51], a[184:187], v[84:87]
  v_mfma_f32_16x16x32_bf16 v[88:91], v[48:51], a[188:191], v[88:91]
  s_waitcnt lgkmcnt(4)
  v_mfma_f32_16x16x32_bf16 v[92:95], v[52:55], a[176:179], v[92:95]
  ds_read_b64_tr_b16 v[64:65], v19 offset:16384
  v_mfma_f32_16x16x32_bf16 v[96:99], v[52:55], a[180:183], v[96:99]
  ds_read_b64_tr_b16 v[66:67], v19 offset:17408
  v_mfma_f32_16x16x32_bf16 v[100:103], v[52:55], a[184:187], v[100:103]
  v_mfma_f32_16x16x32_bf16 v[104:107], v[52:55], a[188:191], v[104:107]
  s_waitcnt lgkmcnt(4)
  v_mfma_f32_16x16x32_bf16 v[108:111], v[56:59], a[176:179], v[108:111]
  ds_read_b64_tr_b16 v[68:69], v20 offset:16384
  v_mfma_f32_16x16x32_bf16 v[112:115], v[56:59], a[180:183], v[112:115]
  ds_read_b64_tr_b16 v[70:71], v20 offset:17408
  v_mfma_f32_16x16x32_bf16 v[116:119], v[56:59], a[184:187], v[116:119]
  v_mfma_f32_16x16x32_bf16 v[120:123], v[56:59], a[188:191], v[120:123]
  s_waitcnt lgkmcnt(4)
  v_mfma_f32_16x16x32_bf16 v[124:127], v[60:63], a[176:179], v[124:127]
  ds_read_b64_tr_b16 v[72:73], v21 offset:16384
  v_mfma_f32_16x16x32_bf16 v[128:131], v[60:63], a[180:183], v[128:131]
  ds_read_b64_tr_b16 v[74:75], v21 offset:17408
  v_mfma_f32_16x16x32_bf16 v[132:135], v[60:63], a[184:187], v[132:135]
  v_mfma_f32_16x16x32_bf16 v[136:139], v[60:63], a[188:191], v[136:139]
  s_waitcnt vmcnt(6)
  s_barrier
  s_waitcnt lgkmcnt(4)
  v_mfma_f32_16x16x32_bf16 v[140:143], v[64:67], a[176:179], v[140:143]
  ds_read_b64_tr_b16 v[48:49], v15 offset:24576
  v_mfma_f32_16x16x32_bf16 v[144:147], v[64:67], a[180:183], v[144:147]
  ds_read_b64_tr_b16 v[50:51], v15 offset:25600
  v_mfma_f32_16x16x32_bf16 v[148:151], v[64:67], a[184:187], v[148:151]
  v_mfma_f32_16x16x32_bf16 v[152:155], v[64:67], a[188:191], v[152:155]
  s_waitcnt lgkmcnt(4)
  v_mfma_f32_16x16x32_bf16 v[156:159], v[68:71], a[176:179], v[156:159]
  ds_read_b64_tr_b16 v[52:53], v16 offset:24576
  v_mfma_f32_16x16x32_bf16 v[160:163], v[68:71], a[180:183], v[160:163]
  ds_read_b64_tr_b16 v[54:55], v16 offset:25600
  v_mfma_f32_16x16x32_bf16 v[164:167], v[68:71], a[184:187], v[164:167]
  v_mfma_f32_16x16x32_bf16 v[168:171], v[68:71], a[188:191], v[168:171]
  s_waitcnt lgkmcnt(4)
  v_mfma_f32_16x16x32_bf16 v[172:175], v[72:75], a[176:179], v[172:175]
  ds_read_b64_tr_b16 v[56:57], v17 offset:24576
  v_mfma_f32_16x16x32_bf16 v[176:179], v[72:75], a[180:183], v[176:179]
  ds_read_b64_tr_b16 v[58:59], v17 offset:25600
  v_mfma_f32_16x16x32_bf16 v[180:183], v[72:75], a[184:187], v[180:183]
  v_mfma_f32_16x16x32_bf16 v[184:187], v[72:75], a[188:191], v[184:187]
  s_waitcnt lgkmcnt(4)
  v_mfma_f32_16x16x32_bf16 v[76:79], v[48:51], a[192:195], v[76:79]
  ds_read_b64_tr_b16 v[60:61], v18 offset:24576
  v_mfma_f32_16x16x32_bf16 v[80:83], v[48:51], a[196:199], v[80:83]
  ds_read_b64_tr_b16 v[62:63], v18 offset:25600
  v_mfma_f32_16x16x32_bf16 v[84:87], v[48:51], a[200:203], v[84:87]
  v_mfma_f32_16x16x32_bf16 v[88:91], v[48:51], a[204:207], v[88:91]
  s_waitcnt lgkmcnt(4)
  v_mfma_f32_16x16x32_bf16 v[92:95], v[52:55], a[192:195], v[92:95]
  ds_read_b64_tr_b16 v[64:65], v19 offset:24576
  v_mfma_f32_16x16x32_bf16 v[96:99], v[52:55], a[196:199], v[96:99]
  ds_read_b64_tr_b16 v[66:67], v19 offset:25600
  v_mfma_f32_16x16x32_bf16 v[100:103], v[52:55], a[200:203], v[100:103]
  s_add_u32 s56, s42, 72
  v_mfma_f32_16x16x32_bf16 v[104:107], v[52:55], a[204:207], v[104:107]
  s_add_u32 m0, s43, 0
  s_waitcnt lgkmcnt(4)
  v_mfma_f32_16x16x32_bf16 v[108:111], v[56:59], a[192:195], v[108:111]
  ds_read_b64_tr_b16 v[68:69], v20 offset:24576
  v_mfma_f32_16x16x32_bf16 v[112:115], v[56:59], a[196:199], v[112:115]
  ds_read_b64_tr_b16 v[70:71], v20 offset:25600
  v_mfma_f32_16x16x32_bf16 v[116:119], v[56:59], a[200:203], v[116:119]
  s_add_u32 s44, s56, 0
  v_mfma_f32_16x16x32_bf16 v[120:123], v[56:59], a[204:207], v[120:123]
  buffer_load_dwordx4 v8, s[12:15], s44 offen lds
  s_waitcnt lgkmcnt(4)
  v_mfma_f32_16x16x32_bf16 v[124:127], v[60:63], a[192:195], v[124:127]
  ds_read_b64_tr_b16 v[72:73], v21 offset:24576
  v_mfma_f32_16x16x32_bf16 v[128:131], v[60:63], a[196:199], v[128:131]
  ds_read_b64_tr_b16 v[74:75], v21 offset:25600
  v_mfma_f32_16x16x32_bf16 v[132:135], v[60:63], a[200:203], v[132:135]
  s_add_u32 m0, s43, 4096
  v_mfma_f32_16x16x32_bf16 v[136:139], v[60:63], a[204:207], v[136:139]
  s_add_u32 s44, s56, 55296
  s_waitcnt lgkmcnt(4)
  v_mfma_f32_16x16x32_bf16 v[140:143], v[64:67], a[192:195], v[140:143]
  ds_read_b64_tr_b16 v[48:49], v15 offset:32768
  v_mfma_f32_16x16x32_bf16 v[144:147], v[64:67], a[196:199], v[144:147]
  ds_read_b64_tr_b16 v[50:51], v15 offset:33792
  v_mfma_f32_16x16x32_bf16 v[148:151], v[64:67], a[200:203], v[148:151]
  buffer_load_dwordx4 v8, s[12:15], s44 offen lds
  v_mfma_f32_16x16x32_bf16 v[152:155], v[64:67], a[204:207], v[152:155]
  s_add_u32 m0, s43, 8192
  s_waitcnt lgkmcnt(4)
  v_mfma_f32_16x16x32_bf16 v[156:159], v[68:71], a[192:195], v[156:159]
  ds_read_b64_tr_b16 v[52:53], v16 offset:32768
  v_mfma_f32_16x16x32_bf16 v[160:163], v[68:71], a[196:199], v[160:163]
  ds_read_b64_tr_b16 v[54:55], v16 offset:33792
  v_mfma_f32_16x16x32_bf16 v[164:167], v[68:71], a[200:203], v[164:167]
  s_add_u32 s44, s56, 110592
  v_mfma_f32_16x16x32_bf16 v[168:171], v[68:71], a[204:207], v[168:171]
  s_waitcnt lgkmcnt(4)
  v_mfma_f32_16x16x32_bf16 v[172:175], v[72:75], a[192:195], v[172:175]
  ds_read_b64_tr_b16 v[56:57], v17 offset:32768
  v_mfma_f32_16x16x32_bf16 v[176:179], v[72:75], a[196:199], v[176:179]
  ds_read_b64_tr_b16 v[58:59], v17 offset:33792
  v_mfma_f32_16x16x32_bf16 v[180:183], v[72:75], a[200:203], v[180:183]
  buffer_load_dwordx4 v8, s[12:15], s44 offen lds
  v_mfma_f32_16x16x32_bf16 v[184:187], v[72:75], a[204:207], v[184:187]
  s_waitcnt lgkmcnt(4)
  v_mfma_f32_16x16x32_bf16 v[76:79], v[48:51], a[208:211], v[76:79]
  ds_read_b64_tr_b16 v[60:61], v18 offset:32768
  v_mfma_f32_16x16x32_bf16 v[80:83], v[48:51], a[212:215], v[80:83]
  ds_read_b64_tr_b16 v[62:63], v18 offset:33792
  v_mfma_f32_16x16x32_bf16 v[84:87], v[48:51], a[216:219], v[84:87]
  v_mfma_f32_16x16x32_bf16 v[88:91], v[48:51], a[220:223], v[88:91]
  s_waitcnt lgkmcnt(4)
  v_mfma_f32_16x16x32_bf16 v[92:95], v[52:55], a[208:211], v[92:95]
  ds_read_b64_tr_b16 v[64:65], v19 offset:32768
  v_mfma_f32_16x16x32_bf16 v[96:99], v[52:55], a[212:215], v[96:99]
  ds_read_b64_tr_b16 v[66:67], v19 offset:33792
  v_mfma_f32_16x16x32_bf16 v[100:103], v[52:55], a[216:219], v[100:103]
  s_add_u32 m0, s43, 12288
  v_mfma_f32_16x16x32_bf16 v[104:107], v[52:55], a[220:223], v[104:107]
  s_add_u32 s44, s56, 165888
  s_waitcnt lgkmcnt(4)
  v_mfma_f32_16x16x32_bf16 v[108:111], v[56:59], a[208:211], v[108:111]
  ds_read_b64_tr_b16 v[68:69], v20 offset:32768
  v_mfma_f32_16x16x32_bf16 v[112:115], v[56:59], a[212:215], v[112:115]
  ds_read_b64_tr_b16 v[70:71], v20 offset:33792
  v_mfma_f32_16x16x32_bf16 v[116:119], v[56:59], a[216:219], v[116:119]
  buffer_load_dwordx4 v8, s[12:15], s44 offen lds
  v_mfma_f32_16x16x32_bf16 v[120:123], v[56:59], a[220:223], v[120:123]
  s_add_u32 m0, s43, 16384
  s_waitcnt lgkmcnt(4)
  v_mfma_f32_16x16x32_bf16 v[124:127], v[60:63], a[208:211], v[124:127]
  ds_read_b64_tr_b16 v[72:73], v21 offset:32768
  v_mfma_f32_16x16x32_bf16 v[128:131], v[60:63], a[212:215], v[128:131]
  ds_read_b64_tr_b16 v[74:75], v21 offset:33792
  v_mfma_f32_16x16x32_bf16 v[132:135], v[60:63], a[216:219], v[132:135]
  s_add_u32 s44, s56, 221184
  v_mfma_f32_16x16x32_bf16 v[136:139], v[60:63], a[220:223], v[136:139]
  buffer_load_dwordx4 v8, s[12:15], s44 offen lds
  s_waitcnt lgkmcnt(4)
  v_mfma_f32_16x16x32_bf16 v[140:143], v[64:67], a[208:211], v[140:143]
  ds_read_b64_tr_b16 v[48:49], v15 offset:40960
  v_mfma_f32_16x16x32_bf16 v[144:147], v[64:67], a[212:215], v[144:147]
  ds_read_b64_tr_b16 v[50:51], v15 offset:41984
  v_mfma_f32_16x16x32_bf16 v[148:151], v[64:67], a[216:219], v[148:151]
  s_add_u32 m0, s43, 20480
  v_mfma_f32_16x16x32_bf16 v[152:155], v[64:67], a[220:223], v[152:155]
  s_add_u32 s44, s56, 276480
  s_waitcnt lgkmcnt(4)
  v_mfma_f32_16x16x32_bf16 v[156:159], v[68:71], a[208:211], v[156:159]
  ds_read_b64_tr_b16 v[52:53], v16 offset:40960
  v_mfma_f32_16x16x32_bf16 v[160:163], v[68:71], a[212:215], v[160:163]
  ds_read_b64_tr_b16 v[54:55], v16 offset:41984
  v_mfma_f32_16x16x32_bf16 v[164:167], v[68:71], a[216:219], v[164:167]
  buffer_load_dwordx4 v8, s[12:15], s44 offen lds
  v_mfma_f32_16x16x32_bf16 v[168:171], v[68:71], a[220:223], v[168:171]
  s_waitcnt lgkmcnt(4)
  v_mfma_f32_16x16x32_bf16 v[172:175], v[72:75], a[208:211], v[172:175]
  ds_read_b64_tr_b16 v[56:57], v17 offset:40960
  v_mfma_f32_16x16x32_bf16 v[176:179], v[72:75], a[212:215], v[176:179]
  ds_read_b64_tr_b16 v[58:59], v17 offset:41984
  v_mfma_f32_16x16x32_bf16 v[180:183], v[72:75], a[216:219], v[180:183]
  s_add_u32 s56, s56, 331776
  v_mfma_f32_16x16x32_bf16 v[184:187], v[72:75], a[220:223], v[184:187]
  s_waitcnt lgkmcnt(4)
  v_mfma_f32_16x16x32_bf16 v[76:79], v[48:51], a[224:227], v[76:79]
  ds_read_b64_tr_b16 v[60:61], v18 offset:40960
  v_mfma_f32_16x16x32_bf16 v[80:83], v[48:51], a[228:231], v[80:83]
  ds_read_b64_tr_b16 v[62:63], v18 offset:41984
  v_mfma_f32_16x16x32_bf16 v[84:87], v[48:51], a[232:235], v[84:87]
  v_mfma_f32_16x16x32_bf16 v[88:91], v[48:51], a[236:239], v[88:91]
  s_waitcnt lgkmcnt(4)
  v_mfma_f32_16x16x32_bf16 v[92:95], v[52:55], a[224:227], v[92:95]
  ds_read_b64_tr_b16 v[64:65], v19 offset:40960
  v_mfma_f32_16x16x32_bf16 v[96:99], v[52:55], a[228:231], v[96:99]
  ds_read_b64_tr_b16 v[66:67], v19 offset:41984
  v_mfma_f32_16x16x32_bf16 v[100:103], v[52:55], a[232:235], v[100:103]
  v_mfma_f32_16x16x32_bf16 v[104:107], v[52:55], a[236:239], v[104:107]
  s_waitcnt lgkmcnt(4)
  v_mfma_f32_16x16x32_bf16 v[108:111], v[56:59], a[224:227], v[108:111]
  ds_read_b64_tr_b16 v[68:69], v20 offset:40960
  v_mfma_f32_16x16x32_bf16 v[112:115], v[56:59], a[228:231], v[112:115]
  ds_read_b64_tr_b16 v[70:71], v20 offset:41984
  v_mfma_f32_16x16x32_bf16 v[116:119], v[56:59], a[232:235], v[116:119]
  v_mfma_f32_16x16x32_bf16 v[120:123], v[56:59], a[236:239], v[120:123]
  s_waitcnt lgkmcnt(4)
  v_mfma_f32_16x16x32_bf16 v[124:127], v[60:63], a[224:227], v[124:127]
  ds_read_b64_tr_b16 v[72:73], v21 offset:40960
  v_mfma_f32_16x16x32_bf16 v[128:131], v[60:63], a[228:231], v[128:131]
  ds_read_b64_tr_b16 v[74:75], v21 offset:41984
  v_mfma_f32_16x16x32_bf16 v[132:135], v[60:63], a[232:235], v[132:135]
  v_mfma_f32_16x16x32_bf16 v[136:139], v[60:63], a[236:239], v[136:139]
  s_waitcnt vmcnt(6)
  s_barrier
  s_waitcnt lgkmcnt(4)
  v_mfma_f32_16x16x32_bf16 v[140:143], v[64:67], a[224:227], v[140:143]
  ds_read_b64_tr_b16 v[48:49], v22 offset:0
  v_mfma_f32_16x16x32_bf16 v[144:147], v[64:67], a[228:231], v[144:147]
  ds_read_b64_tr_b16 v[50:51], v22 offset:1024
  v_mfma_f32_16x16x32_bf16 v[148:151], v[64:67], a[232:235], v[148:151]
  v_mfma_f32_16x16x32_bf16 v[152:155], v[64:67], a[236:239], v[152:155]
  s_waitcnt lgkmcnt(4)
  v_mfma_f32_16x16x32_bf16 v[156:159], v[68:71], a[224:227], v[156:159]
  ds_read_b64_tr_b16 v[52:53], v23 offset:0
  v_mfma_f32_16x16x32_bf16 v[160:163], v[68:71], a[228:231], v[160:163]
  ds_read_b64_tr_b16 v[54:55], v23 offset:1024
  v_mfma_f32_16x16x32_bf16 v[164:167], v[68:71], a[232:235], v[164:167]
  v_mfma_f32_16x16x32_bf16 v[168:171], v[68:71], a[236:239], v[168:171]
  s_waitcnt lgkmcnt(4)
  v_mfma_f32_16x16x32_bf16 v[172:175], v[72:75], a[224:227], v[172:175]
  ds_read_b64_tr_b16 v[56:57], v24 offset:0
  v_mfma_f32_16x16x32_bf16 v[176:179], v[72:75], a[228:231], v[176:179]
  ds_read_b64_tr_b16 v[58:59], v24 offset:1024
  v_mfma_f32_16x16x32_bf16 v[180:183], v[72:75], a[232:235], v[180:183]
  v_mfma_f32_16x16x32_bf16 v[184:187], v[72:75], a[236:239], v[184:187]
  s_waitcnt lgkmcnt(4)
  v_mfma_f32_16x16x32_bf16 v[76:79], v[48:51], a[240:243], v[76:79]
  ds_read_b64_tr_b16 v[60:61], v25 offset:0
  v_mfma_f32_16x16x32_bf16 v[80:83], v[48:51], a[244:247], v[80:83]
  ds_read_b64_tr_b16 v[62:63], v25 offset:1024
  v_mfma_f32_16x16x32_bf16 v[84:87], v[48:51], a[248:251], v[84:87]
  v_mfma_f32_16x16x32_bf16 v[88:91], v[48:51], a[252:255], v[88:91]
  s_waitcnt lgkmcnt(4)
  v_mfma_f32_16x16x32_bf16 v[92:95], v[52:55], a[240:243], v[92:95]
  ds_read_b64_tr_b16 v[64:65], v26 offset:0
  v_mfma_f32_16x16x32_bf16 v[96:99], v[52:55], a[244:247], v[96:99]
  ds_read_b64_tr_b16 v[66:67], v26 offset:1024
  v_mfma_f32_16x16x32_bf16 v[100:103], v[52:55], a[248:251], v[100:103]
  s_add_u32 m0, s43, 24576
  v_mfma_f32_16x16x32_bf16 v[104:107], v[52:55], a[252:255], v[104:107]
  s_add_u32 s44, s56, 0
  s_waitcnt lgkmcnt(4)
  v_mfma_f32_16x16x32_bf16 v[108:111], v[56:59], a[240:243], v[108:111]
  ds_read_b64_tr_b16 v[68:69], v27 offset:0
  v_mfma_f32_16x16x32_bf16 v[112:115], v[56:59], a[244:247], v[112:115]
  ds_read_b64_tr_b16 v[70:71], v27 offset:1024
  v_mfma_f32_16x16x32_bf16 v[116:119], v[56:59], a[248:251], v[116:119]
  buffer_load_dwordx4 v8, s[12:15], s44 offen lds
  v_mfma_f32_16x16x32_bf16 v[120:123], v[56:59], a[252:255], v[120:123]
  s_add_u32 m0, s43, 28672
  s_waitcnt lgkmcnt(4)
  v_mfma_f32_16x16x32_bf16 v[124:127], v[60:63], a[240:243], v[124:127]
  ds_read_b64_tr_b16 v[72:73], v28 offset:0
  v_mfma_f32_16x16x32_bf16 v[128:131], v[60:63], a[244:247], v[128:131]
  ds_read_b64_tr_b16 v[74:75], v28 offset:1024
  v_mfma_f32_16x16x32_bf16 v[132:135], v[60:63], a[248:251], v[132:135]
  s_add_u32 s44, s56, 55296
  v_mfma_f32_16x16x32_bf16 v[136:139], v[60:63], a[252:255], v[136:139]
  buffer_load_dwordx4 v8, s[12:15], s44 offen lds
  s_waitcnt lgkmcnt(4)
  v_mfma_f32_16x16x32_bf16 v[140:143], v[64:67], a[240:243], v[140:143]
  ds_read_b64_tr_b16 v[48:49], v22 offset:8192
  v_mfma_f32_16x16x32_bf16 v[144:147], v[64:67], a[244:247], v[144:147]
  ds_read_b64_tr_b16 v[50:51], v22 offset:9216
  v_mfma_f32_16x16x32_bf16 v[148:151], v[64:67], a[248:251], v[148:151]
  s_add_u32 m0, s43, 32768
  v_mfma_f32_16x16x32_bf16 v[152:155], v[64:67], a[252:255], v[152:155]
  s_waitcnt lgkmcnt(4)
  v_mfma_f32_16x16x32_bf16 v[156:159], v[68:71], a[240:243], v[156:159]
  ds_read_b64_tr_b16 v[52:53], v23 offset:8192
  v_mfma_f32_16x16x32_bf16 v[160:163], v[68:71], a[244:247], v[160:163]
  ds_read_b64_tr_b16 v[54:55], v23 offset:9216
  v_mfma_f32_16x16x32_bf16 v[164:167], v[68:71], a[248:251], v[164:167]
  s_add_u32 s44, s56, 110592
  v_mfma_f32_16x16x32_bf16 v[168:171], v[68:71], a[252:255], v[168:171]
  s_waitcnt lgkmcnt(4)
  v_mfma_f32_16x16x32_bf16 v[172:175], v[72:75], a[240:243], v[172:175]
  ds_read_b64_tr_b16 v[56:57], v24 offset:8192
  v_mfma_f32_16x16x32_bf16 v[176:179], v[72:75], a[244:247], v[176:179]
  ds_read_b64_tr_b16 v[58:59], v24 offset:9216
  v_mfma_f32_16x16x32_bf16 v[180:183], v[72:75], a[248:251], v[180:183]
  buffer_load_dwordx4 v8, s[12:15], s44 offen lds
  v_mfma_f32_16x16x32_bf16 v[184:187], v[72:75], a[252:255], v[184:187]
  s_waitcnt lgkmcnt(4)
  v_mfma_f32_16x16x32_bf16 v[76:79], v[48:51], v[188:191], v[76:79]
  ds_read_b64_tr_b16 v[60:61], v25 offset:8192
  v_mfma_f32_16x16x32_bf16 v[80:83], v[48:51], v[192:195], v[80:83]
  ds_read_b64_tr_b16 v[62:63], v25 offset:9216
  v_mfma_f32_16x16x32_bf16 v[84:87], v[48:51], v[196:199], v[84:87]
  v_mfma_f32_16x16x32_bf16 v[88:91], v[48:51], v[200:203], v[88:91]
  s_waitcnt lgkmcnt(4)
  v_mfma_f32_16x16x32_bf16 v[92:95], v[52:55], v[188:191], v[92:95]
  ds_read_b64_tr_b16 v[64:65], v26 offset:8192
  v_mfma_f32_16x16x32_bf16 v[96:99], v[52:55], v[192:195], v[96:99]
  ds_read_b64_tr_b16 v[66:67], v26 offset:9216
  v_mfma_f32_16x16x32_bf16 v[100:103], v[52:55], v[196:199], v[100:103]
  s_add_u32 m0, s43, 36864
  v_mfma_f32_16x16x32_bf16 v[104:107], v[52:55], v[200:203], v[104:107]
  s_add_u32 s44, s56, 165888
  s_waitcnt lgkmcnt(4)
  v_mfma_f32_16x16x32_bf16 v[108:111], v[56:59], v[188:191], v[108:111]
  ds_read_b64_tr_b16 v[68:69], v27 offset:8192
  v_mfma_f32_16x16x32_bf16 v[112:115], v[56:59], v[192:195], v[112:115]
  ds_read_b64_tr_b16 v[70:71], v27 offset:9216
  v_mfma_f32_16x16x32_bf16 v[116:119], v[56:59], v[196:199], v[116:119]
  buffer_load_dwordx4 v8, s[12:15], s44 offen lds
  v_mfma_f32_16x16x32_bf16 v[120:123], v[56:59], v[200:203], v[120:123]
  s_add_u32 m0, s43, 40960
  s_waitcnt lgkmcnt(4)
  v_mfma_f32_16x16x32_bf16 v[124:127], v[60:63], v[188:191], v[124:127]
  ds_read_b64_tr_b16 v[72:73], v28 offset:8192
  v_mfma_f32_16x16x32_bf16 v[128:131], v[60:63], v[192:195], v[128:131]
  ds_read_b64_tr_b16 v[74:75], v28 offset:9216
  v_mfma_f32_16x16x32_bf16 v[132:135], v[60:63], v[196:199], v[132:135]
  s_add_u32 s44, s56, 221184
  v_mfma_f32_16x16x32_bf16 v[136:139], v[60:63], v[200:203], v[136:139]
  buffer_load_dwordx4 v8, s[12:15], s44 offen lds
  s_waitcnt lgkmcnt(4)
  v_mfma_f32_16x16x32_bf16 v[140:143], v[64:67], v[188:191], v[140:143]
  ds_read_b64_tr_b16 v[48:49], v22 offset:16384
  v_mfma_f32_16x16x32_bf16 v[144:147], v[64:67], v[192:195], v[144:147]
  ds_read_b64_tr_b16 v[50:51], v22 offset:17408
  v_mfma_f32_16x16x32_bf16 v[148:151], v[64:67], v[196:199], v[148:151]
  s_add_u32 m0, s43, 45056
  v_mfma_f32_16x16x32_bf16 v[152:155], v[64:67], v[200:203], v[152:155]
  s_add_u32 s44, s56, 276480
  s_waitcnt lgkmcnt(4)
  v_mfma_f32_16x16x32_bf16 v[156:159], v[68:71], v[188:191], v[156:159]
  ds_read_b64_tr_b16 v[52:53], v23 offset:16384
  v_mfma_f32_16x16x32_bf16 v[160:163], v[68:71], v[192:195], v[160:163]
  ds_read_b64_tr_b16 v[54:55], v23 offset:17408
  v_mfma_f32_16x16x32_bf16 v[164:167], v[68:71], v[196:199], v[164:167]
  buffer_load_dwordx4 v8, s[12:15], s44 offen lds
  v_mfma_f32_16x16x32_bf16 v[168:171], v[68:71], v[200:203], v[168:171]
  s_waitcnt lgkmcnt(4)
  v_mfma_f32_16x16x32_bf16 v[172:175], v[72:75], v[188:191], v[172:175]
  ds_read_b64_tr_b16 v[56:57], v24 offset:16384
  v_mfma_f32_16x16x32_bf16 v[176:179], v[72:75], v[192:195], v[176:179]
  ds_read_b64_tr_b16 v[58:59], v24 offset:17408
  v_mfma_f32_16x16x32_bf16 v[180:183], v[72:75], v[196:199], v[180:183]
  s_add_u32 s56, s56, 331776
  v_mfma_f32_16x16x32_bf16 v[184:187], v[72:75], v[200:203], v[184:187]
  s_waitcnt lgkmcnt(4)
  v_mfma_f32_16x16x32_bf16 v[76:79], v[48:51], v[204:207], v[76:79]
  ds_read_b64_tr_b16 v[60:61], v25 offset:16384
  v_mfma_f32_16x16x32_bf16 v[80:83], v[48:51], v[208:211], v[80:83]
  ds_read_b64_tr_b16 v[62:63], v25 offset:17408
  v_mfma_f32_16x16x32_bf16 v[84:87], v[48:51], v[212:215], v[84:87]
  v_mfma_f32_16x16x32_bf16 v[88:91], v[48:51], v[216:219], v[88:91]
  s_waitcnt lgkmcnt(4)
  v_mfma_f32_16x16x32_bf16 v[92:95], v[52:55], v[204:207], v[92:95]
  ds_read_b64_tr_b16 v[64:65], v26 offset:16384
  v_mfma_f32_16x16x32_bf16 v[96:99], v[52:55], v[208:211], v[96:99]
  ds_read_b64_tr_b16 v[66:67], v26 offset:17408
  v_mfma_f32_16x16x32_bf16 v[100:103], v[52:55], v[212:215], v[100:103]
  v_mfma_f32_16x16x32_bf16 v[104:107], v[52:55], v[216:219], v[104:107]
  s_waitcnt lgkmcnt(4)
  v_mfma_f32_16x16x32_bf16 v[108:111], v[56:59], v[204:207], v[108:111]
  ds_read_b64_tr_b16 v[68:69], v27 offset:16384
  v_mfma_f32_16x16x32_bf16 v[112:115], v[56:59], v[208:211], v[112:115]
  ds_read_b64_tr_b16 v[70:71], v27 offset:17408
  v_mfma_f32_16x16x32_bf16 v[116:119], v[56:59], v[212:215], v[116:119]
  v_mfma_f32_16x16x32_bf16 v[120:123], v[56:59], v[216:219], v[120:123]
  s_waitcnt lgkmcnt(4)
  v_mfma_f32_16x16x32_bf16 v[124:127], v[60:63], v[204:207], v[124:127]
  ds_read_b64_tr_b16 v[72:73], v28 offset:16384
  v_mfma_f32_16x16x32_bf16 v[128:131], v[60:63], v[208:211], v[128:131]
  ds_read_b64_tr_b16 v[74:75], v28 offset:17408
  v_mfma_f32_16x16x32_bf16 v[132:135], v[60:63], v[212:215], v[132:135]
  v_mfma_f32_16x16x32_bf16 v[136:139], v[60:63], v[216:219], v[136:139]
  s_waitcnt vmcnt(6)
  s_barrier
  s_waitcnt lgkmcnt(4)
  v_mfma_f32_16x16x32_bf16 v[140:143], v[64:67], v[204:207], v[140:143]
  ds_read_b64_tr_b16 v[48:49], v15 offset:0
  v_mfma_f32_16x16x32_bf16 v[144:147], v[64:67], v[208:211], v[144:147]
  ds_read_b64_tr_b16 v[50:51], v15 offset:1024
  v_mfma_f32_16x16x32_bf16 v[148:151], v[64:67], v[212:215], v[148:151]
  v_mfma_f32_16x16x32_bf16 v[152:155], v[64:67], v[216:219], v[152:155]
  s_waitcnt lgkmcnt(4)
  v_mfma_f32_16x16x32_bf16 v[156:159], v[68:71], v[204:207], v[156:159]
  ds_read_b64_tr_b16 v[52:53], v16 offset:0
  v_mfma_f32_16x16x32_bf16 v[160:163], v[68:71], v[208:211], v[160:163]
  ds_read_b64_tr_b16 v[54:55], v16 offset:1024
  v_mfma_f32_16x16x32_bf16 v[164:167], v[68:71], v[212:215], v[164:167]
  v_mfma_f32_16x16x32_bf16 v[168:171], v[68:71], v[216:219], v[168:171]
  s_waitcnt lgkmcnt(4)
  v_mfma_f32_16x16x32_bf16 v[172:175], v[72:75], v[204:207], v[172:175]
  ds_read_b64_tr_b16 v[56:57], v17 offset:0
  v_mfma_f32_16x16x32_bf16 v[176:179], v[72:75], v[208:211], v[176:179]
  ds_read_b64_tr_b16 v[58:59], v17 offset:1024
  v_mfma_f32_16x16x32_bf16 v[180:183], v[72:75], v[212:215], v[180:183]
  v_mfma_f32_16x16x32_bf16 v[184:187], v[72:75], v[216:219], v[184:187]
  s_branch L_at_pair
L_at_pairs_done:
  v_lshlrev_b32 v4, 4, v2
  v_add_u32 v4, 148480, v4
  ds_read_b128 v[76:79], v4 offset:0
  ds_read_b128 v[80:83], v4 offset:64
  ds_read_b128 v[84:87], v4 offset:128
  ds_read_b128 v[88:91], v4 offset:192
  ds_read_b128 v[92:95], v4 offset:256
  ds_read_b128 v[96:99], v4 offset:320
  ds_read_b128 v[108:111], v4 offset:384
  ds_read_b128 v[112:115], v4 offset:448
  ds_read_b128 v[116:119], v4 offset:512
  ds_read_b128 v[120:123], v4 offset:576
  ds_read_b128 v[124:127], v4 offset:640
  ds_read_b128 v[128:131], v4 offset:704
  s_waitcnt lgkmcnt(6)
  ds_read_b128 v[140:143], v4 offset:768
  ds_read_b128 v[144:147], v4 offset:832
  ds_read_b128 v[148:151], v4 offset:896
  ds_read_b128 v[152:155], v4 offset:960
  ds_read_b128 v[156:159], v4 offset:1024
  ds_read_b128 v[160:163], v4 offset:1088
  s_waitcnt lgkmcnt(12)
  v_mfma_f32_16x16x32_bf16 v[172:175], v[76:79], a[0:3], 0
  v_mfma_f32_16x16x32_bf16 v[176:179], v[76:79], a[4:7], 0
  v_mfma_f32_16x16x32_bf16 v[180:183], v[76:79], a[8:11], 0
  v_mfma_f32_16x16x32_bf16 v[184:187], v[76:79], a[12:15], 0
  v_mfma_f32_16x16x32_bf16 v[172:175], v[80:83], a[16:19], v[172:175]
  v_mfma_f32_16x16x32_bf16 v[176:179], v[80:83], a[20:23], v[176:179]
  v_mfma_f32_16x16x32_bf16 v[180:183], v[80:83], a[24:27], v[180:183]
  v_mfma_f32_16x16x32_bf16 v[184:187], v[80:83], a[28:31], v[184:187]
  v_mfma_f32_16x16x32_bf16 v[172:175], v[84:87], a[32:35], v[172:175]
  v_mfma_f32_16x16x32_bf16 v[176:179], v[84:87], a[36:39], v[176:179]
  v_mfma_f32_16x16x32_bf16 v[180:183], v[84:87], a[40:43], v[180:183]
  v_mfma_f32_16x16x32_bf16 v[184:187], v[84:87], a[44:47], v[184:187]
  v_mfma_f32_16x16x32_bf16 v[172:175], v[88:91], a[48:51], v[172:175]
  v_mfma_f32_16x16x32_bf16 v[176:179], v[88:91], a[52:55], v[176:179]
  v_mfma_f32_16x16x32_bf16 v[180:183], v[88:91], a[56:59], v[180:183]
  v_mfma_f32_16x16x32_bf16 v[184:187], v[88:91], a[60:63], v[184:187]
  v_mfma_f32_16x16x32_bf16 v[172:175], v[92:95], a[64:67], v[172:175]
  v_mfma_f32_16x16x32_bf16 v[176:179], v[92:95], a[68:71], v[176:179]
  v_mfma_f32_16x16x32_bf16 v[180:183], v[92:95], a[72:75], v[180:183]
  v_mfma_f32_16x16x32_bf16 v[184:187], v[92:95], a[76:79], v[184:187]
  v_mfma_f32_16x16x32_bf16 v[172:175], v[96:99], a[80:83], v[172:175]
  v_mfma_f32_16x16x32_bf16 v[176:179], v[96:99], a[84:87], v[176:179]
  v_mfma_f32_16x16x32_bf16 v[180:183], v[96:99], a[88:91], v[180:183]
  v_mfma_f32_16x16x32_bf16 v[184:187], v[96:99], a[92:95], v[184:187]
  s_waitcnt lgkmcnt(6)
  v_mfma_f32_16x16x32_bf16 v[172:175], v[108:111], a[96:99], v[172:175]
  v_mfma_f32_16x16x32_bf16 v[176:179], v[108:111], a[100:103], v[176:179]
  v_mfma_f32_16x16x32_bf16 v[180:183], v[108:111], a[104:107], v[180:183]
  v_mfma_f32_16x16x32_bf16 v[184:187], v[108:111], a[108:111], v[184:187]
  v_mfma_f32_16x16x32_bf16 v[172:175], v[112:115], a[112:115], v[172:175]
  v_mfma_f32_16x16x32_bf16 v[176:179], v[112:115], a[116:119], v[176:179]
  v_mfma_f32_16x16x32_bf16 v[180:183], v[112:115], a[120:123], v[180:183]
  v_mfma_f32_16x16x32_bf16 v[184:187], v[112:115], a[124:127], v[184:187]
  v_mfma_f32_16x16x32_bf16 v[172:175], v[116:119], a[128:131], v[172:175]
  v_mfma_f32_16x16x32_bf16 v[176:179], v[116:119], a[132:135], v[176:179]
  v_mfma_f32_16x16x32_bf16 v[180:183], v[116:119], a[136:139], v[180:183]
  v_mfma_f32_16x16x32_bf16 v[184:187], v[116:119], a[140:143], v[184:187]
  v_mfma_f32_16x16x32_bf16 v[172:175], v[120:123], a[144:147], v[172:175]
  v_mfma_f32_16x16x32_bf16 v[176:179], v[120:123], a[148:151], v[176:179]
  v_mfma_f32_16x16x32_bf16 v[180:183], v[120:123], a[152:155], v[180:183]
  v_mfma_f32_16x16x32_bf16 v[184:187], v[120:123], a[156:159], v[184:187]
  v_mfma_f32_16x16x32_bf16 v[172:175], v[124:127], a[160:163], v[172:175]
  v_mfma_f32_16x16x32_bf16 v[176:179], v[124:127], a[164:167], v[176:179]
  v_mfma_f32_16x16x32_bf16 v[180:183], v[124:127], a[168:171], v[180:183]
  v_mfma_f32_16x16x32_bf16 v[184:187], v[124:127], a[172:175], v[184:187]
  v_mfma_f32_16x16x32_bf16 v[172:175], v[128:131], a[176:179], v[172:175]
  v_mfma_f32_16x16x32_bf16 v[176:179], v[128:131], a[180:183], v[176:179]
  v_mfma_f32_16x16x32_bf16 v[180:183], v[128:131], a[184:187], v[180:183]
  v_mfma_f32_16x16x32_bf16 v[184:187], v[128:131], a[188:191], v[184:187]
  s_waitcnt lgkmcnt(0)
  v_mfma_f32_16x16x32_bf16 v[172:175], v[140:143], a[192:195], v[172:175]
  v_mfma_f32_16x16x32_bf16 v[176:179], v[140:143], a[196:199], v[176:179]
  v_mfma_f32_16x16x32_bf16 v[180:183], v[140:143], a[200:203], v[180:183]
  v_mfma_f32_16x16x32_bf16 v[184:187], v[140:143], a[204:207], v[184:187]
  v_mfma_f32_16x16x32_bf16 v[172:175], v[144:147], a[208:211], v[172:175]
  v_mfma_f32_16x16x32_bf16 v[176:179], v[144:147], a[212:215], v[176:179]
  v_mfma_f32_16x16x32_bf16 v[180:183], v[144:147], a[216:219], v[180:183]
  v_mfma_f32_16x16x32_bf16 v[184:187], v[144:147], a[220:223], v[184:187]
  v_mfma_f32_16x16x32_bf16 v[172:175], v[148:151], a[224:227], v[172:175]
  v_mfma_f32_16x16x32_bf16 v[176:179], v[148:151], a[228:231], v[176:179]
  v_mfma_f32_16x16x32_bf16 v[180:183], v[148:151], a[232:235], v[180:183]
  v_mfma_f32_16x16x32_bf16 v[184:187], v[148:151], a[236:239], v[184:187]
  v_mfma_f32_16x16x32_bf16 v[172:175], v[152:155], a[240:243], v[172:175]
  v_mfma_f32_16x16x32_bf16 v[176:179], v[152:155], a[244:247], v[176:179]
  v_mfma_f32_16x16x32_bf16 v[180:183], v[152:155], a[248:251], v[180:183]
  v_mfma_f32_16x16x32_bf16 v[184:187], v[152:155], a[252:255], v[184:187]
  v_mfma_f32_16x16x32_bf16 v[172:175], v[156:159], v[188:191], v[172:175]
  v_mfma_f32_16x16x32_bf16 v[176:179], v[156:159], v[192:195], v[176:179]
  v_mfma_f32_16x16x32_bf16 v[180:183], v[156:159], v[196:199], v[180:183]
  v_mfma_f32_16x16x32_bf16 v[184:187], v[156:159], v[200:203], v[184:187]
  v_mfma_f32_16x16x32_bf16 v[172:175], v[160:163], v[204:207], v[172:175]
  v_mfma_f32_16x16x32_bf16 v[176:179], v[160:163], v[208:211], v[176:179]
  v_mfma_f32_16x16x32_bf16 v[180:183], v[160:163], v[212:215], v[180:183]
  v_mfma_f32_16x16x32_bf16 v[184:187], v[160:163], v[216:219], v[184:187]
  s_nop 7
  v_mul_f32 v29, 0xbfb8aa3b, v172
  v_mul_f32 v30, 0xbfb8aa3b, v176
  v_mul_f32 v31, 0xbfb8aa3b, v180
  v_mul_f32 v32, 0xbfb8aa3b, v184
  v_exp_f32 v29, v29
  v_exp_f32 v30, v30
  v_exp_f32 v31, v31
  v_exp_f32 v32, v32
  v_add_f32 v29, 1.0, v29
  v_add_f32 v30, 1.0, v30
  v_add_f32 v31, 1.0, v31
  v_add_f32 v32, 1.0, v32
  v_rcp_f32 v29, v29
  v_rcp_f32 v30, v30
  v_rcp_f32 v31, v31
  v_rcp_f32 v32, v32
  s_cmp_eq_u32 s32, 0
  s_cbranch_scc0 L_at_nog1
  s_lshl_b32 s44, s34, 2
  s_add_u32 s44, s44, s36
  s_lshl_b32 s44, s44, 8
  v_lshlrev_b32 v4, 2, v3
  v_add_u32 v4, s44, v4
  v_add_u32 v4, 21463040, v4
  v_cmp_gt_u32 vcc, 16, v1
  s_and_saveexec_b64 s[80:81], vcc
  s_cbranch_execz L_at_nog1b
  v_sub_f32 v172, 1.0, v29
  global_store_dword v4, v172, s[70:71] offset:0 sc1
  v_sub_f32 v173, 1.0, v30
  global_store_dword v4, v173, s[70:71] offset:64 sc1
  v_sub_f32 v174, 1.0, v31
  global_store_dword v4, v174, s[70:71] offset:128 sc1
  v_sub_f32 v175, 1.0, v32
  global_store_dword v4, v175, s[70:71] offset:192 sc1
L_at_nog1b:
  s_mov_b64 exec, s[80:81]
L_at_nog1:
  s_waitcnt vmcnt(0)
  s_barrier
  s_cmp_eq_u32 s36, 0
  s_cbranch_scc0 L_at_nosig1
  v_mov_b32 v244, 21447680
  v_mov_b32 v245, 1
  s_mov_b64 s[80:81], exec
  s_mov_b64 exec, 1
  global_atomic_add v244, v245, s[70:71]
  s_mov_b64 exec, s[80:81]
L_at_nosig1:
  v_add_u32 v244, 0, v33
  ds_read_b64_tr_b16 v[92:93], v244 offset:0
  ds_read_b64_tr_b16 v[94:95], v244 offset:1536
  ds_read_b64_tr_b16 v[104:105], v244 offset:3072
  ds_read_b64_tr_b16 v[96:97], v244 offset:32
  ds_read_b64_tr_b16 v[98:99], v244 offset:1568
  ds_read_b64_tr_b16 v[106:107], v244 offset:3104
  ds_read_b64_tr_b16 v[100:101], v244 offset:64
  ds_read_b64_tr_b16 v[102:103], v244 offset:1600
  ds_read_b64_tr_b16 v[140:141], v244 offset:3136
  s_waitcnt lgkmcnt(0)
  v_mfma_f32_16x16x32_bf16 v[76:79], v[92:95], v[220:223], 0
  v_mfma_f32_16x16x32_bf16 v[80:83], v[96:99], v[220:223], 0
  v_mfma_f32_16x16x32_bf16 v[84:87], v[100:103], v[220:223], 0
  v_mfma_f32_16x16x32_bf16 v[172:175], v[92:95], v[226:229], 0
  v_mfma_f32_16x16x32_bf16 v[176:179], v[96:99], v[226:229], 0
  v_mfma_f32_16x16x32_bf16 v[180:183], v[100:103], v[226:229], 0
  s_nop 0
  v_mfma_f32_16x16x16_bf16 v[76:79], v[104:105], v[224:225], v[76:79]
  v_mfma_f32_16x16x16_bf16 v[80:83], v[106:107], v[224:225], v[80:83]
  v_mfma_f32_16x16x16_bf16 v[84:87], v[140:141], v[224:225], v[84:87]
  v_mfma_f32_16x16x16_bf16 v[172:175], v[104:105], v[230:231], v[172:175]
  v_mfma_f32_16x16x16_bf16 v[176:179], v[106:107], v[230:231], v[176:179]
  v_mfma_f32_16x16x16_bf16 v[180:183], v[140:141], v[230:231], v[180:183]
  s_swappc_b64 s[84:85], s[86:87]
  v_accvgpr_write_b32 a0, v76
  v_accvgpr_write_b32 a1, v77
  v_accvgpr_write_b32 a2, v78
  v_accvgpr_write_b32 a3, v79
  v_accvgpr_write_b32 a4, v80
  v_accvgpr_write_b32 a5, v81
  v_accvgpr_write_b32 a6, v82
  v_accvgpr_write_b32 a7, v83
  v_accvgpr_write_b32 a8, v84
  v_accvgpr_write_b32 a9, v85
  v_accvgpr_write_b32 a10, 0
  v_accvgpr_write_b32 a11, 0
  v_accvgpr_write_b32 a12, v172
  v_accvgpr_write_b32 a13, v173
  v_accvgpr_write_b32 a14, v174
  v_accvgpr_write_b32 a15, v175
  v_accvgpr_write_b32 a16, v176
  v_accvgpr_write_b32 a17, v177
  v_accvgpr_write_b32 a18, v178
  v_accvgpr_write_b32 a19, v179
  v_accvgpr_write_b32 a20, v180
  v_accvgpr_write_b32 a21, v181
  v_accvgpr_write_b32 a22, 0
  v_accvgpr_write_b32 a23, 0
  v_mfma_f32_16x16x32_bf16 v[76:79], v[92:95], v[232:235], 0
  v_mfma_f32_16x16x32_bf16 v[80:83], v[96:99], v[232:235], 0
  v_mfma_f32_16x16x32_bf16 v[84:87], v[100:103], v[232:235], 0
  v_mfma_f32_16x16x32_bf16 v[172:175], v[92:95], v[238:241], 0
  v_mfma_f32_16x16x32_bf16 v[176:179], v[96:99], v[238:241], 0
  v_mfma_f32_16x16x32_bf16 v[180:183], v[100:103], v[238:241], 0
  s_nop 0
  v_mfma_f32_16x16x16_bf16 v[76:79], v[104:105], v[236:237], v[76:79]
  v_mfma_f32_16x16x16_bf16 v[80:83], v[106:107], v[236:237], v[80:83]
  v_mfma_f32_16x16x16_bf16 v[84:87], v[140:141], v[236:237], v[84:87]
  v_mfma_f32_16x16x16_bf16 v[172:175], v[104:105], v[242:243], v[172:175]
  v_mfma_f32_16x16x16_bf16 v[176:179], v[106:107], v[242:243], v[176:179]
  v_mfma_f32_16x16x16_bf16 v[180:183], v[140:141], v[242:243], v[180:183]
  s_swappc_b64 s[84:85], s[86:87]
  v_accvgpr_write_b32 a24, v76
  v_accvgpr_write_b32 a25, v77
  v_accvgpr_write_b32 a26, v78
  v_accvgpr_write_b32 a27, v79
  v_accvgpr_write_b32 a28, v80
  v_accvgpr_write_b32 a29, v81
  v_accvgpr_write_b32 a30, v82
  v_accvgpr_write_b32 a31, v83
  v_accvgpr_write_b32 a32, v84
  v_accvgpr_write_b32 a33, v85
  v_accvgpr_write_b32 a34, 0
  v_accvgpr_write_b32 a35, 0
  v_accvgpr_write_b32 a36, v172
  v_accvgpr_write_b32 a37, v173
  v_accvgpr_write_b32 a38, v174
  v_accvgpr_write_b32 a39, v175
  v_accvgpr_write_b32 a40, v176
  v_accvgpr_write_b32 a41, v177
  v_accvgpr_write_b32 a42, v178
  v_accvgpr_write_b32 a43, v179
  v_accvgpr_write_b32 a44, v180
  v_accvgpr_write_b32 a45, v181
  v_accvgpr_write_b32 a46, 0
  v_accvgpr_write_b32 a47, 0
  s_cmp_eq_u32 s36, 0
  s_cbranch_scc0 L_at_nopoll1
  v_mov_b32 v244, 21447680
L_at_poll1:
  global_load_dword v245, v244, s[70:71] sc1
  s_waitcnt vmcnt(0)
  v_readfirstlane_b32 s44, v245
  s_cmp_ge_u32 s44, 64
  s_cbranch_scc1 L_at_nopoll1
  s_sleep 2
  s_branch L_at_poll1
L_at_nopoll1:
  s_barrier
  s_mul_i32 s45, s32, 24576
  s_mul_i32 s44, s36, 6144
  s_add_u32 s45, s45, s44
  s_add_u32 m0, s44, 0
  s_add_u32 s72, s45, 0
  buffer_load_dwordx4 v43, s[28:31], s72 offen sc1 lds
  s_add_u32 m0, s44, 1024
  s_add_u32 s72, s45, 1024
  buffer_load_dwordx4 v43, s[28:31], s72 offen sc1 lds
  s_add_u32 m0, s44, 2048
  s_add_u32 s72, s45, 2048
  buffer_load_dwordx4 v43, s[28:31], s72 offen sc1 lds
  s_add_u32 m0, s44, 3072
  s_add_u32 s72, s45, 3072
  buffer_load_dwordx4 v43, s[28:31], s72 offen sc1 lds
  s_add_u32 m0, s44, 4096
  s_add_u32 s72, s45, 4096
  buffer_load_dwordx4 v43, s[28:31], s72 offen sc1 lds
  s_add_u32 m0, s44, 5120
  s_add_u32 s72, s45, 5120
  buffer_load_dwordx4 v43, s[28:31], s72 offen sc1 lds
  v_add_u32 v244, 4608, v33
  ds_read_b64_tr_b16 v[92:93], v244 offset:0
  ds_read_b64_tr_b16 v[94:95], v244 offset:1536
  ds_read_b64_tr_b16 v[104:105], v244 offset:3072
  ds_read_b64_tr_b16 v[96:97], v244 offset:32
  ds_read_b64_tr_b16 v[98:99], v244 offset:1568
  ds_read_b64_tr_b16 v[106:107], v244 offset:3104
  ds_read_b64_tr_b16 v[100:101], v244 offset:64
  ds_read_b64_tr_b16 v[102:103], v244 offset:1600
  ds_read_b64_tr_b16 v[140:141], v244 offset:3136
  s_waitcnt lgkmcnt(0)
  v_mfma_f32_16x16x32_bf16 v[76:79], v[92:95], v[48:51], 0
  v_mfma_f32_16x16x32_bf16 v[80:83], v[96:99], v[48:51], 0
  v_mfma_f32_16x16x32_bf16 v[84:87], v[100:103], v[48:51], 0
  v_mfma_f32_16x16x32_bf16 v[172:175], v[92:95], v[54:57], 0
  v_mfma_f32_16x16x32_bf16 v[176:179], v[96:99], v[54:57], 0
  v_mfma_f32_16x16x32_bf16 v[180:183], v[100:103], v[54:57], 0
  s_nop 0
  v_mfma_f32_16x16x16_bf16 v[76:79], v[104:105], v[52:53], v[76:79]
  v_mfma_f32_16x16x16_bf16 v[80:83], v[106:107], v[52:53], v[80:83]
  v_mfma_f32_16x16x16_bf16 v[84:87], v[140:141], v[52:53], v[84:87]
  v_mfma_f32_16x16x16_bf16 v[172:175], v[104:105], v[58:59], v[172:175]
  v_mfma_f32_16x16x16_bf16 v[176:179], v[106:107], v[58:59], v[176:179]
  v_mfma_f32_16x16x16_bf16 v[180:183], v[140:141], v[58:59], v[180:183]
  s_swappc_b64 s[84:85], s[86:87]
  v_accvgpr_write_b32 a48, v76
  v_accvgpr_write_b32 a49, v77
  v_accvgpr_write_b32 a50, v78
  v_accvgpr_write_b32 a51, v79
  v_accvgpr_write_b32 a52, v80
  v_accvgpr_write_b32 a53, v81
  v_accvgpr_write_b32 a54, v82
  v_accvgpr_write_b32 a55, v83
  v_accvgpr_write_b32 a56, v84
  v_accvgpr_write_b32 a57, v85
  v_accvgpr_write_b32 a58, 0
  v_accvgpr_write_b32 a59, 0
  v_accvgpr_write_b32 a60, v172
  v_accvgpr_write_b32 a61, v173
  v_accvgpr_write_b32 a62, v174
  v_accvgpr_write_b32 a63, v175
  v_accvgpr_write_b32 a64, v176
  v_accvgpr_write_b32 a65, v177
  v_accvgpr_write_b32 a66, v178
  v_accvgpr_write_b32 a67, v179
  v_accvgpr_write_b32 a68, v180
  v_accvgpr_write_b32 a69, v181
  v_accvgpr_write_b32 a70, 0
  v_accvgpr_write_b32 a71, 0
  v_mfma_f32_16x16x32_bf16 v[76:79], v[92:95], v[60:63], 0
  v_mfma_f32_16x16x32_bf16 v[80:83], v[96:99], v[60:63], 0
  v_mfma_f32_16x16x32_bf16 v[84:87], v[100:103], v[60:63], 0
  v_mfma_f32_16x16x32_bf16 v[172:175], v[92:95], v[66:69], 0
  v_mfma_f32_16x16x32_bf16 v[176:179], v[96:99], v[66:69], 0
  v_mfma_f32_16x16x32_bf16 v[180:183], v[100:103], v[66:69], 0
  s_nop 0
  v_mfma_f32_16x16x16_bf16 v[76:79], v[104:105], v[64:65], v[76:79]
  v_mfma_f32_16x16x16_bf16 v[80:83], v[106:107], v[64:65], v[80:83]
  v_mfma_f32_16x16x16_bf16 v[84:87], v[140:141], v[64:65], v[84:87]
  v_mfma_f32_16x16x16_bf16 v[172:175], v[104:105], v[70:71], v[172:175]
  v_mfma_f32_16x16x16_bf16 v[176:179], v[106:107], v[70:71], v[176:179]
  v_mfma_f32_16x16x16_bf16 v[180:183], v[140:141], v[70:71], v[180:183]
  s_swappc_b64 s[84:85], s[86:87]
  v_accvgpr_write_b32 a72, v76
  v_accvgpr_write_b32 a73, v77
  v_accvgpr_write_b32 a74, v78
  v_accvgpr_write_b32 a75, v79
  v_accvgpr_write_b32 a76, v80
  v_accvgpr_write_b32 a77, v81
  v_accvgpr_write_b32 a78, v82
  v_accvgpr_write_b32 a79, v83
  v_accvgpr_write_b32 a80, v84
  v_accvgpr_write_b32 a81, v85
  v_accvgpr_write_b32 a82, 0
  v_accvgpr_write_b32 a83, 0
  v_accvgpr_write_b32 a84, v172
  v_accvgpr_write_b32 a85, v173
  v_accvgpr_write_b32 a86, v174
  v_accvgpr_write_b32 a87, v175
  v_accvgpr_write_b32 a88, v176
  v_accvgpr_write_b32 a89, v177
  v_accvgpr_write_b32 a90, v178
  v_accvgpr_write_b32 a91, v179
  v_accvgpr_write_b32 a92, v180
  v_accvgpr_write_b32 a93, v181
  v_accvgpr_write_b32 a94, 0
  v_accvgpr_write_b32 a95, 0
  s_waitcnt vmcnt(0)
  s_barrier
  ds_read_b128 v[220:223], v41 offset:0
  ds_read_b128 v[224:227], v41 offset:16
  ds_read_b128 v[228:231], v41 offset:32
  ds_read_b128 v[232:235], v41 offset:48
  ds_read_b128 v[236:239], v41 offset:64
  ds_read_b128 v[240:243], v41 offset:80
  ds_read_b128 v[188:191], v42 offset:0
  ds_read_b128 v[192:195], v42 offset:16
  ds_read_b128 v[196:199], v42 offset:32
  ds_read_b128 v[200:203], v42 offset:48
  ds_read_b128 v[204:207], v42 offset:64
  ds_read_b128 v[208:211], v42 offset:80
  s_waitcnt lgkmcnt(6)
  v_cvt_pk_bf16_f32 v244, v220, v221
  v_cndmask_b32 v76, 0, v244, s[76:77]
  v_cndmask_b32 v88, v244, 0, s[76:77]
  v_cvt_pk_bf16_f32 v244, v222, v223
  v_cndmask_b32 v77, 0, v244, s[76:77]
  v_cndmask_b32 v89, v244, 0, s[76:77]
  v_cvt_pk_bf16_f32 v244, v224, v225
  v_cndmask_b32 v78, 0, v244, s[76:77]
  v_cndmask_b32 v90, v244, 0, s[76:77]
  v_cvt_pk_bf16_f32 v244, v226, v227
  v_cndmask_b32 v79, 0, v244, s[76:77]
  v_cndmask_b32 v91, v244, 0, s[76:77]
  v_cvt_pk_bf16_f32 v244, v228, v229
  v_cndmask_b32 v80, 0, v244, s[76:77]
  v_cndmask_b32 v92, v244, 0, s[76:77]
  v_cvt_pk_bf16_f32 v244, v230, v231
  v_cndmask_b32 v81, 0, v244, s[76:77]
  v_cndmask_b32 v93, v244, 0, s[76:77]
  v_cvt_pk_bf16_f32 v244, v232, v233
  v_cndmask_b32 v82, 0, v244, s[76:77]
  v_cndmask_b32 v94, v244, 0, s[76:77]
  v_cvt_pk_bf16_f32 v244, v234, v235
  v_cndmask_b32 v83, 0, v244, s[76:77]
  v_cndmask_b32 v95, v244, 0, s[76:77]
  v_cvt_pk_bf16_f32 v244, v236, v237
  v_cndmask_b32 v84, 0, v244, s[76:77]
  v_cndmask_b32 v96, v244, 0, s[76:77]
  v_cvt_pk_bf16_f32 v244, v238, v239
  v_cndmask_b32 v85, 0, v244, s[76:77]
  v_cndmask_b32 v97, v244, 0, s[76:77]
  v_cvt_pk_bf16_f32 v244, v240, v241
  v_cndmask_b32 v86, 0, v244, s[76:77]
  v_cndmask_b32 v98, v244, 0, s[76:77]
  v_cvt_pk_bf16_f32 v244, v242, v243
  v_cndmask_b32 v87, 0, v244, s[76:77]
  v_cndmask_b32 v99, v244, 0, s[76:77]
  s_waitcnt lgkmcnt(0)
  v_cvt_pk_bf16_f32 v244, v188, v189
  v_cndmask_b32 v100, 0, v244, s[74:75]
  v_cvt_pk_bf16_f32 v244, v190, v191
  v_cndmask_b32 v101, 0, v244, s[74:75]
  v_cvt_pk_bf16_f32 v244, v192, v193
  v_cndmask_b32 v102, 0, v244, s[74:75]
  v_cvt_pk_bf16_f32 v244, v194, v195
  v_cndmask_b32 v103, 0, v244, s[74:75]
  v_cvt_pk_bf16_f32 v244, v196, v197
  v_cndmask_b32 v104, 0, v244, s[74:75]
  v_cvt_pk_bf16_f32 v244, v198, v199
  v_cndmask_b32 v105, 0, v244, s[74:75]
  v_cvt_pk_bf16_f32 v244, v200, v201
  v_cndmask_b32 v106, 0, v244, s[74:75]
  v_cvt_pk_bf16_f32 v244, v202, v203
  v_cndmask_b32 v107, 0, v244, s[74:75]
  v_cvt_pk_bf16_f32 v244, v204, v205
  v_cndmask_b32 v108, 0, v244, s[74:75]
  v_cvt_pk_bf16_f32 v244, v206, v207
  v_cndmask_b32 v109, 0, v244, s[74:75]
  v_cvt_pk_bf16_f32 v244, v208, v209
  v_cndmask_b32 v110, 0, v244, s[74:75]
  v_cvt_pk_bf16_f32 v244, v210, v211
  v_cndmask_b32 v111, 0, v244, s[74:75]
  s_lshl_b32 s44, s32, 1
  s_add_u32 s44, s44, 0
  s_add_u32 s45, s44, 144
  s_lshl_b32 s45, s45, 10
  s_lshr_b32 s72, s44, 3
  s_add_u32 s72, s72, 160
  s_lshl_b32 s72, s72, 10
  s_and_b32 s82, s44, 7
  s_lshr_b32 s83, s82, 1
  s_lshl_b32 s83, s83, 8
  s_and_b32 s82, s82, 1
  s_lshl_b32 s82, s82, 3
  s_add_u32 s83, s83, s82
  s_add_u32 s72, s72, s83
  v_mfma_f32_16x16x32_bf16 v[140:143], v[76:79], a[0:3], 0
  v_mfma_f32_16x16x32_bf16 v[140:143], v[80:83], a[4:7], v[140:143]
  v_mfma_f32_16x16x32_bf16 v[140:143], v[84:87], a[8:11], v[140:143]
  v_mfma_f32_16x16x32_bf16 v[144:147], v[88:91], a[0:3], 0
  v_mfma_f32_16x16x32_bf16 v[144:147], v[92:95], a[4:7], v[144:147]
  v_mfma_f32_16x16x32_bf16 v[144:147], v[96:99], a[8:11], v[144:147]
  v_mfma_f32_16x16x32_bf16 v[148:151], v[100:103], a[0:3], 0
  v_mfma_f32_16x16x32_bf16 v[148:151], v[104:107], a[4:7], v[148:151]
  v_mfma_f32_16x16x32_bf16 v[148:151], v[108:111], a[8:11], v[148:151]
  v_mfma_f32_16x16x32_bf16 v[172:175], v[76:79], a[12:15], 0
  v_mfma_f32_16x16x32_bf16 v[172:175], v[80:83], a[16:19], v[172:175]
  v_mfma_f32_16x16x32_bf16 v[172:175], v[84:87], a[20:23], v[172:175]
  v_mfma_f32_16x16x32_bf16 v[176:179], v[88:91], a[12:15], 0
  v_mfma_f32_16x16x32_bf16 v[176:179], v[92:95], a[16:19], v[176:179]
  v_mfma_f32_16x16x32_bf16 v[176:179], v[96:99], a[20:23], v[176:179]
  v_mfma_f32_16x16x32_bf16 v[180:183], v[100:103], a[12:15], 0
  v_mfma_f32_16x16x32_bf16 v[180:183], v[104:107], a[16:19], v[180:183]
  v_mfma_f32_16x16x32_bf16 v[180:183], v[108:111], a[20:23], v[180:183]
  s_nop 7
  v_add_f32 v244, 0x358637bd, v148
  v_add_f32 v245, 0x358637bd, v149
  v_add_f32 v248, 0x358637bd, v180
  v_add_f32 v249, 0x358637bd, v181
  v_rcp_f32 v244, v244
  v_rcp_f32 v245, v245
  v_rcp_f32 v248, v248
  v_rcp_f32 v249, v249
  s_nop 0
  v_mul_f32 v244, v244, v29
  v_mul_f32 v245, v245, v29
  v_mul_f32 v140, v140, v244
  v_mul_f32 v144, v144, v245
  v_mul_f32 v141, v141, v244
  v_mul_f32 v145, v145, v245
  v_mul_f32 v142, v142, v244
  v_mul_f32 v146, v146, v245
  v_mul_f32 v143, v143, v244
  v_mul_f32 v147, v147, v245
  v_cndmask_b32 v246, v244, v245, s[78:79]
  v_mul_f32 v150, v150, v246
  v_mul_f32 v151, v151, v246
  v_cvt_pk_bf16_f32 v152, v140, v141
  v_cvt_pk_bf16_f32 v153, v142, v143
  v_cvt_pk_bf16_f32 v154, v144, v145
  v_cvt_pk_bf16_f32 v155, v146, v147
  v_cvt_pk_bf16_f32 v148, v150, v151
  s_add_u32 s82, s88, s45
  buffer_store_dwordx4 v[152:155], v43, s[24:27], s82 offen sc1
  s_add_u32 s82, s88, s72
  s_mov_b64 s[80:81], exec
  s_mov_b64 exec, s[76:77]
  buffer_store_dword v148, v44, s[24:27], s82 offen sc1
  s_mov_b64 exec, s[80:81]
  v_mul_f32 v248, v248, v30
  v_mul_f32 v249, v249, v30
  v_mul_f32 v172, v172, v248
  v_mul_f32 v176, v176, v249
  v_mul_f32 v173, v173, v248
  v_mul_f32 v177, v177, v249
  v_mul_f32 v174, v174, v248
  v_mul_f32 v178, v178, v249
  v_mul_f32 v175, v175, v248
  v_mul_f32 v179, v179, v249
  v_cndmask_b32 v250, v248, v249, s[78:79]
  v_mul_f32 v182, v182, v250
  v_mul_f32 v183, v183, v250
  v_cvt_pk_bf16_f32 v184, v172, v173
  v_cvt_pk_bf16_f32 v185, v174, v175
  v_cvt_pk_bf16_f32 v186, v176, v177
  v_cvt_pk_bf16_f32 v187, v178, v179
  v_cvt_pk_bf16_f32 v180, v182, v183
  s_add_u32 s82, s89, s45
  buffer_store_dwordx4 v[184:187], v43, s[24:27], s82 offen sc1
  s_add_u32 s82, s89, s72
  s_mov_b64 s[80:81], exec
  s_mov_b64 exec, s[76:77]
  buffer_store_dword v180, v44, s[24:27], s82 offen sc1
  s_mov_b64 exec, s[80:81]
  s_nop 1
  v_mfma_f32_16x16x32_bf16 v[140:143], v[76:79], a[24:27], 0
  v_mfma_f32_16x16x32_bf16 v[140:143], v[80:83], a[28:31], v[140:143]
  v_mfma_f32_16x16x32_bf16 v[140:143], v[84:87], a[32:35], v[140:143]
  v_mfma_f32_16x16x32_bf16 v[144:147], v[88:91], a[24:27], 0
  v_mfma_f32_16x16x32_bf16 v[144:147], v[92:95], a[28:31], v[144:147]
  v_mfma_f32_16x16x32_bf16 v[144:147], v[96:99], a[32:35], v[144:147]
  v_mfma_f32_16x16x32_bf16 v[148:151], v[100:103], a[24:27], 0
  v_mfma_f32_16x16x32_bf16 v[148:151], v[104:107], a[28:31], v[148:151]
  v_mfma_f32_16x16x32_bf16 v[148:151], v[108:111], a[32:35], v[148:151]
  v_mfma_f32_16x16x32_bf16 v[172:175], v[76:79], a[36:39], 0
  v_mfma_f32_16x16x32_bf16 v[172:175], v[80:83], a[40:43], v[172:175]
  v_mfma_f32_16x16x32_bf16 v[172:175], v[84:87], a[44:47], v[172:175]
  v_mfma_f32_16x16x32_bf16 v[176:179], v[88:91], a[36:39], 0
  v_mfma_f32_16x16x32_bf16 v[176:179], v[92:95], a[40:43], v[176:179]
  v_mfma_f32_16x16x32_bf16 v[176:179], v[96:99], a[44:47], v[176:179]
  v_mfma_f32_16x16x32_bf16 v[180:183], v[100:103], a[36:39], 0
  v_mfma_f32_16x16x32_bf16 v[180:183], v[104:107], a[40:43], v[180:183]
  v_mfma_f32_16x16x32_bf16 v[180:183], v[108:111], a[44:47], v[180:183]
  s_nop 7
  v_add_f32 v244, 0x358637bd, v148
  v_add_f32 v245, 0x358637bd, v149
  v_add_f32 v248, 0x358637bd, v180
  v_add_f32 v249, 0x358637bd, v181
  v_rcp_f32 v244, v244
  v_rcp_f32 v245, v245
  v_rcp_f32 v248, v248
  v_rcp_f32 v249, v249
  s_nop 0
  v_mul_f32 v244, v244, v31
  v_mul_f32 v245, v245, v31
  v_mul_f32 v140, v140, v244
  v_mul_f32 v144, v144, v245
  v_mul_f32 v141, v141, v244
  v_mul_f32 v145, v145, v245
  v_mul_f32 v142, v142, v244
  v_mul_f32 v146, v146, v245
  v_mul_f32 v143, v143, v244
  v_mul_f32 v147, v147, v245
  v_cndmask_b32 v246, v244, v245, s[78:79]
  v_mul_f32 v150, v150, v246
  v_mul_f32 v151, v151, v246
  v_cvt_pk_bf16_f32 v152, v140, v141
  v_cvt_pk_bf16_f32 v153, v142, v143
  v_cvt_pk_bf16_f32 v154, v144, v145
  v_cvt_pk_bf16_f32 v155, v146, v147
  v_cvt_pk_bf16_f32 v148, v150, v151
  s_add_u32 s82, s90, s45
  buffer_store_dwordx4 v[152:155], v43, s[24:27], s82 offen sc1
  s_add_u32 s82, s90, s72
  s_mov_b64 s[80:81], exec
  s_mov_b64 exec, s[76:77]
  buffer_store_dword v148, v44, s[24:27], s82 offen sc1
  s_mov_b64 exec, s[80:81]
  v_mul_f32 v248, v248, v32
  v_mul_f32 v249, v249, v32
  v_mul_f32 v172, v172, v248
  v_mul_f32 v176, v176, v249
  v_mul_f32 v173, v173, v248
  v_mul_f32 v177, v177, v249
  v_mul_f32 v174, v174, v248
  v_mul_f32 v178, v178, v249
  v_mul_f32 v175, v175, v248
  v_mul_f32 v179, v179, v249
  v_cndmask_b32 v250, v248, v249, s[78:79]
  v_mul_f32 v182, v182, v250
  v_mul_f32 v183, v183, v250
  v_cvt_pk_bf16_f32 v184, v172, v173
  v_cvt_pk_bf16_f32 v185, v174, v175
  v_cvt_pk_bf16_f32 v186, v176, v177
  v_cvt_pk_bf16_f32 v187, v178, v179
  v_cvt_pk_bf16_f32 v180, v182, v183
  s_add_u32 s82, s91, s45
  buffer_store_dwordx4 v[184:187], v43, s[24:27], s82 offen sc1
  s_add_u32 s82, s91, s72
  s_mov_b64 s[80:81], exec
  s_mov_b64 exec, s[76:77]
  buffer_store_dword v180, v44, s[24:27], s82 offen sc1
  s_mov_b64 exec, s[80:81]
  s_nop 1
  ds_read_b128 v[220:223], v41 offset:12288
  ds_read_b128 v[224:227], v41 offset:12304
  ds_read_b128 v[228:231], v41 offset:12320
  ds_read_b128 v[232:235], v41 offset:12336
  ds_read_b128 v[236:239], v41 offset:12352
  ds_read_b128 v[240:243], v41 offset:12368
  ds_read_b128 v[188:191], v42 offset:12288
  ds_read_b128 v[192:195], v42 offset:12304
  ds_read_b128 v[196:199], v42 offset:12320
  ds_read_b128 v[200:203], v42 offset:12336
  ds_read_b128 v[204:207], v42 offset:12352
  ds_read_b128 v[208:211], v42 offset:12368
  s_waitcnt lgkmcnt(6)
  v_cvt_pk_bf16_f32 v244, v220, v221
  v_cndmask_b32 v76, 0, v244, s[76:77]
  v_cndmask_b32 v88, v244, 0, s[76:77]
  v_cvt_pk_bf16_f32 v244, v222, v223
  v_cndmask_b32 v77, 0, v244, s[76:77]
  v_cndmask_b32 v89, v244, 0, s[76:77]
  v_cvt_pk_bf16_f32 v244, v224, v225
  v_cndmask_b32 v78, 0, v244, s[76:77]
  v_cndmask_b32 v90, v244, 0, s[76:77]
  v_cvt_pk_bf16_f32 v244, v226, v227
  v_cndmask_b32 v79, 0, v244, s[76:77]
  v_cndmask_b32 v91, v244, 0, s[76:77]
  v_cvt_pk_bf16_f32 v244, v228, v229
  v_cndmask_b32 v80, 0, v244, s[76:77]
  v_cndmask_b32 v92, v244, 0, s[76:77]
  v_cvt_pk_bf16_f32 v244, v230, v231
  v_cndmask_b32 v81, 0, v244, s[76:77]
  v_cndmask_b32 v93, v244, 0, s[76:77]
  v_cvt_pk_bf16_f32 v244, v232, v233
  v_cndmask_b32 v82, 0, v244, s[76:77]
  v_cndmask_b32 v94, v244, 0, s[76:77]
  v_cvt_pk_bf16_f32 v244, v234, v235
  v_cndmask_b32 v83, 0, v244, s[76:77]
  v_cndmask_b32 v95, v244, 0, s[76:77]
  v_cvt_pk_bf16_f32 v244, v236, v237
  v_cndmask_b32 v84, 0, v244, s[76:77]
  v_cndmask_b32 v96, v244, 0, s[76:77]
  v_cvt_pk_bf16_f32 v244, v238, v239
  v_cndmask_b32 v85, 0, v244, s[76:77]
  v_cndmask_b32 v97, v244, 0, s[76:77]
  v_cvt_pk_bf16_f32 v244, v240, v241
  v_cndmask_b32 v86, 0, v244, s[76:77]
  v_cndmask_b32 v98, v244, 0, s[76:77]
  v_cvt_pk_bf16_f32 v244, v242, v243
  v_cndmask_b32 v87, 0, v244, s[76:77]
  v_cndmask_b32 v99, v244, 0, s[76:77]
  s_waitcnt lgkmcnt(0)
  v_cvt_pk_bf16_f32 v244, v188, v189
  v_cndmask_b32 v100, 0, v244, s[74:75]
  v_cvt_pk_bf16_f32 v244, v190, v191
  v_cndmask_b32 v101, 0, v244, s[74:75]
  v_cvt_pk_bf16_f32 v244, v192, v193
  v_cndmask_b32 v102, 0, v244, s[74:75]
  v_cvt_pk_bf16_f32 v244, v194, v195
  v_cndmask_b32 v103, 0, v244, s[74:75]
  v_cvt_pk_bf16_f32 v244, v196, v197
  v_cndmask_b32 v104, 0, v244, s[74:75]
  v_cvt_pk_bf16_f32 v244, v198, v199
  v_cndmask_b32 v105, 0, v244, s[74:75]
  v_cvt_pk_bf16_f32 v244, v200, v201
  v_cndmask_b32 v106, 0, v244, s[74:75]
  v_cvt_pk_bf16_f32 v244, v202, v203
  v_cndmask_b32 v107, 0, v244, s[74:75]
  v_cvt_pk_bf16_f32 v244, v204, v205
  v_cndmask_b32 v108, 0, v244, s[74:75]
  v_cvt_pk_bf16_f32 v244, v206, v207
  v_cndmask_b32 v109, 0, v244, s[74:75]
  v_cvt_pk_bf16_f32 v244, v208, v209
  v_cndmask_b32 v110, 0, v244, s[74:75]
  v_cvt_pk_bf16_f32 v244, v210, v211
  v_cndmask_b32 v111, 0, v244, s[74:75]
  s_lshl_b32 s44, s32, 1
  s_add_u32 s44, s44, 1
  s_add_u32 s45, s44, 144
  s_lshl_b32 s45, s45, 10
  s_lshr_b32 s72, s44, 3
  s_add_u32 s72, s72, 160
  s_lshl_b32 s72, s72, 10
  s_and_b32 s82, s44, 7
  s_lshr_b32 s83, s82, 1
  s_lshl_b32 s83, s83, 8
  s_and_b32 s82, s82, 1
  s_lshl_b32 s82, s82, 3
  s_add_u32 s83, s83, s82
  s_add_u32 s72, s72, s83
  v_mfma_f32_16x16x32_bf16 v[140:143], v[76:79], a[48:51], 0
  v_mfma_f32_16x16x32_bf16 v[140:143], v[80:83], a[52:55], v[140:143]
  v_mfma_f32_16x16x32_bf16 v[140:143], v[84:87], a[56:59], v[140:143]
  v_mfma_f32_16x16x32_bf16 v[144:147], v[88:91], a[48:51], 0
  v_mfma_f32_16x16x32_bf16 v[144:147], v[92:95], a[52:55], v[144:147]
  v_mfma_f32_16x16x32_bf16 v[144:147], v[96:99], a[56:59], v[144:147]
  v_mfma_f32_16x16x32_bf16 v[148:151], v[100:103], a[48:51], 0
  v_mfma_f32_16x16x32_bf16 v[148:151], v[104:107], a[52:55], v[148:151]
  v_mfma_f32_16x16x32_bf16 v[148:151], v[108:111], a[56:59], v[148:151]
  v_mfma_f32_16x16x32_bf16 v[172:175], v[76:79], a[60:63], 0
  v_mfma_f32_16x16x32_bf16 v[172:175], v[80:83], a[64:67], v[172:175]
  v_mfma_f32_16x16x32_bf16 v[172:175], v[84:87], a[68:71], v[172:175]
  v_mfma_f32_16x16x32_bf16 v[176:179], v[88:91], a[60:63], 0
  v_mfma_f32_16x16x32_bf16 v[176:179], v[92:95], a[64:67], v[176:179]
  v_mfma_f32_16x16x32_bf16 v[176:179], v[96:99], a[68:71], v[176:179]
  v_mfma_f32_16x16x32_bf16 v[180:183], v[100:103], a[60:63], 0
  v_mfma_f32_16x16x32_bf16 v[180:183], v[104:107], a[64:67], v[180:183]
  v_mfma_f32_16x16x32_bf16 v[180:183], v[108:111], a[68:71], v[180:183]
  s_nop 7
  v_add_f32 v244, 0x358637bd, v148
  v_add_f32 v245, 0x358637bd, v149
  v_add_f32 v248, 0x358637bd, v180
  v_add_f32 v249, 0x358637bd, v181
  v_rcp_f32 v244, v244
  v_rcp_f32 v245, v245
  v_rcp_f32 v248, v248
  v_rcp_f32 v249, v249
  s_nop 0
  v_mul_f32 v244, v244, v29
  v_mul_f32 v245, v245, v29
  v_mul_f32 v140, v140, v244
  v_mul_f32 v144, v144, v245
  v_mul_f32 v141, v141, v244
  v_mul_f32 v145, v145, v245
  v_mul_f32 v142, v142, v244
  v_mul_f32 v146, v146, v245
  v_mul_f32 v143, v143, v244
  v_mul_f32 v147, v147, v245
  v_cndmask_b32 v246, v244, v245, s[78:79]
  v_mul_f32 v150, v150, v246
  v_mul_f32 v151, v151, v246
  v_cvt_pk_bf16_f32 v152, v140, v141
  v_cvt_pk_bf16_f32 v153, v142, v143
  v_cvt_pk_bf16_f32 v154, v144, v145
  v_cvt_pk_bf16_f32 v155, v146, v147
  v_cvt_pk_bf16_f32 v148, v150, v151
  s_add_u32 s82, s88, s45
  buffer_store_dwordx4 v[152:155], v43, s[24:27], s82 offen sc1
  s_add_u32 s82, s88, s72
  s_mov_b64 s[80:81], exec
  s_mov_b64 exec, s[76:77]
  buffer_store_dword v148, v44, s[24:27], s82 offen sc1
  s_mov_b64 exec, s[80:81]
  v_mul_f32 v248, v248, v30
  v_mul_f32 v249, v249, v30
  v_mul_f32 v172, v172, v248
  v_mul_f32 v176, v176, v249
  v_mul_f32 v173, v173, v248
  v_mul_f32 v177, v177, v249
  v_mul_f32 v174, v174, v248
  v_mul_f32 v178, v178, v249
  v_mul_f32 v175, v175, v248
  v_mul_f32 v179, v179, v249
  v_cndmask_b32 v250, v248, v249, s[78:79]
  v_mul_f32 v182, v182, v250
  v_mul_f32 v183, v183, v250
  v_cvt_pk_bf16_f32 v184, v172, v173
  v_cvt_pk_bf16_f32 v185, v174, v175
  v_cvt_pk_bf16_f32 v186, v176, v177
  v_cvt_pk_bf16_f32 v187, v178, v179
  v_cvt_pk_bf16_f32 v180, v182, v183
  s_add_u32 s82, s89, s45
  buffer_store_dwordx4 v[184:187], v43, s[24:27], s82 offen sc1
  s_add_u32 s82, s89, s72
  s_mov_b64 s[80:81], exec
  s_mov_b64 exec, s[76:77]
  buffer_store_dword v180, v44, s[24:27], s82 offen sc1
  s_mov_b64 exec, s[80:81]
  s_nop 1
  v_mfma_f32_16x16x32_bf16 v[140:143], v[76:79], a[72:75], 0
  v_mfma_f32_16x16x32_bf16 v[140:143], v[80:83], a[76:79], v[140:143]
  v_mfma_f32_16x16x32_bf16 v[140:143], v[84:87], a[80:83], v[140:143]
  v_mfma_f32_16x16x32_bf16 v[144:147], v[88:91], a[72:75], 0
  v_mfma_f32_16x16x32_bf16 v[144:147], v[92:95], a[76:79], v[144:147]
  v_mfma_f32_16x16x32_bf16 v[144:147], v[96:99], a[80:83], v[144:147]
  v_mfma_f32_16x16x32_bf16 v[148:151], v[100:103], a[72:75], 0
  v_mfma_f32_16x16x32_bf16 v[148:151], v[104:107], a[76:79], v[148:151]
  v_mfma_f32_16x16x32_bf16 v[148:151], v[108:111], a[80:83], v[148:151]
  v_mfma_f32_16x16x32_bf16 v[172:175], v[76:79], a[84:87], 0
  v_mfma_f32_16x16x32_bf16 v[172:175], v[80:83], a[88:91], v[172:175]
  v_mfma_f32_16x16x32_bf16 v[172:175], v[84:87], a[92:95], v[172:175]
  v_mfma_f32_16x16x32_bf16 v[176:179], v[88:91], a[84:87], 0
  v_mfma_f32_16x16x32_bf16 v[176:179], v[92:95], a[88:91], v[176:179]
  v_mfma_f32_16x16x32_bf16 v[176:179], v[96:99], a[92:95], v[176:179]
  v_mfma_f32_16x16x32_bf16 v[180:183], v[100:103], a[84:87], 0
  v_mfma_f32_16x16x32_bf16 v[180:183], v[104:107], a[88:91], v[180:183]
  v_mfma_f32_16x16x32_bf16 v[180:183], v[108:111], a[92:95], v[180:183]
  s_nop 7
  v_add_f32 v244, 0x358637bd, v148
  v_add_f32 v245, 0x358637bd, v149
  v_add_f32 v248, 0x358637bd, v180
  v_add_f32 v249, 0x358637bd, v181
  v_rcp_f32 v244, v244
  v_rcp_f32 v245, v245
  v_rcp_f32 v248, v248
  v_rcp_f32 v249, v249
  s_nop 0
  v_mul_f32 v244, v244, v31
  v_mul_f32 v245, v245, v31
  v_mul_f32 v140, v140, v244
  v_mul_f32 v144, v144, v245
  v_mul_f32 v141, v141, v244
  v_mul_f32 v145, v145, v245
  v_mul_f32 v142, v142, v244
  v_mul_f32 v146, v146, v245
  v_mul_f32 v143, v143, v244
  v_mul_f32 v147, v147, v245
  v_cndmask_b32 v246, v244, v245, s[78:79]
  v_mul_f32 v150, v150, v246
  v_mul_f32 v151, v151, v246
  v_cvt_pk_bf16_f32 v152, v140, v141
  v_cvt_pk_bf16_f32 v153, v142, v143
  v_cvt_pk_bf16_f32 v154, v144, v145
  v_cvt_pk_bf16_f32 v155, v146, v147
  v_cvt_pk_bf16_f32 v148, v150, v151
  s_add_u32 s82, s90, s45
  buffer_store_dwordx4 v[152:155], v43, s[24:27], s82 offen sc1
  s_add_u32 s82, s90, s72
  s_mov_b64 s[80:81], exec
  s_mov_b64 exec, s[76:77]
  buffer_store_dword v148, v44, s[24:27], s82 offen sc1
  s_mov_b64 exec, s[80:81]
  v_mul_f32 v248, v248, v32
  v_mul_f32 v249, v249, v32
  v_mul_f32 v172, v172, v248
  v_mul_f32 v176, v176, v249
  v_mul_f32 v173, v173, v248
  v_mul_f32 v177, v177, v249
  v_mul_f32 v174, v174, v248
  v_mul_f32 v178, v178, v249
  v_mul_f32 v175, v175, v248
  v_mul_f32 v179, v179, v249
  v_cndmask_b32 v250, v248, v249, s[78:79]
  v_mul_f32 v182, v182, v250
  v_mul_f32 v183, v183, v250
  v_cvt_pk_bf16_f32 v184, v172, v173
  v_cvt_pk_bf16_f32 v185, v174, v175
  v_cvt_pk_bf16_f32 v186, v176, v177
  v_cvt_pk_bf16_f32 v187, v178, v179
  v_cvt_pk_bf16_f32 v180, v182, v183
  s_add_u32 s82, s91, s45
  buffer_store_dwordx4 v[184:187], v43, s[24:27], s82 offen sc1
  s_add_u32 s82, s91, s72
  s_mov_b64 s[80:81], exec
  s_mov_b64 exec, s[76:77]
  buffer_store_dword v180, v44, s[24:27], s82 offen sc1
  s_mov_b64 exec, s[80:81]
  s_nop 1
  s_waitcnt vmcnt(0)
  s_barrier
  s_cmp_eq_u32 s36, 0
  s_cbranch_scc0 L_at_nosig2
  s_add_u32 s44, s34, 96
  s_lshl_b32 s44, s44, 7
  s_add_u32 s44, s44, 21430272
  v_mov_b32 v244, s44
  v_mov_b32 v245, 1
  s_mov_b64 s[80:81], exec
  s_mov_b64 exec, 1
  global_atomic_add v244, v245, s[70:71]
  s_mov_b64 exec, s[80:81]
L_at_nosig2:
  s_lshl_b32 s30, s34, 2
  s_lshr_b32 s31, s32, 1
  s_add_u32 s30, s30, s31
  s_and_b32 s31, s32, 1
  s_add_u32 s31, s31, 6
  s_branch L_at_end
L_at_sm2:
  s_nop 6
  v_max3_f32 v244, v76, v77, v78
  v_max3_f32 v245, -v76, -v77, -v78
  v_max3_f32 v248, v172, v173, v174
  v_max3_f32 v249, -v172, -v173, -v174
  v_max3_f32 v244, v244, v79, v80
  v_max3_f32 v245, v245, -v79, -v80
  v_max3_f32 v248, v248, v175, v176
  v_max3_f32 v249, v249, -v175, -v176
  v_max3_f32 v244, v244, v81, v82
  v_max3_f32 v245, v245, -v81, -v82
  v_max3_f32 v248, v248, v177, v178
  v_max3_f32 v249, v249, -v177, -v178
  v_max3_f32 v244, v244, v83, v84
  v_max3_f32 v245, v245, -v83, -v84
  v_max3_f32 v248, v248, v179, v180
  v_max3_f32 v249, v249, -v179, -v180
  s_nop 0
  v_permlane16_swap_b32 v244, v245
  v_permlane16_swap_b32 v248, v249
  s_nop 0
  v_max_f32 v244, v244, v245
  v_max_f32 v248, v248, v249
  v_mov_b32 v245, v244
  v_mov_b32 v249, v248
  s_nop 0
  v_permlane16_swap_b32 v244, v245
  v_permlane16_swap_b32 v248, v249
  s_nop 0
  v_pk_mul_f32 v[244:245], v[244:245], s[58:59] neg_lo:[1,0] neg_hi:[1,0]
  v_pk_mul_f32 v[248:249], v[248:249], s[58:59] neg_lo:[1,0] neg_hi:[1,0]
  v_pk_fma_f32 v[108:109], v[76:77], s[58:59], v[244:245] op_sel:[0,0,0] op_sel_hi:[0,1,1] neg_hi:[1,0,0]
  v_pk_fma_f32 v[142:143], v[172:173], s[58:59], v[248:249] op_sel:[0,0,0] op_sel_hi:[0,1,1] neg_hi:[1,0,0]
  v_pk_fma_f32 v[110:111], v[76:77], s[58:59], v[244:245] op_sel:[1,0,0] op_sel_hi:[1,1,1] neg_hi:[1,0,0]
  v_pk_fma_f32 v[144:145], v[172:173], s[58:59], v[248:249] op_sel:[1,0,0] op_sel_hi:[1,1,1] neg_hi:[1,0,0]
  v_pk_fma_f32 v[112:113], v[78:79], s[58:59], v[244:245] op_sel:[0,0,0] op_sel_hi:[0,1,1] neg_hi:[1,0,0]
  v_pk_fma_f32 v[146:147], v[174:175], s[58:59], v[248:249] op_sel:[0,0,0] op_sel_hi:[0,1,1] neg_hi:[1,0,0]
  v_pk_fma_f32 v[114:115], v[78:79], s[58:59], v[244:245] op_sel:[1,0,0] op_sel_hi:[1,1,1] neg_hi:[1,0,0]
  v_pk_fma_f32 v[148:149], v[174:175], s[58:59], v[248:249] op_sel:[1,0,0] op_sel_hi:[1,1,1] neg_hi:[1,0,0]
  v_pk_fma_f32 v[116:117], v[80:81], s[58:59], v[244:245] op_sel:[0,0,0] op_sel_hi:[0,1,1] neg_hi:[1,0,0]
  v_pk_fma_f32 v[150:151], v[176:177], s[58:59], v[248:249] op_sel:[0,0,0] op_sel_hi:[0,1,1] neg_hi:[1,0,0]
  v_pk_fma_f32 v[118:119], v[80:81], s[58:59], v[244:245] op_sel:[1,0,0] op_sel_hi:[1,1,1] neg_hi:[1,0,0]
  v_pk_fma_f32 v[152:153], v[176:177], s[58:59], v[248:249] op_sel:[1,0,0] op_sel_hi:[1,1,1] neg_hi:[1,0,0]
  v_pk_fma_f32 v[120:121], v[82:83], s[58:59], v[244:245] op_sel:[0,0,0] op_sel_hi:[0,1,1] neg_hi:[1,0,0]
  v_pk_fma_f32 v[154:155], v[178:179], s[58:59], v[248:249] op_sel:[0,0,0] op_sel_hi:[0,1,1] neg_hi:[1,0,0]
  v_pk_fma_f32 v[122:123], v[82:83], s[58:59], v[244:245] op_sel:[1,0,0] op_sel_hi:[1,1,1] neg_hi:[1,0,0]
  v_pk_fma_f32 v[184:185], v[178:179], s[58:59], v[248:249] op_sel:[1,0,0] op_sel_hi:[1,1,1] neg_hi:[1,0,0]
  v_pk_fma_f32 v[88:89], v[84:85], s[58:59], v[244:245] op_sel:[0,0,0] op_sel_hi:[0,1,1] neg_hi:[1,0,0]
  v_pk_fma_f32 v[186:187], v[180:181], s[58:59], v[248:249] op_sel:[0,0,0] op_sel_hi:[0,1,1] neg_hi:[1,0,0]
  v_exp_f32 v108, v108
  v_exp_f32 v109, v109
  v_exp_f32 v142, v142
  v_exp_f32 v143, v143
  v_exp_f32 v110, v110
  v_exp_f32 v111, v111
  v_exp_f32 v144, v144
  v_exp_f32 v145, v145
  v_exp_f32 v112, v112
  v_exp_f32 v113, v113
  v_exp_f32 v146, v146
  v_exp_f32 v147, v147
  v_exp_f32 v114, v114
  v_exp_f32 v115, v115
  v_exp_f32 v148, v148
  v_exp_f32 v149, v149
  v_exp_f32 v116, v116
  v_exp_f32 v117, v117
  v_exp_f32 v150, v150
  v_exp_f32 v151, v151
  v_exp_f32 v118, v118
  v_exp_f32 v119, v119
  v_exp_f32 v152, v152
  v_exp_f32 v153, v153
  v_exp_f32 v120, v120
  v_exp_f32 v121, v121
  v_exp_f32 v154, v154
  v_exp_f32 v155, v155
  v_exp_f32 v122, v122
  v_exp_f32 v123, v123
  v_exp_f32 v184, v184
  v_exp_f32 v185, v185
  v_exp_f32 v88, v88
  v_exp_f32 v89, v89
  v_exp_f32 v186, v186
  v_exp_f32 v187, v187
  v_pk_add_f32 v[246:247], v[108:109], v[110:111]
  v_pk_add_f32 v[250:251], v[142:143], v[144:145]
  v_pk_add_f32 v[246:247], v[246:247], v[112:113]
  v_pk_add_f32 v[250:251], v[250:251], v[146:147]
  v_pk_add_f32 v[246:247], v[246:247], v[114:115]
  v_pk_add_f32 v[250:251], v[250:251], v[148:149]
  v_pk_add_f32 v[246:247], v[246:247], v[116:117]
  v_pk_add_f32 v[250:251], v[250:251], v[150:151]
  v_pk_add_f32 v[246:247], v[246:247], v[118:119]
  v_pk_add_f32 v[250:251], v[250:251], v[152:153]
  v_pk_add_f32 v[246:247], v[246:247], v[120:121]
  v_pk_add_f32 v[250:251], v[250:251], v[154:155]
  v_pk_add_f32 v[246:247], v[246:247], v[122:123]
  v_pk_add_f32 v[250:251], v[250:251], v[184:185]
  v_pk_add_f32 v[246:247], v[246:247], v[88:89]
  v_pk_add_f32 v[250:251], v[250:251], v[186:187]
  s_nop 0
  v_permlane16_swap_b32 v246, v247
  v_permlane16_swap_b32 v250, v251
  s_nop 0
  v_add_f32 v246, v246, v247
  v_add_f32 v250, v250, v251
  v_mov_b32 v247, v246
  v_mov_b32 v251, v250
  s_nop 0
  v_permlane16_swap_b32 v246, v247
  v_permlane16_swap_b32 v250, v251
  s_nop 0
  v_rcp_f32 v246, v246
  v_rcp_f32 v247, v247
  v_rcp_f32 v250, v250
  v_rcp_f32 v251, v251
  s_nop 0
  v_pk_mul_f32 v[108:109], v[108:109], v[246:247]
  v_pk_mul_f32 v[142:143], v[142:143], v[250:251]
  v_pk_mul_f32 v[110:111], v[110:111], v[246:247]
  v_pk_mul_f32 v[144:145], v[144:145], v[250:251]
  v_pk_mul_f32 v[112:113], v[112:113], v[246:247]
  v_pk_mul_f32 v[146:147], v[146:147], v[250:251]
  v_pk_mul_f32 v[114:115], v[114:115], v[246:247]
  v_pk_mul_f32 v[148:149], v[148:149], v[250:251]
  v_pk_mul_f32 v[116:117], v[116:117], v[246:247]
  v_pk_mul_f32 v[150:151], v[150:151], v[250:251]
  v_pk_mul_f32 v[118:119], v[118:119], v[246:247]
  v_pk_mul_f32 v[152:153], v[152:153], v[250:251]
  v_pk_mul_f32 v[120:121], v[120:121], v[246:247]
  v_pk_mul_f32 v[154:155], v[154:155], v[250:251]
  v_pk_mul_f32 v[122:123], v[122:123], v[246:247]
  v_pk_mul_f32 v[184:185], v[184:185], v[250:251]
  v_pk_mul_f32 v[88:89], v[88:89], v[246:247]
  v_pk_mul_f32 v[186:187], v[186:187], v[250:251]
  v_cvt_pk_bf16_f32 v76, v108, v109
  v_cvt_pk_bf16_f32 v172, v142, v143
  v_cvt_pk_bf16_f32 v77, v110, v111
  v_cvt_pk_bf16_f32 v173, v144, v145
  v_cvt_pk_bf16_f32 v78, v112, v113
  v_cvt_pk_bf16_f32 v174, v146, v147
  v_cvt_pk_bf16_f32 v79, v114, v115
  v_cvt_pk_bf16_f32 v175, v148, v149
  v_cvt_pk_bf16_f32 v80, v116, v117
  v_cvt_pk_bf16_f32 v176, v150, v151
  v_cvt_pk_bf16_f32 v81, v118, v119
  v_cvt_pk_bf16_f32 v177, v152, v153
  v_cvt_pk_bf16_f32 v82, v120, v121
  v_cvt_pk_bf16_f32 v178, v154, v155
  v_cvt_pk_bf16_f32 v83, v122, v123
  v_cvt_pk_bf16_f32 v179, v184, v185
  v_cvt_pk_bf16_f32 v84, v88, v89
  v_cvt_pk_bf16_f32 v180, v186, v187
  v_mov_b32 v85, 0
  v_mov_b32 v181, 0
  s_setpc_b64 s[84:85]
L_at_end:
L_reduce:
  s_load_dwordx4 s[52:55], s[0:1], 80
  s_load_dwordx2 s[50:51], s[0:1], 72
  v_lshrrev_b32 v2, 6, v0
  v_and_b32 v3, 63, v0
  v_readfirstlane_b32 s28, v2
  s_waitcnt lgkmcnt(0)
  s_mov_b32 s58, s54
  s_mov_b32 s59, s55
  s_and_b32 s21, s28, 1
  s_lshr_b32 s22, s28, 1
  s_lshl_b32 s20, s31, 1
  s_add_u32 s22, s22, s20
  s_lshl_b32 s20, s30, 4
  s_add_u32 s22, s22, s20
  s_add_u32 s8, s54, 21495808
  s_addc_u32 s9, s55, 0
  s_and_b32 s9, s9, 0xffff
  s_mov_b32 s10, 14155776
  s_mov_b32 s11, 0x00020000
  s_mov_b32 s12, s50
  s_and_b32 s13, s51, 0xffff
  s_mov_b32 s14, 2359296
  s_mov_b32 s15, 0x00020000
  s_mul_i32 s23, s22, 4608
  s_lshl_b32 s24, s21, 11
  s_add_u32 s23, s23, s24
  v_lshlrev_b32 v4, 4, v3
  v_lshlrev_b32 v5, 3, v3
  s_add_u32 s25, s23, 2048
  s_mov_b32 s36, s8
  s_mov_b32 s37, s9
  s_cmp_eq_u32 s21, 1
  s_cselect_b32 s38, 14155776, 0
  s_mov_b32 s39, 0x00020000
  s_cmp_eq_u32 s28, 0
  s_cbranch_scc0 L_polld_p
  s_add_u32 s40, s30, 104
  s_lshl_b32 s40, s40, 7
  s_add_u32 s40, s40, 21430272
  v_mov_b32 v6, s40
L_poll_p:
  global_load_dword v7, v6, s[58:59] sc1
  s_waitcnt vmcnt(0)
  v_readfirstlane_b32 s40, v7
  s_cmp_ge_u32 s40, 6
  s_cbranch_scc1 L_polld_p
  s_sleep 4
  s_branch L_poll_p
L_polld_p:
  s_barrier
  s_add_u32 s26, s23, 0
  buffer_load_dwordx4 v[16:19], v4, s[8:11], s26 offen sc1
  buffer_load_dwordx4 v[20:23], v4, s[8:11], s26 offen offset:1024 sc1
  s_add_u32 s27, s25, 0
  buffer_load_dwordx2 v[24:25], v5, s[36:39], s27 offen sc1
  s_add_u32 s26, s23, 2359296
  buffer_load_dwordx4 v[26:29], v4, s[8:11], s26 offen sc1
  buffer_load_dwordx4 v[30:33], v4, s[8:11], s26 offen offset:1024 sc1
  s_add_u32 s27, s25, 2359296
  buffer_load_dwordx2 v[34:35], v5, s[36:39], s27 offen sc1
  s_add_u32 s26, s23, 4718592
  buffer_load_dwordx4 v[36:39], v4, s[8:11], s26 offen sc1
  buffer_load_dwordx4 v[40:43], v4, s[8:11], s26 offen offset:1024 sc1
  s_add_u32 s27, s25, 4718592
  buffer_load_dwordx2 v[44:45], v5, s[36:39], s27 offen sc1
  s_add_u32 s26, s23, 7077888
  buffer_load_dwordx4 v[46:49], v4, s[8:11], s26 offen sc1
  buffer_load_dwordx4 v[50:53], v4, s[8:11], s26 offen offset:1024 sc1
  s_add_u32 s27, s25, 7077888
  buffer_load_dwordx2 v[54:55], v5, s[36:39], s27 offen sc1
  s_add_u32 s26, s23, 9437184
  buffer_load_dwordx4 v[56:59], v4, s[8:11], s26 offen sc1
  buffer_load_dwordx4 v[60:63], v4, s[8:11], s26 offen offset:1024 sc1
  s_add_u32 s27, s25, 9437184
  buffer_load_dwordx2 v[64:65], v5, s[36:39], s27 offen sc1
  s_add_u32 s26, s23, 11796480
  buffer_load_dwordx4 v[66:69], v4, s[8:11], s26 offen sc1
  buffer_load_dwordx4 v[70:73], v4, s[8:11], s26 offen offset:1024 sc1
  s_add_u32 s27, s25, 11796480
  buffer_load_dwordx2 v[74:75], v5, s[36:39], s27 offen sc1
  s_lshr_b32 s29, s22, 4
  s_lshr_b32 s34, s29, 2
  s_and_b32 s35, s29, 3
  s_and_b32 s32, s22, 15
  s_lshl_b32 s33, s34, 4
  s_add_u32 s33, s33, s32
  s_mul_i32 s33, s33, 18432
  s_mul_i32 s34, s35, 288
  s_add_u32 s33, s33, s34
  s_lshl_b32 s34, s21, 7
  s_add_u32 s33, s33, s34
  v_and_b32 v6, 15, v3
  v_mul_u32_u24 v6, 1152, v6
  v_lshrrev_b32 v7, 4, v3
  v_lshl_add_u32 v6, v7, 3, v6
  s_mov_b32 s35, 0xffff0000
  s_waitcnt vmcnt(15)
  v_lshlrev_b32 v100, 16, v16
  v_and_b32 v101, s35, v16
  v_lshlrev_b32 v102, 16, v17
  v_and_b32 v103, s35, v17
  v_lshlrev_b32 v104, 16, v18
  v_and_b32 v105, s35, v18
  v_lshlrev_b32 v106, 16, v19
  v_and_b32 v107, s35, v19
  v_lshlrev_b32 v108, 16, v20
  v_and_b32 v109, s35, v20
  v_lshlrev_b32 v110, 16, v21
  v_and_b32 v111, s35, v21
  v_lshlrev_b32 v112, 16, v22
  v_and_b32 v113, s35, v22
  v_lshlrev_b32 v114, 16, v23
  v_and_b32 v115, s35, v23
  v_lshlrev_b32 v116, 16, v24
  v_and_b32 v117, s35, v24
  v_lshlrev_b32 v118, 16, v25
  v_and_b32 v119, s35, v25
  s_waitcnt vmcnt(12)
  v_lshlrev_b32 v8, 16, v26
  v_and_b32 v9, s35, v26
  v_pk_add_f32 v[100:101], v[100:101], v[8:9]
  v_lshlrev_b32 v8, 16, v27
  v_and_b32 v9, s35, v27
  v_pk_add_f32 v[102:103], v[102:103], v[8:9]
  v_lshlrev_b32 v8, 16, v28
  v_and_b32 v9, s35, v28
  v_pk_add_f32 v[104:105], v[104:105], v[8:9]
  v_lshlrev_b32 v8, 16, v29
  v_and_b32 v9, s35, v29
  v_pk_add_f32 v[106:107], v[106:107], v[8:9]
  v_lshlrev_b32 v8, 16, v30
  v_and_b32 v9, s35, v30
  v_pk_add_f32 v[108:109], v[108:109], v[8:9]
  v_lshlrev_b32 v8, 16, v31
  v_and_b32 v9, s35, v31
  v_pk_add_f32 v[110:111], v[110:111], v[8:9]
  v_lshlrev_b32 v8, 16, v32
  v_and_b32 v9, s35, v32
  v_pk_add_f32 v[112:113], v[112:113], v[8:9]
  v_lshlrev_b32 v8, 16, v33
  v_and_b32 v9, s35, v33
  v_pk_add_f32 v[114:115], v[114:115], v[8:9]
  v_lshlrev_b32 v8, 16, v34
  v_and_b32 v9, s35, v34
  v_pk_add_f32 v[116:117], v[116:117], v[8:9]
  v_lshlrev_b32 v8, 16, v35
  v_and_b32 v9, s35, v35
  v_pk_add_f32 v[118:119], v[118:119], v[8:9]
  s_waitcnt vmcnt(9)
  v_lshlrev_b32 v8, 16, v36
  v_and_b32 v9, s35, v36
  v_pk_add_f32 v[100:101], v[100:101], v[8:9]
  v_lshlrev_b32 v8, 16, v37
  v_and_b32 v9, s35, v37
  v_pk_add_f32 v[102:103], v[102:103], v[8:9]
  v_lshlrev_b32 v8, 16, v38
  v_and_b32 v9, s35, v38
  v_pk_add_f32 v[104:105], v[104:105], v[8:9]
  v_lshlrev_b32 v8, 16, v39
  v_and_b32 v9, s35, v39
  v_pk_add_f32 v[106:107], v[106:107], v[8:9]
  v_lshlrev_b32 v8, 16, v40
  v_and_b32 v9, s35, v40
  v_pk_add_f32 v[108:109], v[108:109], v[8:9]
  v_lshlrev_b32 v8, 16, v41
  v_and_b32 v9, s35, v41
  v_pk_add_f32 v[110:111], v[110:111], v[8:9]
  v_lshlrev_b32 v8, 16, v42
  v_and_b32 v9, s35, v42
  v_pk_add_f32 v[112:113], v[112:113], v[8:9]
  v_lshlrev_b32 v8, 16, v43
  v_and_b32 v9, s35, v43
  v_pk_add_f32 v[114:115], v[114:115], v[8:9]
  v_lshlrev_b32 v8, 16, v44
  v_and_b32 v9, s35, v44
  v_pk_add_f32 v[116:117], v[116:117], v[8:9]
  v_lshlrev_b32 v8, 16, v45
  v_and_b32 v9, s35, v45
  v_pk_add_f32 v[118:119], v[118:119], v[8:9]
  s_waitcnt vmcnt(6)
  v_lshlrev_b32 v8, 16, v46
  v_and_b32 v9, s35, v46
  v_pk_add_f32 v[100:101], v[100:101], v[8:9]
  v_lshlrev_b32 v8, 16, v47
  v_and_b32 v9, s35, v47
  v_pk_add_f32 v[102:103], v[102:103], v[8:9]
  v_lshlrev_b32 v8, 16, v48
  v_and_b32 v9, s35, v48
  v_pk_add_f32 v[104:105], v[104:105], v[8:9]
  v_lshlrev_b32 v8, 16, v49
  v_and_b32 v9, s35, v49
  v_pk_add_f32 v[106:107], v[106:107], v[8:9]
  v_lshlrev_b32 v8, 16, v50
  v_and_b32 v9, s35, v50
  v_pk_add_f32 v[108:109], v[108:109], v[8:9]
  v_lshlrev_b32 v8, 16, v51
  v_and_b32 v9, s35, v51
  v_pk_add_f32 v[110:111], v[110:111], v[8:9]
  v_lshlrev_b32 v8, 16, v52
  v_and_b32 v9, s35, v52
  v_pk_add_f32 v[112:113], v[112:113], v[8:9]
  v_lshlrev_b32 v8, 16, v53
  v_and_b32 v9, s35, v53
  v_pk_add_f32 v[114:115], v[114:115], v[8:9]
  v_lshlrev_b32 v8, 16, v54
  v_and_b32 v9, s35, v54
  v_pk_add_f32 v[116:117], v[116:117], v[8:9]
  v_lshlrev_b32 v8, 16, v55
  v_and_b32 v9, s35, v55
  v_pk_add_f32 v[118:119], v[118:119], v[8:9]
  s_waitcnt vmcnt(3)
  v_lshlrev_b32 v8, 16, v56
  v_and_b32 v9, s35, v56
  v_pk_add_f32 v[100:101], v[100:101], v[8:9]
  v_lshlrev_b32 v8, 16, v57
  v_and_b32 v9, s35, v57
  v_pk_add_f32 v[102:103], v[102:103], v[8:9]
  v_lshlrev_b32 v8, 16, v58
  v_and_b32 v9, s35, v58
  v_pk_add_f32 v[104:105], v[104:105], v[8:9]
  v_lshlrev_b32 v8, 16, v59
  v_and_b32 v9, s35, v59
  v_pk_add_f32 v[106:107], v[106:107], v[8:9]
  v_lshlrev_b32 v8, 16, v60
  v_and_b32 v9, s35, v60
  v_pk_add_f32 v[108:109], v[108:109], v[8:9]
  v_lshlrev_b32 v8, 16, v61
  v_and_b32 v9, s35, v61
  v_pk_add_f32 v[110:111], v[110:111], v[8:9]
  v_lshlrev_b32 v8, 16, v62
  v_and_b32 v9, s35, v62
  v_pk_add_f32 v[112:113], v[112:113], v[8:9]
  v_lshlrev_b32 v8, 16, v63
  v_and_b32 v9, s35, v63
  v_pk_add_f32 v[114:115], v[114:115], v[8:9]
  v_lshlrev_b32 v8, 16, v64
  v_and_b32 v9, s35, v64
  v_pk_add_f32 v[116:117], v[116:117], v[8:9]
  v_lshlrev_b32 v8, 16, v65
  v_and_b32 v9, s35, v65
  v_pk_add_f32 v[118:119], v[118:119], v[8:9]
  s_waitcnt vmcnt(0)
  v_lshlrev_b32 v8, 16, v66
  v_and_b32 v9, s35, v66
  v_pk_add_f32 v[100:101], v[100:101], v[8:9]
  v_lshlrev_b32 v8, 16, v67
  v_and_b32 v9, s35, v67
  v_pk_add_f32 v[102:103], v[102:103], v[8:9]
  v_lshlrev_b32 v8, 16, v68
  v_and_b32 v9, s35, v68
  v_pk_add_f32 v[104:105], v[104:105], v[8:9]
  v_lshlrev_b32 v8, 16, v69
  v_and_b32 v9, s35, v69
  v_pk_add_f32 v[106:107], v[106:107], v[8:9]
  v_lshlrev_b32 v8, 16, v70
  v_and_b32 v9, s35, v70
  v_pk_add_f32 v[108:109], v[108:109], v[8:9]
  v_lshlrev_b32 v8, 16, v71
  v_and_b32 v9, s35, v71
  v_pk_add_f32 v[110:111], v[110:111], v[8:9]
  v_lshlrev_b32 v8, 16, v72
  v_and_b32 v9, s35, v72
  v_pk_add_f32 v[112:113], v[112:113], v[8:9]
  v_lshlrev_b32 v8, 16, v73
  v_and_b32 v9, s35, v73
  v_pk_add_f32 v[114:115], v[114:115], v[8:9]
  v_lshlrev_b32 v8, 16, v74
  v_and_b32 v9, s35, v74
  v_pk_add_f32 v[116:117], v[116:117], v[8:9]
  v_lshlrev_b32 v8, 16, v75
  v_and_b32 v9, s35, v75
  v_pk_add_f32 v[118:119], v[118:119], v[8:9]
  v_cvt_pk_bf16_f32 v16, v100, v101
  v_cvt_pk_bf16_f32 v17, v102, v103
  v_cvt_pk_bf16_f32 v18, v104, v105
  v_cvt_pk_bf16_f32 v19, v106, v107
  v_cvt_pk_bf16_f32 v20, v108, v109
  v_cvt_pk_bf16_f32 v21, v110, v111
  v_cvt_pk_bf16_f32 v22, v112, v113
  v_cvt_pk_bf16_f32 v23, v114, v115
  v_cvt_pk_bf16_f32 v24, v116, v117
  v_cvt_pk_bf16_f32 v25, v118, v119
  buffer_store_dwordx2 v[16:17], v6, s[12:15], s33 offen offset:0
  buffer_store_dwordx2 v[18:19], v6, s[12:15], s33 offen offset:32
  buffer_store_dwordx2 v[20:21], v6, s[12:15], s33 offen offset:64
  buffer_store_dwordx2 v[22:23], v6, s[12:15], s33 offen offset:96
  s_cmp_eq_u32 s21, 1
  s_cbranch_scc0 L_rd_done
  buffer_store_dwordx2 v[24:25], v6, s[12:15], s33 offen offset:128
L_rd_done:
L_exit:
  s_endpgm
L_code_end:
L_at_table:
  .short 0, 2, 4, 6, 32, 34, 36, 38, 64, 8, 10, 12, 14, 40, 42, 44
  .short 46, 72, 96, 98, 100, 102, 128, 130, 132, 134, 160, 104, 106, 108, 110, 136
  .short 138, 140, 142, 168, 192, 194, 196, 198, 224, 226, 228, 230, 256, 200, 202, 204
  .short 206, 232, 234, 236, 238, 264, 288, 290, 292, 294, 320, 322, 324, 326, 352, 296
  .short 298, 300, 302, 328, 330, 332, 334, 360, 384, 386, 388, 390, 416, 418, 420, 422
  .short 448, 392, 394, 396, 398, 424, 426, 428, 430, 456, 480, 482, 484, 486, 512, 514
  .short 516, 518, 544, 488, 490, 492, 494, 520, 522, 524, 526, 552, 576, 578, 580, 582
  .short 608, 610, 612, 614, 640, 584, 586, 588, 590, 616, 618, 620, 622, 648, 672, 674
  .short 676, 678, 704, 706, 708, 710, 736, 680, 682, 684, 686, 712, 714, 716, 718, 744
  .short 768, 770, 772, 774, 800, 802, 804, 806, 832, 776, 778, 780, 782, 808, 810, 812
  .short 814, 840, 864, 866, 868, 870, 896, 898, 900, 902, 928, 872, 874, 876, 878, 904
  .short 906, 908, 910, 936, 960, 962, 964, 966, 992, 994, 996, 998, 1024, 968, 970, 972
  .short 974, 1000, 1002, 1004, 1006, 1032, 1056, 1058, 1060, 1062, 1088, 1090, 1092, 1094, 1120, 1064
  .short 1066, 1068, 1070, 1096, 1098, 1100, 1102, 1128, 1152, 1154, 1156, 1158, 1184, 1186, 1188, 1190
  .short 1216, 1160, 1162, 1164, 1166, 1192, 1194, 1196, 1198, 1224, 1248, 1250, 1252, 1254, 1280, 1282
  .short 1284, 1286, 1312, 1256, 1258, 1260, 1262, 1288, 1290, 1292, 1294, 1320, 1344, 1346, 1348, 1350
  .short 1376, 1378, 1380, 1382, 1408, 1352, 1354, 1356, 1358, 1384, 1386, 1388, 1390, 1416, 1440, 1442
  .short 1444, 1446, 1472, 1474, 1476, 1478, 1504, 1448, 1450, 1452, 1454, 1480, 1482, 1484, 1486, 1512
  .short 1536, 1538, 1540, 1542, 1568, 1570, 1572, 1574, 1600, 1544, 1546, 1548, 1550, 1576, 1578, 1580
  .short 1582, 1608, 1632, 1634, 1636, 1638, 1664, 1666, 1668, 1670, 1696, 1640, 1642, 1644, 1646, 1672
  .short 1674, 1676, 1678, 1704, 1744, 1746, 1748, 1750, 1776, 1778, 1780, 1782, 1808, 1752, 1754, 1756
  .short 1758, 1784, 1786, 1788, 1790, 1816, 1840, 1842, 1844, 1846, 1872, 1874, 1876, 1878, 1904, 1848
  .short 1850, 1852, 1854, 1880, 1882, 1884, 1886, 1912, 1936, 1938, 1940, 1942, 1968, 1970, 1972, 1974
  .short 2000, 1944, 1946, 1948, 1950, 1976, 1978, 1980, 1982, 2008, 2032, 2034, 2036, 2038, 2064, 2066
  .short 2068, 2070, 2096, 2040, 2042, 2044, 2046, 2072, 2074, 2076, 2078, 2104, 2128, 2130, 2132, 2134
  .short 2160, 2162, 2164, 2166, 2192, 2136, 2138, 2140, 2142, 2168, 2170, 2172, 2174, 2200, 2224, 2226
  .short 2228, 2230, 2256, 2258, 2260, 2262, 2288, 2232, 2234, 2236, 2238, 2264, 2266, 2268, 2270, 2296
  .short 2320, 2322, 2324, 2326, 2352, 2354, 2356, 2358, 2384, 2328, 2330, 2332, 2334, 2360, 2362, 2364
  .short 2366, 2392, 2416, 2418, 2420, 2422, 2448, 2450, 2452, 2454, 2480, 2424, 2426, 2428, 2430, 2456
  .short 2458, 2460, 2462, 2488, 2512, 2514, 2516, 2518, 2544, 2546, 2548, 2550, 2576, 2520, 2522, 2524
  .short 2526, 2552, 2554, 2556, 2558, 2584, 2608, 2610, 2612, 2614, 2640, 2642, 2644, 2646, 2672, 2616
  .short 2618, 2620, 2622, 2648, 2650, 2652, 2654, 2680, 2704, 2706, 2708, 2710, 2736, 2738, 2740, 2742
  .short 2768, 2712, 2714, 2716, 2718, 2744, 2746, 2748, 2750, 2776, 2800, 2802, 2804, 2806, 2832, 2834
  .short 2836, 2838, 2864, 2808, 2810, 2812, 2814, 2840, 2842, 2844, 2846, 2872, 2896, 2898, 2900, 2902
  .short 2928, 2930, 2932, 2934, 2960, 2904, 2906, 2908, 2910, 2936, 2938, 2940, 2942, 2968, 2992, 2994
  .short 2996, 2998, 3024, 3026, 3028, 3030, 3056, 3000, 3002, 3004, 3006, 3032, 3034, 3036, 3038, 3064
  .short 3088, 3090, 3092, 3094, 3120, 3122, 3124, 3126, 3152, 3096, 3098, 3100, 3102, 3128, 3130, 3132
  .short 3134, 3160, 3184, 3186, 3188, 3190, 3216, 3218, 3220, 3222, 3248, 3192, 3194, 3196, 3198, 3224
  .short 3226, 3228, 3230, 3256, 3280, 3282, 3284, 3286, 3312, 3314, 3316, 3318, 3344, 3288, 3290, 3292
  .short 3294, 3320, 3322, 3324, 3326, 3352, 3376, 3378, 3380, 3382, 3408, 3410, 3412, 3414, 3440, 3384
  .short 3386, 3388, 3390, 3416, 3418, 3420, 3422, 3448, 4600, 4600, 4600, 4600, 4600, 4600, 4600, 4600
  .short 4600, 4600, 4600, 4600, 4600, 4600, 4600, 4600, 4600, 4600, 4600, 4600, 4600, 4600, 4600, 4600
  .short 4600, 4600, 4600, 4600, 4600, 4600, 4600, 4600, 4600, 4600, 4600, 4600, 4600, 4600, 4600, 4600
  .short 4600, 4600, 4600, 4600, 4600, 4600, 4600, 4600, 4600, 4600, 4600, 4600, 4600, 4600, 4600, 4600
  .short 4600, 4600, 4600, 4600, 4600, 4600, 4600, 4600, 4600, 4600, 4600, 4600, 4600, 4600, 4600, 4600
  .short 4600, 4600, 4600, 4600, 4600, 4600, 4600, 4600, 4600, 4600, 4600, 4600, 4600, 4600, 4600, 4600
  .short 4600, 4600, 4600, 4600, 4600, 4600, 4600, 4600, 4600, 4600, 4600, 4600, 4600, 4600, 4600, 4600
  .short 4600, 4600, 4600, 4600, 4600, 4600, 4600, 4600, 4600, 4600, 4600, 4600, 4600, 4600, 4600, 4600
.p2align 2
L_dn_table:
  .long 0, 1, 2, 3, 4, 5, 6, 7, 8, 9, 10, 11, 12, 13, 14, 15, 18, 19, 20, 21, 22, 23, 24, 25, 26, 27, 28, 29, 30, 31, 32, 33, 36, 37, 38, 39, 40, 41, 42, 43, 44, 45, 46, 47, 48, 49, 50, 51, 54, 55, 56, 57, 58, 59, 60, 61, 62, 63, 64, 65, 66, 67, 68, 69, 72, 73, 74, 75, 76, 77, 78, 79, 80, 81, 82, 83, 84, 85, 86, 87, 90, 91, 92, 93, 94, 95, 96, 97, 98, 99, 100, 101, 102, 103, 104, 105
  .long 108, 109, 110, 111, 112, 113, 114, 115, 116, 117, 118, 119, 120, 121, 122, 123, 126, 127, 128, 129, 130, 131, 132, 133, 134, 135, 136, 137, 138, 139, 140, 141, 144, 145, 146, 147, 148, 149, 150, 151, 152, 153, 154, 155, 156, 157, 158, 159, 162, 163, 164, 165, 166, 167, 168, 169, 170, 171, 172, 173, 174, 175, 176, 177, 180, 181, 182, 183, 184, 185, 186, 187, 188, 189, 190, 191, 192, 193, 194, 195, 198, 199, 200, 201, 202, 203, 204, 205, 206, 207, 208, 209, 210, 211, 212, 213
  .long 216, 217, 218, 219, 220, 221, 222, 223, 224, 225, 226, 227, 228, 229, 230, 231, 234, 235, 236, 237, 238, 239, 240, 241, 242, 243, 244, 245, 246, 247, 248, 249, 252, 253, 254, 255, 256, 257, 258, 259, 260, 261, 262, 263, 264, 265, 266, 267, 270, 271, 272, 273, 274, 275, 276, 277, 278, 279, 280, 281, 282, 283, 284, 285, 288, 289, 290, 291, 292, 293, 294, 295, 296, 297, 298, 299, 300, 301, 302, 303, 306, 307, 308, 309, 310, 311, 312, 313, 314, 315, 316, 317, 318, 319, 320, 321
  .long 324, 325, 326, 327, 328, 329, 330, 331, 332, 333, 334, 335, 336, 337, 338, 339, 342, 343, 344, 345, 346, 347, 348, 349, 350, 351, 352, 353, 354, 355, 356, 357, 360, 361, 362, 363, 364, 365, 366, 367, 368, 369, 370, 371, 372, 373, 374, 375, 378, 379, 380, 381, 382, 383, 384, 385, 386, 387, 388, 389, 390, 391, 392, 393, 396, 397, 398, 399, 400, 401, 402, 403, 404, 405, 406, 407, 408, 409, 410, 411, 414, 415, 416, 417, 418, 419, 420, 421, 422, 423, 424, 425, 426, 427, 428, 429
  .long 432, 433, 434, 435, 436, 437, 438, 439, 440, 441, 442, 443, 444, 445, 446, 447, 450, 451, 452, 453, 454, 455, 456, 457, 458, 459, 460, 461, 462, 463, 464, 465, 468, 469, 470, 471, 472, 473, 474, 475, 476, 477, 478, 479, 480, 481, 482, 483, 486, 487, 488, 489, 490, 491, 492, 493, 494, 495, 496, 497, 498, 499, 500, 501, 504, 505, 506, 507, 508, 509, 510, 511, 512, 513, 514, 515, 516, 517, 518, 519, 522, 523, 524, 525, 526, 527, 528, 529, 530, 531, 532, 533, 534, 535, 536, 537
  .long 540, 541, 542, 543, 544, 545, 546, 547, 548, 549, 550, 551, 552, 553, 554, 555, 558, 559, 560, 561, 562, 563, 564, 565, 566, 567, 568, 569, 570, 571, 572, 573, 16, 17, 34, 35, 88, 89, 106, 107, 160, 161, 178, 179, 232, 233, 250, 251, 52, 53, 70, 71, 124, 125, 142, 143, 196, 197, 214, 215, 268, 269, 286, 287, 304, 305, 322, 323, 376, 377, 394, 395, 448, 449, 466, 467, 520, 521, 538, 539, 340, 341, 358, 359, 412, 413, 430, 431, 484, 485, 502, 503, 556, 557, 574, 575
L_all_end:
.section .rodata,"a"
.p2align 6
.amdhsa_kernel gated_mix__linear_kernel_hedgehog__geglu_ffn__prompt_kernel
  .amdhsa_next_free_vgpr 512
  .amdhsa_next_free_sgpr 102
  .amdhsa_accum_offset 256
  .amdhsa_group_segment_fixed_size 0
  .amdhsa_kernarg_size 96
  .amdhsa_user_sgpr_count 2
  .amdhsa_user_sgpr_kernarg_segment_ptr 1
  .amdhsa_system_sgpr_workgroup_id_x 1
  .amdhsa_float_denorm_mode_32 3
.end_amdhsa_kernel
```
